```python
import torch

def _softmax(x, axis=-1):
    return torch.softmax(x, dim=axis)
def _gelu(x):
    return torch.nn.functional.gelu(x, approximate="tanh")
def _silu(x):
    return torch.nn.functional.silu(x)
def _sigmoid(x):
    return torch.sigmoid(x)
def _layernorm(x, axis=-1, eps=1e-5):
    m = x.mean(dim=axis, keepdim=True)
    v = x.var(dim=axis, keepdim=True, unbiased=False)
    return (x - m) / torch.sqrt(v + eps)
def _scatter_add(tgt, idx, src, axis=0):
    return tgt.clone().index_add_(axis, idx, src)
def _segment_sum(src, seg, n):
    out = torch.zeros((n,) + src.shape[1:], dtype=src.dtype)
    return out.index_add_(0, seg, src)
def _pad(x, pw):
    flat = tuple(v for pair in reversed(pw) for v in pair)
    return torch.nn.functional.pad(x, flat)

kernel_name = 'interleave_layers__linear_attn_block__dense_activation_relu__prompt'

def setup_inputs():

    _w = (lambda a: (lambda t: t.to(torch.bfloat16) if t.is_floating_point() else t)(torch.as_tensor(a)))
    def _A_setup():
        B, S, D = 1, 2048, 512
        return {
            "x": _w((lambda *s: torch.randn(*s, dtype=torch.bfloat16) * 0.05)(B, S, D)),
            "wqkv": _w((lambda *s: torch.randn(*s, dtype=torch.bfloat16) * 0.1)(D, 3 * D)),
            "wo": _w((lambda *s: torch.randn(*s, dtype=torch.bfloat16) * 0.05)(D, D)),
        }
    _A_in = _A_setup()

    def _B_setup():
        B, S, D, Dff = 1, 2048, 512, 1376
        return {
            "x": _w((lambda *s: torch.randn(*s, dtype=torch.bfloat16) * 0.05)(B, S, D)),
            "w1": _w((lambda *s: torch.randn(*s, dtype=torch.bfloat16) * 0.05)(D, Dff)),
            "w2": _w((lambda *s: torch.randn(*s, dtype=torch.bfloat16) * 0.05)(Dff, D)),
        }
    _B_in = _B_setup()

    return {
        "A_x": _A_in["x"],
        "A_wqkv": _A_in["wqkv"],
        "A_wo": _A_in["wo"],
        "B_x": _B_in["x"],
        "B_w1": _B_in["w1"],
        "B_w2": _B_in["w2"],
    }

def reference(A_x, A_wqkv, A_wo, B_x, B_w1, B_w2):
    def _A_ref(x, wqkv, wo):
        B, S, D = x.shape
        H = 32; Dh = D // H
        qkv = (lambda x, *d: x.permute(*d))((x @ wqkv).reshape(B, S, 3, H, Dh), 2, 0, 3, 1, 4)
        q, k, v = qkv[0], qkv[1], qkv[2]
        phi = lambda t: torch.where(t > 0, t + 1, torch.exp(t)) + 1e-6
        pq, pk = phi(q), phi(k)
        kv = torch.einsum("bhsd,bhse->bhde", pk, v)
        z = torch.einsum("bhsd->bhd", pk)
        num = torch.einsum("bhqd,bhde->bhqe", pq, kv)
        den = torch.einsum("bhqd,bhd->bhq", pq, z)[..., None] + 1e-6
        o = num / den
        return (lambda x, *d: x.permute(*d))(o, 0, 2, 1, 3).reshape(B, S, D) @ wo

    def _B_ref(x, w1, w2):
        h = torch.einsum("bsd,df->bsf", x, w1)
        zero = torch.zeros_like(h)
        h = torch.maximum(h, zero)
        return torch.einsum("bsf,fd->bsd", h, w2)

    x = A_x
    x = x + _A_ref(_layernorm(x, axis=-1), A_wqkv, A_wo)
    x = x + _B_ref(_layernorm(x, axis=-1), B_w1, B_w2)
    x = x + _A_ref(_layernorm(x, axis=-1), A_wqkv, A_wo)
    x = x + _B_ref(_layernorm(x, axis=-1), B_w1, B_w2)
    return x
```

```asm
; @launch grid=(256,1,1) block=(256,1,1) lds=163840
.amdgcn_target "amdgcn-amd-amdhsa--gfx950"
.text
.globl interleave_layers__linear_attn_block__dense_activation_relu__prompt_kernel
.p2align 8
.type interleave_layers__linear_attn_block__dense_activation_relu__prompt_kernel,@function
interleave_layers__linear_attn_block__dense_activation_relu__prompt_kernel:
    s_cmp_ge_u32 s2, 256
    s_cbranch_scc1 Lend
    s_load_dwordx16 s[80:95], s[0:1], 0
    s_load_dwordx2 s[96:97], s[0:1], 64
    s_getpc_b64 s[62:63]
Lpc0:
    s_lshr_b32 s79, s2, 3
    v_lshlrev_b32 v32, 4, v0
    s_lshl_b32 s3, s79, 12
    s_and_b32 s62, s62, -16
    s_cmp_lt_u32 s3, Lslow-Lpc0
    s_cselect_b32 s3, s3, 0
    v_add_u32 v32, s3, v32
    global_load_dwordx4 v[144:147], v32, s[62:63]
    v_lshrrev_b32 v32, 6, v0
    v_and_b32 v33, 63, v0
    v_readfirstlane_b32 s24, v32
    s_and_b32 s27, s2, 7
    s_lshr_b32 s28, s79, 3
    s_and_b32 s25, s79, 7
    s_lshl_b32 s26, s27, 2
    s_add_u32 s26, s26, s28
    v_lshrrev_b32 v34, 4, v33
    v_and_b32 v35, 15, v33
    v_lshrrev_b32 v36, 3, v33
    v_and_b32 v37, 7, v33
    v_lshlrev_b32 v39, 7, v33
    v_min_u32 v38, 11, v35
    v_lshlrev_b32 v38, 7, v38
    v_and_b32 v42, 3, v33
    v_lshlrev_b32 v42, 7, v42
    v_xor_b32 v54, v34, v35
    v_lshlrev_b32 v54, 4, v54
    v_lshl_add_u32 v41, v34, 10, v54
    s_lshl_b32 s60, s27, 18
    s_lshl_b32 s61, s79, 13
    s_add_u32 s60, s60, s61
    s_cmp_eq_u32 s24, 0
    s_cselect_b32 s60, s60, 0x40000000
    v_xor_b32 v45, 64, v41
    v_xor_b32 v46, 128, v41
    v_xor_b32 v47, 192, v41
    s_mov_b32 s63, 0
    s_lshl_b32 s61, s2, 2
    s_add_u32 s61, s61, s24
    s_lshr_b32 s62, s61, 1
    s_mul_i32 s62, s62, 3072
    s_lshl_b32 s59, s61, 9
    s_and_b32 s61, s61, 1
    s_mul_i32 s61, s61, 1536
    s_add_u32 s61, s62, s61
    s_lshl_b32 s62, s79, 2
    s_add_u32 s62, s62, s24
    s_movk_i32 s31, 3072
    v_lshlrev_b32 v140, 7, v35
    v_mov_b32 v143, 0x40000000
    v_cmp_gt_u32 vcc, 16, v33
    v_mad_u32_u24 v141, v34, s31, v140
    s_nop 0
    v_cndmask_b32 v142, v143, v140, vcc
    v_cmp_gt_u32 vcc, 32, v33
    s_mov_b32 s6, 0x10000000
    s_nop 0
    v_cndmask_b32 v140, v143, v141, vcc
    s_mov_b32 s7, 0x20000
    s_mov_b32 s22, 0x80000
    s_mov_b32 s23, 0x20000
    s_mov_b32 s18, 0x180000
    s_mov_b32 s19, 0x20000
    s_mov_b32 s14, 0x200000
    s_mov_b32 s15, 0x20000
    s_lshl_b32 s56, s26, 16
    s_lshl_b32 s57, s24, 14
    s_add_u32 s56, s56, s57
    s_mul_i32 s98, s24, 24576
    s_lshl_b32 s3, s25, 7
    s_add_u32 s98, s98, s3
    s_add_u32 s98, s98, 1024
    s_lshl_b32 s99, s24, 10
    s_add_u32 s99, s99, 65536
    v_bfe_u32 v40, v36, 1, 1
    s_and_b32 s3, s24, 1
    s_lshl_b32 s31, s3, 1
    v_or_b32 v40, s31, v40
    v_lshlrev_b32 v40, 1, v40
    v_xor_b32 v40, v40, v37
    v_lshlrev_b32 v40, 4, v40
    s_movk_i32 s31, 3072
    v_mad_u32_u24 v40, v36, s31, v40
    s_waitcnt lgkmcnt(0)
    s_mov_b32 s12, s80
    s_mov_b32 s13, s81
    s_mov_b32 s16, s82
    s_mov_b32 s17, s83
    buffer_load_dword v141, v39, s[12:15], s60 offen
    buffer_load_dword v139, v38, s[16:19], s61 offen
    s_mov_b32 s4, s96
    s_mov_b32 s5, s97
    s_mov_b32 s20, s84
    s_mov_b32 s21, s85
    buffer_load_dword v43, off, s[4:7], 0 sc1
    s_add_u32 m0, s57, 0
    s_add_u32 s30, s56, 0
    buffer_load_dwordx4 v41, s[12:15], s30 offen lds
    s_add_u32 m0, s57, 1024
    s_add_u32 s30, s56, 4096
    buffer_load_dwordx4 v45, s[12:15], s30 offen lds
    s_add_u32 m0, s57, 2048
    s_add_u32 s30, s56, 8192
    buffer_load_dwordx4 v46, s[12:15], s30 offen lds
    s_add_u32 m0, s57, 3072
    s_add_u32 s30, s56, 12288
    buffer_load_dwordx4 v47, s[12:15], s30 offen lds
    s_add_u32 m0, s99, 0
    s_add_u32 s30, s98, 0
    buffer_load_dwordx4 v40, s[16:19], s30 offen lds
    s_add_u32 m0, s99, 4096
    s_add_u32 s30, s98, 98304
    buffer_load_dwordx4 v40, s[16:19], s30 offen lds
    s_mov_b32 s10, 0x200000
    s_mov_b32 s11, 0x20000
    v_lshlrev_b32 v0, 4, v33
    s_lshl_b32 s41, s24, 12
    s_lshl_b32 s33, s28, 12
    v_mov_b32 v42, 0
    s_lshl_b32 s32, s26, 20
    s_add_u32 s32, s32, 16777216
    s_lshl_b32 s31, s25, 2
    s_add_u32 s31, s31, s24
    s_lshl_b32 s39, s27, 17
    s_lshl_b32 s3, s31, 12
    s_add_u32 s39, s39, s3
    s_add_u32 s39, s39, 2097152
    s_lshl_b32 s40, s31, 13
    s_add_u32 s40, s40, 4194304
    s_lshr_b32 s31, s24, 1
    s_and_b32 s3, s24, 1
    s_lshl_b32 s42, s31, 14
    s_lshl_b32 s54, s25, 1
    s_add_u32 s54, s54, s3
    s_lshl_b32 s43, s54, 10
    s_add_u32 s43, s43, s42
    s_add_u32 s43, s43, s32
    s_lshl_b32 s44, s31, 11
    s_lshl_b32 s55, s54, 3
    s_add_u32 s44, s44, s55
    s_add_u32 s44, s44, s32
    s_lshl_b32 s70, s26, 16
    s_add_u32 s70, s70, s42
    s_lshl_b32 s55, s54, 6
    s_add_u32 s70, s70, s55
    v_lshl_add_u32 v116, v35, 8, v54
    s_and_b32 s55, s54, 3
    s_lshl_b32 s55, s55, 6
    v_xor_b32 v55, s55, v116
    s_lshr_b32 s55, s54, 2
    s_sub_u32 s55, s55, s63
    s_and_b32 s55, s55, 3
    s_lshl_b32 s55, s55, 12
    s_add_u32 s55, s55, s42
    v_add_u32 v55, s55, v55
    s_lshl_b32 s55, s3, 12
    s_add_u32 s42, s42, s55
    s_add_u32 s38, s32, s42
    s_lshl_b32 s67, s25, 1
    s_add_u32 s67, s67, s31
    s_lshl_b32 s67, s67, 10
    s_add_u32 s67, s67, s32
    v_mov_b32 v48, 0x40000000
    v_lshlrev_b32 v49, 2, v34
    v_lshl_add_u32 v7, v35, 7, v49
    v_cmp_gt_u32 vcc, 32, v33
    s_nop 1
    v_cndmask_b32 v7, v48, v7, vcc
    v_cndmask_b32 v6, v48, v39, vcc
    s_add_u32 s34, s41, s33
    s_and_b32 s34, s34, 0x3fff
    s_add_u32 s34, s34, s32
    s_mov_b32 s8, s92
    s_mov_b32 s9, s93
    v_xor_b32 v117, 64, v116
    v_xor_b32 v118, 128, v116
    v_xor_b32 v119, 192, v116
    s_and_b32 s3, s24, 1
    v_lshlrev_b32 v1, 4, v34
    v_add_u32 v1, 159744, v1
    s_add_u32 m0, s99, 8192
    s_add_u32 s30, s98, 1024
    buffer_load_dwordx4 v40, s[16:19], s30 offen lds
    v_lshlrev_b32 v2, 2, v35
    v_add_u32 v2, 159744, v2
    v_and_b32 v3, 31, v33
    v_lshlrev_b32 v3, 2, v3
    v_cmp_eq_u32 vcc, 0, v33
    s_lshl_b32 s31, s3, 3
    v_add_u32 v9, s31, v0
    s_add_u32 m0, s99, 12288
    s_add_u32 s30, s98, 99328
    buffer_load_dwordx4 v40, s[16:19], s30 offen lds
    v_cndmask_b32 v4, v48, v42, vcc
    s_lshl_b32 s31, s24, 3
    v_add_u32 v8, s31, v36
    v_lshlrev_b32 v8, 2, v8
    v_add_u32 v8, 159744, v8
    v_lshrrev_b32 v50, 2, v35
    v_and_b32 v49, 3, v33
    s_add_u32 m0, s99, 16384
    s_add_u32 s30, s98, 196608
    buffer_load_dwordx4 v40, s[16:19], s30 offen lds
    v_lshl_add_u32 v51, v34, 3, v50
    v_lshlrev_b32 v51, 7, v51
    v_lshl_add_u32 v51, v49, 3, v51
    v_lshl_add_u32 v52, v34, 2, v50
    v_lshlrev_b32 v52, 7, v52
    v_lshl_add_u32 v52, v49, 4, v52
    s_add_u32 s31, s41, 131072
    v_add_u32 v53, s31, v51
    s_add_u32 m0, s99, 20480
    s_add_u32 s30, s98, 294912
    buffer_load_dwordx4 v40, s[16:19], s30 offen lds
    v_add_u32 v52, s31, v52
    v_lshrrev_b32 v54, 1, v50
    v_and_b32 v56, 1, v34
    v_lshl_or_b32 v54, v56, 1, v54
    v_xor_b32 v54, s24, v54
    v_lshl_add_u32 v51, v54, 5, v51
    v_add_u32 v51, 65536, v51
    s_add_u32 m0, s99, 24576
    s_add_u32 s30, s98, 197632
    buffer_load_dwordx4 v40, s[16:19], s30 offen lds
    s_mov_b32 s45, 0x3F803F80
    s_mov_b32 s46, 0x00003F80
    s_mov_b32 s47, 0x3F800000
    s_mov_b32 s48, 0x35c1a2a0
    s_mov_b32 s49, 0x3f317218
    s_mov_b32 s50, 0x3fb8aa3b
    v_mov_b32 v112, s45
    s_add_u32 m0, s99, 28672
    s_add_u32 s30, s98, 295936
    buffer_load_dwordx4 v40, s[16:19], s30 offen lds
    v_mov_b32 v113, s45
    v_mov_b32 v114, s45
    v_mov_b32 v115, s45
    v_cmp_eq_u32 vcc, v34, v50
    s_lshl_b32 s31, s24, 6
    v_add_u32 v54, s31, v2
    v_mov_b32 v56, 162560
    v_cndmask_b32 v54, v56, v54, vcc
    s_mul_i32 s36, s2, 3
    s_add_u32 s36, s36, s24
    s_add_u32 s36, s36, 255
    s_cmp_eq_u32 s24, 0
    s_cselect_b32 s36, s2, s36
    s_and_b32 s63, s36, 7
    s_lshr_b32 s36, s36, 3
    s_lshl_b32 s52, s63, 7
    s_cmp_lt_u32 s36, 16
    s_cbranch_scc0 Lpp1
    s_mov_b32 s20, s84
    s_mov_b32 s21, s85
    s_mov_b32 s22, 524288
    s_movk_i32 s53, 1024
    s_mov_b32 s54, s36
    s_lshl_b32 s64, s63, 17
    s_lshl_b32 s62, s36, 12
    s_add_u32 s64, s64, s62
    s_add_u32 s64, s64, 5308416
    s_movk_i32 s65, 1024
    s_mov_b32 s35, 1
    s_branch Lpp4
Lpp1:
    s_cmp_lt_u32 s36, 32
    s_cbranch_scc0 Lpp2
    s_mov_b32 s20, s82
    s_mov_b32 s21, s83
    s_mov_b32 s22, 1572864
    s_movk_i32 s53, 3072
    s_sub_u32 s54, s36, 16
    s_lshl_b32 s64, s63, 17
    s_lshl_b32 s62, s54, 10
    s_add_u32 s64, s64, s62
    s_add_u32 s64, s64, 5242880
    s_movk_i32 s65, 16384
    s_mov_b32 s35, 0
    s_branch Lpp4
Lpp2:
    s_cmp_lt_u32 s36, 80
    s_cbranch_scc0 Lpp3
    s_mov_b32 s20, s88
    s_mov_b32 s21, s89
    s_mov_b32 s22, 1409024
    s_movk_i32 s53, 2752
    s_sub_u32 s62, s36, 32
    s_and_b32 s54, s62, 15
    s_lshr_b32 s62, s62, 4
    s_min_u32 s52, s63, 3
    s_mul_i32 s55, s63, 5
    s_add_u32 s52, s52, s55
    s_lshl_b32 s52, s52, 6
    s_lshl_b32 s55, s62, 7
    s_add_u32 s52, s52, s55
    s_mul_i32 s64, s63, 196608
    s_lshl_b32 s62, s62, 16
    s_add_u32 s64, s64, s62
    s_lshl_b32 s62, s54, 10
    s_add_u32 s64, s64, s62
    s_add_u32 s64, s64, 6291456
    s_movk_i32 s65, 16384
    s_mov_b32 s35, 0
    s_branch Lpp4
Lpp3:
    s_mov_b32 s20, s90
    s_mov_b32 s21, s91
    s_mov_b32 s22, 1409024
    s_movk_i32 s53, 1024
    s_sub_u32 s54, s36, 80
    s_mul_i32 s64, s63, 176128
    s_lshl_b32 s62, s54, 12
    s_add_u32 s64, s64, s62
    s_add_u32 s64, s64, 8388608
    s_movk_i32 s65, 1024
    s_mov_b32 s35, 1
Lpp4:
    v_mul_u32_u24 v44, s53, v36
    v_lshl_add_u32 v44, v37, 4, v44
    s_lshl_b32 s54, s54, 5
    s_mul_i32 s58, s54, s53
    s_add_u32 s58, s58, s52
    s_lshl_b32 s59, s53, 3
    s_lshl_b32 s101, s63, 9
    s_lshl_b32 s3, s36, 2
    s_add_u32 s101, s101, s3
    s_add_u32 s101, s101, 8192
    v_mul_u32_u24 v27, s65, v36
    v_lshl_add_u32 v27, v37, 7, v27
    v_cmp_gt_u32 vcc, 32, v33
    v_mov_b32 v26, 0x40000000
    s_nop 0
    v_cndmask_b32 v27, v26, v27, vcc
    s_cmp_lg_u32 s24, 0
    s_cbranch_scc1 Lskip5
    s_add_u32 m0, s41, 131072
    s_nop 0
    buffer_load_dwordx4 v44, s[20:23], s58 offen nt lds
    s_add_u32 s58, s58, s59
    s_add_u32 m0, s41, 132096
    s_nop 0
    buffer_load_dwordx4 v44, s[20:23], s58 offen nt lds
    s_add_u32 s58, s58, s59
    s_add_u32 m0, s41, 133120
    s_nop 0
    buffer_load_dwordx4 v44, s[20:23], s58 offen nt lds
    s_add_u32 s58, s58, s59
    s_add_u32 m0, s41, 134144
    s_nop 0
    buffer_load_dwordx4 v44, s[20:23], s58 offen nt lds
    s_add_u32 s58, s58, s59
    s_mov_b32 s58, 0x40000000
Lskip5:
    s_add_u32 m0, s57, 4096
    s_add_u32 s30, s56, 256
    buffer_load_dwordx4 v41, s[12:15], s30 offen lds
    s_lshr_b32 s3, s24, 1
    s_mul_i32 s31, s24, 11
    s_cmp_eq_u32 s24, 3
    s_cselect_b32 s0, 6, 7
    s_add_u32 s0, s0, s31
    s_mul_i32 s3, s3, 44032
    s_add_u32 s3, s3, s32
    s_lshl_b32 s60, s31, 10
    s_add_u32 s60, s60, s3
    s_lshl_b32 s61, s0, 10
    s_add_u32 s61, s61, s3
    s_mul_i32 s3, s25, 176128
    s_add_u32 s3, s3, 8388608
    s_lshl_b32 s62, s31, 12
    s_add_u32 s62, s62, s3
    s_add_u32 m0, s57, 5120
    s_add_u32 s30, s56, 4352
    buffer_load_dwordx4 v45, s[12:15], s30 offen lds
    s_lshl_b32 s63, s0, 12
    s_add_u32 s63, s63, s3
    s_and_b32 s31, s24, 1
    s_lshl_b32 s31, s31, 11
    s_sub_u32 s68, s62, s31
    s_add_u32 s62, s62, s31
    s_sub_u32 s69, s63, s31
    s_add_u32 s63, s63, s31
    s_lshl_b32 s31, s25, 17
    s_lshl_b32 s3, s24, 14
    s_add_u32 s71, s31, s3
    s_add_u32 s71, s71, 5242880
    s_mul_i32 s72, s25, 196608
    s_add_u32 s72, s72, 6291456
    s_lshl_b32 s78, s27, 7
    s_add_u32 s78, s78, 4096
    v_add_u32 v28, s57, v116
    v_add_u32 v29, s57, v117
    v_add_u32 v31, s57, v118
    v_add_u32 v42, s57, v119
    s_waitcnt vmcnt(6)
    s_waitcnt lgkmcnt(0)
    s_barrier
    ds_read_b64_tr_b16 a[192:193], v51 offset:0
    ds_read_b64_tr_b16 v[192:193], v51 offset:8192
    ds_read_b64_tr_b16 a[194:195], v51 offset:512
    ds_read_b64_tr_b16 v[194:195], v51 offset:8704
    ds_read_b128 v[128:131], v116 offset:0
    ds_read_b128 v[132:135], v116 offset:16384
    ds_read_b128 v[136:139], v116 offset:32768
    ds_read_b128 v[140:143], v116 offset:49152
    ds_read_b64_tr_b16 a[196:197], v51 offset:4096
    ds_read_b64_tr_b16 v[196:197], v51 offset:12288
    ds_read_b64_tr_b16 a[198:199], v51 offset:4608
    ds_read_b64_tr_b16 v[198:199], v51 offset:12800
    ds_read_b128 v[144:147], v117 offset:0
    ds_read_b128 v[148:151], v117 offset:16384
    ds_read_b128 v[152:155], v117 offset:32768
    ds_read_b128 v[156:159], v117 offset:49152
    ds_read_b128 v[96:99], v28 offset:0
    ds_read_b128 v[100:103], v29 offset:0
    s_add_u32 m0, s57, 6144
    s_add_u32 s30, s56, 8448
    buffer_load_dwordx4 v46, s[12:15], s30 offen lds
    s_add_u32 m0, s57, 7168
    s_add_u32 s30, s56, 12544
    buffer_load_dwordx4 v47, s[12:15], s30 offen lds
    s_add_u32 m0, s99, 32768
    s_add_u32 s30, s98, 393216
    buffer_load_dwordx4 v40, s[16:19], s30 offen lds
    s_add_u32 m0, s99, 36864
    s_add_u32 s30, s98, 491520
    buffer_load_dwordx4 v40, s[16:19], s30 offen lds
    s_add_u32 m0, s99, 40960
    s_add_u32 s30, s98, 394240
    buffer_load_dwordx4 v40, s[16:19], s30 offen lds
    s_add_u32 m0, s99, 45056
    s_add_u32 s30, s98, 492544
    buffer_load_dwordx4 v40, s[16:19], s30 offen lds
    s_add_u32 m0, s99, 49152
    s_add_u32 s30, s98, 589824
    buffer_load_dwordx4 v40, s[16:19], s30 offen lds
    s_add_u32 m0, s99, 53248
    s_add_u32 s30, s98, 688128
    buffer_load_dwordx4 v40, s[16:19], s30 offen lds
    s_add_u32 m0, s99, 57344
    s_add_u32 s30, s98, 590848
    buffer_load_dwordx4 v40, s[16:19], s30 offen lds
    s_add_u32 m0, s99, 61440
    s_add_u32 s30, s98, 689152
    buffer_load_dwordx4 v40, s[16:19], s30 offen lds
    v_readfirstlane_b32 s29, v43
    s_nop 0
    s_add_u32 s29, s29, 0x9E3779B0
    s_and_b32 s29, s29, -16
    s_getreg_b32 s100, hwreg(HW_REG_XCC_ID, 0, 4)
    s_add_u32 s100, s100, s29
    v_mov_b32 v5, s29
    v_mov_b32 v48, s100
    s_cmp_lg_u32 s24, 0
    s_cbranch_scc1 Lskip6
    s_lshl_b32 s3, s79, 2
    s_add_u32 s31, s78, s3
    buffer_store_dword v48, v4, s[4:7], s31 offen sc1
Lskip6:
    s_waitcnt vmcnt(12)
    s_waitcnt lgkmcnt(0)
    s_barrier
    s_cmp_eq_u32 s24, 0
    s_cselect_b32 s0, s64, 0x40000000
    s_cselect_b32 s1, s101, 0x40000000
    s_cmp_lg_u32 s24, 0
    s_cbranch_scc1 Lskip7
    s_waitcnt vmcnt(12)
    s_cmp_eq_u32 s35, 1
    s_cbranch_scc1 Lskip8
    ds_read_b64_tr_b16 a[0:1], v53 offset:0
    ds_read_b64_tr_b16 a[2:3], v53 offset:512
    ds_read_b64_tr_b16 a[4:5], v53 offset:32
    ds_read_b64_tr_b16 a[6:7], v53 offset:544
    ds_read_b64_tr_b16 a[8:9], v53 offset:64
    ds_read_b64_tr_b16 a[10:11], v53 offset:576
    ds_read_b64_tr_b16 a[12:13], v53 offset:96
    ds_read_b64_tr_b16 a[14:15], v53 offset:608
    s_waitcnt lgkmcnt(0)
Lskip8:
    s_cmp_eq_u32 s35, 1
    s_cbranch_scc0 Lskip9
    ds_read_b64_tr_b16 a[0:1], v52 offset:0
    ds_read_b64_tr_b16 a[2:3], v52 offset:2048
    ds_read_b64_tr_b16 a[4:5], v52 offset:8
    ds_read_b64_tr_b16 a[6:7], v52 offset:2056
    ds_read_b64_tr_b16 a[8:9], v52 offset:64
    ds_read_b64_tr_b16 a[10:11], v52 offset:2112
    ds_read_b64_tr_b16 a[12:13], v52 offset:72
    ds_read_b64_tr_b16 a[14:15], v52 offset:2120
    s_waitcnt lgkmcnt(0)
Lskip9:
Lskip7:
    v_mfma_f32_16x16x32_bf16 v[120:123], v[96:99], v[112:115], 0
    s_add_u32 m0, s57, 8192
    s_add_u32 s30, s56, 512
    ds_read_b64_tr_b16 a[200:201], v51 offset:16384
    v_mfma_f32_16x16x32_bf16 v[124:127], v[96:99], v[96:99], 0
    buffer_load_dwordx4 v41, s[12:15], s30 offen lds
    v_mfma_f32_16x16x32_bf16 v[120:123], v[100:103], v[112:115], v[120:123]
    s_add_u32 m0, s57, 9216
    s_add_u32 s30, s56, 4608
    ds_read_b64_tr_b16 v[200:201], v51 offset:24576
    v_mfma_f32_16x16x32_bf16 v[124:127], v[100:103], v[100:103], v[124:127]
    ds_read_b64_tr_b16 a[202:203], v51 offset:16896
    ds_read_b64_tr_b16 v[202:203], v51 offset:25088
    v_mfma_f32_16x16x32_bf16 v[56:59], v[128:131], a[192:195], 0
    buffer_load_dwordx4 v45, s[12:15], s30 offen lds
    v_mfma_f32_16x16x32_bf16 v[60:63], v[128:131], v[192:195], 0
    s_add_u32 m0, s57, 10240
    s_add_u32 s30, s56, 8704
    ds_read_b128 v[160:163], v118 offset:0
    v_mfma_f32_16x16x32_bf16 v[64:67], v[132:135], a[192:195], 0
    ds_read_b128 v[164:167], v118 offset:16384
    v_mfma_f32_16x16x32_bf16 v[68:71], v[132:135], v[192:195], 0
    buffer_load_dwordx4 v46, s[12:15], s30 offen lds
    v_mfma_f32_16x16x32_bf16 v[72:75], v[136:139], a[192:195], 0
    s_add_u32 m0, s57, 11264
    s_add_u32 s30, s56, 12800
    ds_read_b128 v[168:171], v118 offset:32768
    v_mfma_f32_16x16x32_bf16 v[76:79], v[136:139], v[192:195], 0
    ds_read_b128 v[172:175], v118 offset:49152
    v_mfma_f32_16x16x32_bf16 v[80:83], v[140:143], a[192:195], 0
    buffer_load_dwordx4 v47, s[12:15], s30 offen lds
    v_mfma_f32_16x16x32_bf16 v[84:87], v[140:143], v[192:195], 0
    s_add_u32 m0, s99, 0
    s_add_u32 s30, s98, 786432
    ds_read_b64_tr_b16 a[204:205], v51 offset:20480
    v_mfma_f32_16x16x32_bf16 v[88:91], v[112:115], a[192:195], 0
    ds_read_b64_tr_b16 v[204:205], v51 offset:28672
    ds_read_b64_tr_b16 a[206:207], v51 offset:20992
    v_mfma_f32_16x16x32_bf16 v[92:95], v[112:115], v[192:195], 0
    buffer_load_dwordx4 v40, s[16:19], s30 offen lds
    v_mfma_f32_16x16x32_bf16 v[56:59], v[144:147], a[196:199], v[56:59]
    s_add_u32 m0, s99, 4096
    s_add_u32 s30, s98, 884736
    ds_read_b64_tr_b16 v[206:207], v51 offset:29184
    v_mfma_f32_16x16x32_bf16 v[60:63], v[144:147], v[196:199], v[60:63]
    ds_read_b128 v[176:179], v119 offset:0
    v_mfma_f32_16x16x32_bf16 v[64:67], v[148:151], a[196:199], v[64:67]
    buffer_load_dwordx4 v40, s[16:19], s30 offen lds
    v_mfma_f32_16x16x32_bf16 v[68:71], v[148:151], v[196:199], v[68:71]
    s_add_u32 m0, s99, 8192
    s_add_u32 s30, s98, 787456
    ds_read_b128 v[180:183], v119 offset:16384
    v_mfma_f32_16x16x32_bf16 v[72:75], v[152:155], a[196:199], v[72:75]
    ds_read_b128 v[184:187], v119 offset:32768
    v_mfma_f32_16x16x32_bf16 v[76:79], v[152:155], v[196:199], v[76:79]
    buffer_load_dwordx4 v40, s[16:19], s30 offen lds
    v_mfma_f32_16x16x32_bf16 v[80:83], v[156:159], a[196:199], v[80:83]
    s_add_u32 m0, s99, 12288
    s_add_u32 s30, s98, 885760
    ds_read_b128 v[188:191], v119 offset:49152
    v_mfma_f32_16x16x32_bf16 v[84:87], v[156:159], v[196:199], v[84:87]
    ds_read_b128 v[104:107], v31 offset:0
    v_mfma_f32_16x16x32_bf16 v[88:91], v[112:115], a[196:199], v[88:91]
    buffer_load_dwordx4 v40, s[16:19], s30 offen lds
    v_mfma_f32_16x16x32_bf16 v[92:95], v[112:115], v[196:199], v[92:95]
    ds_read_b128 v[108:111], v42 offset:0
    buffer_store_dwordx4 a[0:3], v0, s[4:7], s0 offen sc1
    s_add_u32 s0, s0, s65
    buffer_store_dwordx4 a[4:7], v0, s[4:7], s0 offen sc1
    s_add_u32 s0, s0, s65
    buffer_store_dwordx4 a[8:11], v0, s[4:7], s0 offen sc1
    s_add_u32 s0, s0, s65
    buffer_store_dwordx4 a[12:15], v0, s[4:7], s0 offen sc1
    s_add_u32 s0, s0, s65
    s_waitcnt vmcnt(16)
    s_waitcnt lgkmcnt(0)
    s_barrier
    v_mfma_f32_16x16x32_bf16 v[120:123], v[104:107], v[112:115], v[120:123]
    s_add_u32 m0, s57, 12288
    s_add_u32 s30, s56, 768
    ds_read_b64_tr_b16 a[208:209], v51 offset:32768
    v_mfma_f32_16x16x32_bf16 v[124:127], v[104:107], v[104:107], v[124:127]
    buffer_load_dwordx4 v41, s[12:15], s30 offen lds
    v_mfma_f32_16x16x32_bf16 v[120:123], v[108:111], v[112:115], v[120:123]
    s_add_u32 m0, s57, 13312
    s_add_u32 s30, s56, 4864
    ds_read_b64_tr_b16 v[208:209], v51 offset:40960
    v_mfma_f32_16x16x32_bf16 v[124:127], v[108:111], v[108:111], v[124:127]
    ds_read_b64_tr_b16 a[210:211], v51 offset:33280
    ds_read_b64_tr_b16 v[210:211], v51 offset:41472
    v_mfma_f32_16x16x32_bf16 v[56:59], v[160:163], a[200:203], v[56:59]
    buffer_load_dwordx4 v45, s[12:15], s30 offen lds
    v_mfma_f32_16x16x32_bf16 v[60:63], v[160:163], v[200:203], v[60:63]
    s_add_u32 m0, s57, 14336
    s_add_u32 s30, s56, 8960
    ds_read_b128 v[128:131], v116 offset:4096
    v_mfma_f32_16x16x32_bf16 v[64:67], v[164:167], a[200:203], v[64:67]
    ds_read_b128 v[132:135], v116 offset:20480
    v_mfma_f32_16x16x32_bf16 v[68:71], v[164:167], v[200:203], v[68:71]
    buffer_load_dwordx4 v46, s[12:15], s30 offen lds
    v_mfma_f32_16x16x32_bf16 v[72:75], v[168:171], a[200:203], v[72:75]
    s_add_u32 m0, s57, 15360
    s_add_u32 s30, s56, 13056
    ds_read_b128 v[136:139], v116 offset:36864
    v_mfma_f32_16x16x32_bf16 v[76:79], v[168:171], v[200:203], v[76:79]
    ds_read_b128 v[140:143], v116 offset:53248
    v_mfma_f32_16x16x32_bf16 v[80:83], v[172:175], a[200:203], v[80:83]
    buffer_load_dwordx4 v47, s[12:15], s30 offen lds
    v_mfma_f32_16x16x32_bf16 v[84:87], v[172:175], v[200:203], v[84:87]
    s_add_u32 m0, s99, 16384
    s_add_u32 s30, s98, 983040
    ds_read_b64_tr_b16 a[212:213], v51 offset:36864
    v_mfma_f32_16x16x32_bf16 v[88:91], v[112:115], a[200:203], v[88:91]
    ds_read_b64_tr_b16 v[212:213], v51 offset:45056
    ds_read_b64_tr_b16 a[214:215], v51 offset:37376
    v_mfma_f32_16x16x32_bf16 v[92:95], v[112:115], v[200:203], v[92:95]
    buffer_load_dwordx4 v40, s[16:19], s30 offen lds
    v_mfma_f32_16x16x32_bf16 v[56:59], v[176:179], a[204:207], v[56:59]
    s_add_u32 m0, s99, 20480
    s_add_u32 s30, s98, 1081344
    ds_read_b64_tr_b16 v[214:215], v51 offset:45568
    v_mfma_f32_16x16x32_bf16 v[60:63], v[176:179], v[204:207], v[60:63]
    ds_read_b128 v[144:147], v117 offset:4096
    v_mfma_f32_16x16x32_bf16 v[64:67], v[180:183], a[204:207], v[64:67]
    buffer_load_dwordx4 v40, s[16:19], s30 offen lds
    v_mfma_f32_16x16x32_bf16 v[68:71], v[180:183], v[204:207], v[68:71]
    s_add_u32 m0, s99, 24576
    s_add_u32 s30, s98, 984064
    ds_read_b128 v[148:151], v117 offset:20480
    v_mfma_f32_16x16x32_bf16 v[72:75], v[184:187], a[204:207], v[72:75]
    ds_read_b128 v[152:155], v117 offset:36864
    v_mfma_f32_16x16x32_bf16 v[76:79], v[184:187], v[204:207], v[76:79]
    buffer_load_dwordx4 v40, s[16:19], s30 offen lds
    v_mfma_f32_16x16x32_bf16 v[80:83], v[188:191], a[204:207], v[80:83]
    s_add_u32 m0, s99, 28672
    s_add_u32 s30, s98, 1082368
    ds_read_b128 v[156:159], v117 offset:53248
    v_mfma_f32_16x16x32_bf16 v[84:87], v[188:191], v[204:207], v[84:87]
    ds_read_b128 v[96:99], v28 offset:4096
    v_mfma_f32_16x16x32_bf16 v[88:91], v[112:115], a[204:207], v[88:91]
    buffer_load_dwordx4 v40, s[16:19], s30 offen lds
    v_mfma_f32_16x16x32_bf16 v[92:95], v[112:115], v[204:207], v[92:95]
    ds_read_b128 v[100:103], v29 offset:4096
    ds_read_b128 v[104:107], v31 offset:4096
    s_waitcnt vmcnt(20)
    s_waitcnt lgkmcnt(0)
    s_barrier
    v_mfma_f32_16x16x32_bf16 v[120:123], v[96:99], v[112:115], v[120:123]
    s_add_u32 m0, s99, 32768
    s_add_u32 s30, s98, 1179648
    ds_read_b64_tr_b16 a[216:217], v51 offset:49152
    v_mfma_f32_16x16x32_bf16 v[124:127], v[96:99], v[96:99], v[124:127]
    buffer_load_dwordx4 v40, s[16:19], s30 offen lds
    v_mfma_f32_16x16x32_bf16 v[120:123], v[100:103], v[112:115], v[120:123]
    s_add_u32 m0, s99, 36864
    s_add_u32 s30, s98, 1277952
    ds_read_b64_tr_b16 v[216:217], v51 offset:57344
    v_mfma_f32_16x16x32_bf16 v[124:127], v[100:103], v[100:103], v[124:127]
    ds_read_b64_tr_b16 a[218:219], v51 offset:49664
    ds_read_b64_tr_b16 v[218:219], v51 offset:57856
    v_mfma_f32_16x16x32_bf16 v[120:123], v[104:107], v[112:115], v[120:123]
    s_lshl_b32 s13, s25, 17
    ds_read_b128 v[160:163], v118 offset:4096
    s_lshl_b32 s12, s28, 2
    v_mfma_f32_16x16x32_bf16 v[124:127], v[104:107], v[104:107], v[124:127]
    s_add_u32 s12, s12, s24
    buffer_load_dwordx4 v40, s[16:19], s30 offen lds
    v_mfma_f32_16x16x32_bf16 v[56:59], v[128:131], a[208:211], v[56:59]
    s_add_u32 m0, s99, 40960
    s_add_u32 s30, s98, 1180672
    ds_read_b128 v[164:167], v118 offset:20480
    v_mfma_f32_16x16x32_bf16 v[60:63], v[128:131], v[208:211], v[60:63]
    s_lshl_b32 s12, s12, 12
    ds_read_b128 v[168:171], v118 offset:36864
    s_mul_i32 s14, s25, 176128
    v_mfma_f32_16x16x32_bf16 v[64:67], v[132:135], a[208:211], v[64:67]
    s_add_u32 s14, s14, 8388608
    ds_read_b128 v[172:175], v118 offset:53248
    s_add_u32 s15, s60, 5120
    s_cmp_eq_u32 s24, 3
    s_cselect_b32 s15, 0x40000000, s15
    v_mfma_f32_16x16x32_bf16 v[68:71], v[132:135], v[208:211], v[68:71]
    s_mov_b32 s52, 0xAAAAAAAA
    buffer_load_dwordx4 v40, s[16:19], s30 offen lds
    v_mfma_f32_16x16x32_bf16 v[72:75], v[136:139], a[208:211], v[72:75]
    s_add_u32 m0, s99, 45056
    s_add_u32 s30, s98, 1278976
    ds_read_b64_tr_b16 a[220:221], v51 offset:53248
    v_mfma_f32_16x16x32_bf16 v[76:79], v[136:139], v[208:211], v[76:79]
    s_mov_b32 s53, 0xAAAAAAAA
    ds_read_b64_tr_b16 v[220:221], v51 offset:61440
    ds_read_b64_tr_b16 a[222:223], v51 offset:53760
    v_mfma_f32_16x16x32_bf16 v[80:83], v[140:143], a[208:211], v[80:83]
    s_waitcnt vmcnt(11)
    buffer_store_dword v5, v4, s[4:7], s1 offen sc1
    v_mfma_f32_16x16x32_bf16 v[84:87], v[140:143], v[208:211], v[84:87]
    s_mov_b32 s66, 0x40000
    buffer_load_dwordx4 v40, s[16:19], s30 offen lds
    v_mfma_f32_16x16x32_bf16 v[88:91], v[112:115], a[208:211], v[88:91]
    s_lshr_b32 s73, s24, 1
    ds_read_b64_tr_b16 v[222:223], v51 offset:61952
    ds_read_b128 v[176:179], v119 offset:4096
    v_mfma_f32_16x16x32_bf16 v[92:95], v[112:115], v[208:211], v[92:95]
    s_mul_i32 s73, s73, 88064
    ds_read_b128 v[180:183], v119 offset:20480
    s_sub_u32 s73, 44032, s73
    v_mfma_f32_16x16x32_bf16 v[56:59], v[144:147], a[212:215], v[56:59]
    ds_read_b128 v[184:187], v119 offset:36864
    v_mfma_f32_16x16x32_bf16 v[60:63], v[144:147], v[212:215], v[60:63]
    ds_read_b128 v[188:191], v119 offset:53248
    v_mfma_f32_16x16x32_bf16 v[64:67], v[148:151], a[212:215], v[64:67]
    ds_read_b128 v[108:111], v42 offset:4096
    v_mfma_f32_16x16x32_bf16 v[68:71], v[148:151], v[212:215], v[68:71]
    v_mfma_f32_16x16x32_bf16 v[72:75], v[152:155], a[212:215], v[72:75]
    v_mfma_f32_16x16x32_bf16 v[76:79], v[152:155], v[212:215], v[76:79]
    v_mfma_f32_16x16x32_bf16 v[80:83], v[156:159], a[212:215], v[80:83]
    v_mfma_f32_16x16x32_bf16 v[84:87], v[156:159], v[212:215], v[84:87]
    v_mfma_f32_16x16x32_bf16 v[88:91], v[112:115], a[212:215], v[88:91]
    v_mfma_f32_16x16x32_bf16 v[92:95], v[112:115], v[212:215], v[92:95]
    s_waitcnt lgkmcnt(0)
    s_barrier
    v_mfma_f32_16x16x32_bf16 v[120:123], v[108:111], v[112:115], v[120:123]
    s_add_u32 m0, s99, 49152
    s_add_u32 s30, s98, 1376256
    ds_read_b64_tr_b16 a[224:225], v51 offset:0
    v_mfma_f32_16x16x32_bf16 v[124:127], v[108:111], v[108:111], v[124:127]
    buffer_load_dwordx4 v40, s[16:19], s30 offen lds
    v_mfma_f32_16x16x32_bf16 v[56:59], v[160:163], a[216:219], v[56:59]
    s_add_u32 m0, s99, 53248
    s_add_u32 s30, s98, 1474560
    ds_read_b64_tr_b16 v[224:225], v51 offset:8192
    v_mfma_f32_16x16x32_bf16 v[60:63], v[160:163], v[216:219], v[60:63]
    ds_read_b64_tr_b16 a[226:227], v51 offset:512
    ds_read_b64_tr_b16 v[226:227], v51 offset:8704
    v_mfma_f32_16x16x32_bf16 v[64:67], v[164:167], a[216:219], v[64:67]
    buffer_load_dwordx4 v40, s[16:19], s30 offen lds
    v_mfma_f32_16x16x32_bf16 v[68:71], v[164:167], v[216:219], v[68:71]
    s_add_u32 m0, s99, 57344
    s_add_u32 s30, s98, 1377280
    ds_read_b128 v[128:131], v116 offset:8192
    v_mfma_f32_16x16x32_bf16 v[72:75], v[168:171], a[216:219], v[72:75]
    ds_read_b128 v[132:135], v116 offset:24576
    v_mfma_f32_16x16x32_bf16 v[76:79], v[168:171], v[216:219], v[76:79]
    buffer_load_dwordx4 v40, s[16:19], s30 offen lds
    v_mfma_f32_16x16x32_bf16 v[80:83], v[172:175], a[216:219], v[80:83]
    s_add_u32 m0, s99, 61440
    s_add_u32 s30, s98, 1475584
    ds_read_b128 v[136:139], v116 offset:40960
    v_mfma_f32_16x16x32_bf16 v[84:87], v[172:175], v[216:219], v[84:87]
    ds_read_b128 v[140:143], v116 offset:57344
    v_mfma_f32_16x16x32_bf16 v[88:91], v[112:115], a[216:219], v[88:91]
    buffer_load_dwordx4 v40, s[16:19], s30 offen lds
    v_mfma_f32_16x16x32_bf16 v[92:95], v[112:115], v[216:219], v[92:95]
    s_add_u32 m0, s41, 131072
    ds_read_b64_tr_b16 a[228:229], v51 offset:4096
    ds_read_b64_tr_b16 v[228:229], v51 offset:12288
    v_mfma_f32_16x16x32_bf16 v[56:59], v[176:179], a[220:223], v[56:59]
    ds_read_b64_tr_b16 a[230:231], v51 offset:4608
    ds_read_b64_tr_b16 v[230:231], v51 offset:12800
    v_mfma_f32_16x16x32_bf16 v[60:63], v[176:179], v[220:223], v[60:63]
    buffer_load_dwordx4 v44, s[20:23], s58 offen nt lds
    v_mfma_f32_16x16x32_bf16 v[64:67], v[180:183], a[220:223], v[64:67]
    s_add_u32 s58, s58, s59
    s_add_u32 m0, s41, 132096
    ds_read_b128 v[144:147], v117 offset:8192
    v_mfma_f32_16x16x32_bf16 v[68:71], v[180:183], v[220:223], v[68:71]
    ds_read_b128 v[148:151], v117 offset:24576
    v_mfma_f32_16x16x32_bf16 v[72:75], v[184:187], a[220:223], v[72:75]
    buffer_load_dwordx4 v44, s[20:23], s58 offen nt lds
    v_mfma_f32_16x16x32_bf16 v[76:79], v[184:187], v[220:223], v[76:79]
    s_add_u32 s58, s58, s59
    ds_read_b128 v[152:155], v117 offset:40960
    v_mfma_f32_16x16x32_bf16 v[80:83], v[188:191], a[220:223], v[80:83]
    ds_read_b128 v[156:159], v117 offset:57344
    v_mfma_f32_16x16x32_bf16 v[84:87], v[188:191], v[220:223], v[84:87]
    ds_read_b128 v[96:99], v28 offset:8192
    v_mfma_f32_16x16x32_bf16 v[88:91], v[112:115], a[220:223], v[88:91]
    ds_read_b128 v[100:103], v29 offset:8192
    v_mfma_f32_16x16x32_bf16 v[92:95], v[112:115], v[220:223], v[92:95]
    ds_read_b128 v[104:107], v31 offset:8192
    ds_read_b128 v[108:111], v42 offset:8192
    s_waitcnt vmcnt(11)
    s_waitcnt lgkmcnt(0)
    s_barrier
    v_mov_b32 v32, 0
    v_mov_b32 v33, 0
    v_mov_b32 v34, 0
    v_mov_b32 v35, 0
    v_mfma_f32_16x16x32_bf16 v[120:123], v[96:99], v[112:115], v[120:123]
    s_add_u32 m0, s41, 133120
    s_nop 0
    buffer_load_dwordx4 v44, s[20:23], s58 offen nt lds
    v_mfma_f32_16x16x32_bf16 v[124:127], v[96:99], v[96:99], v[124:127]
    s_add_u32 s58, s58, s59
    s_add_u32 m0, s41, 134144
    ds_read_b64_tr_b16 a[232:233], v51 offset:16384
    v_mfma_f32_16x16x32_bf16 v[120:123], v[100:103], v[112:115], v[120:123]
    ds_read_b64_tr_b16 v[232:233], v51 offset:24576
    ds_read_b64_tr_b16 a[234:235], v51 offset:16896
    v_mfma_f32_16x16x32_bf16 v[124:127], v[100:103], v[100:103], v[124:127]
    ds_read_b64_tr_b16 v[234:235], v51 offset:25088
    ds_read_b128 v[160:163], v118 offset:8192
    v_mfma_f32_16x16x32_bf16 v[120:123], v[104:107], v[112:115], v[120:123]
    buffer_load_dwordx4 v44, s[20:23], s58 offen nt lds
    v_mfma_f32_16x16x32_bf16 v[124:127], v[104:107], v[104:107], v[124:127]
    s_add_u32 s58, s58, s59
    s_and_b32 s51, s24, 1
    s_lshl_b32 s51, s51, 15
    v_mfma_f32_16x16x32_bf16 v[120:123], v[108:111], v[112:115], v[120:123]
    s_add_u32 s30, s67, s51
    ds_read_b128 v[164:167], v118 offset:24576
    v_mfma_f32_16x16x32_bf16 v[124:127], v[108:111], v[108:111], v[124:127]
    ds_read_b128 v[168:171], v118 offset:40960
    v_mfma_f32_16x16x32_bf16 v[56:59], v[128:131], a[224:227], v[56:59]
    buffer_store_dwordx4 v[32:35], v0, s[4:7], s30 offen
    v_mfma_f32_16x16x32_bf16 v[60:63], v[128:131], v[224:227], v[60:63]
    s_add_u32 s30, s30, 16384
    ds_read_b128 v[172:175], v118 offset:57344
    v_mfma_f32_16x16x32_bf16 v[64:67], v[132:135], a[224:227], v[64:67]
    ds_read_b64_tr_b16 a[236:237], v51 offset:20480
    ds_read_b64_tr_b16 v[236:237], v51 offset:28672
    v_mfma_f32_16x16x32_bf16 v[68:71], v[132:135], v[224:227], v[68:71]
    ds_read_b64_tr_b16 a[238:239], v51 offset:20992
    ds_read_b64_tr_b16 v[238:239], v51 offset:29184
    v_mfma_f32_16x16x32_bf16 v[72:75], v[136:139], a[224:227], v[72:75]
    buffer_store_dwordx4 v[32:35], v0, s[4:7], s30 offen
    v_mfma_f32_16x16x32_bf16 v[76:79], v[136:139], v[224:227], v[76:79]
    s_add_u32 s30, s43, 131072
    ds_read_b128 v[176:179], v119 offset:8192
    v_mfma_f32_16x16x32_bf16 v[80:83], v[140:143], a[224:227], v[80:83]
    ds_read_b128 v[180:183], v119 offset:24576
    v_mfma_f32_16x16x32_bf16 v[84:87], v[140:143], v[224:227], v[84:87]
    ds_read_b128 v[184:187], v119 offset:40960
    v_mfma_f32_16x16x32_bf16 v[88:91], v[112:115], a[224:227], v[88:91]
    buffer_store_dwordx4 v[32:35], v0, s[4:7], s30 offen
    v_mfma_f32_16x16x32_bf16 v[92:95], v[112:115], v[224:227], v[92:95]
    ds_read_b128 v[188:191], v119 offset:57344
    v_mfma_f32_16x16x32_bf16 v[56:59], v[144:147], a[228:231], v[56:59]
    ds_read_b128 v[96:99], v28 offset:12288
    v_mfma_f32_16x16x32_bf16 v[60:63], v[144:147], v[228:231], v[60:63]
    ds_read_b128 v[100:103], v29 offset:12288
    v_mfma_f32_16x16x32_bf16 v[64:67], v[148:151], a[228:231], v[64:67]
    ds_read_b128 v[104:107], v31 offset:12288
    v_mfma_f32_16x16x32_bf16 v[68:71], v[148:151], v[228:231], v[68:71]
    ds_read_b128 v[108:111], v42 offset:12288
    v_mfma_f32_16x16x32_bf16 v[72:75], v[152:155], a[228:231], v[72:75]
    v_mfma_f32_16x16x32_bf16 v[76:79], v[152:155], v[228:231], v[76:79]
    v_mfma_f32_16x16x32_bf16 v[80:83], v[156:159], a[228:231], v[80:83]
    v_mfma_f32_16x16x32_bf16 v[84:87], v[156:159], v[228:231], v[84:87]
    v_mfma_f32_16x16x32_bf16 v[88:91], v[112:115], a[228:231], v[88:91]
    v_mfma_f32_16x16x32_bf16 v[92:95], v[112:115], v[228:231], v[92:95]
    s_waitcnt vmcnt(11)
    s_waitcnt lgkmcnt(0)
    s_barrier
    s_min_u32 s54, s25, 3
    s_mul_i32 s55, s25, 5
    s_add_u32 s54, s54, s55
    s_add_u32 s58, s54, s24
    s_lshl_b32 s58, s58, 10
    s_add_u32 s58, s58, s32
    s_lshr_b32 s3, s24, 1
    s_add_u32 s59, s54, s3
    s_add_u32 s59, s59, 4
    s_lshl_b32 s59, s59, 10
    s_cmp_ge_u32 s25, 3
    s_cselect_b32 s54, s3, 0
    s_cmp_lg_u32 s54, 0
    s_cselect_b32 s59, 0x40000000, s59
    s_add_u32 s59, s59, s32
    s_lshl_b32 s16, s41, 1
    s_cmp_eq_u32 s24, 3
    s_cselect_b32 s31, 126976, 0
    s_cselect_b32 s3, 0, 131072
    s_add_u32 s16, s16, s31
    s_add_u32 s16, s16, s3
    s_mov_b32 s17, 0x80008000
    s_lshr_b32 s19, s41, 2
    s_add_u32 s19, s19, s32
    s_sub_u32 s21, s63, 4096
    s_sub_u32 s22, s69, 4096
    s_sub_u32 s20, s61, 1024
    s_sub_u32 s31, s36, 32
    s_cmp_ge_u32 s31, 91
    s_cselect_b32 s64, 0x40000000, s64
    s_cselect_b32 s101, 0x40000000, s101
    v_mfma_f32_16x16x32_bf16 v[120:123], v[96:99], v[112:115], v[120:123]
    buffer_load_dword v36, v3, s[4:7], s78 offen sc1
    s_add_u32 s30, s39, 0
    s_cmp_lg_u32 s24, s28
    s_cselect_b32 s30, 0x40000000, s30
    s_mov_b32 m0, 163328
    v_mfma_f32_16x16x32_bf16 v[124:127], v[96:99], v[96:99], v[124:127]
    ds_read_b64_tr_b16 a[240:241], v51 offset:32768
    ds_read_b64_tr_b16 v[240:241], v51 offset:40960
    v_mfma_f32_16x16x32_bf16 v[120:123], v[100:103], v[112:115], v[120:123]
    ds_read_b64_tr_b16 a[242:243], v51 offset:33280
    ds_read_b64_tr_b16 v[242:243], v51 offset:41472
    v_mfma_f32_16x16x32_bf16 v[124:127], v[100:103], v[100:103], v[124:127]
    ds_read_b128 v[128:131], v116 offset:12288
    v_mfma_f32_16x16x32_bf16 v[120:123], v[104:107], v[112:115], v[120:123]
    buffer_load_dword v6, s[4:7], s30 offen lds
    v_mfma_f32_16x16x32_bf16 v[124:127], v[104:107], v[104:107], v[124:127]
    s_add_u32 s30, s43, 163840
    ds_read_b128 v[132:135], v116 offset:28672
    v_mfma_f32_16x16x32_bf16 v[120:123], v[108:111], v[112:115], v[120:123]
    ds_read_b128 v[136:139], v116 offset:45056
    v_mfma_f32_16x16x32_bf16 v[124:127], v[108:111], v[108:111], v[124:127]
    ds_read_b128 v[140:143], v116 offset:61440
    v_mfma_f32_16x16x32_bf16 v[56:59], v[160:163], a[232:235], v[56:59]
    buffer_store_dwordx4 v[32:35], v0, s[4:7], s30 offen
    v_mfma_f32_16x16x32_bf16 v[60:63], v[160:163], v[232:235], v[60:63]
    s_add_u32 s30, s44, 720896
    ds_read_b64_tr_b16 a[244:245], v51 offset:36864
    ds_read_b64_tr_b16 v[244:245], v51 offset:45056
    v_mfma_f32_16x16x32_bf16 v[64:67], v[164:167], a[232:235], v[64:67]
    ds_read_b64_tr_b16 a[246:247], v51 offset:37376
    ds_read_b64_tr_b16 v[246:247], v51 offset:45568
    v_mfma_f32_16x16x32_bf16 v[68:71], v[164:167], v[232:235], v[68:71]
    ds_read_b128 v[144:147], v117 offset:12288
    v_mfma_f32_16x16x32_bf16 v[72:75], v[168:171], a[232:235], v[72:75]
    buffer_store_dword v32, v7, s[4:7], s30 offen
    v_mfma_f32_16x16x32_bf16 v[76:79], v[168:171], v[232:235], v[76:79]
    s_add_u32 s30, s44, 724992
    ds_read_b128 v[148:151], v117 offset:28672
    v_mfma_f32_16x16x32_bf16 v[80:83], v[172:175], a[232:235], v[80:83]
    ds_read_b128 v[152:155], v117 offset:45056
    v_mfma_f32_16x16x32_bf16 v[84:87], v[172:175], v[232:235], v[84:87]
    ds_read_b128 v[156:159], v117 offset:61440
    v_mfma_f32_16x16x32_bf16 v[88:91], v[112:115], a[232:235], v[88:91]
    buffer_store_dword v32, v7, s[4:7], s30 offen
    v_mfma_f32_16x16x32_bf16 v[92:95], v[112:115], v[232:235], v[92:95]
    ds_read_b128 v[104:107], v55
    v_mfma_f32_16x16x32_bf16 v[56:59], v[176:179], a[236:239], v[56:59]
    ds_read_b128 v[108:111], v55 offset:32768
    v_mfma_f32_16x16x32_bf16 v[60:63], v[176:179], v[236:239], v[60:63]
    v_mfma_f32_16x16x32_bf16 v[64:67], v[180:183], a[236:239], v[64:67]
    v_mfma_f32_16x16x32_bf16 v[68:71], v[180:183], v[236:239], v[68:71]
    v_mfma_f32_16x16x32_bf16 v[72:75], v[184:187], a[236:239], v[72:75]
    v_mfma_f32_16x16x32_bf16 v[76:79], v[184:187], v[236:239], v[76:79]
    v_mfma_f32_16x16x32_bf16 v[80:83], v[188:191], a[236:239], v[80:83]
    v_mfma_f32_16x16x32_bf16 v[84:87], v[188:191], v[236:239], v[84:87]
    v_mfma_f32_16x16x32_bf16 v[88:91], v[112:115], a[236:239], v[88:91]
    v_mfma_f32_16x16x32_bf16 v[92:95], v[112:115], v[236:239], v[92:95]
    s_waitcnt vmcnt(12)
    s_waitcnt lgkmcnt(0)
    s_barrier
    s_mov_b32 s54, 0xAAAAAAAA
    s_mov_b32 s55, 0xAAAAAAAA
    s_mov_b32 s56, 0xCCCCCCCC
    s_mov_b32 s57, 0xCCCCCCCC
    v_mfma_f32_16x16x32_bf16 v[56:59], v[128:131], a[240:243], v[56:59]
    ds_read_b64_tr_b16 a[248:249], v51 offset:49152
    ds_read_b64_tr_b16 v[248:249], v51 offset:57344
    v_mfma_f32_16x16x32_bf16 v[60:63], v[128:131], v[240:243], v[60:63]
    ds_read_b64_tr_b16 a[250:251], v51 offset:49664
    ds_read_b64_tr_b16 v[250:251], v51 offset:57856
    v_mfma_f32_16x16x32_bf16 v[64:67], v[132:135], a[240:243], v[64:67]
    ds_read_b128 v[160:163], v118 offset:12288
    v_mfma_f32_16x16x32_bf16 v[68:71], v[132:135], v[240:243], v[68:71]
    ds_read_b128 v[164:167], v118 offset:28672
    v_mfma_f32_16x16x32_bf16 v[72:75], v[136:139], a[240:243], v[72:75]
    ds_read_b128 v[168:171], v118 offset:45056
    v_cndmask_b32 v48, v120, v121, s[54:55]
    v_mfma_f32_16x16x32_bf16 v[76:79], v[136:139], v[240:243], v[76:79]
    ds_read_b128 v[172:175], v118 offset:61440
    v_cndmask_b32 v122, v122, v123, s[54:55]
    v_mfma_f32_16x16x32_bf16 v[80:83], v[140:143], a[240:243], v[80:83]
    ds_read_b64_tr_b16 a[252:253], v51 offset:53248
    ds_read_b64_tr_b16 v[252:253], v51 offset:61440
    v_mfma_f32_16x16x32_bf16 v[84:87], v[140:143], v[240:243], v[84:87]
    ds_read_b64_tr_b16 a[254:255], v51 offset:53760
    ds_read_b64_tr_b16 v[254:255], v51 offset:61952
    v_mfma_f32_16x16x32_bf16 v[88:91], v[112:115], a[240:243], v[88:91]
    ds_read_b128 v[176:179], v119 offset:12288
    v_cndmask_b32 v48, v48, v122, s[56:57]
    v_mfma_f32_16x16x32_bf16 v[92:95], v[112:115], v[240:243], v[92:95]
    ds_read_b128 v[180:183], v119 offset:28672
    v_cndmask_b32 v49, v124, v125, s[54:55]
    v_mfma_f32_16x16x32_bf16 v[56:59], v[144:147], a[244:247], v[56:59]
    s_lshl_b32 s30, s25, 9
    s_add_u32 s30, s30, 8192
    ds_read_b128 v[184:187], v119 offset:45056
    v_mfma_f32_16x16x32_bf16 v[60:63], v[144:147], v[244:247], v[60:63]
    buffer_load_dword v38, v3, s[4:7], s30 offen sc1
    v_mfma_f32_16x16x32_bf16 v[64:67], v[148:151], a[244:247], v[64:67]
    ds_read_b128 v[188:191], v119 offset:61440
    v_cndmask_b32 v126, v126, v127, s[54:55]
    v_mfma_f32_16x16x32_bf16 v[68:71], v[148:151], v[244:247], v[68:71]
    v_cndmask_b32 v49, v49, v126, s[56:57]
    v_mul_f32 v48, 0xbb000000, v48
    v_mfma_f32_16x16x32_bf16 v[72:75], v[152:155], a[244:247], v[72:75]
    v_mul_f32 v49, 0x3b000000, v49
    v_fma_f32 v49, -v48, v48, v49
    v_mfma_f32_16x16x32_bf16 v[76:79], v[152:155], v[244:247], v[76:79]
    ds_write_b32 v54, v48 offset:768
    v_mfma_f32_16x16x32_bf16 v[80:83], v[156:159], a[244:247], v[80:83]
    v_max_f32 v49, 0, v49
    v_add_f32 v49, 0x3727c5ac, v49
    v_mfma_f32_16x16x32_bf16 v[84:87], v[156:159], v[244:247], v[84:87]
    v_rsq_f32 v49, v49
    v_mfma_f32_16x16x32_bf16 v[88:91], v[112:115], a[244:247], v[88:91]
    v_mul_f32 v50, v48, v49
    v_mfma_f32_16x16x32_bf16 v[92:95], v[112:115], v[244:247], v[92:95]
    ds_write_b32 v54, v49 offset:0
    v_mul_f32 v49, s50, v49
    ds_write_b32 v54, v50 offset:256
    ds_write_b32 v54, v49 offset:512
    s_waitcnt lgkmcnt(0)
    s_barrier
    v_mfma_f32_16x16x32_bf16 v[88:91], v[112:115], a[248:251], v[88:91]
    s_lshl_b32 s18, s25, 2
    s_add_u32 s18, s18, s24
    s_lshl_b32 s18, s18, 2
    v_mfma_f32_16x16x32_bf16 v[92:95], v[112:115], v[248:251], v[92:95]
    s_add_u32 s37, s32, 753664
    s_add_u32 s18, s18, s37
    s_waitcnt vmcnt(5)
    v_subrev_u32 v37, s29, v36
    v_cmp_le_u32 vcc, 16, v37
    s_nop 3
    s_cbranch_vccnz Lrare10
Lrare10b:
    s_waitcnt vmcnt(0)
    v_cmp_ne_u32 vcc, s29, v38
    s_nop 3
    s_cbranch_vccnz Lrare12
Lrare12b:
    s_add_u32 s30, s12, s13
    s_add_u32 s30, s30, 5242880
    s_mov_b32 m0, 163328
    s_nop 0
    buffer_load_dword v6, s[4:7], s30 offen lds
    v_cmp_ne_u32 vcc, s100, v36
    v_mfma_f32_16x16x32_bf16 v[88:91], v[112:115], a[252:255], v[88:91]
    ds_read_b128 v[32:35], v1 offset:512
    ds_read_b128 v[36:39], v1 offset:0
    v_mfma_f32_16x16x32_bf16 v[92:95], v[112:115], v[252:255], v[92:95]
    ds_read_b128 v[40:43], v1 offset:256
    v_mfma_f32_16x16x32_bf16 v[56:59], v[160:163], a[248:251], v[56:59]
    v_mfma_f32_16x16x32_bf16 v[60:63], v[160:163], v[248:251], v[60:63]
    v_mfma_f32_16x16x32_bf16 v[56:59], v[176:179], a[252:255], v[56:59]
    v_mfma_f32_16x16x32_bf16 v[60:63], v[176:179], v[252:255], v[60:63]
    v_mfma_f32_16x16x32_bf16 v[64:67], v[164:167], a[248:251], v[64:67]
    v_mul_f32 v10, s50, v88
    s_nop 0
    v_mov_b32 v11, v92
    v_mfma_f32_16x16x32_bf16 v[68:71], v[164:167], v[248:251], v[68:71]
    v_lshlrev_b32 v12, 16, v104
    v_and_b32 v13, 0xffff0000, v104
    v_mfma_f32_16x16x32_bf16 v[64:67], v[180:183], a[252:255], v[64:67]
    v_lshlrev_b32 v14, 16, v105
    v_and_b32 v15, 0xffff0000, v105
    v_mfma_f32_16x16x32_bf16 v[68:71], v[180:183], v[252:255], v[68:71]
    v_lshlrev_b32 v16, 16, v106
    v_and_b32 v17, 0xffff0000, v106
    v_mfma_f32_16x16x32_bf16 v[72:75], v[168:171], a[248:251], v[72:75]
    v_lshlrev_b32 v18, 16, v107
    v_and_b32 v19, 0xffff0000, v107
    v_mfma_f32_16x16x32_bf16 v[76:79], v[168:171], v[248:251], v[76:79]
    v_lshlrev_b32 v20, 16, v108
    v_and_b32 v21, 0xffff0000, v108
    v_mfma_f32_16x16x32_bf16 v[72:75], v[184:187], a[252:255], v[72:75]
    v_lshlrev_b32 v22, 16, v109
    v_and_b32 v23, 0xffff0000, v109
    v_mfma_f32_16x16x32_bf16 v[76:79], v[184:187], v[252:255], v[76:79]
    v_lshlrev_b32 v24, 16, v110
    v_and_b32 v25, 0xffff0000, v110
    v_mfma_f32_16x16x32_bf16 v[80:83], v[172:175], a[248:251], v[80:83]
    v_lshlrev_b32 v26, 16, v111
    v_and_b32 v27, 0xffff0000, v111
    v_mfma_f32_16x16x32_bf16 v[84:87], v[172:175], v[248:251], v[84:87]
    v_mov_b32 v108, v53
    v_mov_b32 v109, v52
    v_mfma_f32_16x16x32_bf16 v[80:83], v[188:191], a[252:255], v[80:83]
    v_mfma_f32_16x16x32_bf16 v[84:87], v[188:191], v[252:255], v[84:87]
    ds_read_b128 v[44:47], v1 offset:576
    ds_read_b128 v[48:51], v1 offset:64
    ds_read_b128 v[52:55], v1 offset:320
    s_waitcnt lgkmcnt(3)
    v_pk_fma_f32 v[96:97], v[40:41], v[10:11], s[48:49] op_sel_hi:[1,0,0]
    v_pk_fma_f32 v[98:99], v[42:43], v[10:11], s[48:49] op_sel_hi:[1,0,0]
    v_pk_mul_f32 v[104:105], v[40:41], v[10:11] op_sel:[0,1] op_sel_hi:[1,1]
    v_pk_mul_f32 v[106:107], v[42:43], v[10:11] op_sel:[0,1] op_sel_hi:[1,1]
    v_pk_fma_f32 v[96:97], v[56:57], v[32:33], v[96:97]
    v_pk_fma_f32 v[98:99], v[58:59], v[34:35], v[98:99]
    v_exp_f32 v100, v96 clamp
    v_max_f32 v96, s48, v96
    v_exp_f32 v101, v97 clamp
    v_max_f32 v97, s48, v97
    v_exp_f32 v102, v98 clamp
    v_max_f32 v98, s48, v98
    v_exp_f32 v103, v99 clamp
    v_max_f32 v99, s48, v99
    v_pk_fma_f32 v[104:105], v[60:61], v[36:37], v[104:105]
    v_pk_fma_f32 v[106:107], v[62:63], v[38:39], v[106:107]
    v_pk_fma_f32 v[96:97], v[96:97], s[48:49], v[100:101] op_sel:[0,1,0] op_sel_hi:[1,1,1]
    v_pk_fma_f32 v[98:99], v[98:99], s[48:49], v[102:103] op_sel:[0,1,0] op_sel_hi:[1,1,1]
    v_cvt_pk_bf16_f32 v124, v104, v105
    v_cvt_pk_bf16_f32 v125, v106, v107
    v_cvt_pk_bf16_f32 v120, v96, v97
    v_cvt_pk_bf16_f32 v121, v98, v99
    ds_read_b128 v[32:35], v1 offset:640
    ds_read_b128 v[36:39], v1 offset:128
    ds_read_b128 v[40:43], v1 offset:384
    s_waitcnt lgkmcnt(3)
    v_pk_fma_f32 v[96:97], v[52:53], v[10:11], s[48:49] op_sel_hi:[1,0,0]
    v_pk_fma_f32 v[98:99], v[54:55], v[10:11], s[48:49] op_sel_hi:[1,0,0]
    s_add_u32 s30, s12, s13
    s_add_u32 s30, s30, 5308416
    s_mov_b32 m0, 163328
    s_nop 0
    buffer_load_dword v6, s[4:7], s30 offen lds
    v_pk_mul_f32 v[104:105], v[52:53], v[10:11] op_sel:[0,1] op_sel_hi:[1,1]
    v_pk_mul_f32 v[106:107], v[54:55], v[10:11] op_sel:[0,1] op_sel_hi:[1,1]
    v_pk_fma_f32 v[96:97], v[64:65], v[44:45], v[96:97]
    v_pk_fma_f32 v[98:99], v[66:67], v[46:47], v[98:99]
    v_exp_f32 v100, v96 clamp
    v_max_f32 v96, s48, v96
    v_exp_f32 v101, v97 clamp
    v_max_f32 v97, s48, v97
    v_exp_f32 v102, v98 clamp
    v_max_f32 v98, s48, v98
    v_exp_f32 v103, v99 clamp
    v_max_f32 v99, s48, v99
    v_pk_fma_f32 v[104:105], v[68:69], v[48:49], v[104:105]
    v_pk_fma_f32 v[106:107], v[70:71], v[50:51], v[106:107]
    v_pk_fma_f32 v[96:97], v[96:97], s[48:49], v[100:101] op_sel:[0,1,0] op_sel_hi:[1,1,1]
    v_pk_fma_f32 v[98:99], v[98:99], s[48:49], v[102:103] op_sel:[0,1,0] op_sel_hi:[1,1,1]
    v_cvt_pk_bf16_f32 v126, v104, v105
    v_cvt_pk_bf16_f32 v127, v106, v107
    v_cvt_pk_bf16_f32 v122, v96, v97
    v_cvt_pk_bf16_f32 v123, v98, v99
    s_nop 1
    v_mfma_f32_16x16x32_bf16 v[92:95], v[120:123], v[112:115], 0
    v_mfma_f32_16x16x32_bf16 v[88:91], v[120:123], v[124:127], 0
    ds_read_b128 v[44:47], v1 offset:704
    ds_read_b128 v[48:51], v1 offset:192
    ds_read_b128 v[52:55], v1 offset:448
    s_waitcnt lgkmcnt(3)
    v_pk_fma_f32 v[96:97], v[40:41], v[10:11], s[48:49] op_sel_hi:[1,0,0]
    v_pk_fma_f32 v[98:99], v[42:43], v[10:11], s[48:49] op_sel_hi:[1,0,0]
    v_pk_mul_f32 v[104:105], v[40:41], v[10:11] op_sel:[0,1] op_sel_hi:[1,1]
    v_pk_mul_f32 v[106:107], v[42:43], v[10:11] op_sel:[0,1] op_sel_hi:[1,1]
    v_pk_fma_f32 v[96:97], v[72:73], v[32:33], v[96:97]
    v_pk_fma_f32 v[98:99], v[74:75], v[34:35], v[98:99]
    v_exp_f32 v100, v96 clamp
    v_max_f32 v96, s48, v96
    v_exp_f32 v101, v97 clamp
    v_max_f32 v97, s48, v97
    v_exp_f32 v102, v98 clamp
    v_max_f32 v98, s48, v98
    v_exp_f32 v103, v99 clamp
    v_max_f32 v99, s48, v99
    v_pk_fma_f32 v[104:105], v[76:77], v[36:37], v[104:105]
    v_pk_fma_f32 v[106:107], v[78:79], v[38:39], v[106:107]
    v_pk_fma_f32 v[96:97], v[96:97], s[48:49], v[100:101] op_sel:[0,1,0] op_sel_hi:[1,1,1]
    v_pk_fma_f32 v[98:99], v[98:99], s[48:49], v[102:103] op_sel:[0,1,0] op_sel_hi:[1,1,1]
    v_cvt_pk_bf16_f32 v124, v104, v105
    v_cvt_pk_bf16_f32 v125, v106, v107
    v_cvt_pk_bf16_f32 v120, v96, v97
    v_cvt_pk_bf16_f32 v121, v98, v99
    s_waitcnt lgkmcnt(0)
    v_pk_fma_f32 v[96:97], v[52:53], v[10:11], s[48:49] op_sel_hi:[1,0,0]
    v_pk_fma_f32 v[98:99], v[54:55], v[10:11], s[48:49] op_sel_hi:[1,0,0]
    v_pk_mul_f32 v[104:105], v[52:53], v[10:11] op_sel:[0,1] op_sel_hi:[1,1]
    v_pk_mul_f32 v[106:107], v[54:55], v[10:11] op_sel:[0,1] op_sel_hi:[1,1]
    v_pk_fma_f32 v[96:97], v[80:81], v[44:45], v[96:97]
    v_pk_fma_f32 v[98:99], v[82:83], v[46:47], v[98:99]
    v_exp_f32 v100, v96 clamp
    v_max_f32 v96, s48, v96
    v_exp_f32 v101, v97 clamp
    v_max_f32 v97, s48, v97
    v_exp_f32 v102, v98 clamp
    v_max_f32 v98, s48, v98
    v_exp_f32 v103, v99 clamp
    v_max_f32 v99, s48, v99
    v_pk_fma_f32 v[104:105], v[84:85], v[48:49], v[104:105]
    v_pk_fma_f32 v[106:107], v[86:87], v[50:51], v[106:107]
    v_pk_fma_f32 v[96:97], v[96:97], s[48:49], v[100:101] op_sel:[0,1,0] op_sel_hi:[1,1,1]
    v_pk_fma_f32 v[98:99], v[98:99], s[48:49], v[102:103] op_sel:[0,1,0] op_sel_hi:[1,1,1]
    v_cvt_pk_bf16_f32 v126, v104, v105
    v_cvt_pk_bf16_f32 v127, v106, v107
    v_cvt_pk_bf16_f32 v122, v96, v97
    v_cvt_pk_bf16_f32 v123, v98, v99
    s_nop 1
    v_mfma_f32_16x16x32_bf16 v[92:95], v[120:123], v[112:115], v[92:95]
    v_mfma_f32_16x16x32_bf16 v[88:91], v[120:123], v[124:127], v[88:91]
    s_cbranch_vccnz Lslow
    v_mov_b32 v99, v5
    s_lshl_b32 s31, s28, 10
    s_add_u32 s31, s31, s39
    s_add_u32 s31, s31, 0
    s_nop 1
    v_cvt_pk_bf16_f32 v100, v92, v93
    v_cvt_pk_bf16_f32 v101, v94, v95
    v_cvt_pk_bf16_f32 v96, v88, v89
    v_cvt_pk_bf16_f32 v97, v90, v91
    v_cndmask_b32 v98, v100, v101, s[52:53]
    buffer_store_dwordx4 v[96:99], v0, s[4:7], s31 offen
    s_sleep 2
    s_cmp_lg_u32 s24, s28
    s_cbranch_scc1 Lskip14
    s_add_u32 s31, s39, 0
    buffer_load_dwordx4 v[68:71], v0, s[4:7], s31 offen offset:0 sc1
    buffer_load_dwordx4 v[72:75], v0, s[4:7], s31 offen offset:1024 sc1
    buffer_load_dwordx4 v[76:79], v0, s[4:7], s31 offen offset:2048 sc1
    buffer_load_dwordx4 v[80:83], v0, s[4:7], s31 offen offset:3072 sc1
Lskip14:
    buffer_store_dword v5, v4, s[4:7], s18 offen offset:0
    s_cmp_lg_u32 s24, s28
    s_cbranch_scc1 Lskip15
    s_waitcnt vmcnt(4)
    v_cmp_ne_u32 s[54:55], s29, v71
    s_waitcnt vmcnt(3)
    v_cmp_ne_u32 s[56:57], s29, v75
    s_nop 0
    s_or_b64 s[54:55], s[54:55], s[56:57]
    s_waitcnt vmcnt(2)
    v_cmp_ne_u32 s[56:57], s29, v79
    s_nop 0
    s_or_b64 s[54:55], s[54:55], s[56:57]
    s_waitcnt vmcnt(1)
    v_cmp_ne_u32 s[56:57], s29, v83
    s_nop 0
    s_or_b64 s[54:55], s[54:55], s[56:57]
    s_cmp_lg_u64 s[54:55], 0
    s_cbranch_scc1 Lrare16
Lrare16b:
    v_lshlrev_b32 v84, 16, v68
    v_and_b32 v85, 0xffff0000, v68
    v_lshlrev_b32 v86, 16, v69
    v_and_b32 v87, 0xffff0000, v69
    v_lshlrev_b32 v28, 16, v70
    v_and_b32 v29, 0xffff0000, v70
    v_dot2_f32_bf16 v84, v72, s46, v84
    v_dot2_f32_bf16 v85, v72, s47, v85
    v_dot2_f32_bf16 v86, v73, s46, v86
    v_dot2_f32_bf16 v87, v73, s47, v87
    v_dot2_f32_bf16 v28, v74, s46, v28
    v_dot2_f32_bf16 v29, v74, s47, v29
    v_dot2_f32_bf16 v84, v76, s46, v84
    v_dot2_f32_bf16 v85, v76, s47, v85
    v_dot2_f32_bf16 v86, v77, s46, v86
    v_dot2_f32_bf16 v87, v77, s47, v87
    v_dot2_f32_bf16 v28, v78, s46, v28
    v_dot2_f32_bf16 v29, v78, s47, v29
    v_dot2_f32_bf16 v84, v80, s46, v84
    v_dot2_f32_bf16 v85, v80, s47, v85
    v_dot2_f32_bf16 v86, v81, s46, v86
    v_dot2_f32_bf16 v87, v81, s47, v87
    v_dot2_f32_bf16 v28, v82, s46, v28
    v_dot2_f32_bf16 v29, v82, s47, v29
    s_lshl_b32 s31, s27, 10
    s_add_u32 s31, s31, s40
    s_add_u32 s31, s31, 0
    v_cvt_pk_bf16_f32 v68, v84, v85
    v_cvt_pk_bf16_f32 v69, v86, v87
    v_cvt_pk_bf16_f32 v70, v28, v29
    buffer_store_dwordx4 v[68:71], v0, s[4:7], s31 offen sc1
Lskip15:
    s_add_u32 s30, s71, 0
    buffer_load_dwordx4 v[128:131], v0, s[4:7], s30 offen offset:0 sc1
    buffer_load_dwordx4 v[132:135], v0, s[4:7], s30 offen offset:1024 sc1
    buffer_load_dwordx4 v[136:139], v0, s[4:7], s30 offen offset:2048 sc1
    buffer_load_dwordx4 v[140:143], v0, s[4:7], s30 offen offset:3072 sc1
    s_add_u32 s30, s71, 4096
    buffer_load_dwordx4 v[144:147], v0, s[4:7], s30 offen offset:0 sc1
    buffer_load_dwordx4 v[148:151], v0, s[4:7], s30 offen offset:1024 sc1
    buffer_load_dwordx4 v[152:155], v0, s[4:7], s30 offen offset:2048 sc1
    buffer_load_dwordx4 v[156:159], v0, s[4:7], s30 offen offset:3072 sc1
    s_cmp_eq_u32 s35, 1
    s_cbranch_scc1 Lskip18
    ds_read_b64_tr_b16 a[16:17], v108 offset:0
    ds_read_b64_tr_b16 a[18:19], v108 offset:512
    ds_read_b64_tr_b16 a[20:21], v108 offset:32
    ds_read_b64_tr_b16 a[22:23], v108 offset:544
    ds_read_b64_tr_b16 a[24:25], v108 offset:64
    ds_read_b64_tr_b16 a[26:27], v108 offset:576
    ds_read_b64_tr_b16 a[28:29], v108 offset:96
    ds_read_b64_tr_b16 a[30:31], v108 offset:608
    s_waitcnt lgkmcnt(0)
Lskip18:
    s_cmp_eq_u32 s35, 1
    s_cbranch_scc0 Lskip19
    ds_read_b64_tr_b16 a[16:17], v109 offset:0
    ds_read_b64_tr_b16 a[18:19], v109 offset:2048
    ds_read_b64_tr_b16 a[20:21], v109 offset:8
    ds_read_b64_tr_b16 a[22:23], v109 offset:2056
    ds_read_b64_tr_b16 a[24:25], v109 offset:64
    ds_read_b64_tr_b16 a[26:27], v109 offset:2112
    ds_read_b64_tr_b16 a[28:29], v109 offset:72
    ds_read_b64_tr_b16 a[30:31], v109 offset:2120
    s_waitcnt lgkmcnt(0)
Lskip19:
    buffer_store_dwordx4 a[16:19], v0, s[4:7], s64 offen sc1
    s_add_u32 s64, s64, s65
    buffer_store_dwordx4 a[20:23], v0, s[4:7], s64 offen sc1
    s_add_u32 s64, s64, s65
    buffer_store_dwordx4 a[24:27], v0, s[4:7], s64 offen sc1
    s_add_u32 s64, s64, s65
    buffer_store_dwordx4 a[28:31], v0, s[4:7], s64 offen sc1
    s_add_u32 s30, s71, 8192
    buffer_load_dwordx4 v[160:163], v0, s[4:7], s30 offen offset:0 sc1
    buffer_load_dwordx4 v[164:167], v0, s[4:7], s30 offen offset:1024 sc1
    buffer_load_dwordx4 v[168:171], v0, s[4:7], s30 offen offset:2048 sc1
    buffer_load_dwordx4 v[172:175], v0, s[4:7], s30 offen offset:3072 sc1
    s_add_u32 s30, s71, 12288
    buffer_load_dwordx4 v[176:179], v0, s[4:7], s30 offen offset:0 sc1
    buffer_load_dwordx4 v[180:183], v0, s[4:7], s30 offen offset:1024 sc1
    buffer_load_dwordx4 v[184:187], v0, s[4:7], s30 offen offset:2048 sc1
    buffer_load_dwordx4 v[188:191], v0, s[4:7], s30 offen offset:3072 sc1
    s_lshl_b32 s31, s24, 6
    v_add_u32 v30, s31, v1
    ds_read_b128 v[32:35], v116 offset:0
    ds_read_b128 v[36:39], v117 offset:0
    ds_read_b128 v[40:43], v118 offset:0
    ds_read_b128 v[44:47], v119 offset:0
    ds_read_b128 v[48:51], v116 offset:4096
    ds_read_b128 v[52:55], v117 offset:4096
    ds_read_b128 v[56:59], v118 offset:4096
    ds_read_b32 v88, v2 offset:256
    ds_read_b32 v89, v2 offset:512
    ds_read_b32 v90, v2 offset:320
    ds_read_b32 v91, v2 offset:576
    s_waitcnt vmcnt(19) lgkmcnt(10)
    v_mfma_f32_16x16x32_bf16 v[96:99], v[128:131], v[32:35], 0
    s_add_u32 s51, s33, 0
    s_and_b32 s51, s51, 0x3fff
    s_lshl_b32 s30, s41, 2
    s_add_u32 s30, s30, s51
    s_add_u32 m0, s30, 65536
    s_add_u32 s30, s71, s51
    s_add_u32 s30, s30, 65536
    buffer_load_dwordx4 v0, s[4:7], s30 offen offset:0 sc1 lds
    ds_read_b128 v[60:63], v119 offset:4096
    v_mfma_f32_16x16x32_bf16 v[92:95], v[128:131], v[112:115], 0
    s_waitcnt vmcnt(19) lgkmcnt(10)
    v_mfma_f32_16x16x32_bf16 v[96:99], v[132:135], v[36:39], v[96:99]
    ds_read_b128 v[32:35], v116 offset:8192
    v_mfma_f32_16x16x32_bf16 v[92:95], v[132:135], v[112:115], v[92:95]
    s_waitcnt vmcnt(18) lgkmcnt(10)
    buffer_load_dwordx4 v0, s[4:7], s30 offen offset:1024 sc1 lds
    v_mfma_f32_16x16x32_bf16 v[96:99], v[136:139], v[40:43], v[96:99]
    ds_read_b128 v[36:39], v117 offset:8192
    v_mfma_f32_16x16x32_bf16 v[92:95], v[136:139], v[112:115], v[92:95]
    s_waitcnt vmcnt(18) lgkmcnt(10)
    v_mfma_f32_16x16x32_bf16 v[96:99], v[140:143], v[44:47], v[96:99]
    buffer_load_dwordx4 v0, s[4:7], s30 offen offset:2048 sc1 lds
    ds_read_b128 v[40:43], v118 offset:8192
    v_mfma_f32_16x16x32_bf16 v[92:95], v[140:143], v[112:115], v[92:95]
    s_waitcnt vmcnt(18) lgkmcnt(10)
    v_mfma_f32_16x16x32_bf16 v[96:99], v[144:147], v[48:51], v[96:99]
    ds_read_b128 v[44:47], v119 offset:8192
    v_mfma_f32_16x16x32_bf16 v[92:95], v[144:147], v[112:115], v[92:95]
    s_waitcnt vmcnt(17) lgkmcnt(10)
    buffer_load_dwordx4 v0, s[4:7], s30 offen offset:3072 sc1 lds
    v_mfma_f32_16x16x32_bf16 v[96:99], v[148:151], v[52:55], v[96:99]
    ds_read_b128 v[48:51], v116 offset:12288
    v_mfma_f32_16x16x32_bf16 v[92:95], v[148:151], v[112:115], v[92:95]
    s_waitcnt vmcnt(17) lgkmcnt(10)
    v_mfma_f32_16x16x32_bf16 v[96:99], v[152:155], v[56:59], v[96:99]
    s_add_u32 s51, s33, 4096
    s_and_b32 s51, s51, 0x3fff
    s_lshl_b32 s30, s41, 2
    s_add_u32 s30, s30, s51
    s_add_u32 m0, s30, 65536
    s_add_u32 s30, s71, s51
    s_add_u32 s30, s30, 65536
    buffer_load_dwordx4 v0, s[4:7], s30 offen offset:0 sc1 lds
    ds_read_b128 v[52:55], v117 offset:12288
    v_mfma_f32_16x16x32_bf16 v[92:95], v[152:155], v[112:115], v[92:95]
    s_waitcnt vmcnt(17) lgkmcnt(6)
    v_mfma_f32_16x16x32_bf16 v[96:99], v[156:159], v[60:63], v[96:99]
    ds_read_b128 v[56:59], v118 offset:12288
    v_mfma_f32_16x16x32_bf16 v[92:95], v[156:159], v[112:115], v[92:95]
    s_waitcnt vmcnt(12) lgkmcnt(6)
    buffer_load_dwordx4 v0, s[4:7], s30 offen offset:1024 sc1 lds
    v_mfma_f32_16x16x32_bf16 v[96:99], v[160:163], v[32:35], v[96:99]
    ds_read_b128 v[60:63], v119 offset:12288
    v_mfma_f32_16x16x32_bf16 v[92:95], v[160:163], v[112:115], v[92:95]
    s_waitcnt vmcnt(12) lgkmcnt(6)
    v_mfma_f32_16x16x32_bf16 v[96:99], v[164:167], v[36:39], v[96:99]
    buffer_load_dwordx4 v0, s[4:7], s30 offen offset:2048 sc1 lds
    ds_read_b128 v[32:35], v116 offset:16384
    v_mfma_f32_16x16x32_bf16 v[92:95], v[164:167], v[112:115], v[92:95]
    s_waitcnt vmcnt(12) lgkmcnt(6)
    v_mfma_f32_16x16x32_bf16 v[96:99], v[168:171], v[40:43], v[96:99]
    ds_read_b128 v[36:39], v117 offset:16384
    v_mfma_f32_16x16x32_bf16 v[92:95], v[168:171], v[112:115], v[92:95]
    s_waitcnt vmcnt(11) lgkmcnt(6)
    buffer_load_dwordx4 v0, s[4:7], s30 offen offset:3072 sc1 lds
    v_mfma_f32_16x16x32_bf16 v[96:99], v[172:175], v[44:47], v[96:99]
    ds_read_b128 v[40:43], v118 offset:16384
    v_mfma_f32_16x16x32_bf16 v[92:95], v[172:175], v[112:115], v[92:95]
    s_waitcnt vmcnt(11) lgkmcnt(6)
    v_mfma_f32_16x16x32_bf16 v[96:99], v[176:179], v[48:51], v[96:99]
    buffer_store_dword v5, v4, s[4:7], s101 offen sc1
    s_add_u32 s51, s33, 8192
    s_and_b32 s51, s51, 0x3fff
    s_lshl_b32 s30, s41, 2
    s_add_u32 s30, s30, s51
    s_add_u32 m0, s30, 65536
    s_add_u32 s30, s71, s51
    s_add_u32 s30, s30, 65536
    buffer_load_dwordx4 v0, s[4:7], s30 offen offset:0 sc1 lds
    ds_read_b128 v[44:47], v119 offset:16384
    v_mfma_f32_16x16x32_bf16 v[92:95], v[176:179], v[112:115], v[92:95]
    s_waitcnt vmcnt(12) lgkmcnt(6)
    v_mfma_f32_16x16x32_bf16 v[96:99], v[180:183], v[52:55], v[96:99]
    ds_read_b128 v[48:51], v116 offset:20480
    v_mfma_f32_16x16x32_bf16 v[92:95], v[180:183], v[112:115], v[92:95]
    s_waitcnt vmcnt(11) lgkmcnt(6)
    buffer_load_dwordx4 v0, s[4:7], s30 offen offset:1024 sc1 lds
    v_mfma_f32_16x16x32_bf16 v[96:99], v[184:187], v[56:59], v[96:99]
    ds_read_b128 v[52:55], v117 offset:20480
    v_mfma_f32_16x16x32_bf16 v[92:95], v[184:187], v[112:115], v[92:95]
    s_waitcnt vmcnt(11) lgkmcnt(6)
    v_mfma_f32_16x16x32_bf16 v[96:99], v[188:191], v[60:63], v[96:99]
    buffer_load_dwordx4 v0, s[4:7], s30 offen offset:2048 sc1 lds
    ds_read_b128 v[56:59], v118 offset:20480
    v_mfma_f32_16x16x32_bf16 v[92:95], v[188:191], v[112:115], v[92:95]
    s_waitcnt lgkmcnt(6)
    v_mfma_f32_16x16x32_bf16 v[100:103], v[128:131], v[32:35], 0
    s_waitcnt lgkmcnt(5)
    ds_read_b128 v[60:63], v119 offset:20480
    v_mfma_f32_16x16x32_bf16 v[100:103], v[132:135], v[36:39], v[100:103]
    s_waitcnt lgkmcnt(5)
    buffer_load_dwordx4 v0, s[4:7], s30 offen offset:3072 sc1 lds
    ds_read_b128 v[32:35], v116 offset:24576
    v_mfma_f32_16x16x32_bf16 v[100:103], v[136:139], v[40:43], v[100:103]
    s_waitcnt lgkmcnt(5)
    ds_read_b128 v[36:39], v117 offset:24576
    v_mfma_f32_16x16x32_bf16 v[100:103], v[140:143], v[44:47], v[100:103]
    s_waitcnt lgkmcnt(5)
    ds_read_b128 v[40:43], v118 offset:24576
    v_mul_f32 v92, s50, v92
    v_mfma_f32_16x16x32_bf16 v[100:103], v[144:147], v[48:51], v[100:103]
    s_waitcnt lgkmcnt(5)
    s_add_u32 s51, s33, 12288
    s_and_b32 s51, s51, 0x3fff
    s_lshl_b32 s30, s41, 2
    s_add_u32 s30, s30, s51
    s_add_u32 m0, s30, 65536
    s_add_u32 s30, s71, s51
    s_add_u32 s30, s30, 65536
    buffer_load_dwordx4 v0, s[4:7], s30 offen offset:0 sc1 lds
    ds_read_b128 v[44:47], v119 offset:24576
    v_mfma_f32_16x16x32_bf16 v[100:103], v[148:151], v[52:55], v[100:103]
    s_waitcnt lgkmcnt(5)
    ds_read_b128 v[48:51], v116 offset:28672
    v_mul_f32 v93, s50, v93
    v_mfma_f32_16x16x32_bf16 v[100:103], v[152:155], v[56:59], v[100:103]
    s_waitcnt lgkmcnt(5)
    ds_read_b128 v[52:55], v117 offset:28672
    v_mul_f32 v94, s50, v94
    v_mfma_f32_16x16x32_bf16 v[100:103], v[156:159], v[60:63], v[100:103]
    s_waitcnt lgkmcnt(5)
    buffer_load_dwordx4 v0, s[4:7], s30 offen offset:1024 sc1 lds
    ds_read_b128 v[56:59], v118 offset:28672
    v_mfma_f32_16x16x32_bf16 v[100:103], v[160:163], v[32:35], v[100:103]
    s_waitcnt lgkmcnt(5)
    ds_read_b128 v[60:63], v119 offset:28672
    v_mul_f32 v95, s50, v95
    v_mfma_f32_16x16x32_bf16 v[100:103], v[164:167], v[36:39], v[100:103]
    s_waitcnt lgkmcnt(5)
    ds_read_b128 v[32:35], v116 offset:32768
    v_mfma_f32_16x16x32_bf16 v[100:103], v[168:171], v[40:43], v[100:103]
    s_waitcnt lgkmcnt(5)
    buffer_load_dwordx4 v0, s[4:7], s30 offen offset:2048 sc1 lds
    ds_read_b128 v[36:39], v117 offset:32768
    v_mfma_f32_16x16x32_bf16 v[100:103], v[172:175], v[44:47], v[100:103]
    s_waitcnt lgkmcnt(5)
    ds_read_b128 v[40:43], v118 offset:32768
    v_mfma_f32_16x16x32_bf16 v[100:103], v[176:179], v[48:51], v[100:103]
    s_waitcnt lgkmcnt(5)
    ds_read_b128 v[44:47], v119 offset:32768
    v_mfma_f32_16x16x32_bf16 v[100:103], v[180:183], v[52:55], v[100:103]
    s_waitcnt lgkmcnt(5)
    buffer_load_dwordx4 v0, s[4:7], s30 offen offset:3072 sc1 lds
    ds_read_b128 v[48:51], v116 offset:36864
    v_mfma_f32_16x16x32_bf16 v[100:103], v[184:187], v[56:59], v[100:103]
    s_waitcnt lgkmcnt(5)
    ds_read_b128 v[52:55], v117 offset:36864
    v_mfma_f32_16x16x32_bf16 v[100:103], v[188:191], v[60:63], v[100:103]
    s_waitcnt lgkmcnt(5)
    ds_read_b128 v[56:59], v118 offset:36864
    v_mfma_f32_16x16x32_bf16 v[104:107], v[128:131], v[32:35], 0
    s_waitcnt lgkmcnt(5)
    s_lshl_b32 s30, s25, 13
    s_add_u32 s30, s30, s32
    s_cmp_eq_u32 s24, 1
    s_cselect_b32 s51, 131072, 0
    s_cmp_eq_u32 s24, 2
    s_cselect_b32 s51, 720896, s51
    s_add_u32 s30, s30, s51
    s_cmp_ge_u32 s25, 2
    s_cselect_b32 s51, 2, 9
    s_cmp_eq_u32 s24, s51
    s_cselect_b32 s30, 0x40000000, s30
    s_cmp_eq_u32 s24, 3
    s_cselect_b32 s30, 0x40000000, s30
    s_mov_b32 m0, 163328
    v_lshlrev_b32 v31, 3, v0
    buffer_load_dword v31, s[4:7], s30 offen lds
    ds_read_b128 v[60:63], v119 offset:36864
    v_mfma_f32_16x16x32_bf16 v[104:107], v[132:135], v[36:39], v[104:107]
    s_waitcnt lgkmcnt(5)
    ds_read_b128 v[32:35], v116 offset:40960
    ds_write_b128 v30, v[92:95] offset:2816
    v_fma_f32 v120, v88, v92, s48
    v_fma_f32 v121, v88, v93, s48
    v_fma_f32 v122, v88, v94, s48
    v_fma_f32 v123, v88, v95, s48
    v_fma_f32 v120, v96, v89, v120
    v_fma_f32 v121, v97, v89, v121
    v_fma_f32 v122, v98, v89, v122
    v_fma_f32 v123, v99, v89, v123
    v_exp_f32 v124, v120 clamp
    v_max_f32 v120, s48, v120
    v_exp_f32 v125, v121 clamp
    v_max_f32 v121, s48, v121
    v_exp_f32 v126, v122 clamp
    v_max_f32 v122, s48, v122
    v_exp_f32 v127, v123 clamp
    v_max_f32 v123, s48, v123
    v_fma_f32 v120, v120, s49, v124
    v_fma_f32 v121, v121, s49, v125
    v_fma_f32 v122, v122, s49, v126
    v_fma_f32 v123, v123, s49, v127
    v_cvt_pk_bf16_f32 v64, v120, v121
    v_cvt_pk_bf16_f32 v65, v122, v123
    ds_read_b32 v88, v2 offset:384
    ds_read_b32 v89, v2 offset:640
    v_mfma_f32_16x16x32_bf16 v[104:107], v[136:139], v[40:43], v[104:107]
    s_waitcnt lgkmcnt(8)
    ds_read_b128 v[36:39], v117 offset:40960
    v_mfma_f32_16x16x32_bf16 v[104:107], v[140:143], v[44:47], v[104:107]
    s_waitcnt lgkmcnt(8)
    ds_read_b128 v[40:43], v118 offset:40960
    v_fma_f32 v120, v90, v92, s48
    v_mfma_f32_16x16x32_bf16 v[104:107], v[144:147], v[48:51], v[104:107]
    s_waitcnt lgkmcnt(8)
    ds_read_b128 v[44:47], v119 offset:40960
    v_fma_f32 v121, v90, v93, s48
    v_mfma_f32_16x16x32_bf16 v[104:107], v[148:151], v[52:55], v[104:107]
    s_waitcnt lgkmcnt(8)
    ds_read_b128 v[48:51], v116 offset:45056
    v_fma_f32 v122, v90, v94, s48
    v_mfma_f32_16x16x32_bf16 v[104:107], v[152:155], v[56:59], v[104:107]
    s_waitcnt lgkmcnt(8)
    ds_read_b128 v[52:55], v117 offset:45056
    v_fma_f32 v123, v90, v95, s48
    v_mfma_f32_16x16x32_bf16 v[104:107], v[156:159], v[60:63], v[104:107]
    s_waitcnt lgkmcnt(8)
    ds_read_b128 v[56:59], v118 offset:45056
    v_fma_f32 v120, v100, v91, v120
    v_mfma_f32_16x16x32_bf16 v[104:107], v[160:163], v[32:35], v[104:107]
    s_waitcnt lgkmcnt(5)
    ds_read_b128 v[60:63], v119 offset:45056
    v_fma_f32 v121, v101, v91, v121
    v_mfma_f32_16x16x32_bf16 v[104:107], v[164:167], v[36:39], v[104:107]
    s_waitcnt lgkmcnt(5)
    ds_read_b128 v[32:35], v116 offset:49152
    v_fma_f32 v122, v102, v91, v122
    v_mfma_f32_16x16x32_bf16 v[104:107], v[168:171], v[40:43], v[104:107]
    s_waitcnt lgkmcnt(5)
    ds_read_b128 v[36:39], v117 offset:49152
    v_fma_f32 v123, v103, v91, v123
    v_mfma_f32_16x16x32_bf16 v[104:107], v[172:175], v[44:47], v[104:107]
    s_waitcnt lgkmcnt(5)
    ds_read_b128 v[40:43], v118 offset:49152
    v_exp_f32 v124, v120 clamp
    v_mfma_f32_16x16x32_bf16 v[104:107], v[176:179], v[48:51], v[104:107]
    s_waitcnt lgkmcnt(5)
    ds_read_b128 v[44:47], v119 offset:49152
    v_max_f32 v120, s48, v120
    v_mfma_f32_16x16x32_bf16 v[104:107], v[180:183], v[52:55], v[104:107]
    s_waitcnt lgkmcnt(5)
    ds_read_b128 v[48:51], v116 offset:53248
    v_exp_f32 v125, v121 clamp
    v_mfma_f32_16x16x32_bf16 v[104:107], v[184:187], v[56:59], v[104:107]
    s_waitcnt lgkmcnt(5)
    ds_read_b128 v[52:55], v117 offset:53248
    v_max_f32 v121, s48, v121
    v_mfma_f32_16x16x32_bf16 v[104:107], v[188:191], v[60:63], v[104:107]
    s_waitcnt lgkmcnt(5)
    ds_read_b128 v[56:59], v118 offset:53248
    v_exp_f32 v126, v122 clamp
    v_mfma_f32_16x16x32_bf16 v[108:111], v[128:131], v[32:35], 0
    s_waitcnt lgkmcnt(5)
    ds_read_b128 v[60:63], v119 offset:53248
    v_max_f32 v122, s48, v122
    v_mfma_f32_16x16x32_bf16 v[108:111], v[132:135], v[36:39], v[108:111]
    s_waitcnt lgkmcnt(5)
    ds_read_b128 v[32:35], v116 offset:57344
    v_exp_f32 v127, v123 clamp
    v_max_f32 v123, s48, v123
    v_fma_f32 v120, v120, s49, v124
    v_fma_f32 v121, v121, s49, v125
    v_fma_f32 v122, v122, s49, v126
    v_fma_f32 v123, v123, s49, v127
    v_cvt_pk_bf16_f32 v66, v120, v121
    v_cvt_pk_bf16_f32 v67, v122, v123
    ds_read_b32 v90, v2 offset:448
    ds_read_b32 v91, v2 offset:704
    v_mfma_f32_16x16x32_bf16 v[108:111], v[136:139], v[40:43], v[108:111]
    s_waitcnt lgkmcnt(7)
    ds_read_b128 v[36:39], v117 offset:57344
    v_mfma_f32_16x16x32_bf16 v[108:111], v[140:143], v[44:47], v[108:111]
    s_waitcnt lgkmcnt(7)
    ds_read_b128 v[40:43], v118 offset:57344
    v_fma_f32 v120, v88, v92, s48
    v_mfma_f32_16x16x32_bf16 v[108:111], v[144:147], v[48:51], v[108:111]
    s_waitcnt lgkmcnt(7)
    ds_read_b128 v[44:47], v119 offset:57344
    v_fma_f32 v121, v88, v93, s48
    v_mfma_f32_16x16x32_bf16 v[108:111], v[148:151], v[52:55], v[108:111]
    s_waitcnt lgkmcnt(7)
    ds_read_b128 v[48:51], v116 offset:61440
    v_fma_f32 v122, v88, v94, s48
    v_mfma_f32_16x16x32_bf16 v[108:111], v[152:155], v[56:59], v[108:111]
    s_waitcnt lgkmcnt(7)
    ds_read_b128 v[52:55], v117 offset:61440
    v_fma_f32 v123, v88, v95, s48
    v_mfma_f32_16x16x32_bf16 v[108:111], v[156:159], v[60:63], v[108:111]
    s_waitcnt lgkmcnt(7)
    ds_read_b128 v[56:59], v118 offset:61440
    v_fma_f32 v120, v104, v89, v120
    v_mfma_f32_16x16x32_bf16 v[108:111], v[160:163], v[32:35], v[108:111]
    s_waitcnt lgkmcnt(5)
    ds_read_b128 v[60:63], v119 offset:61440
    v_fma_f32 v121, v105, v89, v121
    v_mfma_f32_16x16x32_bf16 v[108:111], v[164:167], v[36:39], v[108:111]
    s_waitcnt lgkmcnt(5)
    v_fma_f32 v122, v106, v89, v122
    v_fma_f32 v123, v107, v89, v123
    v_mfma_f32_16x16x32_bf16 v[108:111], v[168:171], v[40:43], v[108:111]
    s_waitcnt lgkmcnt(4)
    v_exp_f32 v124, v120 clamp
    v_mfma_f32_16x16x32_bf16 v[108:111], v[172:175], v[44:47], v[108:111]
    s_waitcnt lgkmcnt(3)
    v_max_f32 v120, s48, v120
    v_exp_f32 v125, v121 clamp
    v_mfma_f32_16x16x32_bf16 v[108:111], v[176:179], v[48:51], v[108:111]
    s_waitcnt lgkmcnt(2)
    v_max_f32 v121, s48, v121
    v_exp_f32 v126, v122 clamp
    v_mfma_f32_16x16x32_bf16 v[108:111], v[180:183], v[52:55], v[108:111]
    s_waitcnt lgkmcnt(1)
    v_max_f32 v122, s48, v122
    v_exp_f32 v127, v123 clamp
    v_mfma_f32_16x16x32_bf16 v[108:111], v[184:187], v[56:59], v[108:111]
    s_waitcnt lgkmcnt(0)
    v_max_f32 v123, s48, v123
    v_fma_f32 v120, v120, s49, v124
    v_mfma_f32_16x16x32_bf16 v[108:111], v[188:191], v[60:63], v[108:111]
    v_fma_f32 v121, v121, s49, v125
    v_fma_f32 v122, v122, s49, v126
    v_fma_f32 v123, v123, s49, v127
    v_cvt_pk_bf16_f32 v68, v120, v121
    v_cvt_pk_bf16_f32 v69, v122, v123
    v_pk_fma_f32 v[120:121], v[92:93], v[90:91], s[48:49] op_sel_hi:[1,0,0]
    v_pk_fma_f32 v[122:123], v[94:95], v[90:91], s[48:49] op_sel_hi:[1,0,0]
    s_nop 0
    v_pk_fma_f32 v[120:121], v[108:109], v[90:91], v[120:121] op_sel:[0,1,0] op_sel_hi:[1,1,1]
    v_pk_fma_f32 v[122:123], v[110:111], v[90:91], v[122:123] op_sel:[0,1,0] op_sel_hi:[1,1,1]
    v_exp_f32 v124, v120 clamp
    v_max_f32 v120, s48, v120
    v_exp_f32 v125, v121 clamp
    v_max_f32 v121, s48, v121
    v_exp_f32 v126, v122 clamp
    v_max_f32 v122, s48, v122
    v_exp_f32 v127, v123 clamp
    v_max_f32 v123, s48, v123
    v_pk_fma_f32 v[120:121], v[120:121], s[48:49], v[124:125] op_sel:[0,1,0] op_sel_hi:[1,1,1]
    v_pk_fma_f32 v[122:123], v[122:123], s[48:49], v[126:127] op_sel:[0,1,0] op_sel_hi:[1,1,1]
    v_cvt_pk_bf16_f32 v70, v120, v121
    v_cvt_pk_bf16_f32 v71, v122, v123
    v_mov_b32 v72, 0x358637bd
    v_mov_b32 v73, 0x358637bd
    v_mov_b32 v74, 0x358637bd
    v_mov_b32 v75, 0x358637bd
    s_and_b32 s31, s24, 1
    s_lshl_b32 s31, s31, 11
    s_add_u32 s31, s31, 65536
    v_add_u32 v30, s31, v0
    s_waitcnt vmcnt(1)
    s_barrier
    buffer_load_dword v31, v3, s[4:7], s37 offen offset:0 sc1
    ds_read_b128 v[96:99], v30 offset:0
    ds_read_b128 v[100:103], v30 offset:1024
    ds_read_b128 v[104:107], v30 offset:4096
    ds_read_b128 v[108:111], v30 offset:5120
    ds_read_b128 v[112:115], v30 offset:8192
    ds_read_b128 v[116:119], v30 offset:9216
    ds_read_b128 v[120:123], v30 offset:16384
    ds_read_b128 v[124:127], v30 offset:17408
    ds_read_b128 v[128:131], v30 offset:20480
    ds_read_b128 v[132:135], v30 offset:21504
    ds_read_b128 v[136:139], v30 offset:24576
    ds_read_b128 v[140:143], v30 offset:25600
    s_sleep 6
    s_add_u32 s31, s40, 0
    buffer_load_dwordx4 v[32:35], v0, s[4:7], s31 offen offset:0 sc1
    buffer_load_dwordx4 v[36:39], v0, s[4:7], s31 offen offset:1024 sc1
    buffer_load_dwordx4 v[40:43], v0, s[4:7], s31 offen offset:2048 sc1
    buffer_load_dwordx4 v[44:47], v0, s[4:7], s31 offen offset:3072 sc1
    s_add_u32 s31, s40, 4096
    buffer_load_dwordx4 v[48:51], v0, s[4:7], s31 offen offset:0 sc1
    buffer_load_dwordx4 v[52:55], v0, s[4:7], s31 offen offset:1024 sc1
    buffer_load_dwordx4 v[56:59], v0, s[4:7], s31 offen offset:2048 sc1
    buffer_load_dwordx4 v[60:63], v0, s[4:7], s31 offen offset:3072 sc1
    ds_read_b128 v[144:147], v30 offset:32768
    ds_read_b128 v[148:151], v30 offset:33792
    ds_read_b128 v[152:155], v30 offset:36864
    ds_read_b128 v[156:159], v30 offset:37888
    ds_read_b128 v[160:163], v30 offset:40960
    ds_read_b128 v[164:167], v30 offset:41984
    ds_read_b128 v[168:171], v30 offset:49152
    ds_read_b128 v[172:175], v30 offset:50176
    ds_read_b128 v[176:179], v30 offset:53248
    ds_read_b128 v[180:183], v30 offset:54272
    ds_read_b128 v[184:187], v30 offset:57344
    ds_read_b128 v[188:191], v30 offset:58368
    s_waitcnt vmcnt(7)
    v_lshlrev_b32 v76, 16, v32
    v_and_b32 v77, 0xffff0000, v32
    v_lshlrev_b32 v78, 16, v33
    v_and_b32 v79, 0xffff0000, v33
    v_lshlrev_b32 v80, 16, v34
    v_and_b32 v81, 0xffff0000, v34
    v_xor_b32 v28, s29, v35
    s_waitcnt vmcnt(6)
    v_dot2c_f32_bf16 v76, s46, v36
    v_dot2c_f32_bf16 v77, s47, v36
    v_dot2c_f32_bf16 v78, s46, v37
    v_dot2c_f32_bf16 v79, s47, v37
    v_dot2c_f32_bf16 v80, s46, v38
    v_dot2c_f32_bf16 v81, s47, v38
    v_bitop3_b32 v28, v5, v39, v28 bitop3:0xbe
    s_waitcnt vmcnt(5)
    v_dot2c_f32_bf16 v76, s46, v40
    v_dot2c_f32_bf16 v77, s47, v40
    v_dot2c_f32_bf16 v78, s46, v41
    v_dot2c_f32_bf16 v79, s47, v41
    v_dot2c_f32_bf16 v80, s46, v42
    v_dot2c_f32_bf16 v81, s47, v42
    v_bitop3_b32 v28, v5, v43, v28 bitop3:0xbe
    s_waitcnt vmcnt(4)
    v_dot2c_f32_bf16 v76, s46, v44
    v_dot2c_f32_bf16 v77, s47, v44
    v_dot2c_f32_bf16 v78, s46, v45
    v_dot2c_f32_bf16 v79, s47, v45
    v_dot2c_f32_bf16 v80, s46, v46
    v_dot2c_f32_bf16 v81, s47, v46
    v_bitop3_b32 v28, v5, v47, v28 bitop3:0xbe
    s_waitcnt vmcnt(3)
    v_dot2c_f32_bf16 v76, s46, v48
    v_dot2c_f32_bf16 v77, s47, v48
    v_dot2c_f32_bf16 v78, s46, v49
    v_dot2c_f32_bf16 v79, s47, v49
    v_dot2c_f32_bf16 v80, s46, v50
    v_dot2c_f32_bf16 v81, s47, v50
    v_bitop3_b32 v28, v5, v51, v28 bitop3:0xbe
    s_waitcnt vmcnt(2)
    v_dot2c_f32_bf16 v76, s46, v52
    v_dot2c_f32_bf16 v77, s47, v52
    v_dot2c_f32_bf16 v78, s46, v53
    v_dot2c_f32_bf16 v79, s47, v53
    v_dot2c_f32_bf16 v80, s46, v54
    v_dot2c_f32_bf16 v81, s47, v54
    v_bitop3_b32 v28, v5, v55, v28 bitop3:0xbe
    s_waitcnt vmcnt(1)
    v_dot2c_f32_bf16 v76, s46, v56
    v_dot2c_f32_bf16 v77, s47, v56
    v_dot2c_f32_bf16 v78, s46, v57
    v_dot2c_f32_bf16 v79, s47, v57
    v_dot2c_f32_bf16 v80, s46, v58
    v_dot2c_f32_bf16 v81, s47, v58
    v_bitop3_b32 v28, v5, v59, v28 bitop3:0xbe
    s_waitcnt vmcnt(0)
    v_dot2c_f32_bf16 v76, s46, v60
    v_dot2c_f32_bf16 v77, s47, v60
    v_dot2c_f32_bf16 v78, s46, v61
    v_dot2c_f32_bf16 v79, s47, v61
    v_dot2c_f32_bf16 v80, s46, v62
    v_dot2c_f32_bf16 v81, s47, v62
    v_bitop3_b32 v28, v5, v63, v28 bitop3:0xbe
    v_cmp_ne_u32 s[54:55], 0, v28
    s_nop 1
    s_cmp_lg_u64 s[54:55], 0
    s_cbranch_scc1 Lrare20
Lrare20b:
    v_cvt_pk_bf16_f32 v86, v80, v81
    v_cvt_pk_bf16_f32 v82, v76, v77
    v_cvt_pk_bf16_f32 v83, v78, v79
    v_mov_b32_dpp v84, v86 quad_perm:[0,0,2,2] row_mask:0xf bank_mask:0xf
    v_mov_b32_dpp v85, v86 quad_perm:[1,1,3,3] row_mask:0xf bank_mask:0xf
    s_add_u32 s31, s67, 0
    s_nop 0
    v_mfma_f32_16x16x16_bf16 v[32:35], v[84:85], v[64:65], v[72:75]
    v_mfma_f32_16x16x16_bf16 v[48:51], v[82:83], v[64:65], 0
    v_mfma_f32_16x16x16_bf16 v[36:39], v[84:85], v[66:67], v[72:75]
    v_mfma_f32_16x16x16_bf16 v[52:55], v[82:83], v[66:67], 0
    v_mfma_f32_16x16x16_bf16 v[40:43], v[84:85], v[68:69], v[72:75]
    v_mfma_f32_16x16x16_bf16 v[56:59], v[82:83], v[68:69], 0
    v_mfma_f32_16x16x16_bf16 v[44:47], v[84:85], v[70:71], v[72:75]
    v_mfma_f32_16x16x16_bf16 v[60:63], v[82:83], v[70:71], 0
    s_nop 0
    v_rcp_f32 v32, v32
    s_nop 0
    v_rcp_f32 v36, v36
    v_pk_mul_f32 v[48:49], v[48:49], v[32:33] op_sel_hi:[1,0]
    v_pk_mul_f32 v[50:51], v[50:51], v[32:33] op_sel_hi:[1,0]
    v_cvt_pk_bf16_f32 v88, v48, v49
    v_cvt_pk_bf16_f32 v89, v50, v51
    v_or_b32 v88, 1, v88
    buffer_store_dwordx2 v[88:89], v9, s[4:7], s31 offen
    s_add_u32 s31, s31, 16384
    v_rcp_f32 v40, v40
    v_pk_mul_f32 v[52:53], v[52:53], v[36:37] op_sel_hi:[1,0]
    v_pk_mul_f32 v[54:55], v[54:55], v[36:37] op_sel_hi:[1,0]
    v_cvt_pk_bf16_f32 v90, v52, v53
    v_cvt_pk_bf16_f32 v91, v54, v55
    v_or_b32 v90, 1, v90
    buffer_store_dwordx2 v[90:91], v9, s[4:7], s31 offen
    s_add_u32 s31, s31, 16384
    v_rcp_f32 v44, v44
    v_pk_mul_f32 v[56:57], v[56:57], v[40:41] op_sel_hi:[1,0]
    v_pk_mul_f32 v[58:59], v[58:59], v[40:41] op_sel_hi:[1,0]
    v_cvt_pk_bf16_f32 v92, v56, v57
    v_cvt_pk_bf16_f32 v93, v58, v59
    v_or_b32 v92, 1, v92
    buffer_store_dwordx2 v[92:93], v9, s[4:7], s31 offen
    s_add_u32 s31, s31, 16384
    v_pk_mul_f32 v[60:61], v[60:61], v[44:45] op_sel_hi:[1,0]
    v_pk_mul_f32 v[62:63], v[62:63], v[44:45] op_sel_hi:[1,0]
    v_cvt_pk_bf16_f32 v94, v60, v61
    v_cvt_pk_bf16_f32 v95, v62, v63
    v_or_b32 v94, 1, v94
    buffer_store_dwordx2 v[94:95], v9, s[4:7], s31 offen
    ds_read_b128 v[64:67], v30 offset:12288
    ds_read_b128 v[68:71], v30 offset:13312
    ds_read_b128 v[72:75], v30 offset:28672
    ds_read_b128 v[76:79], v30 offset:29696
    ds_read_b128 v[80:83], v30 offset:45056
    ds_read_b128 v[84:87], v30 offset:46080
    ds_read_b128 v[88:91], v30 offset:61440
    ds_read_b128 v[92:95], v30 offset:62464
    v_cmp_ne_u32 vcc, s29, v31
    s_cbranch_vccnz Lrare30
Lrare30b:
Lpf32:
    s_sub_u32 s66, s66, 1
    s_cbranch_scc1 Lbail
    v_lshrrev_b32 v34, 2, v0
    s_lshl_b32 s31, s25, 9
    s_add_u32 s31, s31, 8192
    buffer_load_dword v32, v34, s[4:7], s31 offen offset:128 sc1
    buffer_load_dword v33, v3, s[4:7], s31 offen offset:364 sc1
    s_waitcnt vmcnt(0)
    v_cmp_ne_u32 vcc, s29, v32
    v_cmp_ne_u32 s[56:57], s29, v33
    s_nop 0
    s_or_b64 vcc, vcc, s[56:57]
    s_cbranch_vccnz Lpf32
    s_add_u32 s51, s33, 0
    s_and_b32 s51, s51, 0x3fff
    s_lshl_b32 s30, s41, 3
    s_add_u32 s30, s30, s51
    s_add_u32 s30, s30, s72
    s_add_u32 s30, s30, 0
    buffer_load_dwordx4 a[0:3], v0, s[4:7], s30 offen offset:0 sc1
    buffer_load_dwordx4 a[4:7], v0, s[4:7], s30 offen offset:1024 sc1
    buffer_load_dwordx4 a[8:11], v0, s[4:7], s30 offen offset:2048 sc1
    buffer_load_dwordx4 a[12:15], v0, s[4:7], s30 offen offset:3072 sc1
    s_add_u32 s51, s33, 0
    s_and_b32 s51, s51, 0x3fff
    s_lshl_b32 s30, s41, 3
    s_add_u32 s30, s30, s51
    s_add_u32 s30, s30, s72
    s_add_u32 s30, s30, 16384
    buffer_load_dwordx4 a[64:67], v0, s[4:7], s30 offen offset:0 sc1
    buffer_load_dwordx4 a[68:71], v0, s[4:7], s30 offen offset:1024 sc1
    buffer_load_dwordx4 a[72:75], v0, s[4:7], s30 offen offset:2048 sc1
    buffer_load_dwordx4 a[76:79], v0, s[4:7], s30 offen offset:3072 sc1
    s_add_u32 s51, s33, 0
    s_and_b32 s51, s51, 0x3fff
    s_lshl_b32 s30, s41, 2
    s_add_u32 s30, s30, s51
    s_add_u32 s30, s30, s72
    s_add_u32 s30, s30, 131072
    buffer_load_dwordx4 a[128:131], v0, s[4:7], s30 offen offset:0 sc1
    buffer_load_dwordx4 a[132:135], v0, s[4:7], s30 offen offset:1024 sc1
    buffer_load_dwordx4 a[136:139], v0, s[4:7], s30 offen offset:2048 sc1
    buffer_load_dwordx4 a[140:143], v0, s[4:7], s30 offen offset:3072 sc1
    s_add_u32 s51, s33, 4096
    s_and_b32 s51, s51, 0x3fff
    s_lshl_b32 s30, s41, 3
    s_add_u32 s30, s30, s51
    s_add_u32 s30, s30, s72
    s_add_u32 s30, s30, 0
    buffer_load_dwordx4 a[16:19], v0, s[4:7], s30 offen offset:0 sc1
    buffer_load_dwordx4 a[20:23], v0, s[4:7], s30 offen offset:1024 sc1
    buffer_load_dwordx4 a[24:27], v0, s[4:7], s30 offen offset:2048 sc1
    buffer_load_dwordx4 a[28:31], v0, s[4:7], s30 offen offset:3072 sc1
    s_waitcnt lgkmcnt(0)
    s_barrier
    v_lshlrev_b32 v28, 7, v3
    v_and_b32 v28, 0x3c00, v28
    v_and_b32 v29, 4, v3
    v_lshl_add_u32 v28, v29, 1, v28
    s_add_u32 s31, s32, 49152
Lop33:
    s_sub_u32 s66, s66, 1
    s_cbranch_scc1 Lbail
    buffer_load_dword v31, v28, s[4:7], s31 offen offset:1008 sc1
    s_waitcnt vmcnt(0)
    v_and_b32 v31, 1, v31
    v_cmp_ne_u32 vcc, 1, v31
    s_cbranch_vccnz Lop33
    s_add_u32 m0, s42, 65536
    s_add_u32 s31, s38, 0
    buffer_load_dwordx4 v0, s[4:7], s31 offen offset:0 sc1 lds
    buffer_load_dwordx4 v0, s[4:7], s31 offen offset:1024 sc1 lds
    buffer_load_dwordx4 v0, s[4:7], s31 offen offset:2048 sc1 lds
    buffer_load_dwordx4 v0, s[4:7], s31 offen offset:3072 sc1 lds
    s_add_u32 m0, s42, 73728
    s_add_u32 s31, s38, 8192
    buffer_load_dwordx4 v0, s[4:7], s31 offen offset:0 sc1 lds
    buffer_load_dwordx4 v0, s[4:7], s31 offen offset:1024 sc1 lds
    buffer_load_dwordx4 v0, s[4:7], s31 offen offset:2048 sc1 lds
    buffer_load_dwordx4 v0, s[4:7], s31 offen offset:3072 sc1 lds
    s_add_u32 m0, s42, 98304
    s_add_u32 s31, s38, 32768
    buffer_load_dwordx4 v0, s[4:7], s31 offen offset:0 sc1 lds
    buffer_load_dwordx4 v0, s[4:7], s31 offen offset:1024 sc1 lds
    buffer_load_dwordx4 v0, s[4:7], s31 offen offset:2048 sc1 lds
    buffer_load_dwordx4 v0, s[4:7], s31 offen offset:3072 sc1 lds
    s_add_u32 m0, s42, 106496
    s_add_u32 s31, s38, 40960
    buffer_load_dwordx4 v0, s[4:7], s31 offen offset:0 sc1 lds
    buffer_load_dwordx4 v0, s[4:7], s31 offen offset:1024 sc1 lds
    buffer_load_dwordx4 v0, s[4:7], s31 offen offset:2048 sc1 lds
    buffer_load_dwordx4 v0, s[4:7], s31 offen offset:3072 sc1 lds
    s_and_b32 s31, s42, 0x4000
    s_add_u32 s31, s31, 65536
    v_add_u32 v30, s31, v0
    s_add_u32 s31, s42, 65536
    v_add_u32 v28, s31, v0
    v_add_u32 v29, 8, v28
    s_waitcnt vmcnt(12)
    ds_read_b128 v[32:35], v28 offset:0
    ds_read_b128 v[36:39], v28 offset:1024
    ds_read_b128 v[40:43], v28 offset:2048
    ds_read_b128 v[44:47], v28 offset:3072
    s_waitcnt vmcnt(8)
    ds_read_b128 v[48:51], v28 offset:8192
    ds_read_b128 v[52:55], v28 offset:9216
    ds_read_b128 v[56:59], v28 offset:10240
    ds_read_b128 v[60:63], v28 offset:11264
    s_waitcnt lgkmcnt(6)
    v_bitop3_b32 v32, v32, v34, v36 bitop3:0x80
    s_waitcnt lgkmcnt(5)
    v_bitop3_b32 v38, v38, v40, v42 bitop3:0x80
    s_waitcnt lgkmcnt(4)
    v_bitop3_b32 v32, v32, v38, v44 bitop3:0x80
    v_bitop3_b32 v32, v32, v46, 1 bitop3:0x80
    v_cmp_ne_u32 s[56:57], 1, v32
    s_nop 1
    s_cmp_lg_u64 s[56:57], 0
    s_cbranch_scc1 Lrare34
Lrare34b:
    s_waitcnt lgkmcnt(2)
    v_bitop3_b32 v48, v48, v50, v52 bitop3:0x80
    s_waitcnt lgkmcnt(1)
    v_bitop3_b32 v54, v54, v56, v58 bitop3:0x80
    s_waitcnt lgkmcnt(0)
    v_bitop3_b32 v48, v48, v54, v60 bitop3:0x80
    v_bitop3_b32 v48, v48, v62, 1 bitop3:0x80
    v_cmp_ne_u32 s[56:57], 1, v48
    s_nop 1
    s_cmp_lg_u64 s[56:57], 0
    s_cbranch_scc1 Lrare36
Lrare36b:
    s_barrier
    ds_read_b128 v[32:35], v30 offset:0
    ds_read_b128 v[36:39], v30 offset:1024
    ds_read_b128 v[40:43], v30 offset:2048
    ds_read_b128 v[44:47], v30 offset:3072
    ds_read_b128 v[48:51], v30 offset:4096
    s_waitcnt lgkmcnt(4)
    v_mfma_f32_16x16x32_bf16 v[12:15], v[96:99], v[32:35], v[12:15]
    s_waitcnt vmcnt(4)
    ds_read2st64_b32 v[56:57], v28 offset0:128 offset1:132
    ds_read2st64_b32 v[58:59], v29 offset0:128 offset1:132
    v_mfma_f32_16x16x32_bf16 v[16:19], v[100:103], v[32:35], v[16:19]
    s_waitcnt lgkmcnt(5)
    ds_read_b128 v[52:55], v30 offset:5120
    ds_read2st64_b32 v[60:61], v28 offset0:136 offset1:140
    v_mfma_f32_16x16x32_bf16 v[12:15], v[104:107], v[36:39], v[12:15]
    ds_read2st64_b32 v[62:63], v29 offset0:136 offset1:140
    v_mfma_f32_16x16x32_bf16 v[16:19], v[108:111], v[36:39], v[16:19]
    s_waitcnt lgkmcnt(7)
    ds_read_b128 v[32:35], v30 offset:6144
    v_mfma_f32_16x16x32_bf16 v[12:15], v[112:115], v[40:43], v[12:15]
    v_mfma_f32_16x16x32_bf16 v[16:19], v[116:119], v[40:43], v[16:19]
    s_waitcnt lgkmcnt(7)
    ds_read_b128 v[36:39], v30 offset:7168
    v_mfma_f32_16x16x32_bf16 v[12:15], v[64:67], v[44:47], v[12:15]
    s_waitcnt lgkmcnt(5)
    v_bitop3_b32 v56, v56, v57, v58 bitop3:0x80
    v_mfma_f32_16x16x32_bf16 v[16:19], v[68:71], v[44:47], v[16:19]
    ds_read_b128 v[40:43], v30 offset:8192
    s_waitcnt lgkmcnt(4)
    v_bitop3_b32 v59, v59, v60, v61 bitop3:0x80
    s_waitcnt lgkmcnt(3)
    v_bitop3_b32 v56, v56, v59, v62 bitop3:0x80
    v_bitop3_b32 v56, v56, v63, 1 bitop3:0x80
    v_cmp_ne_u32 s[56:57], 1, v56
    v_mfma_f32_16x16x32_bf16 v[12:15], v[120:123], v[48:51], v[12:15]
    v_mfma_f32_16x16x32_bf16 v[16:19], v[124:127], v[48:51], v[16:19]
    ds_read_b128 v[44:47], v30 offset:9216
    v_mfma_f32_16x16x32_bf16 v[12:15], v[128:131], v[52:55], v[12:15]
    s_cmp_lg_u64 s[56:57], 0
    s_cbranch_scc1 Lrare38
Lrare38b:
    s_waitcnt vmcnt(0)
    v_mfma_f32_16x16x32_bf16 v[16:19], v[132:135], v[52:55], v[16:19]
    s_waitcnt lgkmcnt(3)
    ds_read_b128 v[48:51], v30 offset:10240
    ds_read2st64_b32 v[56:57], v28 offset0:160 offset1:164
    v_mfma_f32_16x16x32_bf16 v[12:15], v[136:139], v[32:35], v[12:15]
    ds_read2st64_b32 v[58:59], v29 offset0:160 offset1:164
    ds_read2st64_b32 v[60:61], v28 offset0:168 offset1:172
    v_mfma_f32_16x16x32_bf16 v[16:19], v[140:143], v[32:35], v[16:19]
    s_waitcnt lgkmcnt(6)
    ds_read_b128 v[52:55], v30 offset:11264
    ds_read2st64_b32 v[62:63], v29 offset0:168 offset1:172
    v_mfma_f32_16x16x32_bf16 v[12:15], v[72:75], v[36:39], v[12:15]
    v_mfma_f32_16x16x32_bf16 v[16:19], v[76:79], v[36:39], v[16:19]
    s_waitcnt lgkmcnt(7)
    ds_read_b128 v[32:35], v30 offset:12288
    v_mfma_f32_16x16x32_bf16 v[12:15], v[144:147], v[40:43], v[12:15]
    v_mfma_f32_16x16x32_bf16 v[16:19], v[148:151], v[40:43], v[16:19]
    s_waitcnt lgkmcnt(7)
    ds_read_b128 v[36:39], v30 offset:13312
    v_mfma_f32_16x16x32_bf16 v[12:15], v[152:155], v[44:47], v[12:15]
    s_waitcnt lgkmcnt(5)
    v_bitop3_b32 v56, v56, v57, v58 bitop3:0x80
    v_mfma_f32_16x16x32_bf16 v[16:19], v[156:159], v[44:47], v[16:19]
    ds_read_b128 v[40:43], v30 offset:14336
    s_waitcnt lgkmcnt(5)
    v_bitop3_b32 v59, v59, v60, v61 bitop3:0x80
    s_waitcnt lgkmcnt(3)
    v_bitop3_b32 v56, v56, v59, v62 bitop3:0x80
    v_bitop3_b32 v56, v56, v63, 1 bitop3:0x80
    v_cmp_ne_u32 s[56:57], 1, v56
    v_mfma_f32_16x16x32_bf16 v[12:15], v[160:163], v[48:51], v[12:15]
    s_lshl_b32 s30, s24, 3
    s_add_u32 s30, s30, s25
    s_cmp_ge_u32 s30, 22
    s_cselect_b32 s51, 0x40000000, s32
    s_lshl_b32 s30, s30, 13
    s_add_u32 s30, s30, s51
    s_add_u32 s30, s30, 327680
    s_mov_b32 m0, 163328
    v_mfma_f32_16x16x32_bf16 v[16:19], v[164:167], v[48:51], v[16:19]
    ds_read_b128 v[44:47], v30 offset:15360
    v_lshlrev_b32 v31, 3, v0
    v_mfma_f32_16x16x32_bf16 v[12:15], v[80:83], v[52:55], v[12:15]
    s_cmp_lg_u64 s[56:57], 0
    s_cbranch_scc1 Lrare40
Lrare40b:
    s_barrier
    v_mfma_f32_16x16x32_bf16 v[16:19], v[84:87], v[52:55], v[16:19]
    s_waitcnt lgkmcnt(3)
    ds_read_b128 v[48:51], v30 offset:32768
    v_mfma_f32_16x16x32_bf16 v[12:15], v[168:171], v[32:35], v[12:15]
    buffer_load_dword v31, s[4:7], s30 offen lds
    v_mfma_f32_16x16x32_bf16 v[16:19], v[172:175], v[32:35], v[16:19]
    s_waitcnt lgkmcnt(3)
    ds_read_b128 v[52:55], v30 offset:33792
    s_add_u32 s51, s33, 4096
    v_mfma_f32_16x16x32_bf16 v[12:15], v[176:179], v[36:39], v[12:15]
    s_and_b32 s51, s51, 0x3fff
    s_lshl_b32 s30, s41, 3
    s_add_u32 s30, s30, s51
    v_mfma_f32_16x16x32_bf16 v[16:19], v[180:183], v[36:39], v[16:19]
    s_waitcnt lgkmcnt(3)
    ds_read_b128 v[32:35], v30 offset:34816
    s_add_u32 s30, s30, s72
    v_mfma_f32_16x16x32_bf16 v[12:15], v[184:187], v[40:43], v[12:15]
    s_add_u32 s30, s30, 16384
    buffer_load_dwordx4 a[80:83], v0, s[4:7], s30 offen offset:0 sc1
    v_mfma_f32_16x16x32_bf16 v[16:19], v[188:191], v[40:43], v[16:19]
    s_waitcnt lgkmcnt(3)
    ds_read_b128 v[36:39], v30 offset:35840
    v_mfma_f32_16x16x32_bf16 v[12:15], v[88:91], v[44:47], v[12:15]
    v_mfma_f32_16x16x32_bf16 v[16:19], v[92:95], v[44:47], v[16:19]
    s_waitcnt lgkmcnt(3)
    ds_read_b128 v[40:43], v30 offset:36864
    v_mfma_f32_16x16x32_bf16 v[20:23], v[96:99], v[48:51], v[20:23]
    buffer_load_dwordx4 a[84:87], v0, s[4:7], s30 offen offset:1024 sc1
    v_mfma_f32_16x16x32_bf16 v[24:27], v[100:103], v[48:51], v[24:27]
    s_waitcnt lgkmcnt(3)
    ds_read_b128 v[44:47], v30 offset:37888
    v_mfma_f32_16x16x32_bf16 v[20:23], v[104:107], v[52:55], v[20:23]
    v_mfma_f32_16x16x32_bf16 v[24:27], v[108:111], v[52:55], v[24:27]
    s_waitcnt lgkmcnt(3)
    ds_read_b128 v[48:51], v30 offset:38912
    v_cvt_pk_bf16_f32 v96, v12, v13
    v_mfma_f32_16x16x32_bf16 v[20:23], v[112:115], v[32:35], v[20:23]
    v_cvt_pk_bf16_f32 v97, v14, v15
    v_cvt_pk_bf16_f32 v98, v16, v17
    v_mfma_f32_16x16x32_bf16 v[24:27], v[116:119], v[32:35], v[24:27]
    s_waitcnt lgkmcnt(3)
    ds_read_b128 v[52:55], v30 offset:39936
    v_cvt_pk_bf16_f32 v99, v18, v19
    v_mfma_f32_16x16x32_bf16 v[20:23], v[64:67], v[36:39], v[20:23]
    v_or_b32 v96, 1, v96
    v_or_b32 v98, 1, v98
    v_mfma_f32_16x16x32_bf16 v[24:27], v[68:71], v[36:39], v[24:27]
    s_waitcnt lgkmcnt(3)
    ds_read_b128 v[32:35], v30 offset:40960
    s_add_u32 s35, s43, 131072
    v_mfma_f32_16x16x32_bf16 v[20:23], v[120:123], v[40:43], v[20:23]
    s_barrier
    buffer_store_dwordx4 v[96:99], v0, s[4:7], s35 offen
    v_mfma_f32_16x16x32_bf16 v[24:27], v[124:127], v[40:43], v[24:27]
    s_waitcnt lgkmcnt(3)
    ds_read_b128 v[36:39], v30 offset:41984
    v_mfma_f32_16x16x32_bf16 v[20:23], v[128:131], v[44:47], v[20:23]
    buffer_load_dwordx4 a[88:91], v0, s[4:7], s30 offen offset:2048 sc1
    v_mfma_f32_16x16x32_bf16 v[24:27], v[132:135], v[44:47], v[24:27]
    s_waitcnt lgkmcnt(3)
    ds_read_b128 v[40:43], v30 offset:43008
    v_mfma_f32_16x16x32_bf16 v[20:23], v[136:139], v[48:51], v[20:23]
    v_add_f32 v104, v12, v13
    v_mul_f32 v105, v12, v12
    v_mfma_f32_16x16x32_bf16 v[24:27], v[140:143], v[48:51], v[24:27]
    s_waitcnt lgkmcnt(3)
    ds_read_b128 v[44:47], v30 offset:44032
    v_fmac_f32 v105, v13, v13
    v_mfma_f32_16x16x32_bf16 v[20:23], v[72:75], v[52:55], v[20:23]
    buffer_load_dwordx4 a[92:95], v0, s[4:7], s30 offen offset:3072 sc1
    v_mfma_f32_16x16x32_bf16 v[24:27], v[76:79], v[52:55], v[24:27]
    s_waitcnt lgkmcnt(3)
    ds_read_b128 v[48:51], v30 offset:45056
    s_add_u32 s51, s33, 4096
    v_mfma_f32_16x16x32_bf16 v[20:23], v[144:147], v[32:35], v[20:23]
    s_and_b32 s51, s51, 0x3fff
    s_lshl_b32 s30, s41, 2
    s_add_u32 s30, s30, s51
    v_mfma_f32_16x16x32_bf16 v[24:27], v[148:151], v[32:35], v[24:27]
    s_waitcnt lgkmcnt(3)
    ds_read_b128 v[52:55], v30 offset:46080
    s_add_u32 s30, s30, s72
    v_mfma_f32_16x16x32_bf16 v[20:23], v[152:155], v[36:39], v[20:23]
    s_add_u32 s30, s30, 131072
    buffer_load_dwordx4 a[144:147], v0, s[4:7], s30 offen offset:0 sc1
    v_mfma_f32_16x16x32_bf16 v[24:27], v[156:159], v[36:39], v[24:27]
    s_waitcnt lgkmcnt(3)
    ds_read_b128 v[32:35], v30 offset:47104
    v_add_f32 v104, v104, v14
    v_mfma_f32_16x16x32_bf16 v[20:23], v[160:163], v[40:43], v[20:23]
    v_fmac_f32 v105, v14, v14
    v_add_f32 v104, v104, v15
    v_mfma_f32_16x16x32_bf16 v[24:27], v[164:167], v[40:43], v[24:27]
    s_waitcnt lgkmcnt(3)
    ds_read_b128 v[36:39], v30 offset:48128
    v_fmac_f32 v105, v15, v15
    v_mfma_f32_16x16x32_bf16 v[20:23], v[80:83], v[44:47], v[20:23]
    buffer_load_dwordx4 a[148:151], v0, s[4:7], s30 offen offset:1024 sc1
    v_mfma_f32_16x16x32_bf16 v[24:27], v[84:87], v[44:47], v[24:27]
    s_waitcnt lgkmcnt(3)
    v_add_f32 v104, v104, v16
    v_fmac_f32 v105, v16, v16
    v_mfma_f32_16x16x32_bf16 v[20:23], v[168:171], v[48:51], v[20:23]
    v_add_f32 v104, v104, v17
    v_fmac_f32 v105, v17, v17
    v_mfma_f32_16x16x32_bf16 v[24:27], v[172:175], v[48:51], v[24:27]
    s_waitcnt lgkmcnt(2)
    v_add_f32 v104, v104, v18
    v_fmac_f32 v105, v18, v18
    v_mfma_f32_16x16x32_bf16 v[20:23], v[176:179], v[52:55], v[20:23]
    buffer_load_dwordx4 a[152:155], v0, s[4:7], s30 offen offset:2048 sc1
    v_mfma_f32_16x16x32_bf16 v[24:27], v[180:183], v[52:55], v[24:27]
    s_waitcnt lgkmcnt(1)
    v_add_f32 v104, v104, v19
    v_fmac_f32 v105, v19, v19
    v_mfma_f32_16x16x32_bf16 v[20:23], v[184:187], v[32:35], v[20:23]
    s_add_u32 s35, s44, 720896
    v_permlane16_swap_b32 v104, v105
    v_add_f32 v104, v104, v105
    v_mfma_f32_16x16x32_bf16 v[24:27], v[188:191], v[32:35], v[24:27]
    s_waitcnt lgkmcnt(0)
    v_mov_b32 v105, v104
    s_nop 1
    v_permlane32_swap_b32 v104, v105
    v_mfma_f32_16x16x32_bf16 v[20:23], v[88:91], v[36:39], v[20:23]
    buffer_load_dwordx4 a[156:159], v0, s[4:7], s30 offen offset:3072 sc1
    v_mfma_f32_16x16x32_bf16 v[24:27], v[92:95], v[36:39], v[24:27]
    s_add_u32 s51, s33, 8192
    s_and_b32 s51, s51, 0x3fff
    s_lshl_b32 s30, s41, 3
    s_add_u32 s30, s30, s51
    s_add_u32 s30, s30, s72
    s_add_u32 s30, s30, 0
    buffer_load_dwordx4 a[32:35], v0, s[4:7], s30 offen offset:0 sc1
    buffer_load_dwordx4 a[36:39], v0, s[4:7], s30 offen offset:1024 sc1
    v_add_f32 v104, v104, v105
    v_or_b32 v104, 1, v104
    buffer_store_dword v104, v7, s[4:7], s35 offen
    v_cvt_pk_bf16_f32 v100, v20, v21
    v_cvt_pk_bf16_f32 v101, v22, v23
    v_cvt_pk_bf16_f32 v102, v24, v25
    v_cvt_pk_bf16_f32 v103, v26, v27
    v_or_b32 v100, 1, v100
    v_or_b32 v102, 1, v102
    s_add_u32 s31, s43, 163840
    buffer_store_dwordx4 v[100:103], v0, s[4:7], s31 offen
    v_dot2_f32_bf16 v28, v100, s45, 0
    v_dot2_f32_bf16 v29, v100, v100, 0
    v_dot2_f32_bf16 v28, v101, s45, v28
    v_dot2_f32_bf16 v29, v101, v101, v29
    v_dot2_f32_bf16 v28, v102, s45, v28
    v_dot2_f32_bf16 v29, v102, v102, v29
    v_dot2_f32_bf16 v28, v103, s45, v28
    v_dot2_f32_bf16 v29, v103, v103, v29
    s_add_u32 s31, s44, 724992
    s_nop 1
    v_permlane16_swap_b32 v28, v29
    v_add_f32 v28, v28, v29
    v_mov_b32 v29, v28
    s_nop 1
    v_permlane32_swap_b32 v28, v29
    v_add_f32 v28, v28, v29
    v_or_b32 v28, 1, v28
    buffer_store_dword v28, v7, s[4:7], s31 offen
    s_add_u32 m0, s41, 65536
    s_add_u32 s31, s34, 131072
    buffer_load_dwordx4 v0, s[4:7], s31 offen offset:0 sc1 lds
    buffer_load_dwordx4 v0, s[4:7], s31 offen offset:1024 sc1 lds
    buffer_load_dwordx4 v0, s[4:7], s31 offen offset:2048 sc1 lds
    buffer_load_dwordx4 v0, s[4:7], s31 offen offset:3072 sc1 lds
    s_add_u32 m0, s41, 81920
    s_add_u32 s31, s34, 147456
    buffer_load_dwordx4 v0, s[4:7], s31 offen offset:0 sc1 lds
    buffer_load_dwordx4 v0, s[4:7], s31 offen offset:1024 sc1 lds
    buffer_load_dwordx4 v0, s[4:7], s31 offen offset:2048 sc1 lds
    buffer_load_dwordx4 v0, s[4:7], s31 offen offset:3072 sc1 lds
    s_add_u32 s51, s33, 8192
    s_and_b32 s51, s51, 0x3fff
    s_lshl_b32 s30, s41, 3
    s_add_u32 s30, s30, s51
    s_add_u32 s30, s30, s72
    s_add_u32 s30, s30, 0
    buffer_load_dwordx4 a[40:43], v0, s[4:7], s30 offen offset:2048 sc1
    buffer_load_dwordx4 a[44:47], v0, s[4:7], s30 offen offset:3072 sc1
    s_add_u32 s51, s33, 8192
    s_and_b32 s51, s51, 0x3fff
    s_lshl_b32 s30, s41, 3
    s_add_u32 s30, s30, s51
    s_add_u32 s30, s30, s72
    s_add_u32 s30, s30, 16384
    buffer_load_dwordx4 a[96:99], v0, s[4:7], s30 offen offset:0 sc1
    buffer_load_dwordx4 a[100:103], v0, s[4:7], s30 offen offset:1024 sc1
    buffer_load_dwordx4 a[104:107], v0, s[4:7], s30 offen offset:2048 sc1
    buffer_load_dwordx4 a[108:111], v0, s[4:7], s30 offen offset:3072 sc1
    s_add_u32 s51, s33, 8192
    s_and_b32 s51, s51, 0x3fff
    s_lshl_b32 s30, s41, 2
    s_add_u32 s30, s30, s51
    s_add_u32 s30, s30, s72
    s_add_u32 s30, s30, 131072
    buffer_load_dwordx4 a[160:163], v0, s[4:7], s30 offen offset:0 sc1
    buffer_load_dwordx4 a[164:167], v0, s[4:7], s30 offen offset:1024 sc1
    buffer_load_dwordx4 a[168:171], v0, s[4:7], s30 offen offset:2048 sc1
    buffer_load_dwordx4 a[172:175], v0, s[4:7], s30 offen offset:3072 sc1
    s_mul_i32 s31, s24, 192
    v_add_u32 v30, s31, v1
    s_add_u32 s31, s41, 65536
    v_add_u32 v28, s31, v0
    v_add_u32 v94, 65536, v0
    s_waitcnt vmcnt(14)
    ds_read_b128 v[128:131], v28 offset:0
    ds_read_b128 v[132:135], v28 offset:1024
    ds_read_b128 v[136:139], v28 offset:2048
    ds_read_b128 v[140:143], v28 offset:3072
    s_waitcnt lgkmcnt(2)
    v_bitop3_b32 v128, v128, v130, v132 bitop3:0x80
    s_waitcnt lgkmcnt(1)
    v_bitop3_b32 v134, v134, v136, v138 bitop3:0x80
    s_waitcnt lgkmcnt(0)
    v_bitop3_b32 v128, v128, v134, v140 bitop3:0x80
    v_bitop3_b32 v128, v128, v142, 1 bitop3:0x80
    v_cmp_ne_u32 s[56:57], 1, v128
    s_nop 1
    s_cmp_lg_u64 s[56:57], 0
    s_cbranch_scc1 Lrare42
Lrare42b:
    v_mov_b32 v164, s45
    v_mov_b32 v165, s45
    v_mov_b32 v166, s45
    v_mov_b32 v167, s45
    s_barrier
    ds_read_b128 v[32:35], v94 offset:0
    ds_read_b128 v[36:39], v94 offset:1024
    ds_read_b128 v[40:43], v94 offset:2048
    ds_read_b128 v[44:47], v94 offset:3072
    ds_read_b128 v[48:51], v94 offset:4096
    s_waitcnt lgkmcnt(4)
    v_mfma_f32_16x16x32_bf16 v[56:59], a[0:3], v[32:35], 0
    s_add_u32 s51, s33, 12288
    s_and_b32 s51, s51, 0x3fff
    s_lshl_b32 s30, s41, 3
    v_mfma_f32_16x16x32_bf16 v[60:63], a[64:67], v[32:35], 0
    s_add_u32 s30, s30, s51
    s_add_u32 s30, s30, s72
    s_add_u32 s30, s30, 0
    v_mfma_f32_16x16x32_bf16 v[64:67], a[128:131], v[32:35], 0
    ds_read_b128 v[52:55], v94 offset:5120
    v_mfma_f32_16x16x32_bf16 v[80:83], a[0:3], v[164:167], 0
    buffer_load_dwordx4 a[48:51], v0, s[4:7], s30 offen offset:0 sc1
    v_mfma_f32_16x16x32_bf16 v[84:87], a[64:67], v[164:167], 0
    v_mfma_f32_16x16x32_bf16 v[88:91], a[128:131], v[164:167], 0
    s_waitcnt lgkmcnt(4)
    v_mfma_f32_16x16x32_bf16 v[56:59], a[4:7], v[36:39], v[56:59]
    s_waitcnt vmcnt(11)
    ds_read_b128 v[128:131], v28 offset:16384
    ds_read_b128 v[132:135], v28 offset:17408
    v_mfma_f32_16x16x32_bf16 v[60:63], a[68:71], v[36:39], v[60:63]
    ds_read_b128 v[136:139], v28 offset:18432
    ds_read_b128 v[140:143], v28 offset:19456
    v_mfma_f32_16x16x32_bf16 v[64:67], a[132:135], v[36:39], v[64:67]
    ds_read_b128 v[32:35], v94 offset:6144
    v_mfma_f32_16x16x32_bf16 v[80:83], a[4:7], v[164:167], v[80:83]
    buffer_load_dwordx4 a[52:55], v0, s[4:7], s30 offen offset:1024 sc1
    v_mfma_f32_16x16x32_bf16 v[84:87], a[68:71], v[164:167], v[84:87]
    s_add_u32 s51, s33, 12288
    s_and_b32 s51, s51, 0x3fff
    s_lshl_b32 s30, s41, 3
    v_mfma_f32_16x16x32_bf16 v[88:91], a[132:135], v[164:167], v[88:91]
    s_waitcnt lgkmcnt(8)
    s_add_u32 s30, s30, s51
    s_add_u32 s30, s30, s72
    v_mfma_f32_16x16x32_bf16 v[56:59], a[8:11], v[40:43], v[56:59]
    s_add_u32 s30, s30, 0
    v_mfma_f32_16x16x32_bf16 v[60:63], a[72:75], v[40:43], v[60:63]
    buffer_load_dwordx4 a[56:59], v0, s[4:7], s30 offen offset:2048 sc1
    v_mfma_f32_16x16x32_bf16 v[64:67], a[136:139], v[40:43], v[64:67]
    ds_read_b128 v[36:39], v94 offset:7168
    v_mfma_f32_16x16x32_bf16 v[80:83], a[8:11], v[164:167], v[80:83]
    s_waitcnt lgkmcnt(4)
    v_bitop3_b32 v128, v128, v130, v132 bitop3:0x80
    v_mfma_f32_16x16x32_bf16 v[84:87], a[72:75], v[164:167], v[84:87]
    s_waitcnt lgkmcnt(3)
    v_bitop3_b32 v134, v134, v136, v138 bitop3:0x80
    v_mfma_f32_16x16x32_bf16 v[88:91], a[136:139], v[164:167], v[88:91]
    buffer_load_dwordx4 a[60:63], v0, s[4:7], s30 offen offset:3072 sc1
    v_mfma_f32_16x16x32_bf16 v[56:59], a[12:15], v[44:47], v[56:59]
    s_add_u32 s51, s33, 12288
    s_and_b32 s51, s51, 0x3fff
    s_lshl_b32 s30, s41, 3
    v_mfma_f32_16x16x32_bf16 v[60:63], a[76:79], v[44:47], v[60:63]
    s_add_u32 s30, s30, s51
    s_add_u32 s30, s30, s72
    s_add_u32 s30, s30, 16384
    v_mfma_f32_16x16x32_bf16 v[64:67], a[140:143], v[44:47], v[64:67]
    ds_read_b128 v[40:43], v94 offset:8192
    v_mfma_f32_16x16x32_bf16 v[80:83], a[12:15], v[164:167], v[80:83]
    buffer_load_dwordx4 a[112:115], v0, s[4:7], s30 offen offset:0 sc1
    v_mfma_f32_16x16x32_bf16 v[84:87], a[76:79], v[164:167], v[84:87]
    s_waitcnt lgkmcnt(3)
    v_bitop3_b32 v128, v128, v134, v140 bitop3:0x80
    v_bitop3_b32 v128, v128, v142, 1 bitop3:0x80
    v_mfma_f32_16x16x32_bf16 v[88:91], a[140:143], v[164:167], v[88:91]
    v_cmp_ne_u32 s[56:57], 1, v128
    v_mfma_f32_16x16x32_bf16 v[56:59], a[16:19], v[48:51], v[56:59]
    v_mfma_f32_16x16x32_bf16 v[60:63], a[80:83], v[48:51], v[60:63]
    buffer_load_dwordx4 a[116:119], v0, s[4:7], s30 offen offset:1024 sc1
    v_mfma_f32_16x16x32_bf16 v[64:67], a[144:147], v[48:51], v[64:67]
    s_add_u32 s51, s33, 12288
    ds_read_b128 v[44:47], v94 offset:9216
    s_and_b32 s51, s51, 0x3fff
    v_mfma_f32_16x16x32_bf16 v[80:83], a[16:19], v[164:167], v[80:83]
    s_lshl_b32 s30, s41, 3
    s_add_u32 s30, s30, s51
    s_add_u32 s30, s30, s72
    v_mfma_f32_16x16x32_bf16 v[84:87], a[80:83], v[164:167], v[84:87]
    s_add_u32 s30, s30, 16384
    v_mfma_f32_16x16x32_bf16 v[88:91], a[144:147], v[164:167], v[88:91]
    buffer_load_dwordx4 a[120:123], v0, s[4:7], s30 offen offset:2048 sc1
    v_mfma_f32_16x16x32_bf16 v[56:59], a[20:23], v[52:55], v[56:59]
    v_mfma_f32_16x16x32_bf16 v[60:63], a[84:87], v[52:55], v[60:63]
    v_mfma_f32_16x16x32_bf16 v[64:67], a[148:151], v[52:55], v[64:67]
    ds_read_b128 v[48:51], v94 offset:10240
    v_mfma_f32_16x16x32_bf16 v[80:83], a[20:23], v[164:167], v[80:83]
    buffer_load_dwordx4 a[124:127], v0, s[4:7], s30 offen offset:3072 sc1
    v_mfma_f32_16x16x32_bf16 v[84:87], a[84:87], v[164:167], v[84:87]
    s_add_u32 s51, s33, 12288
    s_and_b32 s51, s51, 0x3fff
    s_lshl_b32 s30, s41, 2
    v_mfma_f32_16x16x32_bf16 v[88:91], a[148:151], v[164:167], v[88:91]
    s_waitcnt lgkmcnt(4)
    s_add_u32 s30, s30, s51
    s_add_u32 s30, s30, s72
    v_mfma_f32_16x16x32_bf16 v[56:59], a[24:27], v[32:35], v[56:59]
    s_add_u32 s30, s30, 131072
    v_mfma_f32_16x16x32_bf16 v[60:63], a[88:91], v[32:35], v[60:63]
    buffer_load_dwordx4 a[176:179], v0, s[4:7], s30 offen offset:0 sc1
    v_mfma_f32_16x16x32_bf16 v[64:67], a[152:155], v[32:35], v[64:67]
    ds_read_b128 v[52:55], v94 offset:11264
    v_mfma_f32_16x16x32_bf16 v[80:83], a[24:27], v[164:167], v[80:83]
    v_mfma_f32_16x16x32_bf16 v[84:87], a[88:91], v[164:167], v[84:87]
    v_mfma_f32_16x16x32_bf16 v[88:91], a[152:155], v[164:167], v[88:91]
    s_waitcnt lgkmcnt(4)
    buffer_load_dwordx4 a[180:183], v0, s[4:7], s30 offen offset:1024 sc1
    v_mfma_f32_16x16x32_bf16 v[56:59], a[28:31], v[36:39], v[56:59]
    s_add_u32 s51, s33, 12288
    s_and_b32 s51, s51, 0x3fff
    s_lshl_b32 s30, s41, 2
    v_mfma_f32_16x16x32_bf16 v[60:63], a[92:95], v[36:39], v[60:63]
    s_add_u32 s30, s30, s51
    s_add_u32 s30, s30, s72
    s_add_u32 s30, s30, 131072
    v_mfma_f32_16x16x32_bf16 v[64:67], a[156:159], v[36:39], v[64:67]
    ds_read_b128 v[32:35], v94 offset:12288
    v_mfma_f32_16x16x32_bf16 v[80:83], a[28:31], v[164:167], v[80:83]
    buffer_load_dwordx4 a[184:187], v0, s[4:7], s30 offen offset:2048 sc1
    v_mfma_f32_16x16x32_bf16 v[84:87], a[92:95], v[164:167], v[84:87]
    v_mfma_f32_16x16x32_bf16 v[88:91], a[156:159], v[164:167], v[88:91]
    s_waitcnt lgkmcnt(4)
    v_mfma_f32_16x16x32_bf16 v[56:59], a[32:35], v[40:43], v[56:59]
    s_waitcnt vmcnt(18)
    v_mfma_f32_16x16x32_bf16 v[60:63], a[96:99], v[40:43], v[60:63]
    s_waitcnt vmcnt(14)
    buffer_load_dwordx4 a[188:191], v0, s[4:7], s30 offen offset:3072 sc1
    v_mfma_f32_16x16x32_bf16 v[64:67], a[160:163], v[40:43], v[64:67]
    s_add_u32 s30, s19, 720896
    ds_read_b128 v[36:39], v94 offset:13312
    v_mfma_f32_16x16x32_bf16 v[80:83], a[32:35], v[164:167], v[80:83]
    v_mfma_f32_16x16x32_bf16 v[84:87], a[96:99], v[164:167], v[84:87]
    v_mfma_f32_16x16x32_bf16 v[88:91], a[160:163], v[164:167], v[88:91]
    s_waitcnt lgkmcnt(4)
    buffer_load_dwordx4 v[156:159], v0, s[4:7], s30 offen sc1
    v_mfma_f32_16x16x32_bf16 v[56:59], a[36:39], v[44:47], v[56:59]
    s_add_u32 m0, s41, 98304
    s_add_u32 s30, s34, 163840
    v_mfma_f32_16x16x32_bf16 v[60:63], a[100:103], v[44:47], v[60:63]
    s_waitcnt vmcnt(15)
    v_mfma_f32_16x16x32_bf16 v[64:67], a[164:167], v[44:47], v[64:67]
    ds_read_b128 v[40:43], v94 offset:14336
    v_mfma_f32_16x16x32_bf16 v[80:83], a[36:39], v[164:167], v[80:83]
    buffer_load_dwordx4 v0, s[4:7], s30 offen offset:0 sc1 lds
    v_mfma_f32_16x16x32_bf16 v[84:87], a[100:103], v[164:167], v[84:87]
    v_mfma_f32_16x16x32_bf16 v[88:91], a[164:167], v[164:167], v[88:91]
    s_waitcnt lgkmcnt(4)
    v_mfma_f32_16x16x32_bf16 v[56:59], a[40:43], v[48:51], v[56:59]
    v_mfma_f32_16x16x32_bf16 v[60:63], a[104:107], v[48:51], v[60:63]
    s_waitcnt vmcnt(15)
    buffer_load_dwordx4 v0, s[4:7], s30 offen offset:1024 sc1 lds
    v_mfma_f32_16x16x32_bf16 v[64:67], a[168:171], v[48:51], v[64:67]
    ds_read_b128 v[44:47], v94 offset:15360
    v_mfma_f32_16x16x32_bf16 v[80:83], a[40:43], v[164:167], v[80:83]
    v_mfma_f32_16x16x32_bf16 v[84:87], a[104:107], v[164:167], v[84:87]
    v_mfma_f32_16x16x32_bf16 v[88:91], a[168:171], v[164:167], v[88:91]
    s_waitcnt lgkmcnt(4)
    buffer_load_dwordx4 v0, s[4:7], s30 offen offset:2048 sc1 lds
    v_mfma_f32_16x16x32_bf16 v[56:59], a[44:47], v[52:55], v[56:59]
    s_cmp_lg_u64 s[56:57], 0
    s_cbranch_scc1 Lrare44
Lrare44b:
    s_barrier
    v_mfma_f32_16x16x32_bf16 v[60:63], a[108:111], v[52:55], v[60:63]
    s_waitcnt vmcnt(16)
    v_mfma_f32_16x16x32_bf16 v[64:67], a[172:175], v[52:55], v[64:67]
    ds_read_b128 v[48:51], v94 offset:16384
    v_mfma_f32_16x16x32_bf16 v[80:83], a[44:47], v[164:167], v[80:83]
    buffer_load_dwordx4 v0, s[4:7], s30 offen offset:3072 sc1 lds
    v_mfma_f32_16x16x32_bf16 v[84:87], a[108:111], v[164:167], v[84:87]
    s_add_u32 s30, s19, 724992
    v_mfma_f32_16x16x32_bf16 v[88:91], a[172:175], v[164:167], v[88:91]
    s_waitcnt vmcnt(16) lgkmcnt(4)
    v_mfma_f32_16x16x32_bf16 v[56:59], a[48:51], v[32:35], v[56:59]
    s_waitcnt vmcnt(12)
    v_mfma_f32_16x16x32_bf16 v[60:63], a[112:115], v[32:35], v[60:63]
    s_waitcnt vmcnt(8)
    buffer_load_dwordx4 v[160:163], v0, s[4:7], s30 offen sc1
    v_mfma_f32_16x16x32_bf16 v[64:67], a[176:179], v[32:35], v[64:67]
    s_add_u32 m0, s41, 114688
    ds_read_b128 v[52:55], v94 offset:17408
    s_add_u32 s30, s34, 180224
    v_mfma_f32_16x16x32_bf16 v[80:83], a[48:51], v[164:167], v[80:83]
    v_mfma_f32_16x16x32_bf16 v[84:87], a[112:115], v[164:167], v[84:87]
    v_mfma_f32_16x16x32_bf16 v[88:91], a[176:179], v[164:167], v[88:91]
    s_waitcnt lgkmcnt(4)
    buffer_load_dwordx4 v0, s[4:7], s30 offen offset:0 sc1 lds
    v_mfma_f32_16x16x32_bf16 v[56:59], a[52:55], v[36:39], v[56:59]
    v_mfma_f32_16x16x32_bf16 v[60:63], a[116:119], v[36:39], v[60:63]
    s_waitcnt vmcnt(9)
    v_mfma_f32_16x16x32_bf16 v[64:67], a[180:183], v[36:39], v[64:67]
    ds_read_b128 v[32:35], v94 offset:18432
    v_mfma_f32_16x16x32_bf16 v[80:83], a[52:55], v[164:167], v[80:83]
    buffer_load_dwordx4 v0, s[4:7], s30 offen offset:1024 sc1 lds
    v_mfma_f32_16x16x32_bf16 v[84:87], a[116:119], v[164:167], v[84:87]
    v_mfma_f32_16x16x32_bf16 v[88:91], a[180:183], v[164:167], v[88:91]
    s_waitcnt lgkmcnt(4)
    v_mfma_f32_16x16x32_bf16 v[56:59], a[56:59], v[40:43], v[56:59]
    s_waitcnt vmcnt(7)
    v_bitop3_b32 v31, v156, v157, v158 bitop3:0x80
    v_bitop3_b32 v31, v31, v159, 1 bitop3:0x80
    v_cmp_ne_u32 vcc, 1, v31
    s_cbranch_vccnz Lrare46
Lrare46b:
    v_mfma_f32_16x16x32_bf16 v[60:63], a[120:123], v[40:43], v[60:63]
    buffer_load_dwordx4 v0, s[4:7], s30 offen offset:2048 sc1 lds
    v_mfma_f32_16x16x32_bf16 v[64:67], a[184:187], v[40:43], v[64:67]
    ds_read_b128 v[36:39], v94 offset:19456
    v_add_f32 v156, v156, v158
    v_mfma_f32_16x16x32_bf16 v[80:83], a[56:59], v[164:167], v[80:83]
    v_add_f32 v157, v157, v159
    s_nop 0
    v_mfma_f32_16x16x32_bf16 v[84:87], a[120:123], v[164:167], v[84:87]
    v_add_f32_dpp v156, v156, v156 quad_perm:[1,0,3,2] row_mask:0xf bank_mask:0xf
    v_add_f32_dpp v157, v157, v157 quad_perm:[1,0,3,2] row_mask:0xf bank_mask:0xf
    v_mfma_f32_16x16x32_bf16 v[88:91], a[184:187], v[164:167], v[88:91]
    s_waitcnt lgkmcnt(4)
    buffer_load_dwordx4 v0, s[4:7], s30 offen offset:3072 sc1 lds
    v_mfma_f32_16x16x32_bf16 v[56:59], a[60:63], v[44:47], v[56:59]
    s_lshl_b32 s30, s41, 2
    s_add_u32 m0, s30, 0
    s_add_u32 s30, s62, 4096
    v_mfma_f32_16x16x32_bf16 v[60:63], a[124:127], v[44:47], v[60:63]
    s_add_u32 s51, s68, 4096
    v_add_f32_dpp v156, v156, v156 quad_perm:[2,3,0,1] row_mask:0xf bank_mask:0xf
    v_add_f32_dpp v157, v157, v157 quad_perm:[2,3,0,1] row_mask:0xf bank_mask:0xf
    v_mfma_f32_16x16x32_bf16 v[64:67], a[188:191], v[44:47], v[64:67]
    ds_read_b128 v[40:43], v94 offset:20480
    v_add_f32_dpp v156, v156, v156 row_half_mirror row_mask:0xf bank_mask:0xf
    v_mfma_f32_16x16x32_bf16 v[80:83], a[60:63], v[164:167], v[80:83]
    buffer_load_dwordx4 v0, s[4:7], s30 offen sc1 lds
    v_mfma_f32_16x16x32_bf16 v[84:87], a[124:127], v[164:167], v[84:87]
    v_add_f32_dpp v157, v157, v157 row_half_mirror row_mask:0xf bank_mask:0xf
    v_mul_f32 v156, 0xbb000000, v156
    v_mfma_f32_16x16x32_bf16 v[88:91], a[188:191], v[164:167], v[88:91]
    s_waitcnt lgkmcnt(4)
    v_mul_f32 v157, 0x3b000000, v157
    v_fma_f32 v157, -v156, v156, v157
    v_mfma_f32_16x16x32_bf16 v[68:71], a[0:3], v[48:51], 0
    ds_write_b32 v8, v156 offset:1792
    v_mfma_f32_16x16x32_bf16 v[72:75], a[64:67], v[48:51], 0
    buffer_load_dwordx4 v0, s[4:7], s30 offen offset:1024 sc1 lds
    v_mfma_f32_16x16x32_bf16 v[76:79], a[128:131], v[48:51], 0
    s_waitcnt lgkmcnt(4)
    ds_read_b128 v[44:47], v94 offset:21504
    v_max_f32 v157, 0, v157
    v_mfma_f32_16x16x32_bf16 v[68:71], a[4:7], v[52:55], v[68:71]
    v_add_f32 v157, 0x3727c5ac, v157
    v_mfma_f32_16x16x32_bf16 v[72:75], a[68:71], v[52:55], v[72:75]
    v_rsq_f32 v157, v157
    v_mfma_f32_16x16x32_bf16 v[76:79], a[132:135], v[52:55], v[76:79]
    s_waitcnt lgkmcnt(4)
    ds_read_b128 v[48:51], v94 offset:22528
    v_mul_f32 v158, v156, v157
    v_mfma_f32_16x16x32_bf16 v[68:71], a[8:11], v[32:35], v[68:71]
    s_waitcnt vmcnt(7)
    ds_read_b128 v[128:131], v28 offset:32768
    ds_read_b128 v[132:135], v28 offset:33792
    v_mfma_f32_16x16x32_bf16 v[72:75], a[72:75], v[32:35], v[72:75]
    ds_read_b128 v[136:139], v28 offset:34816
    ds_read_b128 v[140:143], v28 offset:35840
    v_mfma_f32_16x16x32_bf16 v[76:79], a[136:139], v[32:35], v[76:79]
    s_waitcnt lgkmcnt(8)
    ds_read_b128 v[52:55], v94 offset:23552
    v_mfma_f32_16x16x32_bf16 v[68:71], a[12:15], v[36:39], v[68:71]
    buffer_load_dwordx4 v0, s[4:7], s51 offen offset:2048 sc1 lds
    v_mfma_f32_16x16x32_bf16 v[72:75], a[76:79], v[36:39], v[72:75]
    ds_write_b32 v8, v157 offset:1024
    v_mfma_f32_16x16x32_bf16 v[76:79], a[140:143], v[36:39], v[76:79]
    s_waitcnt lgkmcnt(9)
    ds_read_b128 v[32:35], v94 offset:24576
    v_mul_f32 v157, s50, v157
    v_mfma_f32_16x16x32_bf16 v[68:71], a[16:19], v[40:43], v[68:71]
    ds_write_b32 v8, v158 offset:1280
    v_mfma_f32_16x16x32_bf16 v[72:75], a[80:83], v[40:43], v[72:75]
    buffer_load_dwordx4 v0, s[4:7], s51 offen offset:3072 sc1 lds
    v_mfma_f32_16x16x32_bf16 v[76:79], a[144:147], v[40:43], v[76:79]
    s_waitcnt lgkmcnt(9)
    ds_read_b128 v[36:39], v94 offset:25600
    s_lshl_b32 s30, s41, 2
    v_mfma_f32_16x16x32_bf16 v[68:71], a[20:23], v[44:47], v[68:71]
    s_add_u32 m0, s30, 4096
    s_add_u32 s30, s62, 8192
    s_add_u32 s51, s68, 8192
    v_mfma_f32_16x16x32_bf16 v[72:75], a[84:87], v[44:47], v[72:75]
    s_waitcnt lgkmcnt(7)
    v_bitop3_b32 v128, v128, v130, v132 bitop3:0x80
    v_mfma_f32_16x16x32_bf16 v[76:79], a[148:151], v[44:47], v[76:79]
    ds_read_b128 v[40:43], v94 offset:26624
    v_mfma_f32_16x16x32_bf16 v[68:71], a[24:27], v[48:51], v[68:71]
    buffer_load_dwordx4 v0, s[4:7], s30 offen sc1 lds
    v_mfma_f32_16x16x32_bf16 v[72:75], a[88:91], v[48:51], v[72:75]
    s_waitcnt lgkmcnt(7)
    v_bitop3_b32 v134, v134, v136, v138 bitop3:0x80
    v_mfma_f32_16x16x32_bf16 v[76:79], a[152:155], v[48:51], v[76:79]
    s_waitcnt lgkmcnt(5)
    ds_read_b128 v[44:47], v94 offset:27648
    v_bitop3_b32 v128, v128, v134, v140 bitop3:0x80
    v_mfma_f32_16x16x32_bf16 v[68:71], a[28:31], v[52:55], v[68:71]
    v_bitop3_b32 v128, v128, v142, 1 bitop3:0x80
    v_cmp_ne_u32 s[56:57], 1, v128
    v_mfma_f32_16x16x32_bf16 v[72:75], a[92:95], v[52:55], v[72:75]
    buffer_load_dwordx4 v0, s[4:7], s30 offen offset:1024 sc1 lds
    v_mfma_f32_16x16x32_bf16 v[76:79], a[156:159], v[52:55], v[76:79]
    s_waitcnt lgkmcnt(4)
    ds_read_b128 v[48:51], v94 offset:28672
    v_mfma_f32_16x16x32_bf16 v[68:71], a[32:35], v[32:35], v[68:71]
    ds_write_b32 v8, v157 offset:1536
    v_mfma_f32_16x16x32_bf16 v[72:75], a[96:99], v[32:35], v[72:75]
    s_waitcnt vmcnt(10)
    v_bitop3_b32 v31, v160, v161, v162 bitop3:0x80
    v_bitop3_b32 v31, v31, v163, 1 bitop3:0x80
    v_cmp_ne_u32 vcc, 1, v31
    s_cbranch_vccnz Lrare48
Lrare48b:
    v_mfma_f32_16x16x32_bf16 v[76:79], a[160:163], v[32:35], v[76:79]
    s_waitcnt lgkmcnt(4)
    ds_read_b128 v[52:55], v94 offset:29696
    v_add_f32 v160, v160, v162
    v_mfma_f32_16x16x32_bf16 v[68:71], a[36:39], v[36:39], v[68:71]
    buffer_load_dwordx4 v0, s[4:7], s51 offen offset:2048 sc1 lds
    v_mfma_f32_16x16x32_bf16 v[72:75], a[100:103], v[36:39], v[72:75]
    v_add_f32 v161, v161, v163
    s_nop 0
    v_mfma_f32_16x16x32_bf16 v[76:79], a[164:167], v[36:39], v[76:79]
    s_waitcnt lgkmcnt(4)
    ds_read_b128 v[32:35], v94 offset:30720
    v_add_f32_dpp v160, v160, v160 quad_perm:[1,0,3,2] row_mask:0xf bank_mask:0xf
    v_mfma_f32_16x16x32_bf16 v[68:71], a[40:43], v[40:43], v[68:71]
    v_add_f32_dpp v161, v161, v161 quad_perm:[1,0,3,2] row_mask:0xf bank_mask:0xf
    v_add_f32_dpp v160, v160, v160 quad_perm:[2,3,0,1] row_mask:0xf bank_mask:0xf
    v_mfma_f32_16x16x32_bf16 v[72:75], a[104:107], v[40:43], v[72:75]
    buffer_load_dwordx4 v0, s[4:7], s51 offen offset:3072 sc1 lds
    v_mfma_f32_16x16x32_bf16 v[76:79], a[168:171], v[40:43], v[76:79]
    s_waitcnt lgkmcnt(4)
    ds_read_b128 v[36:39], v94 offset:31744
    s_lshl_b32 s30, s41, 2
    v_mfma_f32_16x16x32_bf16 v[68:71], a[44:47], v[44:47], v[68:71]
    s_cmp_lg_u64 s[56:57], 0
    s_cbranch_scc1 Lrare50
Lrare50b:
    s_waitcnt lgkmcnt(3)
    s_barrier
    v_mfma_f32_16x16x32_bf16 v[72:75], a[108:111], v[44:47], v[72:75]
    s_add_u32 m0, s30, 8192
    ds_read_b32 v92, v2 offset:1792
    s_add_u32 s30, s62, 12288
    v_mfma_f32_16x16x32_bf16 v[76:79], a[172:175], v[44:47], v[76:79]
    s_add_u32 s51, s68, 12288
    ds_read_b128 v[40:43], v94 offset:32768
    v_add_f32_dpp v161, v161, v161 quad_perm:[2,3,0,1] row_mask:0xf bank_mask:0xf
    v_mfma_f32_16x16x32_bf16 v[68:71], a[48:51], v[48:51], v[68:71]
    buffer_load_dwordx4 v0, s[4:7], s30 offen sc1 lds
    v_mfma_f32_16x16x32_bf16 v[72:75], a[112:115], v[48:51], v[72:75]
    s_waitcnt lgkmcnt(1)
    v_fma_f32 v56, -v92, v80, -v56
    v_fma_f32 v57, -v92, v81, -v57
    v_mfma_f32_16x16x32_bf16 v[76:79], a[176:179], v[48:51], v[76:79]
    ds_read_b128 v[44:47], v94 offset:33792
    v_fma_f32 v58, -v92, v82, -v58
    v_mfma_f32_16x16x32_bf16 v[68:71], a[52:55], v[52:55], v[68:71]
    v_fma_f32 v59, -v92, v83, -v59
    v_fma_f32 v60, -v92, v84, -v60
    v_mfma_f32_16x16x32_bf16 v[72:75], a[116:119], v[52:55], v[72:75]
    buffer_load_dwordx4 v0, s[4:7], s30 offen offset:1024 sc1 lds
    v_mfma_f32_16x16x32_bf16 v[76:79], a[180:183], v[52:55], v[76:79]
    ds_read_b128 v[48:51], v94 offset:34816
    v_fma_f32 v61, -v92, v85, -v61
    v_mfma_f32_16x16x32_bf16 v[68:71], a[56:59], v[32:35], v[68:71]
    v_fma_f32 v62, -v92, v86, -v62
    v_fma_f32 v63, -v92, v87, -v63
    v_mfma_f32_16x16x32_bf16 v[72:75], a[120:123], v[32:35], v[72:75]
    v_fma_f32 v64, -v92, v88, -v64
    v_fma_f32 v65, -v92, v89, -v65
    v_mfma_f32_16x16x32_bf16 v[76:79], a[184:187], v[32:35], v[76:79]
    ds_read_b128 v[52:55], v94 offset:35840
    v_fma_f32 v66, -v92, v90, -v66
    v_mfma_f32_16x16x32_bf16 v[68:71], a[60:63], v[36:39], v[68:71]
    ds_read_b32 v93, v2 offset:1856
    v_fma_f32 v67, -v92, v91, -v67
    v_mfma_f32_16x16x32_bf16 v[72:75], a[124:127], v[36:39], v[72:75]
    buffer_load_dwordx4 v0, s[4:7], s51 offen offset:2048 sc1 lds
    v_cvt_pk_bf16_f32 v144, v56, v57
    v_cvt_pk_bf16_f32 v145, v58, v59
    v_cvt_pk_bf16_f32 v146, v60, v61
    v_cvt_pk_bf16_f32 v147, v62, v63
    v_cvt_pk_bf16_f32 v148, v64, v65
    v_cvt_pk_bf16_f32 v149, v66, v67
    v_mfma_f32_16x16x32_bf16 v[76:79], a[188:191], v[36:39], v[76:79]
    s_waitcnt lgkmcnt(4)
    ds_read_b128 v[32:35], v94 offset:36864
    v_pk_max_u16 v144, v144, s17
    v_mfma_f32_16x16x32_bf16 v[56:59], a[0:3], v[40:43], 0
    v_pk_max_u16 v145, v145, s17
    v_pk_max_u16 v146, v146, s17
    v_mfma_f32_16x16x32_bf16 v[60:63], a[64:67], v[40:43], 0
    v_pk_max_u16 v147, v147, s17
    v_pk_max_u16 v148, v148, s17
    v_mfma_f32_16x16x32_bf16 v[64:67], a[128:131], v[40:43], 0
    s_waitcnt lgkmcnt(4)
    ds_read_b128 v[36:39], v94 offset:37888
    v_pk_max_u16 v149, v149, s17
    v_mfma_f32_16x16x32_bf16 v[56:59], a[4:7], v[44:47], v[56:59]
    s_add_u32 s35, s58, 327680
    buffer_load_dwordx4 v0, s[4:7], s51 offen offset:3072 sc1 lds
    v_mfma_f32_16x16x32_bf16 v[60:63], a[68:71], v[44:47], v[60:63]
    s_lshl_b32 s30, s41, 2
    s_waitcnt vmcnt(12)
    ds_read_b128 v[128:131], v28 offset:49152
    v_mfma_f32_16x16x32_bf16 v[64:67], a[132:135], v[44:47], v[64:67]
    s_waitcnt lgkmcnt(5)
    ds_read_b128 v[40:43], v94 offset:38912
    ds_read_b128 v[132:135], v28 offset:50176
    v_mfma_f32_16x16x32_bf16 v[56:59], a[8:11], v[48:51], v[56:59]
    s_add_u32 m0, s30, 12288
    ds_read_b128 v[136:139], v28 offset:51200
    ds_read_b128 v[140:143], v28 offset:52224
    v_mfma_f32_16x16x32_bf16 v[60:63], a[72:75], v[48:51], v[60:63]
    s_add_u32 s30, s62, 16384
    s_add_u32 s51, s68, 16384
    s_add_u32 s36, s59, 327680
    buffer_store_dwordx4 v[144:147], v0, s[4:7], s35 offen
    buffer_store_dwordx2 v[148:149], v9, s[4:7], s36 offen
    v_mfma_f32_16x16x32_bf16 v[64:67], a[136:139], v[48:51], v[64:67]
    s_waitcnt lgkmcnt(8)
    ds_read_b128 v[44:47], v94 offset:39936
    v_add_f32_dpp v160, v160, v160 row_half_mirror row_mask:0xf bank_mask:0xf
    v_mfma_f32_16x16x32_bf16 v[56:59], a[12:15], v[52:55], v[56:59]
    buffer_load_dwordx4 v0, s[4:7], s30 offen sc1 lds
    v_mfma_f32_16x16x32_bf16 v[60:63], a[76:79], v[52:55], v[60:63]
    s_waitcnt lgkmcnt(8)
    v_fma_f32 v68, -v93, v80, -v68
    v_fma_f32 v69, -v93, v81, -v69
    v_mfma_f32_16x16x32_bf16 v[64:67], a[140:143], v[52:55], v[64:67]
    s_waitcnt lgkmcnt(7)
    ds_read_b128 v[48:51], v94 offset:40960
    v_fma_f32 v70, -v93, v82, -v70
    v_mfma_f32_16x16x32_bf16 v[56:59], a[16:19], v[32:35], v[56:59]
    v_fma_f32 v71, -v93, v83, -v71
    v_fma_f32 v72, -v93, v84, -v72
    v_mfma_f32_16x16x32_bf16 v[60:63], a[80:83], v[32:35], v[60:63]
    buffer_load_dwordx4 v0, s[4:7], s30 offen offset:1024 sc1 lds
    v_mfma_f32_16x16x32_bf16 v[64:67], a[144:147], v[32:35], v[64:67]
    s_waitcnt lgkmcnt(7)
    ds_read_b128 v[52:55], v94 offset:41984
    v_fma_f32 v73, -v93, v85, -v73
    v_mfma_f32_16x16x32_bf16 v[56:59], a[20:23], v[36:39], v[56:59]
    v_fma_f32 v74, -v93, v86, -v74
    v_fma_f32 v75, -v93, v87, -v75
    v_mfma_f32_16x16x32_bf16 v[60:63], a[84:87], v[36:39], v[60:63]
    v_fma_f32 v76, -v93, v88, -v76
    v_fma_f32 v77, -v93, v89, -v77
    v_mfma_f32_16x16x32_bf16 v[64:67], a[148:151], v[36:39], v[64:67]
    s_waitcnt lgkmcnt(6)
    ds_read_b128 v[32:35], v94 offset:43008
    v_fma_f32 v78, -v93, v90, -v78
    v_mfma_f32_16x16x32_bf16 v[56:59], a[24:27], v[40:43], v[56:59]
    buffer_load_dwordx4 v0, s[4:7], s51 offen offset:2048 sc1 lds
    v_mfma_f32_16x16x32_bf16 v[60:63], a[88:91], v[40:43], v[60:63]
    v_fma_f32 v79, -v93, v91, -v79
    v_cvt_pk_bf16_f32 v150, v68, v69
    v_mfma_f32_16x16x32_bf16 v[64:67], a[152:155], v[40:43], v[64:67]
    s_waitcnt lgkmcnt(3)
    ds_read_b128 v[36:39], v94 offset:44032
    v_cvt_pk_bf16_f32 v151, v70, v71
    v_mfma_f32_16x16x32_bf16 v[56:59], a[28:31], v[44:47], v[56:59]
    v_cvt_pk_bf16_f32 v152, v72, v73
    v_cvt_pk_bf16_f32 v153, v74, v75
    v_mfma_f32_16x16x32_bf16 v[60:63], a[92:95], v[44:47], v[60:63]
    buffer_load_dwordx4 v0, s[4:7], s51 offen offset:3072 sc1 lds
    v_mfma_f32_16x16x32_bf16 v[64:67], a[156:159], v[44:47], v[64:67]
    s_waitcnt lgkmcnt(3)
    ds_read_b128 v[40:43], v94 offset:45056
    v_cvt_pk_bf16_f32 v154, v76, v77
    v_mfma_f32_16x16x32_bf16 v[56:59], a[32:35], v[48:51], v[56:59]
    v_cvt_pk_bf16_f32 v155, v78, v79
    v_pk_max_u16 v150, v150, s17
    v_mfma_f32_16x16x32_bf16 v[60:63], a[96:99], v[48:51], v[60:63]
    v_pk_max_u16 v151, v151, s17
    v_pk_max_u16 v152, v152, s17
    v_mfma_f32_16x16x32_bf16 v[64:67], a[160:163], v[48:51], v[64:67]
    s_waitcnt lgkmcnt(3)
    ds_read_b128 v[44:47], v94 offset:46080
    v_pk_max_u16 v153, v153, s17
    v_mfma_f32_16x16x32_bf16 v[56:59], a[36:39], v[52:55], v[56:59]
    buffer_load_dwordx4 v[176:179], v0, s[4:7], s62 offen sc1
    v_mfma_f32_16x16x32_bf16 v[60:63], a[100:103], v[52:55], v[60:63]
    v_pk_max_u16 v154, v154, s17
    v_pk_max_u16 v155, v155, s17
    v_mfma_f32_16x16x32_bf16 v[64:67], a[164:167], v[52:55], v[64:67]
    s_waitcnt lgkmcnt(3)
    ds_read_b128 v[48:51], v94 offset:47104
    s_add_u32 s35, s58, 371712
    v_mfma_f32_16x16x32_bf16 v[56:59], a[40:43], v[32:35], v[56:59]
    s_add_u32 s36, s59, 371712
    buffer_store_dwordx4 v[150:153], v0, s[4:7], s35 offen
    v_add_f32_dpp v161, v161, v161 row_half_mirror row_mask:0xf bank_mask:0xf
    v_mul_f32 v160, 0xbb000000, v160
    v_mul_f32 v161, 0x3b000000, v161
    v_fma_f32 v161, -v160, v160, v161
    ds_write_b32 v8, v160 offset:1920
    v_max_f32 v161, 0, v161
    v_add_f32 v161, 0x3727c5ac, v161
    v_rsq_f32 v161, v161
    s_nop 0
    v_mul_f32 v162, v160, v161
    ds_write_b32 v8, v161 offset:1152
    v_mul_f32 v161, s50, v161
    ds_write_b32 v8, v162 offset:1408
    ds_write_b32 v8, v161 offset:1664
    v_mfma_f32_16x16x32_bf16 v[60:63], a[104:107], v[32:35], v[60:63]
    buffer_load_dwordx4 v[180:183], v0, s[4:7], s62 offen offset:1024 sc1
    v_bitop3_b32 v128, v128, v130, v132 bitop3:0x80
    v_bitop3_b32 v134, v134, v136, v138 bitop3:0x80
    v_bitop3_b32 v128, v128, v134, v140 bitop3:0x80
    v_bitop3_b32 v128, v128, v142, 1 bitop3:0x80
    v_cmp_ne_u32 s[56:57], 1, v128
    v_mfma_f32_16x16x32_bf16 v[64:67], a[168:171], v[32:35], v[64:67]
    s_waitcnt lgkmcnt(7)
    ds_read_b128 v[52:55], v94 offset:48128
    v_mfma_f32_16x16x32_bf16 v[56:59], a[44:47], v[36:39], v[56:59]
    s_cmp_lg_u64 s[56:57], 0
    s_cbranch_scc1 Lrare52
Lrare52b:
    s_waitcnt lgkmcnt(1)
    s_barrier
    v_mfma_f32_16x16x32_bf16 v[60:63], a[108:111], v[36:39], v[60:63]
    buffer_store_dwordx2 v[154:155], v9, s[4:7], s36 offen
    v_mfma_f32_16x16x32_bf16 v[64:67], a[172:175], v[36:39], v[64:67]
    ds_read_b128 v[32:35], v94 offset:49152
    v_mfma_f32_16x16x32_bf16 v[56:59], a[48:51], v[40:43], v[56:59]
    buffer_load_dwordx4 v[184:187], v0, s[4:7], s68 offen offset:2048 sc1
    v_mfma_f32_16x16x32_bf16 v[60:63], a[112:115], v[40:43], v[60:63]
    ds_write_b128 v30, v[80:83] offset:2048
    v_mfma_f32_16x16x32_bf16 v[64:67], a[176:179], v[40:43], v[64:67]
    ds_read_b128 v[36:39], v94 offset:50176
    v_mfma_f32_16x16x32_bf16 v[56:59], a[52:55], v[44:47], v[56:59]
    ds_write_b128 v30, v[84:87] offset:2112
    v_mfma_f32_16x16x32_bf16 v[60:63], a[116:119], v[44:47], v[60:63]
    buffer_load_dwordx4 v[188:191], v0, s[4:7], s68 offen offset:3072 sc1
    s_cmp_eq_u32 s24, 3
    s_cbranch_scc1 Lskip54
    s_add_u32 m0, s16, 0
    s_add_u32 s30, s62, 20480
    s_add_u32 s51, s68, 20480
    buffer_load_dwordx4 v0, s[4:7], s30 offen sc1 lds
    buffer_load_dwordx4 v0, s[4:7], s30 offen offset:1024 sc1 lds
    buffer_load_dwordx4 v0, s[4:7], s51 offen offset:2048 sc1 lds
    buffer_load_dwordx4 v0, s[4:7], s51 offen offset:3072 sc1 lds
Lskip54:
    v_mfma_f32_16x16x32_bf16 v[64:67], a[180:183], v[44:47], v[64:67]
    s_add_u32 m0, s16, 4096
    ds_read_b128 v[40:43], v94 offset:51200
    s_add_u32 s30, s21, 0
    v_mfma_f32_16x16x32_bf16 v[56:59], a[56:59], v[48:51], v[56:59]
    s_add_u32 s51, s22, 0
    ds_write_b128 v30, v[88:91] offset:2176
    v_mfma_f32_16x16x32_bf16 v[60:63], a[120:123], v[48:51], v[60:63]
    v_mfma_f32_16x16x32_bf16 v[64:67], a[184:187], v[48:51], v[64:67]
    s_waitcnt lgkmcnt(6)
    ds_read_b128 v[44:47], v94 offset:52224
    v_mfma_f32_16x16x32_bf16 v[56:59], a[60:63], v[52:55], v[56:59]
    ds_read_b32 v92, v2 offset:1920
    v_mfma_f32_16x16x32_bf16 v[60:63], a[124:127], v[52:55], v[60:63]
    buffer_load_dwordx4 v0, s[4:7], s30 offen sc1 lds
    v_mfma_f32_16x16x32_bf16 v[64:67], a[188:191], v[52:55], v[64:67]
    s_waitcnt lgkmcnt(7)
    ds_read_b128 v[48:51], v94 offset:53248
    v_mfma_f32_16x16x32_bf16 v[68:71], a[0:3], v[32:35], 0
    v_mfma_f32_16x16x32_bf16 v[72:75], a[64:67], v[32:35], 0
    v_mfma_f32_16x16x32_bf16 v[76:79], a[128:131], v[32:35], 0
    s_waitcnt lgkmcnt(6)
    ds_read_b128 v[52:55], v94 offset:54272
    s_waitcnt vmcnt(3)
    v_mfma_f32_16x16x32_bf16 v[68:71], a[4:7], v[36:39], v[68:71]
    buffer_store_dword v5, v4, s[4:7], s18 offen offset:128
    v_mfma_f32_16x16x32_bf16 v[72:75], a[68:71], v[36:39], v[72:75]
    buffer_load_dwordx4 v0, s[4:7], s30 offen offset:1024 sc1 lds
    v_mfma_f32_16x16x32_bf16 v[76:79], a[132:135], v[36:39], v[76:79]
    s_waitcnt lgkmcnt(5)
    ds_read_b128 v[32:35], v94 offset:55296
    v_mfma_f32_16x16x32_bf16 v[68:71], a[8:11], v[40:43], v[68:71]
    s_waitcnt lgkmcnt(3)
    v_fma_f32 v56, -v92, v80, -v56
    v_fma_f32 v57, -v92, v81, -v57
    v_mfma_f32_16x16x32_bf16 v[72:75], a[72:75], v[40:43], v[72:75]
    v_fma_f32 v58, -v92, v82, -v58
    v_fma_f32 v59, -v92, v83, -v59
    v_mfma_f32_16x16x32_bf16 v[76:79], a[136:139], v[40:43], v[76:79]
    ds_read_b128 v[36:39], v94 offset:56320
    v_fma_f32 v60, -v92, v84, -v60
    v_mfma_f32_16x16x32_bf16 v[68:71], a[12:15], v[44:47], v[68:71]
    s_barrier
    buffer_load_dwordx4 v0, s[4:7], s51 offen offset:2048 sc1 lds
    v_mfma_f32_16x16x32_bf16 v[72:75], a[76:79], v[44:47], v[72:75]
    v_fma_f32 v61, -v92, v85, -v61
    v_fma_f32 v62, -v92, v86, -v62
    v_mfma_f32_16x16x32_bf16 v[76:79], a[140:143], v[44:47], v[76:79]
    s_waitcnt lgkmcnt(3)
    ds_read_b128 v[40:43], v94 offset:57344
    v_fma_f32 v63, -v92, v87, -v63
    v_mfma_f32_16x16x32_bf16 v[68:71], a[16:19], v[48:51], v[68:71]
    v_fma_f32 v64, -v92, v88, -v64
    v_fma_f32 v65, -v92, v89, -v65
    v_mfma_f32_16x16x32_bf16 v[72:75], a[80:83], v[48:51], v[72:75]
    buffer_load_dwordx4 v0, s[4:7], s51 offen offset:3072 sc1 lds
    v_mfma_f32_16x16x32_bf16 v[76:79], a[144:147], v[48:51], v[76:79]
    s_waitcnt lgkmcnt(3)
    ds_read_b128 v[44:47], v94 offset:58368
    s_add_u32 m0, s41, 65536
    v_mfma_f32_16x16x32_bf16 v[68:71], a[20:23], v[52:55], v[68:71]
    s_add_u32 s30, s63, 0
    s_add_u32 s51, s69, 0
    v_fma_f32 v66, -v92, v90, -v66
    v_mfma_f32_16x16x32_bf16 v[72:75], a[84:87], v[52:55], v[72:75]
    v_fma_f32 v67, -v92, v91, -v67
    v_cvt_pk_bf16_f32 v144, v56, v57
    v_mfma_f32_16x16x32_bf16 v[76:79], a[148:151], v[52:55], v[76:79]
    s_waitcnt lgkmcnt(3)
    ds_read_b128 v[48:51], v94 offset:59392
    v_cvt_pk_bf16_f32 v145, v58, v59
    v_mfma_f32_16x16x32_bf16 v[68:71], a[24:27], v[32:35], v[68:71]
    buffer_load_dwordx4 v0, s[4:7], s30 offen sc1 lds
    v_mfma_f32_16x16x32_bf16 v[72:75], a[88:91], v[32:35], v[72:75]
    v_cvt_pk_bf16_f32 v146, v60, v61
    v_cvt_pk_bf16_f32 v147, v62, v63
    v_mfma_f32_16x16x32_bf16 v[76:79], a[152:155], v[32:35], v[76:79]
    s_waitcnt lgkmcnt(3)
    ds_read_b128 v[52:55], v94 offset:60416
    v_cvt_pk_bf16_f32 v148, v64, v65
    v_mfma_f32_16x16x32_bf16 v[68:71], a[28:31], v[36:39], v[68:71]
    v_cvt_pk_bf16_f32 v149, v66, v67
    v_pk_max_u16 v144, v144, s17
    v_mfma_f32_16x16x32_bf16 v[72:75], a[92:95], v[36:39], v[72:75]
    buffer_load_dwordx4 v0, s[4:7], s30 offen offset:1024 sc1 lds
    v_mfma_f32_16x16x32_bf16 v[76:79], a[156:159], v[36:39], v[76:79]
    s_waitcnt lgkmcnt(3)
    ds_read_b128 v[32:35], v94 offset:61440
    v_pk_max_u16 v145, v145, s17
    v_mfma_f32_16x16x32_bf16 v[68:71], a[32:35], v[40:43], v[68:71]
    v_pk_max_u16 v146, v146, s17
    v_pk_max_u16 v147, v147, s17
    v_mfma_f32_16x16x32_bf16 v[72:75], a[96:99], v[40:43], v[72:75]
    v_pk_max_u16 v148, v148, s17
    v_pk_max_u16 v149, v149, s17
    v_mfma_f32_16x16x32_bf16 v[76:79], a[160:163], v[40:43], v[76:79]
    s_waitcnt lgkmcnt(3)
    ds_read_b128 v[36:39], v94 offset:62464
    s_add_u32 s35, s58, 415744
    v_mfma_f32_16x16x32_bf16 v[68:71], a[36:39], v[44:47], v[68:71]
    s_add_u32 s36, s59, 415744
    buffer_load_dwordx4 v0, s[4:7], s51 offen offset:2048 sc1 lds
    v_mfma_f32_16x16x32_bf16 v[72:75], a[100:103], v[44:47], v[72:75]
    buffer_store_dwordx4 v[144:147], v0, s[4:7], s35 offen
    v_mfma_f32_16x16x32_bf16 v[76:79], a[164:167], v[44:47], v[76:79]
    s_waitcnt lgkmcnt(3)
    ds_read_b128 v[40:43], v94 offset:63488
    v_mfma_f32_16x16x32_bf16 v[68:71], a[40:43], v[48:51], v[68:71]
    buffer_store_dwordx2 v[148:149], v9, s[4:7], s36 offen
    v_mfma_f32_16x16x32_bf16 v[72:75], a[104:107], v[48:51], v[72:75]
    buffer_load_dwordx4 v0, s[4:7], s51 offen offset:3072 sc1 lds
    v_mfma_f32_16x16x32_bf16 v[76:79], a[168:171], v[48:51], v[76:79]
    s_waitcnt lgkmcnt(3)
    ds_read_b128 v[44:47], v94 offset:64512
    s_add_u32 m0, s41, 81920
    v_mfma_f32_16x16x32_bf16 v[68:71], a[44:47], v[52:55], v[68:71]
    s_add_u32 s30, s63, 4096
    s_add_u32 s51, s69, 4096
    v_mfma_f32_16x16x32_bf16 v[72:75], a[108:111], v[52:55], v[72:75]
    v_mfma_f32_16x16x32_bf16 v[76:79], a[172:175], v[52:55], v[76:79]
    s_waitcnt lgkmcnt(3)
    buffer_load_dwordx4 v0, s[4:7], s30 offen sc1 lds
    v_mfma_f32_16x16x32_bf16 v[68:71], a[48:51], v[32:35], v[68:71]
    v_mfma_f32_16x16x32_bf16 v[72:75], a[112:115], v[32:35], v[72:75]
    v_mfma_f32_16x16x32_bf16 v[76:79], a[176:179], v[32:35], v[76:79]
    s_waitcnt lgkmcnt(2)
    v_mfma_f32_16x16x32_bf16 v[68:71], a[52:55], v[36:39], v[68:71]
    buffer_load_dwordx4 v0, s[4:7], s30 offen offset:1024 sc1 lds
    v_mfma_f32_16x16x32_bf16 v[72:75], a[116:119], v[36:39], v[72:75]
    v_mfma_f32_16x16x32_bf16 v[76:79], a[180:183], v[36:39], v[76:79]
    s_waitcnt lgkmcnt(1)
    v_mfma_f32_16x16x32_bf16 v[68:71], a[56:59], v[40:43], v[68:71]
    ds_read_b32 v93, v2 offset:1984
    v_mfma_f32_16x16x32_bf16 v[72:75], a[120:123], v[40:43], v[72:75]
    buffer_load_dwordx4 v0, s[4:7], s51 offen offset:2048 sc1 lds
    v_mfma_f32_16x16x32_bf16 v[76:79], a[184:187], v[40:43], v[76:79]
    s_waitcnt lgkmcnt(1)
    v_mfma_f32_16x16x32_bf16 v[68:71], a[60:63], v[44:47], v[68:71]
    v_mfma_f32_16x16x32_bf16 v[72:75], a[124:127], v[44:47], v[72:75]
    v_mfma_f32_16x16x32_bf16 v[76:79], a[188:191], v[44:47], v[76:79]
    buffer_load_dwordx4 v0, s[4:7], s51 offen offset:3072 sc1 lds
    s_waitcnt vmcnt(10)
    s_barrier
    s_waitcnt lgkmcnt(0)
    s_nop 1
    v_pk_fma_f32 v[68:69], v[80:81], v[92:93], v[68:69] op_sel:[0,1,0] op_sel_hi:[1,1,1] neg_lo:[0,1,1] neg_hi:[0,1,1]
    v_pk_fma_f32 v[70:71], v[82:83], v[92:93], v[70:71] op_sel:[0,1,0] op_sel_hi:[1,1,1] neg_lo:[0,1,1] neg_hi:[0,1,1]
    v_pk_fma_f32 v[72:73], v[84:85], v[92:93], v[72:73] op_sel:[0,1,0] op_sel_hi:[1,1,1] neg_lo:[0,1,1] neg_hi:[0,1,1]
    v_pk_fma_f32 v[74:75], v[86:87], v[92:93], v[74:75] op_sel:[0,1,0] op_sel_hi:[1,1,1] neg_lo:[0,1,1] neg_hi:[0,1,1]
    v_pk_fma_f32 v[76:77], v[88:89], v[92:93], v[76:77] op_sel:[0,1,0] op_sel_hi:[1,1,1] neg_lo:[0,1,1] neg_hi:[0,1,1]
    v_pk_fma_f32 v[78:79], v[90:91], v[92:93], v[78:79] op_sel:[0,1,0] op_sel_hi:[1,1,1] neg_lo:[0,1,1] neg_hi:[0,1,1]
    v_cvt_pk_bf16_f32 v150, v68, v69
    v_cvt_pk_bf16_f32 v151, v70, v71
    v_cvt_pk_bf16_f32 v152, v72, v73
    v_cvt_pk_bf16_f32 v153, v74, v75
    v_cvt_pk_bf16_f32 v154, v76, v77
    v_cvt_pk_bf16_f32 v155, v78, v79
    v_pk_max_u16 v150, v150, s17
    v_pk_max_u16 v151, v151, s17
    v_pk_max_u16 v152, v152, s17
    v_pk_max_u16 v153, v153, s17
    v_pk_max_u16 v154, v154, s17
    v_pk_max_u16 v155, v155, s17
    s_add_u32 s35, s58, 459776
    s_add_u32 s36, s59, 459776
    buffer_store_dwordx4 v[150:153], v0, s[4:7], s35 offen
    buffer_store_dwordx2 v[154:155], v9, s[4:7], s36 offen
    s_add_u32 m0, s41, 98304
    s_add_u32 s30, s63, 8192
    s_add_u32 s51, s69, 8192
    buffer_load_dwordx4 v0, s[4:7], s30 offen sc1 lds
    buffer_load_dwordx4 v0, s[4:7], s30 offen offset:1024 sc1 lds
    buffer_load_dwordx4 v0, s[4:7], s51 offen offset:2048 sc1 lds
    buffer_load_dwordx4 v0, s[4:7], s51 offen offset:3072 sc1 lds
    buffer_load_dword v31, v3, s[4:7], s37 offen offset:128 sc1
    s_waitcnt vmcnt(0)
    v_cmp_ne_u32 vcc, s29, v31
    s_cbranch_vccnz Lrare55
Lrare55b:
    s_add_u32 s64, s60, 327680
    s_add_u32 s65, s64, s73
    buffer_load_dwordx4 v[96:99], v0, s[4:7], s64 offen offset:0 sc1
    buffer_load_dwordx4 v[100:103], v0, s[4:7], s65 offen offset:0 sc1
    buffer_load_dwordx4 v[104:107], v0, s[4:7], s64 offen offset:1024 sc1
    buffer_load_dwordx4 v[108:111], v0, s[4:7], s65 offen offset:1024 sc1
    buffer_load_dwordx4 v[112:115], v0, s[4:7], s64 offen offset:2048 sc1
    buffer_load_dwordx4 v[116:119], v0, s[4:7], s65 offen offset:2048 sc1
    buffer_load_dwordx4 v[120:123], v0, s[4:7], s64 offen offset:3072 sc1
    buffer_load_dwordx4 v[124:127], v0, s[4:7], s65 offen offset:3072 sc1
    s_lshl_b32 s31, s41, 2
    s_add_u32 s31, s31, 0
    v_add_u32 v28, s31, v0
    s_add_u32 s31, s41, 65536
    v_add_u32 v29, s31, v0
    v_add_u32 v30, s16, v0
    s_waitcnt vmcnt(7)
    v_mfma_f32_16x16x32_bf16 v[32:35], v[176:179], v[96:99], 0
    s_waitcnt vmcnt(6)
    ds_read_b128 v[160:163], v28 offset:0
    ds_read_b128 v[164:167], v28 offset:1024
    v_mfma_f32_16x16x32_bf16 v[48:51], v[176:179], v[100:103], 0
    s_add_u32 s64, s60, 331776
    ds_read_b128 v[168:171], v28 offset:2048
    ds_read_b128 v[172:175], v28 offset:3072
    v_mfma_f32_16x16x32_bf16 v[36:39], v[180:183], v[96:99], 0
    s_add_u32 s65, s64, s73
    buffer_load_dwordx4 v[128:131], v0, s[4:7], s64 offen offset:0 sc1
    v_mfma_f32_16x16x32_bf16 v[52:55], v[180:183], v[100:103], 0
    v_mfma_f32_16x16x32_bf16 v[40:43], v[184:187], v[96:99], 0
    buffer_load_dwordx4 v[132:135], v0, s[4:7], s65 offen offset:0 sc1
    v_mfma_f32_16x16x32_bf16 v[56:59], v[184:187], v[100:103], 0
    s_add_u32 s64, s15, 327680
    s_add_u32 s65, s64, s73
    v_mfma_f32_16x16x32_bf16 v[44:47], v[188:191], v[96:99], 0
    buffer_load_dwordx4 v[136:139], v0, s[4:7], s64 offen offset:0 sc1
    v_mfma_f32_16x16x32_bf16 v[60:63], v[188:191], v[100:103], 0
    s_waitcnt lgkmcnt(2)
    s_waitcnt vmcnt(8)
    v_mfma_f32_16x16x32_bf16 v[32:35], v[160:163], v[104:107], v[32:35]
    s_waitcnt vmcnt(7)
    ds_read_b128 v[144:147], v28 offset:4096
    ds_read_b128 v[148:151], v28 offset:5120
    v_mfma_f32_16x16x32_bf16 v[48:51], v[160:163], v[108:111], v[48:51]
    ds_read_b128 v[152:155], v28 offset:6144
    ds_read_b128 v[156:159], v28 offset:7168
    v_mfma_f32_16x16x32_bf16 v[36:39], v[164:167], v[104:107], v[36:39]
    s_waitcnt lgkmcnt(4)
    buffer_load_dwordx4 v[140:143], v0, s[4:7], s65 offen offset:0 sc1
    v_mfma_f32_16x16x32_bf16 v[52:55], v[164:167], v[108:111], v[52:55]
    v_mfma_f32_16x16x32_bf16 v[40:43], v[168:171], v[104:107], v[40:43]
    buffer_store_dword v5, v4, s[4:7], s18 offen offset:256
    v_mfma_f32_16x16x32_bf16 v[56:59], v[168:171], v[108:111], v[56:59]
    s_add_u32 s64, s20, 327680
    s_add_u32 s65, s64, s73
    v_mfma_f32_16x16x32_bf16 v[44:47], v[172:175], v[104:107], v[44:47]
    buffer_load_dwordx4 v[96:99], v0, s[4:7], s64 offen offset:0 sc1
    v_mfma_f32_16x16x32_bf16 v[60:63], v[172:175], v[108:111], v[60:63]
    s_waitcnt lgkmcnt(2)
    s_waitcnt vmcnt(9)
    v_mfma_f32_16x16x32_bf16 v[32:35], v[144:147], v[112:115], v[32:35]
    s_waitcnt vmcnt(8)
    ds_read_b128 v[160:163], v28 offset:8192
    ds_read_b128 v[164:167], v28 offset:9216
    v_mfma_f32_16x16x32_bf16 v[48:51], v[144:147], v[116:119], v[48:51]
    ds_read_b128 v[168:171], v28 offset:10240
    ds_read_b128 v[172:175], v28 offset:11264
    v_mfma_f32_16x16x32_bf16 v[36:39], v[148:151], v[112:115], v[36:39]
    s_waitcnt lgkmcnt(4)
    buffer_load_dwordx4 v[100:103], v0, s[4:7], s65 offen offset:0 sc1
    v_mfma_f32_16x16x32_bf16 v[52:55], v[148:151], v[116:119], v[52:55]
    s_add_u32 s64, s61, 327680
    s_add_u32 s65, s64, s73
    v_mfma_f32_16x16x32_bf16 v[40:43], v[152:155], v[112:115], v[40:43]
    buffer_load_dwordx4 v[104:107], v0, s[4:7], s64 offen offset:0 sc1
    v_mfma_f32_16x16x32_bf16 v[56:59], v[152:155], v[116:119], v[56:59]
    v_mfma_f32_16x16x32_bf16 v[44:47], v[156:159], v[112:115], v[44:47]
    buffer_load_dwordx4 v[108:111], v0, s[4:7], s65 offen offset:0 sc1
    v_mfma_f32_16x16x32_bf16 v[60:63], v[156:159], v[116:119], v[60:63]
    s_waitcnt lgkmcnt(2)
    s_waitcnt vmcnt(10)
    s_add_u32 m0, s41, 114688
    v_mfma_f32_16x16x32_bf16 v[32:35], v[160:163], v[120:123], v[32:35]
    s_waitcnt vmcnt(9)
    ds_read_b128 v[144:147], v28 offset:12288
    ds_read_b128 v[148:151], v28 offset:13312
    v_mfma_f32_16x16x32_bf16 v[48:51], v[160:163], v[124:127], v[48:51]
    s_add_u32 s30, s63, 12288
    ds_read_b128 v[152:155], v28 offset:14336
    ds_read_b128 v[156:159], v28 offset:15360
    v_mfma_f32_16x16x32_bf16 v[36:39], v[164:167], v[120:123], v[36:39]
    s_waitcnt lgkmcnt(4)
    s_add_u32 s51, s69, 12288
    v_mfma_f32_16x16x32_bf16 v[52:55], v[164:167], v[124:127], v[52:55]
    buffer_load_dwordx4 v0, s[4:7], s30 offen sc1 lds
    v_mfma_f32_16x16x32_bf16 v[40:43], v[168:171], v[120:123], v[40:43]
    v_mfma_f32_16x16x32_bf16 v[56:59], v[168:171], v[124:127], v[56:59]
    buffer_load_dwordx4 v0, s[4:7], s30 offen offset:1024 sc1 lds
    v_mfma_f32_16x16x32_bf16 v[44:47], v[172:175], v[120:123], v[44:47]
    v_mfma_f32_16x16x32_bf16 v[60:63], v[172:175], v[124:127], v[60:63]
    s_waitcnt lgkmcnt(2)
    s_waitcnt vmcnt(10)
    v_mfma_f32_16x16x32_bf16 v[32:35], v[144:147], v[128:131], v[32:35]
    s_waitcnt vmcnt(9)
    ds_read_b128 v[160:163], v30 offset:0
    ds_read_b128 v[164:167], v30 offset:1024
    v_mfma_f32_16x16x32_bf16 v[48:51], v[144:147], v[132:135], v[48:51]
    ds_read_b128 v[168:171], v30 offset:2048
    ds_read_b128 v[172:175], v30 offset:3072
    v_mfma_f32_16x16x32_bf16 v[36:39], v[148:151], v[128:131], v[36:39]
    s_waitcnt lgkmcnt(4)
    buffer_load_dwordx4 v0, s[4:7], s51 offen offset:2048 sc1 lds
    v_mfma_f32_16x16x32_bf16 v[52:55], v[148:151], v[132:135], v[52:55]
    v_mfma_f32_16x16x32_bf16 v[40:43], v[152:155], v[128:131], v[40:43]
    buffer_load_dwordx4 v0, s[4:7], s51 offen offset:3072 sc1 lds
    v_mfma_f32_16x16x32_bf16 v[56:59], v[152:155], v[132:135], v[56:59]
    v_mfma_f32_16x16x32_bf16 v[44:47], v[156:159], v[128:131], v[44:47]
    buffer_load_dwordx4 v[112:115], v0, s[4:7], s64 offen offset:1024 sc1
    v_mfma_f32_16x16x32_bf16 v[60:63], v[156:159], v[132:135], v[60:63]
    s_waitcnt lgkmcnt(2)
    s_waitcnt vmcnt(11)
    v_mfma_f32_16x16x32_bf16 v[32:35], v[160:163], v[136:139], v[32:35]
    s_waitcnt vmcnt(10)
    ds_read_b128 v[144:147], v30 offset:4096
    ds_read_b128 v[148:151], v30 offset:5120
    v_mfma_f32_16x16x32_bf16 v[48:51], v[160:163], v[140:143], v[48:51]
    ds_read_b128 v[152:155], v30 offset:6144
    ds_read_b128 v[156:159], v30 offset:7168
    v_mfma_f32_16x16x32_bf16 v[36:39], v[164:167], v[136:139], v[36:39]
    s_waitcnt lgkmcnt(4)
    buffer_load_dwordx4 v[116:119], v0, s[4:7], s65 offen offset:1024 sc1
    v_mfma_f32_16x16x32_bf16 v[52:55], v[164:167], v[140:143], v[52:55]
    v_mfma_f32_16x16x32_bf16 v[40:43], v[168:171], v[136:139], v[40:43]
    buffer_load_dword v31, v3, s[4:7], s37 offen offset:256 sc1
    v_mfma_f32_16x16x32_bf16 v[56:59], v[168:171], v[140:143], v[56:59]
    v_mfma_f32_16x16x32_bf16 v[44:47], v[172:175], v[136:139], v[44:47]
    buffer_load_dwordx4 v[120:123], v0, s[4:7], s64 offen offset:2048 sc1
    v_mfma_f32_16x16x32_bf16 v[60:63], v[172:175], v[140:143], v[60:63]
    s_waitcnt lgkmcnt(2)
    s_waitcnt vmcnt(11)
    v_mfma_f32_16x16x32_bf16 v[32:35], v[144:147], v[96:99], v[32:35]
    s_waitcnt vmcnt(10)
    ds_read_b128 v[160:163], v29 offset:0
    ds_read_b128 v[164:167], v29 offset:1024
    v_mfma_f32_16x16x32_bf16 v[48:51], v[144:147], v[100:103], v[48:51]
    ds_read_b128 v[168:171], v29 offset:2048
    ds_read_b128 v[172:175], v29 offset:3072
    v_mfma_f32_16x16x32_bf16 v[36:39], v[148:151], v[96:99], v[36:39]
    s_waitcnt lgkmcnt(4)
    buffer_load_dwordx4 v[124:127], v0, s[4:7], s65 offen offset:2048 sc1
    v_mfma_f32_16x16x32_bf16 v[52:55], v[148:151], v[100:103], v[52:55]
    v_mfma_f32_16x16x32_bf16 v[40:43], v[152:155], v[96:99], v[40:43]
    buffer_load_dwordx4 v[128:131], v0, s[4:7], s64 offen offset:3072 sc1
    v_mfma_f32_16x16x32_bf16 v[56:59], v[152:155], v[100:103], v[56:59]
    v_mfma_f32_16x16x32_bf16 v[44:47], v[156:159], v[96:99], v[44:47]
    buffer_load_dwordx4 v[132:135], v0, s[4:7], s65 offen offset:3072 sc1
    s_waitcnt vmcnt(4)
    v_cmp_ne_u32 vcc, s29, v31
    s_cbranch_vccnz Lrare57
Lrare57b:
    v_mfma_f32_16x16x32_bf16 v[60:63], v[156:159], v[100:103], v[60:63]
    s_waitcnt lgkmcnt(2)
    s_add_u32 s64, s60, 415744
    s_add_u32 s65, s64, s73
    v_mfma_f32_16x16x32_bf16 v[32:35], v[160:163], v[104:107], v[32:35]
    ds_read_b128 v[144:147], v29 offset:16384
    ds_read_b128 v[148:151], v29 offset:17408
    v_mfma_f32_16x16x32_bf16 v[48:51], v[160:163], v[108:111], v[48:51]
    ds_read_b128 v[152:155], v29 offset:18432
    ds_read_b128 v[156:159], v29 offset:19456
    v_mfma_f32_16x16x32_bf16 v[36:39], v[164:167], v[104:107], v[36:39]
    s_waitcnt lgkmcnt(4)
    buffer_load_dwordx4 v[136:139], v0, s[4:7], s64 offen offset:0 sc1
    v_mfma_f32_16x16x32_bf16 v[52:55], v[164:167], v[108:111], v[52:55]
    v_mfma_f32_16x16x32_bf16 v[40:43], v[168:171], v[104:107], v[40:43]
    buffer_load_dwordx4 v[140:143], v0, s[4:7], s65 offen offset:0 sc1
    v_mfma_f32_16x16x32_bf16 v[56:59], v[168:171], v[108:111], v[56:59]
    v_mfma_f32_16x16x32_bf16 v[44:47], v[172:175], v[104:107], v[44:47]
    buffer_load_dwordx4 v[96:99], v0, s[4:7], s64 offen offset:1024 sc1
    v_mfma_f32_16x16x32_bf16 v[60:63], v[172:175], v[108:111], v[60:63]
    s_waitcnt lgkmcnt(2)
    v_mfma_f32_16x16x32_bf16 v[32:35], v[144:147], v[112:115], v[32:35]
    ds_read_b128 v[160:163], v29 offset:32768
    ds_read_b128 v[164:167], v29 offset:33792
    v_mfma_f32_16x16x32_bf16 v[48:51], v[144:147], v[116:119], v[48:51]
    ds_read_b128 v[168:171], v29 offset:34816
    ds_read_b128 v[172:175], v29 offset:35840
    v_mfma_f32_16x16x32_bf16 v[36:39], v[148:151], v[112:115], v[36:39]
    s_waitcnt lgkmcnt(4)
    buffer_load_dwordx4 v[100:103], v0, s[4:7], s65 offen offset:1024 sc1
    v_mfma_f32_16x16x32_bf16 v[52:55], v[148:151], v[116:119], v[52:55]
    v_mfma_f32_16x16x32_bf16 v[40:43], v[152:155], v[112:115], v[40:43]
    buffer_load_dwordx4 v[104:107], v0, s[4:7], s64 offen offset:2048 sc1
    v_mfma_f32_16x16x32_bf16 v[56:59], v[152:155], v[116:119], v[56:59]
    v_mfma_f32_16x16x32_bf16 v[44:47], v[156:159], v[112:115], v[44:47]
    buffer_load_dwordx4 v[108:111], v0, s[4:7], s65 offen offset:2048 sc1
    v_mfma_f32_16x16x32_bf16 v[60:63], v[156:159], v[116:119], v[60:63]
    s_waitcnt lgkmcnt(2)
    s_waitcnt vmcnt(9)
    v_mfma_f32_16x16x32_bf16 v[32:35], v[160:163], v[120:123], v[32:35]
    s_waitcnt vmcnt(8)
    ds_read_b128 v[144:147], v29 offset:49152
    ds_read_b128 v[148:151], v29 offset:50176
    v_mfma_f32_16x16x32_bf16 v[48:51], v[160:163], v[124:127], v[48:51]
    ds_read_b128 v[152:155], v29 offset:51200
    ds_read_b128 v[156:159], v29 offset:52224
    v_mfma_f32_16x16x32_bf16 v[36:39], v[164:167], v[120:123], v[36:39]
    s_waitcnt lgkmcnt(4)
    buffer_load_dwordx4 v[112:115], v0, s[4:7], s64 offen offset:3072 sc1
    v_mfma_f32_16x16x32_bf16 v[52:55], v[164:167], v[124:127], v[52:55]
    v_mfma_f32_16x16x32_bf16 v[40:43], v[168:171], v[120:123], v[40:43]
    buffer_load_dwordx4 v[116:119], v0, s[4:7], s65 offen offset:3072 sc1
    v_mfma_f32_16x16x32_bf16 v[56:59], v[168:171], v[124:127], v[56:59]
    v_mfma_f32_16x16x32_bf16 v[44:47], v[172:175], v[120:123], v[44:47]
    v_mfma_f32_16x16x32_bf16 v[60:63], v[172:175], v[124:127], v[60:63]
    s_waitcnt lgkmcnt(2)
    s_waitcnt vmcnt(9)
    v_mfma_f32_16x16x32_bf16 v[32:35], v[144:147], v[128:131], v[32:35]
    s_waitcnt vmcnt(8)
    s_add_u32 s64, s60, 419840
    s_add_u32 s65, s64, s73
    v_mfma_f32_16x16x32_bf16 v[48:51], v[144:147], v[132:135], v[48:51]
    buffer_load_dwordx4 v[120:123], v0, s[4:7], s64 offen offset:0 sc1
    v_mfma_f32_16x16x32_bf16 v[36:39], v[148:151], v[128:131], v[36:39]
    s_waitcnt lgkmcnt(0)
    v_mfma_f32_16x16x32_bf16 v[52:55], v[148:151], v[132:135], v[52:55]
    buffer_load_dwordx4 v[124:127], v0, s[4:7], s65 offen offset:0 sc1
    v_mfma_f32_16x16x32_bf16 v[40:43], v[152:155], v[128:131], v[40:43]
    v_mfma_f32_16x16x32_bf16 v[56:59], v[152:155], v[132:135], v[56:59]
    v_mfma_f32_16x16x32_bf16 v[44:47], v[156:159], v[128:131], v[44:47]
    v_mfma_f32_16x16x32_bf16 v[60:63], v[156:159], v[132:135], v[60:63]
    s_waitcnt vmcnt(9)
    v_mfma_f32_16x16x32_bf16 v[64:67], v[176:179], v[136:139], 0
    s_waitcnt vmcnt(8)
    ds_read_b128 v[160:163], v28 offset:0
    ds_read_b128 v[164:167], v28 offset:1024
    v_mfma_f32_16x16x32_bf16 v[80:83], v[176:179], v[140:143], 0
    s_add_u32 s64, s15, 415744
    ds_read_b128 v[168:171], v28 offset:2048
    ds_read_b128 v[172:175], v28 offset:3072
    v_mfma_f32_16x16x32_bf16 v[68:71], v[180:183], v[136:139], 0
    s_add_u32 s65, s64, s73
    buffer_load_dwordx4 v[128:131], v0, s[4:7], s64 offen offset:0 sc1
    v_mfma_f32_16x16x32_bf16 v[84:87], v[180:183], v[140:143], 0
    v_mfma_f32_16x16x32_bf16 v[72:75], v[184:187], v[136:139], 0
    buffer_load_dwordx4 v[132:135], v0, s[4:7], s65 offen offset:0 sc1
    v_mfma_f32_16x16x32_bf16 v[88:91], v[184:187], v[140:143], 0
    v_mfma_f32_16x16x32_bf16 v[76:79], v[188:191], v[136:139], 0
    v_mfma_f32_16x16x32_bf16 v[92:95], v[188:191], v[140:143], 0
    s_waitcnt lgkmcnt(2)
    s_waitcnt vmcnt(9)
    v_mfma_f32_16x16x32_bf16 v[64:67], v[160:163], v[96:99], v[64:67]
    s_waitcnt vmcnt(8)
    ds_read_b128 v[144:147], v28 offset:4096
    ds_read_b128 v[148:151], v28 offset:5120
    v_mfma_f32_16x16x32_bf16 v[80:83], v[160:163], v[100:103], v[80:83]
    s_add_u32 s64, s20, 415744
    ds_read_b128 v[152:155], v28 offset:6144
    ds_read_b128 v[156:159], v28 offset:7168
    v_mfma_f32_16x16x32_bf16 v[68:71], v[164:167], v[96:99], v[68:71]
    s_waitcnt lgkmcnt(4)
    s_add_u32 s65, s64, s73
    v_xor_b32 v177, 16384, v28
    v_mfma_f32_16x16x32_bf16 v[84:87], v[164:167], v[100:103], v[84:87]
    buffer_load_dwordx4 v[136:139], v0, s[4:7], s64 offen offset:0 sc1
    v_mfma_f32_16x16x32_bf16 v[72:75], v[168:171], v[96:99], v[72:75]
    v_xor_b32 v178, 32768, v28
    v_xor_b32 v179, 49152, v28
    v_mfma_f32_16x16x32_bf16 v[88:91], v[168:171], v[100:103], v[88:91]
    s_and_b32 s35, s24, 2
    buffer_load_dwordx4 v[140:143], v0, s[4:7], s65 offen offset:0 sc1
    v_mfma_f32_16x16x32_bf16 v[76:79], v[172:175], v[96:99], v[76:79]
    s_lshl_b32 s35, s35, 5
    v_add_u32 v176, s35, v2
    v_mfma_f32_16x16x32_bf16 v[92:95], v[172:175], v[100:103], v[92:95]
    s_waitcnt lgkmcnt(2)
    s_waitcnt vmcnt(9)
    v_mfma_f32_16x16x32_bf16 v[64:67], v[144:147], v[104:107], v[64:67]
    s_waitcnt vmcnt(8)
    ds_read_b128 v[160:163], v28 offset:8192
    ds_read_b128 v[164:167], v28 offset:9216
    v_mfma_f32_16x16x32_bf16 v[80:83], v[144:147], v[108:111], v[80:83]
    s_add_u32 s64, s61, 415744
    ds_read_b128 v[168:171], v28 offset:10240
    ds_read_b128 v[172:175], v28 offset:11264
    v_mfma_f32_16x16x32_bf16 v[68:71], v[148:151], v[104:107], v[68:71]
    s_waitcnt lgkmcnt(4)
    s_add_u32 s65, s64, s73
    v_mfma_f32_16x16x32_bf16 v[84:87], v[148:151], v[108:111], v[84:87]
    buffer_load_dwordx4 v[96:99], v0, s[4:7], s64 offen offset:0 sc1
    v_mfma_f32_16x16x32_bf16 v[72:75], v[152:155], v[104:107], v[72:75]
    ds_write_b128 v28, v[40:43] offset:2048
    v_mfma_f32_16x16x32_bf16 v[88:91], v[152:155], v[108:111], v[88:91]
    buffer_load_dwordx4 v[100:103], v0, s[4:7], s65 offen offset:0 sc1
    v_mfma_f32_16x16x32_bf16 v[76:79], v[156:159], v[104:107], v[76:79]
    ds_write_b128 v28, v[44:47] offset:3072
    v_mfma_f32_16x16x32_bf16 v[92:95], v[156:159], v[108:111], v[92:95]
    s_waitcnt lgkmcnt(4)
    s_waitcnt vmcnt(9)
    v_mfma_f32_16x16x32_bf16 v[64:67], v[160:163], v[112:115], v[64:67]
    s_waitcnt vmcnt(8)
    ds_read_b128 v[144:147], v28 offset:12288
    ds_read_b128 v[148:151], v28 offset:13312
    v_mfma_f32_16x16x32_bf16 v[80:83], v[160:163], v[116:119], v[80:83]
    ds_read_b128 v[152:155], v28 offset:14336
    ds_read_b128 v[156:159], v28 offset:15360
    v_mfma_f32_16x16x32_bf16 v[68:71], v[164:167], v[112:115], v[68:71]
    s_waitcnt lgkmcnt(6)
    buffer_load_dwordx4 v[104:107], v0, s[4:7], s64 offen offset:1024 sc1
    v_mfma_f32_16x16x32_bf16 v[84:87], v[164:167], v[116:119], v[84:87]
    ds_write_b128 v28, v[48:51] offset:4096
    v_mfma_f32_16x16x32_bf16 v[72:75], v[168:171], v[112:115], v[72:75]
    buffer_load_dwordx4 v[108:111], v0, s[4:7], s65 offen offset:1024 sc1
    v_mfma_f32_16x16x32_bf16 v[88:91], v[168:171], v[116:119], v[88:91]
    ds_write_b128 v28, v[52:55] offset:5120
    v_mfma_f32_16x16x32_bf16 v[76:79], v[172:175], v[112:115], v[76:79]
    ds_write_b128 v28, v[56:59] offset:6144
    ds_write_b128 v28, v[60:63] offset:7168
    v_mfma_f32_16x16x32_bf16 v[92:95], v[172:175], v[116:119], v[92:95]
    s_waitcnt lgkmcnt(6)
    s_waitcnt vmcnt(9)
    s_waitcnt lgkmcnt(0)
    s_barrier
    v_mfma_f32_16x16x32_bf16 v[64:67], v[144:147], v[120:123], v[64:67]
    s_waitcnt vmcnt(8)
    ds_read_b128 v[160:163], v30 offset:0
    ds_read_b128 v[164:167], v30 offset:1024
    v_mfma_f32_16x16x32_bf16 v[80:83], v[144:147], v[124:127], v[80:83]
    ds_read_b128 v[168:171], v30 offset:2048
    ds_read_b128 v[172:175], v30 offset:3072
    v_mfma_f32_16x16x32_bf16 v[68:71], v[148:151], v[120:123], v[68:71]
    ds_read_b32 v176, v176 offset:1024
    ds_read_b128 v[40:43], v177 offset:2048
    v_mfma_f32_16x16x32_bf16 v[84:87], v[148:151], v[124:127], v[84:87]
    ds_read_b128 v[44:47], v177 offset:3072
    ds_read_b128 v[48:51], v178 offset:4096
    v_mfma_f32_16x16x32_bf16 v[72:75], v[152:155], v[120:123], v[72:75]
    ds_read_b128 v[52:55], v178 offset:5120
    ds_read_b128 v[56:59], v179 offset:6144
    v_mfma_f32_16x16x32_bf16 v[88:91], v[152:155], v[124:127], v[88:91]
    ds_read_b128 v[60:63], v179 offset:7168
    v_mfma_f32_16x16x32_bf16 v[76:79], v[156:159], v[120:123], v[76:79]
    buffer_load_dwordx4 v[112:115], v0, s[4:7], s64 offen offset:2048 sc1
    v_mfma_f32_16x16x32_bf16 v[92:95], v[156:159], v[124:127], v[92:95]
    s_waitcnt lgkmcnt(9)
    s_waitcnt vmcnt(8)
    v_mfma_f32_16x16x32_bf16 v[64:67], v[160:163], v[128:131], v[64:67]
    s_waitcnt vmcnt(7)
    ds_read_b128 v[144:147], v30 offset:4096
    ds_read_b128 v[148:151], v30 offset:5120
    v_mfma_f32_16x16x32_bf16 v[80:83], v[160:163], v[132:135], v[80:83]
    ds_read_b128 v[152:155], v30 offset:6144
    ds_read_b128 v[156:159], v30 offset:7168
    v_mfma_f32_16x16x32_bf16 v[68:71], v[164:167], v[128:131], v[68:71]
    s_waitcnt lgkmcnt(11)
    buffer_load_dwordx4 v[116:119], v0, s[4:7], s65 offen offset:2048 sc1
    v_mfma_f32_16x16x32_bf16 v[84:87], v[164:167], v[132:135], v[84:87]
    s_waitcnt lgkmcnt(9)
    v_add_f32 v32, v32, v40
    v_add_f32 v33, v33, v41
    v_mfma_f32_16x16x32_bf16 v[72:75], v[168:171], v[128:131], v[72:75]
    buffer_load_dwordx4 v[120:123], v0, s[4:7], s64 offen offset:3072 sc1
    v_mfma_f32_16x16x32_bf16 v[88:91], v[168:171], v[132:135], v[88:91]
    v_add_f32 v34, v34, v42
    v_add_f32 v35, v35, v43
    v_mfma_f32_16x16x32_bf16 v[76:79], v[172:175], v[128:131], v[76:79]
    buffer_load_dwordx4 v[124:127], v0, s[4:7], s65 offen offset:3072 sc1
    s_add_u32 s30, s39, 1048576
    s_cmp_lg_u32 s24, s28
    s_cselect_b32 s30, 0x40000000, s30
    s_mov_b32 m0, 163328
    v_mfma_f32_16x16x32_bf16 v[92:95], v[172:175], v[132:135], v[92:95]
    s_waitcnt lgkmcnt(2)
    s_waitcnt vmcnt(9)
    v_add_f32 v36, v36, v44
    v_mfma_f32_16x16x32_bf16 v[64:67], v[144:147], v[136:139], v[64:67]
    s_waitcnt vmcnt(8)
    ds_read_b128 v[160:163], v29 offset:0
    ds_read_b128 v[164:167], v29 offset:1024
    v_mfma_f32_16x16x32_bf16 v[80:83], v[144:147], v[140:143], v[80:83]
    ds_read_b128 v[168:171], v29 offset:2048
    ds_read_b128 v[172:175], v29 offset:3072
    v_mfma_f32_16x16x32_bf16 v[68:71], v[148:151], v[136:139], v[68:71]
    s_waitcnt lgkmcnt(4)
    buffer_load_dword v6, s[4:7], s30 offen lds
    v_mfma_f32_16x16x32_bf16 v[84:87], v[148:151], v[140:143], v[84:87]
    v_add_f32 v37, v37, v45
    v_add_f32 v38, v38, v46
    v_mfma_f32_16x16x32_bf16 v[72:75], v[152:155], v[136:139], v[72:75]
    v_add_f32 v39, v39, v47
    v_add_f32 v48, v48, v56
    v_mfma_f32_16x16x32_bf16 v[88:91], v[152:155], v[140:143], v[88:91]
    v_add_f32 v49, v49, v57
    v_add_f32 v50, v50, v58
    v_mfma_f32_16x16x32_bf16 v[76:79], v[156:159], v[136:139], v[76:79]
    v_add_f32 v51, v51, v59
    v_add_f32 v52, v52, v60
    v_mfma_f32_16x16x32_bf16 v[92:95], v[156:159], v[140:143], v[92:95]
    s_waitcnt lgkmcnt(2)
    s_waitcnt vmcnt(8)
    v_add_f32 v53, v53, v61
    v_mfma_f32_16x16x32_bf16 v[64:67], v[160:163], v[96:99], v[64:67]
    s_waitcnt vmcnt(7)
    ds_read_b128 v[144:147], v29 offset:16384
    ds_read_b128 v[148:151], v29 offset:17408
    v_mfma_f32_16x16x32_bf16 v[80:83], v[160:163], v[100:103], v[80:83]
    ds_read_b128 v[152:155], v29 offset:18432
    ds_read_b128 v[156:159], v29 offset:19456
    v_mfma_f32_16x16x32_bf16 v[68:71], v[164:167], v[96:99], v[68:71]
    s_waitcnt lgkmcnt(4)
    v_add_f32 v54, v54, v62
    v_add_f32 v55, v55, v63
    v_mfma_f32_16x16x32_bf16 v[84:87], v[164:167], v[100:103], v[84:87]
    v_add_f32 v32, v32, v48
    v_add_f32 v33, v33, v49
    v_mfma_f32_16x16x32_bf16 v[72:75], v[168:171], v[96:99], v[72:75]
    v_add_f32 v34, v34, v50
    v_add_f32 v35, v35, v51
    v_mfma_f32_16x16x32_bf16 v[88:91], v[168:171], v[100:103], v[88:91]
    v_add_f32 v36, v36, v52
    v_add_f32 v37, v37, v53
    v_mfma_f32_16x16x32_bf16 v[76:79], v[172:175], v[96:99], v[76:79]
    v_add_f32 v38, v38, v54
    v_add_f32 v39, v39, v55
    v_mfma_f32_16x16x32_bf16 v[92:95], v[172:175], v[100:103], v[92:95]
    s_waitcnt lgkmcnt(2)
    s_waitcnt vmcnt(6)
    v_fma_f32 v12, -v32, v176, v12
    v_mfma_f32_16x16x32_bf16 v[64:67], v[144:147], v[104:107], v[64:67]
    s_waitcnt vmcnt(5)
    ds_read_b128 v[160:163], v29 offset:32768
    ds_read_b128 v[164:167], v29 offset:33792
    v_mfma_f32_16x16x32_bf16 v[80:83], v[144:147], v[108:111], v[80:83]
    ds_read_b128 v[168:171], v29 offset:34816
    ds_read_b128 v[172:175], v29 offset:35840
    v_mfma_f32_16x16x32_bf16 v[68:71], v[148:151], v[104:107], v[68:71]
    s_waitcnt lgkmcnt(4)
    v_fma_f32 v13, -v33, v176, v13
    v_fma_f32 v14, -v34, v176, v14
    v_mfma_f32_16x16x32_bf16 v[84:87], v[148:151], v[108:111], v[84:87]
    v_fma_f32 v15, -v35, v176, v15
    v_fma_f32 v16, -v36, v176, v16
    v_mfma_f32_16x16x32_bf16 v[72:75], v[152:155], v[104:107], v[72:75]
    v_fma_f32 v17, -v37, v176, v17
    v_fma_f32 v18, -v38, v176, v18
    v_mfma_f32_16x16x32_bf16 v[88:91], v[152:155], v[108:111], v[88:91]
    v_fma_f32 v19, -v39, v176, v19
    v_cvt_pk_bf16_f32 v40, v12, v13
    v_mfma_f32_16x16x32_bf16 v[76:79], v[156:159], v[104:107], v[76:79]
    v_cvt_pk_bf16_f32 v41, v14, v15
    v_cvt_pk_bf16_f32 v42, v16, v17
    v_mfma_f32_16x16x32_bf16 v[92:95], v[156:159], v[108:111], v[92:95]
    s_waitcnt lgkmcnt(2)
    s_waitcnt vmcnt(4)
    v_cvt_pk_bf16_f32 v43, v18, v19
    v_mfma_f32_16x16x32_bf16 v[64:67], v[160:163], v[112:115], v[64:67]
    s_waitcnt vmcnt(3)
    ds_read_b128 v[144:147], v29 offset:49152
    ds_read_b128 v[148:151], v29 offset:50176
    v_mfma_f32_16x16x32_bf16 v[80:83], v[160:163], v[116:119], v[80:83]
    ds_read_b128 v[152:155], v29 offset:51200
    ds_read_b128 v[156:159], v29 offset:52224
    v_mfma_f32_16x16x32_bf16 v[68:71], v[164:167], v[112:115], v[68:71]
    s_waitcnt lgkmcnt(4)
    v_and_b32 v40, -2, v40
    v_and_b32 v42, -2, v42
    v_mfma_f32_16x16x32_bf16 v[84:87], v[164:167], v[116:119], v[84:87]
    s_add_u32 s35, s43, 131072
    buffer_store_dwordx4 v[40:43], v0, s[4:7], s35 offen
    v_mfma_f32_16x16x32_bf16 v[72:75], v[168:171], v[112:115], v[72:75]
    v_add_f32 v44, v12, v13
    v_mul_f32 v45, v12, v12
    v_mfma_f32_16x16x32_bf16 v[88:91], v[168:171], v[116:119], v[88:91]
    v_fmac_f32 v45, v13, v13
    v_add_f32 v44, v44, v14
    v_mfma_f32_16x16x32_bf16 v[76:79], v[172:175], v[112:115], v[76:79]
    v_fmac_f32 v45, v14, v14
    v_add_f32 v44, v44, v15
    v_mfma_f32_16x16x32_bf16 v[92:95], v[172:175], v[116:119], v[92:95]
    s_waitcnt lgkmcnt(2)
    s_waitcnt vmcnt(3) lgkmcnt(1)
    v_fmac_f32 v45, v15, v15
    v_mfma_f32_16x16x32_bf16 v[72:75], v[152:155], v[120:123], v[72:75]
    s_waitcnt vmcnt(2)
    v_add_f32 v44, v44, v16
    v_fmac_f32 v45, v16, v16
    v_mfma_f32_16x16x32_bf16 v[88:91], v[152:155], v[124:127], v[88:91]
    s_waitcnt lgkmcnt(0)
    v_add_f32 v44, v44, v17
    v_fmac_f32 v45, v17, v17
    v_mfma_f32_16x16x32_bf16 v[76:79], v[156:159], v[120:123], v[76:79]
    v_add_f32 v44, v44, v18
    v_fmac_f32 v45, v18, v18
    v_mfma_f32_16x16x32_bf16 v[92:95], v[156:159], v[124:127], v[92:95]
    v_add_f32 v44, v44, v19
    v_fmac_f32 v45, v19, v19
    v_mfma_f32_16x16x32_bf16 v[80:83], v[144:147], v[124:127], v[80:83]
    s_add_u32 s35, s44, 720896
    v_permlane16_swap_b32 v44, v45
    v_add_f32 v44, v44, v45
    v_mfma_f32_16x16x32_bf16 v[84:87], v[148:151], v[124:127], v[84:87]
    v_mov_b32 v45, v44
    s_nop 1
    v_permlane32_swap_b32 v44, v45
    v_mfma_f32_16x16x32_bf16 v[64:67], v[144:147], v[120:123], v[64:67]
    v_add_f32 v44, v44, v45
    v_and_b32 v44, -2, v44
    v_mfma_f32_16x16x32_bf16 v[68:71], v[148:151], v[120:123], v[68:71]
    buffer_store_dword v44, v7, s[4:7], s35 offen
    v_xor_b32 v181, 16384, v28
    v_xor_b32 v182, 32768, v28
    v_xor_b32 v183, 49152, v28
    s_and_b32 s35, s24, 2
    s_lshl_b32 s35, s35, 5
    v_add_u32 v180, s35, v2
    ds_write_b128 v28, v[72:75] offset:10240
    ds_write_b128 v28, v[88:91] offset:14336
    ds_write_b128 v28, v[76:79] offset:11264
    ds_write_b128 v28, v[92:95] offset:15360
    ds_write_b128 v28, v[80:83] offset:12288
    ds_write_b128 v28, v[84:87] offset:13312
    s_waitcnt lgkmcnt(0)
    s_barrier
    ds_read_b32 v180, v180 offset:1152
    ds_read_b128 v[72:75], v181 offset:10240
    ds_read_b128 v[76:79], v181 offset:11264
    ds_read_b128 v[80:83], v182 offset:12288
    ds_read_b128 v[84:87], v182 offset:13312
    ds_read_b128 v[88:91], v183 offset:14336
    ds_read_b128 v[92:95], v183 offset:15360
    s_add_u32 m0, s41, 65536
    s_add_u32 s30, s32, m0
    s_add_u32 s30, s30, 65536
    buffer_load_dwordx4 v0, s[4:7], s30 offen offset:0 sc1 lds
    s_waitcnt lgkmcnt(5)
    v_pk_add_f32 v[64:65], v[64:65], v[72:73]
    v_pk_add_f32 v[66:67], v[66:67], v[74:75]
    s_waitcnt lgkmcnt(4)
    v_pk_add_f32 v[68:69], v[68:69], v[76:77]
    v_pk_add_f32 v[70:71], v[70:71], v[78:79]
    buffer_load_dwordx4 v0, s[4:7], s30 offen offset:1024 sc1 lds
    s_waitcnt lgkmcnt(1)
    v_pk_add_f32 v[80:81], v[80:81], v[88:89]
    v_pk_add_f32 v[82:83], v[82:83], v[90:91]
    s_waitcnt lgkmcnt(0)
    v_pk_add_f32 v[84:85], v[84:85], v[92:93]
    v_pk_add_f32 v[86:87], v[86:87], v[94:95]
    buffer_load_dwordx4 v0, s[4:7], s30 offen offset:2048 sc1 lds
    v_pk_add_f32 v[64:65], v[64:65], v[80:81]
    v_pk_add_f32 v[66:67], v[66:67], v[82:83]
    v_pk_add_f32 v[68:69], v[68:69], v[84:85]
    v_pk_add_f32 v[70:71], v[70:71], v[86:87]
    buffer_load_dwordx4 v0, s[4:7], s30 offen offset:3072 sc1 lds
    v_pk_fma_f32 v[20:21], v[64:65], v[180:181], v[20:21] op_sel_hi:[1,0,1] neg_lo:[1,0,0] neg_hi:[1,0,0]
    v_pk_fma_f32 v[22:23], v[66:67], v[180:181], v[22:23] op_sel_hi:[1,0,1] neg_lo:[1,0,0] neg_hi:[1,0,0]
    v_pk_fma_f32 v[24:25], v[68:69], v[180:181], v[24:25] op_sel_hi:[1,0,1] neg_lo:[1,0,0] neg_hi:[1,0,0]
    v_pk_fma_f32 v[26:27], v[70:71], v[180:181], v[26:27] op_sel_hi:[1,0,1] neg_lo:[1,0,0] neg_hi:[1,0,0]
    s_add_u32 s51, s19, 720896
    buffer_load_dwordx4 v[120:123], v0, s[4:7], s51 offen sc1
    v_cvt_pk_bf16_f32 v72, v20, v21
    v_cvt_pk_bf16_f32 v73, v22, v23
    v_cvt_pk_bf16_f32 v74, v24, v25
    v_cvt_pk_bf16_f32 v75, v26, v27
    s_add_u32 m0, s41, 81920
    s_add_u32 s30, s32, m0
    s_add_u32 s30, s30, 65536
    buffer_load_dwordx4 v0, s[4:7], s30 offen offset:0 sc1 lds
    v_and_b32 v72, -2, v72
    v_and_b32 v74, -2, v74
    s_add_u32 s31, s43, 163840
    buffer_store_dwordx4 v[72:75], v0, s[4:7], s31 offen
    v_dot2_f32_bf16 v76, v72, s45, 0
    v_dot2_f32_bf16 v77, v72, v72, 0
    v_dot2_f32_bf16 v76, v73, s45, v76
    v_dot2_f32_bf16 v77, v73, v73, v77
    v_dot2_f32_bf16 v76, v74, s45, v76
    v_dot2_f32_bf16 v77, v74, v74, v77
    v_dot2_f32_bf16 v76, v75, s45, v76
    v_dot2_f32_bf16 v77, v75, v75, v77
    s_add_u32 s31, s44, 724992
    s_nop 1
    v_permlane16_swap_b32 v76, v77
    v_add_f32 v76, v76, v77
    v_mov_b32 v77, v76
    s_nop 1
    v_permlane32_swap_b32 v76, v77
    v_add_f32 v76, v76, v77
    v_and_b32 v76, -2, v76
    buffer_store_dword v76, v7, s[4:7], s31 offen
    buffer_load_dwordx4 v0, s[4:7], s30 offen offset:1024 sc1 lds
    buffer_load_dwordx4 v0, s[4:7], s30 offen offset:2048 sc1 lds
    buffer_load_dwordx4 v0, s[4:7], s30 offen offset:3072 sc1 lds
    s_add_u32 s30, s71, 0
    buffer_load_dwordx4 v[128:131], v0, s[4:7], s30 offen offset:0 sc1
    buffer_load_dwordx4 v[132:135], v0, s[4:7], s30 offen offset:1024 sc1
    buffer_load_dwordx4 v[136:139], v0, s[4:7], s30 offen offset:2048 sc1
    buffer_load_dwordx4 v[140:143], v0, s[4:7], s30 offen offset:3072 sc1
    v_mov_b32 v112, s45
    v_mov_b32 v113, s45
    v_mov_b32 v114, s45
    v_mov_b32 v115, s45
    v_add_u32 v116, 65536, v0
    v_add_u32 v117, 66560, v0
    v_add_u32 v118, 67584, v0
    v_add_u32 v119, 68608, v0
    s_add_u32 s31, s41, 65536
    v_add_u32 v28, s31, v0
    s_waitcnt vmcnt(11)
    ds_read_b128 v[176:179], v28 offset:0
    ds_read_b128 v[180:183], v28 offset:1024
    ds_read_b128 v[184:187], v28 offset:2048
    ds_read_b128 v[188:191], v28 offset:3072
    s_waitcnt lgkmcnt(2)
    v_bitop3_b32 v176, v176, v178, v180 bitop3:0xfe
    s_waitcnt lgkmcnt(1)
    v_bitop3_b32 v182, v182, v184, v186 bitop3:0xfe
    s_waitcnt lgkmcnt(0)
    v_bitop3_b32 v176, v176, v182, v188 bitop3:0xfe
    v_bitop3_b32 v176, v176, v190, 1 bitop3:0xa8
    v_cmp_ne_u32 s[56:57], 0, v176
    s_nop 1
    s_cmp_lg_u64 s[56:57], 0
    s_cbranch_scc1 Lrare59
Lrare59b:
    s_barrier
    ds_read_b128 v[32:35], v116 offset:0
    ds_read_b128 v[36:39], v117 offset:0
    ds_read_b128 v[40:43], v118 offset:0
    ds_read_b128 v[44:47], v119 offset:0
    ds_read_b128 v[48:51], v116 offset:4096
    s_waitcnt lgkmcnt(4)
    v_mfma_f32_16x16x32_bf16 v[56:59], v[32:35], a[192:195], 0
    v_mfma_f32_16x16x32_bf16 v[60:63], v[32:35], v[192:195], 0
    s_waitcnt lgkmcnt(3)
    ds_read_b128 v[52:55], v117 offset:4096
    v_mfma_f32_16x16x32_bf16 v[56:59], v[36:39], a[196:199], v[56:59]
    s_waitcnt vmcnt(4)
    ds_read_b128 v[176:179], v28 offset:16384
    ds_read_b128 v[180:183], v28 offset:17408
    v_mfma_f32_16x16x32_bf16 v[60:63], v[36:39], v[196:199], v[60:63]
    s_waitcnt lgkmcnt(5)
    ds_read_b128 v[32:35], v118 offset:4096
    ds_read_b128 v[184:187], v28 offset:18432
    v_mfma_f32_16x16x32_bf16 v[56:59], v[40:43], a[200:203], v[56:59]
    ds_read_b128 v[188:191], v28 offset:19456
    v_bitop3_b32 v31, v120, v121, v122 bitop3:0xfe
    v_mfma_f32_16x16x32_bf16 v[60:63], v[40:43], v[200:203], v[60:63]
    s_waitcnt lgkmcnt(7)
    ds_read_b128 v[36:39], v119 offset:4096
    v_bitop3_b32 v31, v31, v123, 1 bitop3:0xa8
    v_cmp_ne_u32 vcc, 0, v31
    s_cbranch_vccnz Lrare61
Lrare61b:
    v_mfma_f32_16x16x32_bf16 v[56:59], v[44:47], a[204:207], v[56:59]
    s_add_u32 m0, s41, 98304
    s_add_u32 s30, s32, m0
    s_add_u32 s30, s30, 65536
    v_mfma_f32_16x16x32_bf16 v[60:63], v[44:47], v[204:207], v[60:63]
    s_waitcnt lgkmcnt(7)
    ds_read_b128 v[40:43], v116 offset:8192
    v_add_f32 v120, v120, v122
    v_mfma_f32_16x16x32_bf16 v[56:59], v[48:51], a[208:211], v[56:59]
    buffer_load_dwordx4 v0, s[4:7], s30 offen offset:0 sc1 lds
    v_mfma_f32_16x16x32_bf16 v[60:63], v[48:51], v[208:211], v[60:63]
    s_waitcnt lgkmcnt(7)
    ds_read_b128 v[44:47], v117 offset:8192
    v_add_f32 v121, v121, v123
    v_mfma_f32_16x16x32_bf16 v[56:59], v[52:55], a[212:215], v[56:59]
    s_nop 0
    v_add_f32_dpp v120, v120, v120 quad_perm:[1,0,3,2] row_mask:0xf bank_mask:0xf
    v_add_f32_dpp v121, v121, v121 quad_perm:[1,0,3,2] row_mask:0xf bank_mask:0xf
    v_mfma_f32_16x16x32_bf16 v[60:63], v[52:55], v[212:215], v[60:63]
    s_waitcnt lgkmcnt(5)
    ds_read_b128 v[48:51], v118 offset:8192
    v_add_f32_dpp v120, v120, v120 quad_perm:[2,3,0,1] row_mask:0xf bank_mask:0xf
    v_mfma_f32_16x16x32_bf16 v[56:59], v[32:35], a[216:219], v[56:59]
    buffer_load_dwordx4 v0, s[4:7], s30 offen offset:1024 sc1 lds
    v_mfma_f32_16x16x32_bf16 v[60:63], v[32:35], v[216:219], v[60:63]
    s_waitcnt lgkmcnt(3)
    ds_read_b128 v[52:55], v119 offset:8192
    v_add_f32_dpp v121, v121, v121 quad_perm:[2,3,0,1] row_mask:0xf bank_mask:0xf
    v_mfma_f32_16x16x32_bf16 v[56:59], v[36:39], a[220:223], v[56:59]
    v_add_f32_dpp v120, v120, v120 row_half_mirror row_mask:0xf bank_mask:0xf
    v_add_f32_dpp v121, v121, v121 row_half_mirror row_mask:0xf bank_mask:0xf
    v_mfma_f32_16x16x32_bf16 v[60:63], v[36:39], v[220:223], v[60:63]
    s_waitcnt lgkmcnt(3)
    ds_read_b128 v[32:35], v116 offset:12288
    v_mul_f32 v120, 0xbb000000, v120
    v_mfma_f32_16x16x32_bf16 v[56:59], v[40:43], a[224:227], v[56:59]
    buffer_load_dwordx4 v0, s[4:7], s30 offen offset:2048 sc1 lds
    v_mfma_f32_16x16x32_bf16 v[60:63], v[40:43], v[224:227], v[60:63]
    s_waitcnt lgkmcnt(3)
    ds_read_b128 v[36:39], v117 offset:12288
    v_mul_f32 v121, 0x3b000000, v121
    v_mfma_f32_16x16x32_bf16 v[56:59], v[44:47], a[228:231], v[56:59]
    v_fma_f32 v121, -v120, v120, v121
    v_bitop3_b32 v176, v176, v178, v180 bitop3:0xfe
    v_mfma_f32_16x16x32_bf16 v[60:63], v[44:47], v[228:231], v[60:63]
    s_waitcnt lgkmcnt(3)
    ds_read_b128 v[40:43], v118 offset:12288
    v_bitop3_b32 v182, v182, v184, v186 bitop3:0xfe
    v_mfma_f32_16x16x32_bf16 v[56:59], v[48:51], a[232:235], v[56:59]
    buffer_load_dwordx4 v0, s[4:7], s30 offen offset:3072 sc1 lds
    v_bitop3_b32 v176, v176, v182, v188 bitop3:0xfe
    v_bitop3_b32 v176, v176, v190, 1 bitop3:0xa8
    v_cmp_ne_u32 s[56:57], 0, v176
    v_mfma_f32_16x16x32_bf16 v[60:63], v[48:51], v[232:235], v[60:63]
    s_waitcnt lgkmcnt(3)
    ds_read_b128 v[44:47], v119 offset:12288
    s_add_u32 s30, s19, 724992
    v_mfma_f32_16x16x32_bf16 v[56:59], v[52:55], a[236:239], v[56:59]
    s_cmp_lg_u64 s[56:57], 0
    s_cbranch_scc1 Lrare63
Lrare63b:
    s_barrier
    v_mfma_f32_16x16x32_bf16 v[60:63], v[52:55], v[236:239], v[60:63]
    s_waitcnt lgkmcnt(3)
    ds_read_b128 v[48:51], v116 offset:16384
    v_mfma_f32_16x16x32_bf16 v[56:59], v[32:35], a[240:243], v[56:59]
    buffer_load_dwordx4 v[124:127], v0, s[4:7], s30 offen sc1
    v_mfma_f32_16x16x32_bf16 v[60:63], v[32:35], v[240:243], v[60:63]
    s_waitcnt lgkmcnt(3)
    ds_read_b128 v[52:55], v117 offset:16384
    s_add_u32 m0, s41, 114688
    ds_write_b32 v8, v120 offset:768
    v_max_f32 v121, 0, v121
    v_add_f32 v121, 0x3727c5ac, v121
    v_rsq_f32 v121, v121
    s_nop 0
    v_mul_f32 v122, v120, v121
    ds_write_b32 v8, v121 offset:0
    v_mul_f32 v121, s50, v121
    ds_write_b32 v8, v122 offset:256
    ds_write_b32 v8, v121 offset:512
    v_mfma_f32_16x16x32_bf16 v[56:59], v[36:39], a[244:247], v[56:59]
    s_add_u32 s30, s32, m0
    s_add_u32 s30, s30, 65536
    v_mfma_f32_16x16x32_bf16 v[60:63], v[36:39], v[244:247], v[60:63]
    s_waitcnt lgkmcnt(7)
    ds_read_b128 v[32:35], v118 offset:16384
    v_mfma_f32_16x16x32_bf16 v[56:59], v[40:43], a[248:251], v[56:59]
    s_waitcnt lgkmcnt(1)
    s_barrier
    ds_read_b128 v[80:83], v1 offset:256
    v_mfma_f32_16x16x32_bf16 v[60:63], v[40:43], v[248:251], v[60:63]
    ds_read_b128 v[36:39], v119 offset:16384
    ds_read_b128 v[72:75], v1 offset:512
    v_mfma_f32_16x16x32_bf16 v[56:59], v[44:47], a[252:255], v[56:59]
    ds_read_b128 v[76:79], v1 offset:0
    v_mfma_f32_16x16x32_bf16 v[60:63], v[44:47], v[252:255], v[60:63]
    ds_read_b128 v[40:43], v116 offset:20480
    v_mfma_f32_16x16x32_bf16 v[64:67], v[48:51], a[192:195], 0
    buffer_load_dwordx4 v0, s[4:7], s30 offen offset:0 sc1 lds
    v_mfma_f32_16x16x32_bf16 v[68:71], v[48:51], v[192:195], 0
    ds_read_b128 v[44:47], v117 offset:20480
    v_mfma_f32_16x16x32_bf16 v[64:67], v[52:55], a[196:199], v[64:67]
    s_waitcnt lgkmcnt(5)
    v_fma_f32 v84, v80, v10, s48
    v_fma_f32 v85, v81, v10, s48
    v_mfma_f32_16x16x32_bf16 v[68:71], v[52:55], v[196:199], v[68:71]
    ds_read_b128 v[48:51], v118 offset:20480
    v_fma_f32 v86, v82, v10, s48
    v_mfma_f32_16x16x32_bf16 v[64:67], v[32:35], a[200:203], v[64:67]
    s_waitcnt vmcnt(2)
    ds_read_b128 v[176:179], v28 offset:32768
    ds_read_b128 v[180:183], v28 offset:33792
    v_mfma_f32_16x16x32_bf16 v[68:71], v[32:35], v[200:203], v[68:71]
    s_waitcnt lgkmcnt(7)
    ds_read_b128 v[52:55], v119 offset:20480
    ds_read_b128 v[184:187], v28 offset:34816
    v_mfma_f32_16x16x32_bf16 v[64:67], v[36:39], a[204:207], v[64:67]
    ds_read_b128 v[188:191], v28 offset:35840
    v_fma_f32 v87, v83, v10, s48
    v_mfma_f32_16x16x32_bf16 v[68:71], v[36:39], v[204:207], v[68:71]
    s_waitcnt lgkmcnt(7)
    ds_read_b128 v[32:35], v116 offset:24576
    v_fma_f32 v84, v56, v72, v84
    v_mfma_f32_16x16x32_bf16 v[64:67], v[40:43], a[208:211], v[64:67]
    buffer_load_dwordx4 v0, s[4:7], s30 offen offset:1024 sc1 lds
    v_mfma_f32_16x16x32_bf16 v[68:71], v[40:43], v[208:211], v[68:71]
    s_waitcnt lgkmcnt(7)
    ds_read_b128 v[36:39], v117 offset:24576
    v_fma_f32 v85, v57, v73, v85
    v_mfma_f32_16x16x32_bf16 v[64:67], v[44:47], a[212:215], v[64:67]
    v_fma_f32 v86, v58, v74, v86
    v_fma_f32 v87, v59, v75, v87
    v_mfma_f32_16x16x32_bf16 v[68:71], v[44:47], v[212:215], v[68:71]
    s_waitcnt lgkmcnt(7)
    ds_read_b128 v[40:43], v118 offset:24576
    v_mul_f32 v92, v80, v11
    v_mfma_f32_16x16x32_bf16 v[64:67], v[48:51], a[216:219], v[64:67]
    buffer_load_dwordx4 v0, s[4:7], s30 offen offset:2048 sc1 lds
    v_mfma_f32_16x16x32_bf16 v[68:71], v[48:51], v[216:219], v[68:71]
    s_waitcnt lgkmcnt(5)
    ds_read_b128 v[44:47], v119 offset:24576
    v_bitop3_b32 v176, v176, v178, v180 bitop3:0xfe
    v_mfma_f32_16x16x32_bf16 v[64:67], v[52:55], a[220:223], v[64:67]
    s_waitcnt lgkmcnt(5)
    v_bitop3_b32 v182, v182, v184, v186 bitop3:0xfe
    v_mul_f32 v93, v81, v11
    v_mfma_f32_16x16x32_bf16 v[68:71], v[52:55], v[220:223], v[68:71]
    s_waitcnt lgkmcnt(3)
    ds_read_b128 v[48:51], v116 offset:28672
    v_bitop3_b32 v176, v176, v182, v188 bitop3:0xfe
    v_mfma_f32_16x16x32_bf16 v[64:67], v[32:35], a[224:227], v[64:67]
    buffer_load_dwordx4 v0, s[4:7], s30 offen offset:3072 sc1 lds
    v_mfma_f32_16x16x32_bf16 v[68:71], v[32:35], v[224:227], v[68:71]
    s_waitcnt lgkmcnt(3)
    ds_read_b128 v[52:55], v117 offset:28672
    s_add_u32 s30, s71, 4096
    v_mfma_f32_16x16x32_bf16 v[64:67], v[36:39], a[228:231], v[64:67]
    v_bitop3_b32 v176, v176, v190, 1 bitop3:0xa8
    v_cmp_ne_u32 s[56:57], 0, v176
    v_mfma_f32_16x16x32_bf16 v[68:71], v[36:39], v[228:231], v[68:71]
    s_waitcnt lgkmcnt(3)
    ds_read_b128 v[32:35], v118 offset:28672
    v_mul_f32 v94, v82, v11
    v_mfma_f32_16x16x32_bf16 v[64:67], v[40:43], a[232:235], v[64:67]
    buffer_load_dwordx4 v[144:147], v0, s[4:7], s30 offen offset:0 sc1
    v_mfma_f32_16x16x32_bf16 v[68:71], v[40:43], v[232:235], v[68:71]
    s_waitcnt lgkmcnt(3)
    ds_read_b128 v[36:39], v119 offset:28672
    v_mul_f32 v95, v83, v11
    v_mfma_f32_16x16x32_bf16 v[64:67], v[44:47], a[236:239], v[64:67]
    s_cmp_lg_u64 s[56:57], 0
    s_cbranch_scc1 Lrare65
Lrare65b:
    s_barrier
    v_mfma_f32_16x16x32_bf16 v[68:71], v[44:47], v[236:239], v[68:71]
    s_waitcnt lgkmcnt(3)
    ds_read_b128 v[40:43], v116 offset:32768
    v_fma_f32 v92, v60, v76, v92
    v_mfma_f32_16x16x32_bf16 v[64:67], v[48:51], a[240:243], v[64:67]
    buffer_load_dwordx4 v[148:151], v0, s[4:7], s30 offen offset:1024 sc1
    v_mfma_f32_16x16x32_bf16 v[68:71], v[48:51], v[240:243], v[68:71]
    s_waitcnt lgkmcnt(3)
    ds_read_b128 v[44:47], v117 offset:32768
    v_fma_f32 v93, v61, v77, v93
    v_mfma_f32_16x16x32_bf16 v[64:67], v[52:55], a[244:247], v[64:67]
    s_waitcnt vmcnt(6)
    v_bitop3_b32 v31, v124, v125, v126 bitop3:0xfe
    v_bitop3_b32 v31, v31, v127, 1 bitop3:0xa8
    v_cmp_ne_u32 vcc, 0, v31
    s_cbranch_vccnz Lrare67
Lrare67b:
    v_mfma_f32_16x16x32_bf16 v[68:71], v[52:55], v[244:247], v[68:71]
    s_waitcnt lgkmcnt(3)
    ds_read_b128 v[48:51], v118 offset:32768
    v_add_f32 v124, v124, v126
    v_mfma_f32_16x16x32_bf16 v[64:67], v[32:35], a[248:251], v[64:67]
    s_waitcnt vmcnt(2)
    ds_read_b128 v[176:179], v28 offset:49152
    ds_read_b128 v[180:183], v28 offset:50176
    v_mfma_f32_16x16x32_bf16 v[68:71], v[32:35], v[248:251], v[68:71]
    s_waitcnt lgkmcnt(5)
    ds_read_b128 v[52:55], v119 offset:32768
    ds_read_b128 v[184:187], v28 offset:51200
    v_exp_f32 v88, v84 clamp
    v_max_f32 v84, s48, v84
    v_exp_f32 v89, v85 clamp
    v_max_f32 v85, s48, v85
    v_exp_f32 v90, v86 clamp
    v_max_f32 v86, s48, v86
    v_exp_f32 v91, v87 clamp
    v_max_f32 v87, s48, v87
    v_fma_f32 v84, v84, s49, v88
    v_fma_f32 v85, v85, s49, v89
    v_fma_f32 v86, v86, s49, v90
    v_fma_f32 v87, v87, s49, v91
    v_cvt_pk_bf16_f32 v96, v84, v85
    v_cvt_pk_bf16_f32 v97, v86, v87
    v_fma_f32 v94, v62, v78, v94
    v_fma_f32 v95, v63, v79, v95
    v_cvt_pk_bf16_f32 v100, v92, v93
    v_cvt_pk_bf16_f32 v101, v94, v95
    v_mfma_f32_16x16x32_bf16 v[64:67], v[36:39], a[252:255], v[64:67]
    ds_read_b128 v[188:191], v28 offset:52224
    v_add_f32 v125, v125, v127
    v_mfma_f32_16x16x32_bf16 v[68:71], v[36:39], v[252:255], v[68:71]
    s_waitcnt lgkmcnt(7)
    ds_read_b128 v[32:35], v116 offset:36864
    ds_read_b128 v[80:83], v1 offset:320
    v_mfma_f32_16x16x32_bf16 v[56:59], v[40:43], a[192:195], 0
    ds_read_b128 v[72:75], v1 offset:576
    ds_read_b128 v[76:79], v1 offset:64
    v_mfma_f32_16x16x32_bf16 v[60:63], v[40:43], v[192:195], 0
    s_waitcnt lgkmcnt(10)
    ds_read_b128 v[36:39], v117 offset:36864
    s_nop 0
    v_mfma_f32_16x16x32_bf16 v[56:59], v[44:47], a[196:199], v[56:59]
    buffer_load_dwordx4 v[152:155], v0, s[4:7], s30 offen offset:2048 sc1
    v_mfma_f32_16x16x32_bf16 v[60:63], v[44:47], v[196:199], v[60:63]
    s_waitcnt lgkmcnt(10)
    ds_read_b128 v[40:43], v118 offset:36864
    v_add_f32_dpp v124, v124, v124 quad_perm:[1,0,3,2] row_mask:0xf bank_mask:0xf
    v_mfma_f32_16x16x32_bf16 v[56:59], v[48:51], a[200:203], v[56:59]
    s_waitcnt lgkmcnt(9)
    v_bitop3_b32 v176, v176, v178, v180 bitop3:0xfe
    v_add_f32_dpp v125, v125, v125 quad_perm:[1,0,3,2] row_mask:0xf bank_mask:0xf
    v_mfma_f32_16x16x32_bf16 v[60:63], v[48:51], v[200:203], v[60:63]
    s_waitcnt lgkmcnt(8)
    ds_read_b128 v[44:47], v119 offset:36864
    v_add_f32_dpp v124, v124, v124 quad_perm:[2,3,0,1] row_mask:0xf bank_mask:0xf
    v_mfma_f32_16x16x32_bf16 v[56:59], v[52:55], a[204:207], v[56:59]
    buffer_load_dwordx4 v[156:159], v0, s[4:7], s30 offen offset:3072 sc1
    v_mfma_f32_16x16x32_bf16 v[60:63], v[52:55], v[204:207], v[60:63]
    s_waitcnt lgkmcnt(6)
    ds_read_b128 v[48:51], v116 offset:40960
    s_add_u32 s30, s71, 8192
    v_mfma_f32_16x16x32_bf16 v[56:59], v[32:35], a[208:211], v[56:59]
    v_bitop3_b32 v182, v182, v184, v186 bitop3:0xfe
    v_bitop3_b32 v176, v176, v182, v188 bitop3:0xfe
    v_mfma_f32_16x16x32_bf16 v[60:63], v[32:35], v[208:211], v[60:63]
    s_waitcnt lgkmcnt(3)
    ds_read_b128 v[52:55], v117 offset:40960
    v_bitop3_b32 v176, v176, v190, 1 bitop3:0xa8
    v_mfma_f32_16x16x32_bf16 v[56:59], v[36:39], a[212:215], v[56:59]
    buffer_load_dwordx4 v[160:163], v0, s[4:7], s30 offen offset:0 sc1
    v_mfma_f32_16x16x32_bf16 v[60:63], v[36:39], v[212:215], v[60:63]
    s_waitcnt lgkmcnt(3)
    ds_read_b128 v[32:35], v118 offset:40960
    v_cmp_ne_u32 s[56:57], 0, v176
    v_mfma_f32_16x16x32_bf16 v[56:59], v[40:43], a[216:219], v[56:59]
    v_add_f32_dpp v125, v125, v125 quad_perm:[2,3,0,1] row_mask:0xf bank_mask:0xf
    v_add_f32_dpp v124, v124, v124 row_half_mirror row_mask:0xf bank_mask:0xf
    v_mfma_f32_16x16x32_bf16 v[60:63], v[40:43], v[216:219], v[60:63]
    s_waitcnt lgkmcnt(3)
    ds_read_b128 v[36:39], v119 offset:40960
    v_add_f32_dpp v125, v125, v125 row_half_mirror row_mask:0xf bank_mask:0xf
    v_mfma_f32_16x16x32_bf16 v[56:59], v[44:47], a[220:223], v[56:59]
    buffer_load_dwordx4 v[164:167], v0, s[4:7], s30 offen offset:1024 sc1
    v_mfma_f32_16x16x32_bf16 v[60:63], v[44:47], v[220:223], v[60:63]
    s_waitcnt lgkmcnt(3)
    ds_read_b128 v[40:43], v116 offset:45056
    v_mul_f32 v124, 0xbb000000, v124
    v_mfma_f32_16x16x32_bf16 v[56:59], v[48:51], a[224:227], v[56:59]
    v_mul_f32 v125, 0x3b000000, v125
    v_fma_f32 v125, -v124, v124, v125
    v_mfma_f32_16x16x32_bf16 v[60:63], v[48:51], v[224:227], v[60:63]
    s_waitcnt lgkmcnt(3)
    ds_read_b128 v[44:47], v117 offset:45056
    v_fma_f32 v84, v80, v10, s48
    v_mfma_f32_16x16x32_bf16 v[56:59], v[52:55], a[228:231], v[56:59]
    buffer_load_dwordx4 v[168:171], v0, s[4:7], s30 offen offset:2048 sc1
    v_mfma_f32_16x16x32_bf16 v[60:63], v[52:55], v[228:231], v[60:63]
    s_waitcnt lgkmcnt(3)
    ds_read_b128 v[48:51], v118 offset:45056
    v_fma_f32 v85, v81, v10, s48
    v_mfma_f32_16x16x32_bf16 v[56:59], v[32:35], a[232:235], v[56:59]
    ds_write_b32 v8, v124 offset:896
    v_mfma_f32_16x16x32_bf16 v[60:63], v[32:35], v[232:235], v[60:63]
    s_waitcnt lgkmcnt(4)
    ds_read_b128 v[52:55], v119 offset:45056
    v_max_f32 v125, 0, v125
    v_add_f32 v125, 0x3727c5ac, v125
    v_rsq_f32 v125, v125
    s_nop 0
    v_mul_f32 v126, v124, v125
    ds_write_b32 v8, v125 offset:128
    v_mul_f32 v125, s50, v125
    ds_write_b32 v8, v126 offset:384
    ds_write_b32 v8, v125 offset:640
    v_mfma_f32_16x16x32_bf16 v[56:59], v[36:39], a[236:239], v[56:59]
    s_cmp_lg_u64 s[56:57], 0
    s_cbranch_scc1 Lrare69
Lrare69b:
    s_waitcnt lgkmcnt(0)
    s_barrier
    v_mfma_f32_16x16x32_bf16 v[60:63], v[36:39], v[236:239], v[60:63]
    ds_read_b128 v[32:35], v116 offset:49152
    v_fma_f32 v86, v82, v10, s48
    v_mfma_f32_16x16x32_bf16 v[56:59], v[40:43], a[240:243], v[56:59]
    buffer_load_dwordx4 v[172:175], v0, s[4:7], s30 offen offset:3072 sc1
    v_mfma_f32_16x16x32_bf16 v[60:63], v[40:43], v[240:243], v[60:63]
    s_add_u32 s51, s33, 0
    ds_read_b128 v[36:39], v117 offset:49152
    s_and_b32 s51, s51, 0x3fff
    v_mfma_f32_16x16x32_bf16 v[56:59], v[44:47], a[244:247], v[56:59]
    s_lshl_b32 s30, s41, 2
    s_add_u32 s30, s30, s51
    s_add_u32 m0, s30, 0
    v_mfma_f32_16x16x32_bf16 v[60:63], v[44:47], v[244:247], v[60:63]
    s_add_u32 s30, s71, s51
    ds_read_b128 v[40:43], v118 offset:49152
    s_add_u32 s30, s30, 65536
    v_mfma_f32_16x16x32_bf16 v[56:59], v[48:51], a[248:251], v[56:59]
    buffer_load_dwordx4 v0, s[4:7], s30 offen offset:0 sc1 lds
    v_mfma_f32_16x16x32_bf16 v[60:63], v[48:51], v[248:251], v[60:63]
    ds_read_b128 v[44:47], v119 offset:49152
    v_fma_f32 v87, v83, v10, s48
    v_fma_f32 v84, v64, v72, v84
    v_fma_f32 v85, v65, v73, v85
    v_fma_f32 v86, v66, v74, v86
    v_fma_f32 v87, v67, v75, v87
    v_exp_f32 v88, v84 clamp
    v_max_f32 v84, s48, v84
    v_exp_f32 v89, v85 clamp
    v_max_f32 v85, s48, v85
    v_exp_f32 v90, v86 clamp
    v_max_f32 v86, s48, v86
    v_exp_f32 v91, v87 clamp
    v_max_f32 v87, s48, v87
    v_fma_f32 v84, v84, s49, v88
    v_fma_f32 v85, v85, s49, v89
    v_fma_f32 v86, v86, s49, v90
    v_fma_f32 v87, v87, s49, v91
    v_cvt_pk_bf16_f32 v98, v84, v85
    v_cvt_pk_bf16_f32 v99, v86, v87
    v_mul_f32 v92, v80, v11
    v_mul_f32 v93, v81, v11
    v_mul_f32 v94, v82, v11
    v_mul_f32 v95, v83, v11
    v_fma_f32 v92, v68, v76, v92
    v_fma_f32 v93, v69, v77, v93
    v_fma_f32 v94, v70, v78, v94
    v_fma_f32 v95, v71, v79, v95
    v_cvt_pk_bf16_f32 v102, v92, v93
    v_cvt_pk_bf16_f32 v103, v94, v95
    v_mfma_f32_16x16x32_bf16 v[56:59], v[52:55], a[252:255], v[56:59]
    v_mfma_f32_16x16x32_bf16 v[108:111], v[96:99], v[112:115], 0
    v_mfma_f32_16x16x32_bf16 v[104:107], v[96:99], v[100:103], 0
    v_mfma_f32_16x16x32_bf16 v[60:63], v[52:55], v[252:255], v[60:63]
    s_waitcnt lgkmcnt(3)
    ds_read_b128 v[48:51], v116 offset:53248
    ds_read_b128 v[80:83], v1 offset:384
    v_mfma_f32_16x16x32_bf16 v[64:67], v[32:35], a[192:195], 0
    ds_read_b128 v[72:75], v1 offset:640
    ds_read_b128 v[76:79], v1 offset:128
    v_mfma_f32_16x16x32_bf16 v[68:71], v[32:35], v[192:195], 0
    s_waitcnt lgkmcnt(6)
    ds_read_b128 v[52:55], v117 offset:53248
    v_mfma_f32_16x16x32_bf16 v[64:67], v[36:39], a[196:199], v[64:67]
    buffer_load_dwordx4 v0, s[4:7], s30 offen offset:1024 sc1 lds
    v_mfma_f32_16x16x32_bf16 v[68:71], v[36:39], v[196:199], v[68:71]
    s_waitcnt lgkmcnt(6)
    ds_read_b128 v[32:35], v118 offset:53248
    v_mfma_f32_16x16x32_bf16 v[64:67], v[40:43], a[200:203], v[64:67]
    s_waitcnt lgkmcnt(4)
    v_fma_f32 v84, v80, v10, s48
    v_fma_f32 v85, v81, v10, s48
    v_mfma_f32_16x16x32_bf16 v[68:71], v[40:43], v[200:203], v[68:71]
    ds_read_b128 v[36:39], v119 offset:53248
    v_fma_f32 v86, v82, v10, s48
    v_mfma_f32_16x16x32_bf16 v[64:67], v[44:47], a[204:207], v[64:67]
    buffer_load_dwordx4 v0, s[4:7], s30 offen offset:2048 sc1 lds
    v_mfma_f32_16x16x32_bf16 v[68:71], v[44:47], v[204:207], v[68:71]
    ds_read_b128 v[40:43], v116 offset:57344
    v_fma_f32 v87, v83, v10, s48
    v_mfma_f32_16x16x32_bf16 v[64:67], v[48:51], a[208:211], v[64:67]
    s_waitcnt lgkmcnt(5)
    v_fma_f32 v84, v56, v72, v84
    v_fma_f32 v85, v57, v73, v85
    v_mfma_f32_16x16x32_bf16 v[68:71], v[48:51], v[208:211], v[68:71]
    s_waitcnt lgkmcnt(3)
    ds_read_b128 v[44:47], v117 offset:57344
    v_fma_f32 v86, v58, v74, v86
    v_mfma_f32_16x16x32_bf16 v[64:67], v[52:55], a[212:215], v[64:67]
    buffer_load_dwordx4 v0, s[4:7], s30 offen offset:3072 sc1 lds
    v_mfma_f32_16x16x32_bf16 v[68:71], v[52:55], v[212:215], v[68:71]
    s_waitcnt lgkmcnt(3)
    ds_read_b128 v[48:51], v118 offset:57344
    s_add_u32 s30, s71, 12288
    v_mfma_f32_16x16x32_bf16 v[64:67], v[32:35], a[216:219], v[64:67]
    v_fma_f32 v87, v59, v75, v87
    v_mul_f32 v92, v80, v11
    v_mfma_f32_16x16x32_bf16 v[68:71], v[32:35], v[216:219], v[68:71]
    s_waitcnt lgkmcnt(3)
    ds_read_b128 v[52:55], v119 offset:57344
    v_mul_f32 v93, v81, v11
    v_mfma_f32_16x16x32_bf16 v[64:67], v[36:39], a[220:223], v[64:67]
    buffer_load_dwordx4 v[176:179], v0, s[4:7], s30 offen offset:0 sc1
    v_mfma_f32_16x16x32_bf16 v[68:71], v[36:39], v[220:223], v[68:71]
    s_waitcnt lgkmcnt(3)
    ds_read_b128 v[32:35], v116 offset:61440
    v_mul_f32 v94, v82, v11
    v_mfma_f32_16x16x32_bf16 v[64:67], v[40:43], a[224:227], v[64:67]
    v_exp_f32 v88, v84 clamp
    v_mfma_f32_16x16x32_bf16 v[68:71], v[40:43], v[224:227], v[68:71]
    s_waitcnt lgkmcnt(3)
    ds_read_b128 v[36:39], v117 offset:61440
    v_max_f32 v84, s48, v84
    v_mfma_f32_16x16x32_bf16 v[64:67], v[44:47], a[228:231], v[64:67]
    buffer_load_dwordx4 v[180:183], v0, s[4:7], s30 offen offset:1024 sc1
    v_mfma_f32_16x16x32_bf16 v[68:71], v[44:47], v[228:231], v[68:71]
    s_waitcnt lgkmcnt(3)
    ds_read_b128 v[40:43], v118 offset:61440
    v_mul_f32 v95, v83, v11
    v_mfma_f32_16x16x32_bf16 v[64:67], v[48:51], a[232:235], v[64:67]
    v_exp_f32 v89, v85 clamp
    v_mfma_f32_16x16x32_bf16 v[68:71], v[48:51], v[232:235], v[68:71]
    s_waitcnt lgkmcnt(3)
    ds_read_b128 v[44:47], v119 offset:61440
    v_max_f32 v85, s48, v85
    v_mfma_f32_16x16x32_bf16 v[64:67], v[52:55], a[236:239], v[64:67]
    buffer_load_dwordx4 v[184:187], v0, s[4:7], s30 offen offset:2048 sc1
    v_mfma_f32_16x16x32_bf16 v[68:71], v[52:55], v[236:239], v[68:71]
    s_waitcnt lgkmcnt(3)
    v_exp_f32 v90, v86 clamp
    v_mfma_f32_16x16x32_bf16 v[64:67], v[32:35], a[240:243], v[64:67]
    v_max_f32 v86, s48, v86
    v_fma_f32 v92, v60, v76, v92
    v_mfma_f32_16x16x32_bf16 v[68:71], v[32:35], v[240:243], v[68:71]
    s_waitcnt lgkmcnt(2)
    buffer_load_dwordx4 v[188:191], v0, s[4:7], s30 offen offset:3072 sc1
    v_mfma_f32_16x16x32_bf16 v[64:67], v[36:39], a[244:247], v[64:67]
    v_exp_f32 v91, v87 clamp
    v_mfma_f32_16x16x32_bf16 v[68:71], v[36:39], v[244:247], v[68:71]
    s_waitcnt lgkmcnt(1)
    v_max_f32 v87, s48, v87
    v_fma_f32 v84, v84, s49, v88
    v_mfma_f32_16x16x32_bf16 v[64:67], v[40:43], a[248:251], v[64:67]
    v_fma_f32 v85, v85, s49, v89
    v_fma_f32 v86, v86, s49, v90
    v_mfma_f32_16x16x32_bf16 v[68:71], v[40:43], v[248:251], v[68:71]
    s_waitcnt lgkmcnt(0)
    v_fma_f32 v87, v87, s49, v91
    v_cvt_pk_bf16_f32 v96, v84, v85
    v_cvt_pk_bf16_f32 v97, v86, v87
    v_fma_f32 v93, v61, v77, v93
    v_fma_f32 v94, v62, v78, v94
    v_fma_f32 v95, v63, v79, v95
    v_cvt_pk_bf16_f32 v100, v92, v93
    v_cvt_pk_bf16_f32 v101, v94, v95
    v_mfma_f32_16x16x32_bf16 v[64:67], v[44:47], a[252:255], v[64:67]
    ds_read_b128 v[80:83], v1 offset:448
    ds_read_b128 v[72:75], v1 offset:704
    v_mfma_f32_16x16x32_bf16 v[68:71], v[44:47], v[252:255], v[68:71]
    ds_read_b128 v[76:79], v1 offset:192
    s_waitcnt lgkmcnt(2)
    v_pk_fma_f32 v[84:85], v[80:81], v[10:11], s[48:49] op_sel_hi:[1,0,0]
    v_pk_fma_f32 v[86:87], v[82:83], v[10:11], s[48:49] op_sel_hi:[1,0,0]
    v_pk_mul_f32 v[92:93], v[80:81], v[10:11] op_sel:[0,1] op_sel_hi:[1,1]
    v_pk_mul_f32 v[94:95], v[82:83], v[10:11] op_sel:[0,1] op_sel_hi:[1,1]
    s_waitcnt lgkmcnt(1)
    v_pk_fma_f32 v[84:85], v[64:65], v[72:73], v[84:85]
    v_pk_fma_f32 v[86:87], v[66:67], v[74:75], v[86:87]
    v_exp_f32 v88, v84 clamp
    v_max_f32 v84, s48, v84
    v_exp_f32 v89, v85 clamp
    v_max_f32 v85, s48, v85
    v_exp_f32 v90, v86 clamp
    v_max_f32 v86, s48, v86
    v_exp_f32 v91, v87 clamp
    v_max_f32 v87, s48, v87
    s_waitcnt lgkmcnt(0)
    v_pk_fma_f32 v[92:93], v[68:69], v[76:77], v[92:93]
    v_pk_fma_f32 v[94:95], v[70:71], v[78:79], v[94:95]
    v_pk_fma_f32 v[84:85], v[84:85], s[48:49], v[88:89] op_sel:[0,1,0] op_sel_hi:[1,1,1]
    v_pk_fma_f32 v[86:87], v[86:87], s[48:49], v[90:91] op_sel:[0,1,0] op_sel_hi:[1,1,1]
    v_cvt_pk_bf16_f32 v102, v92, v93
    v_cvt_pk_bf16_f32 v103, v94, v95
    v_cvt_pk_bf16_f32 v98, v84, v85
    v_cvt_pk_bf16_f32 v99, v86, v87
    s_nop 1
    v_mfma_f32_16x16x32_bf16 v[108:111], v[96:99], v[112:115], v[108:111]
    v_mfma_f32_16x16x32_bf16 v[104:107], v[96:99], v[100:103], v[104:107]
    v_mov_b32 v87, v5
    s_lshl_b32 s31, s28, 10
    s_add_u32 s31, s31, s39
    s_add_u32 s31, s31, 1048576
    s_nop 2
    v_cvt_pk_bf16_f32 v88, v108, v109
    v_cvt_pk_bf16_f32 v89, v110, v111
    v_cvt_pk_bf16_f32 v84, v104, v105
    v_cvt_pk_bf16_f32 v85, v106, v107
    v_cndmask_b32 v86, v88, v89, s[52:53]
    buffer_store_dwordx4 v[84:87], v0, s[4:7], s31 offen
    s_lshl_b32 s31, s24, 6
    v_add_u32 v30, s31, v1
    ds_read_b128 v[92:95], v30 offset:2816
    ds_read_b128 v[32:35], v116 offset:0
    ds_read_b128 v[36:39], v117 offset:0
    ds_read_b128 v[40:43], v118 offset:0
    ds_read_b128 v[44:47], v119 offset:0
    ds_read_b128 v[48:51], v116 offset:4096
    ds_read_b128 v[52:55], v117 offset:4096
    ds_read_b128 v[56:59], v118 offset:4096
    ds_read_b32 v88, v2 offset:256
    ds_read_b32 v89, v2 offset:512
    ds_read_b32 v90, v2 offset:320
    ds_read_b32 v91, v2 offset:576
    s_waitcnt lgkmcnt(10)
    v_mfma_f32_16x16x32_bf16 v[96:99], v[128:131], v[32:35], 0
    s_waitcnt lgkmcnt(9)
    ds_read_b128 v[60:63], v119 offset:4096
    v_mfma_f32_16x16x32_bf16 v[96:99], v[132:135], v[36:39], v[96:99]
    s_waitcnt lgkmcnt(9)
    s_lshl_b32 s30, s25, 13
    s_add_u32 s30, s30, s32
    s_cmp_eq_u32 s24, 1
    s_cselect_b32 s51, 131072, 0
    s_cmp_eq_u32 s24, 2
    s_cselect_b32 s51, 720896, s51
    s_add_u32 s30, s30, s51
    s_cmp_ge_u32 s25, 2
    s_cselect_b32 s51, 2, 9
    s_cmp_eq_u32 s24, s51
    s_cselect_b32 s30, 0x40000000, s30
    s_cmp_eq_u32 s24, 3
    s_cselect_b32 s30, 0x40000000, s30
    s_mov_b32 m0, 163328
    v_lshlrev_b32 v31, 3, v0
    buffer_load_dword v31, s[4:7], s30 offen lds
    ds_read_b128 v[32:35], v116 offset:8192
    v_mfma_f32_16x16x32_bf16 v[96:99], v[136:139], v[40:43], v[96:99]
    s_waitcnt lgkmcnt(9)
    ds_read_b128 v[36:39], v117 offset:8192
    v_mfma_f32_16x16x32_bf16 v[96:99], v[140:143], v[44:47], v[96:99]
    s_waitcnt vmcnt(17) lgkmcnt(9)
    ds_read_b128 v[40:43], v118 offset:8192
    v_mfma_f32_16x16x32_bf16 v[96:99], v[144:147], v[48:51], v[96:99]
    s_waitcnt vmcnt(16) lgkmcnt(9)
    s_cmp_lg_u32 s24, s28
    s_cbranch_scc1 Lskip71
    s_add_u32 s31, s39, 1048576
    buffer_load_dwordx4 v[68:71], v0, s[4:7], s31 offen offset:0 sc1
    buffer_load_dwordx4 v[72:75], v0, s[4:7], s31 offen offset:1024 sc1
    buffer_load_dwordx4 v[76:79], v0, s[4:7], s31 offen offset:2048 sc1
    buffer_load_dwordx4 v[80:83], v0, s[4:7], s31 offen offset:3072 sc1
Lskip71:
    ds_read_b128 v[44:47], v119 offset:8192
    v_mfma_f32_16x16x32_bf16 v[96:99], v[148:151], v[52:55], v[96:99]
    s_waitcnt vmcnt(15) lgkmcnt(9)
    s_add_u32 s51, s33, 4096
    s_and_b32 s51, s51, 0x3fff
    s_lshl_b32 s30, s41, 2
    s_add_u32 s30, s30, s51
    s_add_u32 m0, s30, 0
    s_add_u32 s30, s71, s51
    s_add_u32 s30, s30, 65536
    buffer_load_dwordx4 v0, s[4:7], s30 offen offset:0 sc1 lds
    ds_read_b128 v[48:51], v116 offset:12288
    v_mfma_f32_16x16x32_bf16 v[96:99], v[152:155], v[56:59], v[96:99]
    s_waitcnt vmcnt(15) lgkmcnt(5)
    ds_read_b128 v[52:55], v117 offset:12288
    v_mfma_f32_16x16x32_bf16 v[96:99], v[156:159], v[60:63], v[96:99]
    s_waitcnt vmcnt(14) lgkmcnt(5)
    ds_read_b128 v[56:59], v118 offset:12288
    v_mfma_f32_16x16x32_bf16 v[96:99], v[160:163], v[32:35], v[96:99]
    s_waitcnt vmcnt(13) lgkmcnt(5)
    ds_read_b128 v[60:63], v119 offset:12288
    v_mfma_f32_16x16x32_bf16 v[96:99], v[164:167], v[36:39], v[96:99]
    s_waitcnt vmcnt(12) lgkmcnt(5)
    buffer_load_dwordx4 v0, s[4:7], s30 offen offset:1024 sc1 lds
    ds_read_b128 v[32:35], v116 offset:16384
    v_mfma_f32_16x16x32_bf16 v[96:99], v[168:171], v[40:43], v[96:99]
    s_waitcnt vmcnt(12) lgkmcnt(5)
    ds_read_b128 v[36:39], v117 offset:16384
    v_mfma_f32_16x16x32_bf16 v[96:99], v[172:175], v[44:47], v[96:99]
    s_waitcnt vmcnt(7) lgkmcnt(5)
    ds_read_b128 v[40:43], v118 offset:16384
    v_mfma_f32_16x16x32_bf16 v[96:99], v[176:179], v[48:51], v[96:99]
    s_waitcnt vmcnt(6) lgkmcnt(5)
    ds_read_b128 v[44:47], v119 offset:16384
    v_mfma_f32_16x16x32_bf16 v[96:99], v[180:183], v[52:55], v[96:99]
    s_waitcnt vmcnt(5) lgkmcnt(5)
    buffer_load_dwordx4 v0, s[4:7], s30 offen offset:2048 sc1 lds
    ds_read_b128 v[48:51], v116 offset:20480
    v_mfma_f32_16x16x32_bf16 v[96:99], v[184:187], v[56:59], v[96:99]
    s_waitcnt vmcnt(5) lgkmcnt(5)
    ds_read_b128 v[52:55], v117 offset:20480
    v_mfma_f32_16x16x32_bf16 v[96:99], v[188:191], v[60:63], v[96:99]
    s_waitcnt lgkmcnt(5)
    ds_read_b128 v[56:59], v118 offset:20480
    v_mfma_f32_16x16x32_bf16 v[100:103], v[128:131], v[32:35], 0
    s_waitcnt lgkmcnt(5)
    ds_read_b128 v[60:63], v119 offset:20480
    v_mfma_f32_16x16x32_bf16 v[100:103], v[132:135], v[36:39], v[100:103]
    s_waitcnt lgkmcnt(5)
    buffer_load_dwordx4 v0, s[4:7], s30 offen offset:3072 sc1 lds
    ds_read_b128 v[32:35], v116 offset:24576
    v_mfma_f32_16x16x32_bf16 v[100:103], v[136:139], v[40:43], v[100:103]
    s_waitcnt lgkmcnt(5)
    ds_read_b128 v[36:39], v117 offset:24576
    v_mfma_f32_16x16x32_bf16 v[100:103], v[140:143], v[44:47], v[100:103]
    s_waitcnt lgkmcnt(5)
    ds_read_b128 v[40:43], v118 offset:24576
    v_fma_f32 v120, v88, v92, s48
    v_mfma_f32_16x16x32_bf16 v[100:103], v[144:147], v[48:51], v[100:103]
    s_waitcnt lgkmcnt(5)
    ds_read_b128 v[44:47], v119 offset:24576
    v_fma_f32 v121, v88, v93, s48
    v_mfma_f32_16x16x32_bf16 v[100:103], v[148:151], v[52:55], v[100:103]
    s_waitcnt lgkmcnt(5)
    s_add_u32 s51, s33, 8192
    s_and_b32 s51, s51, 0x3fff
    s_lshl_b32 s30, s41, 2
    s_add_u32 s30, s30, s51
    s_add_u32 m0, s30, 0
    s_add_u32 s30, s71, s51
    s_add_u32 s30, s30, 65536
    buffer_load_dwordx4 v0, s[4:7], s30 offen offset:0 sc1 lds
    ds_read_b128 v[48:51], v116 offset:28672
    v_mfma_f32_16x16x32_bf16 v[100:103], v[152:155], v[56:59], v[100:103]
    s_waitcnt lgkmcnt(5)
    s_cmp_lg_u32 s24, s28
    s_cbranch_scc1 Lskip72
    s_waitcnt vmcnt(8)
    v_cmp_ne_u32 s[54:55], s29, v71
    s_waitcnt vmcnt(7)
    v_cmp_ne_u32 s[56:57], s29, v75
    s_nop 0
    s_or_b64 s[54:55], s[54:55], s[56:57]
    s_waitcnt vmcnt(6)
    v_cmp_ne_u32 s[56:57], s29, v79
    s_nop 0
    s_or_b64 s[54:55], s[54:55], s[56:57]
    s_waitcnt vmcnt(5)
    v_cmp_ne_u32 s[56:57], s29, v83
    s_nop 0
    s_or_b64 s[54:55], s[54:55], s[56:57]
    s_cmp_lg_u64 s[54:55], 0
    s_cbranch_scc1 Lrare73
Lrare73b:
    v_lshlrev_b32 v84, 16, v68
    v_and_b32 v85, 0xffff0000, v68
    v_lshlrev_b32 v86, 16, v69
    v_and_b32 v87, 0xffff0000, v69
    v_lshlrev_b32 v28, 16, v70
    v_and_b32 v29, 0xffff0000, v70
    v_dot2_f32_bf16 v84, v72, s46, v84
    v_dot2_f32_bf16 v85, v72, s47, v85
    v_dot2_f32_bf16 v86, v73, s46, v86
    v_dot2_f32_bf16 v87, v73, s47, v87
    v_dot2_f32_bf16 v28, v74, s46, v28
    v_dot2_f32_bf16 v29, v74, s47, v29
    v_dot2_f32_bf16 v84, v76, s46, v84
    v_dot2_f32_bf16 v85, v76, s47, v85
    v_dot2_f32_bf16 v86, v77, s46, v86
    v_dot2_f32_bf16 v87, v77, s47, v87
    v_dot2_f32_bf16 v28, v78, s46, v28
    v_dot2_f32_bf16 v29, v78, s47, v29
    v_dot2_f32_bf16 v84, v80, s46, v84
    v_dot2_f32_bf16 v85, v80, s47, v85
    v_dot2_f32_bf16 v86, v81, s46, v86
    v_dot2_f32_bf16 v87, v81, s47, v87
    v_dot2_f32_bf16 v28, v82, s46, v28
    v_dot2_f32_bf16 v29, v82, s47, v29
    s_lshl_b32 s31, s27, 10
    s_add_u32 s31, s31, s40
    s_add_u32 s31, s31, 262144
    v_cvt_pk_bf16_f32 v68, v84, v85
    v_cvt_pk_bf16_f32 v69, v86, v87
    v_cvt_pk_bf16_f32 v70, v28, v29
    buffer_store_dwordx4 v[68:71], v0, s[4:7], s31 offen sc1
Lskip72:
    ds_read_b128 v[52:55], v117 offset:28672
    v_mfma_f32_16x16x32_bf16 v[100:103], v[156:159], v[60:63], v[100:103]
    s_waitcnt lgkmcnt(5)
    ds_read_b128 v[56:59], v118 offset:28672
    v_fma_f32 v122, v88, v94, s48
    v_mfma_f32_16x16x32_bf16 v[100:103], v[160:163], v[32:35], v[100:103]
    s_waitcnt lgkmcnt(5)
    ds_read_b128 v[60:63], v119 offset:28672
    v_fma_f32 v123, v88, v95, s48
    v_mfma_f32_16x16x32_bf16 v[100:103], v[164:167], v[36:39], v[100:103]
    s_waitcnt lgkmcnt(5)
    buffer_load_dwordx4 v0, s[4:7], s30 offen offset:1024 sc1 lds
    ds_read_b128 v[32:35], v116 offset:32768
    v_mfma_f32_16x16x32_bf16 v[100:103], v[168:171], v[40:43], v[100:103]
    s_waitcnt lgkmcnt(5)
    ds_read_b128 v[36:39], v117 offset:32768
    v_fma_f32 v120, v96, v89, v120
    v_mfma_f32_16x16x32_bf16 v[100:103], v[172:175], v[44:47], v[100:103]
    s_waitcnt lgkmcnt(5)
    ds_read_b128 v[40:43], v118 offset:32768
    v_fma_f32 v121, v97, v89, v121
    v_mfma_f32_16x16x32_bf16 v[100:103], v[176:179], v[48:51], v[100:103]
    s_waitcnt lgkmcnt(5)
    ds_read_b128 v[44:47], v119 offset:32768
    v_fma_f32 v122, v98, v89, v122
    v_mfma_f32_16x16x32_bf16 v[100:103], v[180:183], v[52:55], v[100:103]
    s_waitcnt lgkmcnt(5)
    buffer_load_dwordx4 v0, s[4:7], s30 offen offset:2048 sc1 lds
    ds_read_b128 v[48:51], v116 offset:36864
    v_mfma_f32_16x16x32_bf16 v[100:103], v[184:187], v[56:59], v[100:103]
    s_waitcnt lgkmcnt(5)
    ds_read_b128 v[52:55], v117 offset:36864
    v_fma_f32 v123, v99, v89, v123
    v_mfma_f32_16x16x32_bf16 v[100:103], v[188:191], v[60:63], v[100:103]
    s_waitcnt lgkmcnt(5)
    ds_read_b128 v[56:59], v118 offset:36864
    v_exp_f32 v124, v120 clamp
    v_mfma_f32_16x16x32_bf16 v[104:107], v[128:131], v[32:35], 0
    s_waitcnt lgkmcnt(5)
    ds_read_b128 v[60:63], v119 offset:36864
    v_max_f32 v120, s48, v120
    v_mfma_f32_16x16x32_bf16 v[104:107], v[132:135], v[36:39], v[104:107]
    s_waitcnt lgkmcnt(5)
    buffer_load_dwordx4 v0, s[4:7], s30 offen offset:3072 sc1 lds
    ds_read_b128 v[32:35], v116 offset:40960
    v_exp_f32 v125, v121 clamp
    v_max_f32 v121, s48, v121
    v_exp_f32 v126, v122 clamp
    v_max_f32 v122, s48, v122
    v_exp_f32 v127, v123 clamp
    v_max_f32 v123, s48, v123
    v_fma_f32 v120, v120, s49, v124
    v_fma_f32 v121, v121, s49, v125
    v_fma_f32 v122, v122, s49, v126
    v_fma_f32 v123, v123, s49, v127
    v_cvt_pk_bf16_f32 v64, v120, v121
    v_cvt_pk_bf16_f32 v65, v122, v123
    ds_read_b32 v88, v2 offset:384
    ds_read_b32 v89, v2 offset:640
    v_mfma_f32_16x16x32_bf16 v[104:107], v[136:139], v[40:43], v[104:107]
    s_waitcnt lgkmcnt(7)
    ds_read_b128 v[36:39], v117 offset:40960
    v_mfma_f32_16x16x32_bf16 v[104:107], v[140:143], v[44:47], v[104:107]
    s_waitcnt lgkmcnt(7)
    ds_read_b128 v[40:43], v118 offset:40960
    v_fma_f32 v120, v90, v92, s48
    v_mfma_f32_16x16x32_bf16 v[104:107], v[144:147], v[48:51], v[104:107]
    s_waitcnt lgkmcnt(7)
    ds_read_b128 v[44:47], v119 offset:40960
    v_fma_f32 v121, v90, v93, s48
    v_mfma_f32_16x16x32_bf16 v[104:107], v[148:151], v[52:55], v[104:107]
    s_waitcnt lgkmcnt(7)
    s_add_u32 s51, s33, 12288
    s_and_b32 s51, s51, 0x3fff
    s_lshl_b32 s30, s41, 2
    s_add_u32 s30, s30, s51
    s_add_u32 m0, s30, 0
    s_add_u32 s30, s71, s51
    s_add_u32 s30, s30, 65536
    buffer_load_dwordx4 v0, s[4:7], s30 offen offset:0 sc1 lds
    ds_read_b128 v[48:51], v116 offset:45056
    v_mfma_f32_16x16x32_bf16 v[104:107], v[152:155], v[56:59], v[104:107]
    s_waitcnt lgkmcnt(7)
    ds_read_b128 v[52:55], v117 offset:45056
    v_fma_f32 v122, v90, v94, s48
    v_mfma_f32_16x16x32_bf16 v[104:107], v[156:159], v[60:63], v[104:107]
    s_waitcnt lgkmcnt(7)
    ds_read_b128 v[56:59], v118 offset:45056
    v_fma_f32 v123, v90, v95, s48
    v_mfma_f32_16x16x32_bf16 v[104:107], v[160:163], v[32:35], v[104:107]
    s_waitcnt lgkmcnt(5)
    ds_read_b128 v[60:63], v119 offset:45056
    v_fma_f32 v120, v100, v91, v120
    v_mfma_f32_16x16x32_bf16 v[104:107], v[164:167], v[36:39], v[104:107]
    s_waitcnt lgkmcnt(5)
    buffer_load_dwordx4 v0, s[4:7], s30 offen offset:1024 sc1 lds
    ds_read_b128 v[32:35], v116 offset:49152
    v_mfma_f32_16x16x32_bf16 v[104:107], v[168:171], v[40:43], v[104:107]
    s_waitcnt lgkmcnt(5)
    ds_read_b128 v[36:39], v117 offset:49152
    v_fma_f32 v121, v101, v91, v121
    v_mfma_f32_16x16x32_bf16 v[104:107], v[172:175], v[44:47], v[104:107]
    s_waitcnt lgkmcnt(5)
    ds_read_b128 v[40:43], v118 offset:49152
    v_fma_f32 v122, v102, v91, v122
    v_mfma_f32_16x16x32_bf16 v[104:107], v[176:179], v[48:51], v[104:107]
    s_waitcnt lgkmcnt(5)
    ds_read_b128 v[44:47], v119 offset:49152
    v_fma_f32 v123, v103, v91, v123
    v_mfma_f32_16x16x32_bf16 v[104:107], v[180:183], v[52:55], v[104:107]
    s_waitcnt lgkmcnt(5)
    buffer_load_dwordx4 v0, s[4:7], s30 offen offset:2048 sc1 lds
    ds_read_b128 v[48:51], v116 offset:53248
    v_mfma_f32_16x16x32_bf16 v[104:107], v[184:187], v[56:59], v[104:107]
    s_waitcnt lgkmcnt(5)
    ds_read_b128 v[52:55], v117 offset:53248
    v_exp_f32 v124, v120 clamp
    v_mfma_f32_16x16x32_bf16 v[104:107], v[188:191], v[60:63], v[104:107]
    s_waitcnt lgkmcnt(5)
    ds_read_b128 v[56:59], v118 offset:53248
    v_max_f32 v120, s48, v120
    v_mfma_f32_16x16x32_bf16 v[108:111], v[128:131], v[32:35], 0
    s_waitcnt lgkmcnt(5)
    ds_read_b128 v[60:63], v119 offset:53248
    v_exp_f32 v125, v121 clamp
    v_mfma_f32_16x16x32_bf16 v[108:111], v[132:135], v[36:39], v[108:111]
    s_waitcnt lgkmcnt(5)
    buffer_load_dwordx4 v0, s[4:7], s30 offen offset:3072 sc1 lds
    ds_read_b128 v[32:35], v116 offset:57344
    v_max_f32 v121, s48, v121
    v_exp_f32 v126, v122 clamp
    v_max_f32 v122, s48, v122
    v_exp_f32 v127, v123 clamp
    v_max_f32 v123, s48, v123
    v_fma_f32 v120, v120, s49, v124
    v_fma_f32 v121, v121, s49, v125
    v_fma_f32 v122, v122, s49, v126
    v_fma_f32 v123, v123, s49, v127
    v_cvt_pk_bf16_f32 v66, v120, v121
    v_cvt_pk_bf16_f32 v67, v122, v123
    ds_read_b32 v90, v2 offset:448
    ds_read_b32 v91, v2 offset:704
    v_mfma_f32_16x16x32_bf16 v[108:111], v[136:139], v[40:43], v[108:111]
    s_waitcnt lgkmcnt(7)
    ds_read_b128 v[36:39], v117 offset:57344
    v_mfma_f32_16x16x32_bf16 v[108:111], v[140:143], v[44:47], v[108:111]
    s_waitcnt lgkmcnt(7)
    ds_read_b128 v[40:43], v118 offset:57344
    v_fma_f32 v120, v88, v92, s48
    v_mfma_f32_16x16x32_bf16 v[108:111], v[144:147], v[48:51], v[108:111]
    s_waitcnt lgkmcnt(7)
    ds_read_b128 v[44:47], v119 offset:57344
    v_fma_f32 v121, v88, v93, s48
    v_mfma_f32_16x16x32_bf16 v[108:111], v[148:151], v[52:55], v[108:111]
    s_waitcnt lgkmcnt(7)
    ds_read_b128 v[48:51], v116 offset:61440
    v_fma_f32 v122, v88, v94, s48
    v_mfma_f32_16x16x32_bf16 v[108:111], v[152:155], v[56:59], v[108:111]
    s_waitcnt lgkmcnt(7)
    ds_read_b128 v[52:55], v117 offset:61440
    v_fma_f32 v123, v88, v95, s48
    v_mfma_f32_16x16x32_bf16 v[108:111], v[156:159], v[60:63], v[108:111]
    s_waitcnt lgkmcnt(7)
    ds_read_b128 v[56:59], v118 offset:61440
    v_fma_f32 v120, v104, v89, v120
    v_mfma_f32_16x16x32_bf16 v[108:111], v[160:163], v[32:35], v[108:111]
    s_waitcnt lgkmcnt(5)
    ds_read_b128 v[60:63], v119 offset:61440
    v_fma_f32 v121, v105, v89, v121
    v_mfma_f32_16x16x32_bf16 v[108:111], v[164:167], v[36:39], v[108:111]
    s_waitcnt lgkmcnt(5)
    v_fma_f32 v122, v106, v89, v122
    v_fma_f32 v123, v107, v89, v123
    v_mfma_f32_16x16x32_bf16 v[108:111], v[168:171], v[40:43], v[108:111]
    s_waitcnt lgkmcnt(4)
    v_exp_f32 v124, v120 clamp
    v_mfma_f32_16x16x32_bf16 v[108:111], v[172:175], v[44:47], v[108:111]
    s_waitcnt lgkmcnt(3)
    v_max_f32 v120, s48, v120
    v_exp_f32 v125, v121 clamp
    v_mfma_f32_16x16x32_bf16 v[108:111], v[176:179], v[48:51], v[108:111]
    s_waitcnt lgkmcnt(2)
    v_max_f32 v121, s48, v121
    v_exp_f32 v126, v122 clamp
    v_mfma_f32_16x16x32_bf16 v[108:111], v[180:183], v[52:55], v[108:111]
    s_waitcnt lgkmcnt(1)
    v_max_f32 v122, s48, v122
    v_exp_f32 v127, v123 clamp
    v_mfma_f32_16x16x32_bf16 v[108:111], v[184:187], v[56:59], v[108:111]
    s_waitcnt lgkmcnt(0)
    v_max_f32 v123, s48, v123
    v_fma_f32 v120, v120, s49, v124
    v_mfma_f32_16x16x32_bf16 v[108:111], v[188:191], v[60:63], v[108:111]
    v_fma_f32 v121, v121, s49, v125
    v_fma_f32 v122, v122, s49, v126
    v_fma_f32 v123, v123, s49, v127
    s_waitcnt vmcnt(15)
    v_cvt_pk_bf16_f32 v68, v120, v121
    v_cvt_pk_bf16_f32 v69, v122, v123
    v_pk_fma_f32 v[120:121], v[92:93], v[90:91], s[48:49] op_sel_hi:[1,0,0]
    v_pk_fma_f32 v[122:123], v[94:95], v[90:91], s[48:49] op_sel_hi:[1,0,0]
    v_pk_fma_f32 v[120:121], v[108:109], v[90:91], v[120:121] op_sel:[0,1,0] op_sel_hi:[1,1,1]
    v_pk_fma_f32 v[122:123], v[110:111], v[90:91], v[122:123] op_sel:[0,1,0] op_sel_hi:[1,1,1]
    v_exp_f32 v124, v120 clamp
    v_max_f32 v120, s48, v120
    v_exp_f32 v125, v121 clamp
    v_max_f32 v121, s48, v121
    v_exp_f32 v126, v122 clamp
    v_max_f32 v122, s48, v122
    v_exp_f32 v127, v123 clamp
    v_max_f32 v123, s48, v123
    v_pk_fma_f32 v[120:121], v[120:121], s[48:49], v[124:125] op_sel:[0,1,0] op_sel_hi:[1,1,1]
    v_pk_fma_f32 v[122:123], v[122:123], s[48:49], v[126:127] op_sel:[0,1,0] op_sel_hi:[1,1,1]
    v_cvt_pk_bf16_f32 v70, v120, v121
    v_cvt_pk_bf16_f32 v71, v122, v123
    s_waitcnt vmcnt(14)
    v_mov_b32 v72, 0x358637bd
    v_mov_b32 v73, 0x358637bd
    v_mov_b32 v74, 0x358637bd
    v_mov_b32 v75, 0x358637bd
    s_and_b32 s31, s24, 1
    s_lshl_b32 s31, s31, 11
    s_add_u32 s31, s31, 0
    v_add_u32 v30, s31, v0
    s_waitcnt vmcnt(0)
    s_barrier
    s_lshl_b32 s30, s41, 2
    s_add_u32 m0, s30, 65536
    s_add_u32 s30, s62, 4096
    s_add_u32 s51, s68, 4096
    buffer_load_dwordx4 v0, s[4:7], s30 offen sc1 lds
    buffer_load_dwordx4 v0, s[4:7], s30 offen offset:1024 sc1 lds
    buffer_load_dwordx4 v0, s[4:7], s51 offen offset:2048 sc1 lds
    buffer_load_dwordx4 v0, s[4:7], s51 offen offset:3072 sc1 lds
    s_lshl_b32 s30, s41, 2
    s_add_u32 m0, s30, 69632
    s_add_u32 s30, s62, 8192
    s_add_u32 s51, s68, 8192
    buffer_load_dwordx4 v0, s[4:7], s30 offen sc1 lds
    buffer_load_dwordx4 v0, s[4:7], s30 offen offset:1024 sc1 lds
    buffer_load_dwordx4 v0, s[4:7], s51 offen offset:2048 sc1 lds
    buffer_load_dwordx4 v0, s[4:7], s51 offen offset:3072 sc1 lds
    ds_read_b128 v[96:99], v30 offset:0
    ds_read_b128 v[100:103], v30 offset:1024
    ds_read_b128 v[104:107], v30 offset:4096
    ds_read_b128 v[108:111], v30 offset:5120
    ds_read_b128 v[112:115], v30 offset:8192
    ds_read_b128 v[116:119], v30 offset:9216
    ds_read_b128 v[120:123], v30 offset:16384
    ds_read_b128 v[124:127], v30 offset:17408
    ds_read_b128 v[128:131], v30 offset:20480
    ds_read_b128 v[132:135], v30 offset:21504
    ds_read_b128 v[136:139], v30 offset:24576
    ds_read_b128 v[140:143], v30 offset:25600
    s_sleep 6
    s_add_u32 s31, s40, 262144
    buffer_load_dwordx4 v[32:35], v0, s[4:7], s31 offen offset:0 sc1
    buffer_load_dwordx4 v[36:39], v0, s[4:7], s31 offen offset:1024 sc1
    buffer_load_dwordx4 v[40:43], v0, s[4:7], s31 offen offset:2048 sc1
    buffer_load_dwordx4 v[44:47], v0, s[4:7], s31 offen offset:3072 sc1
    s_add_u32 s31, s40, 266240
    buffer_load_dwordx4 v[48:51], v0, s[4:7], s31 offen offset:0 sc1
    buffer_load_dwordx4 v[52:55], v0, s[4:7], s31 offen offset:1024 sc1
    buffer_load_dwordx4 v[56:59], v0, s[4:7], s31 offen offset:2048 sc1
    buffer_load_dwordx4 v[60:63], v0, s[4:7], s31 offen offset:3072 sc1
    ds_read_b128 v[144:147], v30 offset:32768
    ds_read_b128 v[148:151], v30 offset:33792
    ds_read_b128 v[152:155], v30 offset:36864
    ds_read_b128 v[156:159], v30 offset:37888
    ds_read_b128 v[160:163], v30 offset:40960
    ds_read_b128 v[164:167], v30 offset:41984
    ds_read_b128 v[168:171], v30 offset:49152
    ds_read_b128 v[172:175], v30 offset:50176
    ds_read_b128 v[176:179], v30 offset:53248
    ds_read_b128 v[180:183], v30 offset:54272
    ds_read_b128 v[184:187], v30 offset:57344
    ds_read_b128 v[188:191], v30 offset:58368
    s_waitcnt vmcnt(7)
    v_lshlrev_b32 v76, 16, v32
    v_and_b32 v77, 0xffff0000, v32
    v_lshlrev_b32 v78, 16, v33
    v_and_b32 v79, 0xffff0000, v33
    v_lshlrev_b32 v80, 16, v34
    v_and_b32 v81, 0xffff0000, v34
    v_xor_b32 v28, s29, v35
    s_waitcnt vmcnt(6)
    v_dot2c_f32_bf16 v76, s46, v36
    v_dot2c_f32_bf16 v77, s47, v36
    v_dot2c_f32_bf16 v78, s46, v37
    v_dot2c_f32_bf16 v79, s47, v37
    v_dot2c_f32_bf16 v80, s46, v38
    v_dot2c_f32_bf16 v81, s47, v38
    v_bitop3_b32 v28, v5, v39, v28 bitop3:0xbe
    s_waitcnt vmcnt(5)
    v_dot2c_f32_bf16 v76, s46, v40
    v_dot2c_f32_bf16 v77, s47, v40
    v_dot2c_f32_bf16 v78, s46, v41
    v_dot2c_f32_bf16 v79, s47, v41
    v_dot2c_f32_bf16 v80, s46, v42
    v_dot2c_f32_bf16 v81, s47, v42
    v_bitop3_b32 v28, v5, v43, v28 bitop3:0xbe
    s_waitcnt vmcnt(4)
    v_dot2c_f32_bf16 v76, s46, v44
    v_dot2c_f32_bf16 v77, s47, v44
    v_dot2c_f32_bf16 v78, s46, v45
    v_dot2c_f32_bf16 v79, s47, v45
    v_dot2c_f32_bf16 v80, s46, v46
    v_dot2c_f32_bf16 v81, s47, v46
    v_bitop3_b32 v28, v5, v47, v28 bitop3:0xbe
    s_waitcnt vmcnt(3)
    v_dot2c_f32_bf16 v76, s46, v48
    v_dot2c_f32_bf16 v77, s47, v48
    v_dot2c_f32_bf16 v78, s46, v49
    v_dot2c_f32_bf16 v79, s47, v49
    v_dot2c_f32_bf16 v80, s46, v50
    v_dot2c_f32_bf16 v81, s47, v50
    v_bitop3_b32 v28, v5, v51, v28 bitop3:0xbe
    s_waitcnt vmcnt(2)
    v_dot2c_f32_bf16 v76, s46, v52
    v_dot2c_f32_bf16 v77, s47, v52
    v_dot2c_f32_bf16 v78, s46, v53
    v_dot2c_f32_bf16 v79, s47, v53
    v_dot2c_f32_bf16 v80, s46, v54
    v_dot2c_f32_bf16 v81, s47, v54
    v_bitop3_b32 v28, v5, v55, v28 bitop3:0xbe
    s_waitcnt vmcnt(1)
    v_dot2c_f32_bf16 v76, s46, v56
    v_dot2c_f32_bf16 v77, s47, v56
    v_dot2c_f32_bf16 v78, s46, v57
    v_dot2c_f32_bf16 v79, s47, v57
    v_dot2c_f32_bf16 v80, s46, v58
    v_dot2c_f32_bf16 v81, s47, v58
    v_bitop3_b32 v28, v5, v59, v28 bitop3:0xbe
    s_waitcnt vmcnt(0)
    v_dot2c_f32_bf16 v76, s46, v60
    v_dot2c_f32_bf16 v77, s47, v60
    v_dot2c_f32_bf16 v78, s46, v61
    v_dot2c_f32_bf16 v79, s47, v61
    v_dot2c_f32_bf16 v80, s46, v62
    v_dot2c_f32_bf16 v81, s47, v62
    v_bitop3_b32 v28, v5, v63, v28 bitop3:0xbe
    v_cmp_ne_u32 s[54:55], 0, v28
    s_nop 1
    s_cmp_lg_u64 s[54:55], 0
    s_cbranch_scc1 Lrare75
Lrare75b:
    v_cvt_pk_bf16_f32 v86, v80, v81
    v_cvt_pk_bf16_f32 v82, v76, v77
    v_cvt_pk_bf16_f32 v83, v78, v79
    v_mov_b32_dpp v84, v86 quad_perm:[0,0,2,2] row_mask:0xf bank_mask:0xf
    v_mov_b32_dpp v85, v86 quad_perm:[1,1,3,3] row_mask:0xf bank_mask:0xf
    s_add_u32 s31, s67, 0
    s_nop 0
    v_mfma_f32_16x16x16_bf16 v[32:35], v[84:85], v[64:65], v[72:75]
    v_mfma_f32_16x16x16_bf16 v[48:51], v[82:83], v[64:65], 0
    v_mfma_f32_16x16x16_bf16 v[36:39], v[84:85], v[66:67], v[72:75]
    v_mfma_f32_16x16x16_bf16 v[52:55], v[82:83], v[66:67], 0
    v_mfma_f32_16x16x16_bf16 v[40:43], v[84:85], v[68:69], v[72:75]
    v_mfma_f32_16x16x16_bf16 v[56:59], v[82:83], v[68:69], 0
    v_mfma_f32_16x16x16_bf16 v[44:47], v[84:85], v[70:71], v[72:75]
    v_mfma_f32_16x16x16_bf16 v[60:63], v[82:83], v[70:71], 0
    s_nop 0
    v_rcp_f32 v32, v32
    s_nop 0
    v_rcp_f32 v36, v36
    v_pk_mul_f32 v[48:49], v[48:49], v[32:33] op_sel_hi:[1,0]
    v_pk_mul_f32 v[50:51], v[50:51], v[32:33] op_sel_hi:[1,0]
    v_cvt_pk_bf16_f32 v88, v48, v49
    v_cvt_pk_bf16_f32 v89, v50, v51
    v_and_b32 v88, -2, v88
    buffer_store_dwordx2 v[88:89], v9, s[4:7], s31 offen
    s_add_u32 s31, s31, 16384
    v_rcp_f32 v40, v40
    v_pk_mul_f32 v[52:53], v[52:53], v[36:37] op_sel_hi:[1,0]
    v_pk_mul_f32 v[54:55], v[54:55], v[36:37] op_sel_hi:[1,0]
    v_cvt_pk_bf16_f32 v90, v52, v53
    v_cvt_pk_bf16_f32 v91, v54, v55
    v_and_b32 v90, -2, v90
    buffer_store_dwordx2 v[90:91], v9, s[4:7], s31 offen
    s_add_u32 s31, s31, 16384
    v_rcp_f32 v44, v44
    v_pk_mul_f32 v[56:57], v[56:57], v[40:41] op_sel_hi:[1,0]
    v_pk_mul_f32 v[58:59], v[58:59], v[40:41] op_sel_hi:[1,0]
    v_cvt_pk_bf16_f32 v92, v56, v57
    v_cvt_pk_bf16_f32 v93, v58, v59
    v_and_b32 v92, -2, v92
    buffer_store_dwordx2 v[92:93], v9, s[4:7], s31 offen
    s_add_u32 s31, s31, 16384
    v_pk_mul_f32 v[60:61], v[60:61], v[44:45] op_sel_hi:[1,0]
    v_pk_mul_f32 v[62:63], v[62:63], v[44:45] op_sel_hi:[1,0]
    v_cvt_pk_bf16_f32 v94, v60, v61
    v_cvt_pk_bf16_f32 v95, v62, v63
    v_and_b32 v94, -2, v94
    buffer_store_dwordx2 v[94:95], v9, s[4:7], s31 offen
    ds_read_b128 v[64:67], v30 offset:12288
    ds_read_b128 v[68:71], v30 offset:13312
    ds_read_b128 v[72:75], v30 offset:28672
    ds_read_b128 v[76:79], v30 offset:29696
    ds_read_b128 v[80:83], v30 offset:45056
    ds_read_b128 v[84:87], v30 offset:46080
    ds_read_b128 v[88:91], v30 offset:61440
    ds_read_b128 v[92:95], v30 offset:62464
    s_waitcnt lgkmcnt(0)
    s_barrier
    v_lshlrev_b32 v28, 7, v3
    v_and_b32 v28, 0x3c00, v28
    v_and_b32 v29, 4, v3
    v_lshl_add_u32 v28, v29, 1, v28
    s_add_u32 s31, s32, 49152
Lop85:
    s_sub_u32 s66, s66, 1
    s_cbranch_scc1 Lbail
    buffer_load_dword v31, v28, s[4:7], s31 offen offset:1008 sc1
    s_waitcnt vmcnt(0)
    v_and_b32 v31, 1, v31
    v_cmp_ne_u32 vcc, 0, v31
    s_cbranch_vccnz Lop85
    s_add_u32 m0, s42, 0
    s_add_u32 s31, s38, 0
    buffer_load_dwordx4 v0, s[4:7], s31 offen offset:0 sc1 lds
    buffer_load_dwordx4 v0, s[4:7], s31 offen offset:1024 sc1 lds
    buffer_load_dwordx4 v0, s[4:7], s31 offen offset:2048 sc1 lds
    buffer_load_dwordx4 v0, s[4:7], s31 offen offset:3072 sc1 lds
    s_add_u32 m0, s42, 8192
    s_add_u32 s31, s38, 8192
    buffer_load_dwordx4 v0, s[4:7], s31 offen offset:0 sc1 lds
    buffer_load_dwordx4 v0, s[4:7], s31 offen offset:1024 sc1 lds
    buffer_load_dwordx4 v0, s[4:7], s31 offen offset:2048 sc1 lds
    buffer_load_dwordx4 v0, s[4:7], s31 offen offset:3072 sc1 lds
    s_add_u32 m0, s42, 32768
    s_add_u32 s31, s38, 32768
    buffer_load_dwordx4 v0, s[4:7], s31 offen offset:0 sc1 lds
    buffer_load_dwordx4 v0, s[4:7], s31 offen offset:1024 sc1 lds
    buffer_load_dwordx4 v0, s[4:7], s31 offen offset:2048 sc1 lds
    buffer_load_dwordx4 v0, s[4:7], s31 offen offset:3072 sc1 lds
    s_add_u32 m0, s42, 40960
    s_add_u32 s31, s38, 40960
    buffer_load_dwordx4 v0, s[4:7], s31 offen offset:0 sc1 lds
    buffer_load_dwordx4 v0, s[4:7], s31 offen offset:1024 sc1 lds
    buffer_load_dwordx4 v0, s[4:7], s31 offen offset:2048 sc1 lds
    buffer_load_dwordx4 v0, s[4:7], s31 offen offset:3072 sc1 lds
    s_and_b32 s31, s42, 0x4000
    s_add_u32 s31, s31, 0
    v_add_u32 v30, s31, v0
    s_add_u32 s31, s42, 0
    v_add_u32 v28, s31, v0
    v_add_u32 v29, 8, v28
    s_waitcnt vmcnt(12)
    ds_read_b128 v[32:35], v28 offset:0
    ds_read_b128 v[36:39], v28 offset:1024
    ds_read_b128 v[40:43], v28 offset:2048
    ds_read_b128 v[44:47], v28 offset:3072
    s_waitcnt vmcnt(8)
    ds_read_b128 v[48:51], v28 offset:8192
    ds_read_b128 v[52:55], v28 offset:9216
    ds_read_b128 v[56:59], v28 offset:10240
    ds_read_b128 v[60:63], v28 offset:11264
    s_waitcnt lgkmcnt(6)
    v_bitop3_b32 v32, v32, v34, v36 bitop3:0xfe
    s_waitcnt lgkmcnt(5)
    v_bitop3_b32 v38, v38, v40, v42 bitop3:0xfe
    s_waitcnt lgkmcnt(4)
    v_bitop3_b32 v32, v32, v38, v44 bitop3:0xfe
    v_bitop3_b32 v32, v32, v46, 1 bitop3:0xa8
    v_cmp_ne_u32 s[56:57], 0, v32
    s_nop 1
    s_cmp_lg_u64 s[56:57], 0
    s_cbranch_scc1 Lrare86
Lrare86b:
    s_waitcnt lgkmcnt(2)
    v_bitop3_b32 v48, v48, v50, v52 bitop3:0xfe
    s_waitcnt lgkmcnt(1)
    v_bitop3_b32 v54, v54, v56, v58 bitop3:0xfe
    s_waitcnt lgkmcnt(0)
    v_bitop3_b32 v48, v48, v54, v60 bitop3:0xfe
    v_bitop3_b32 v48, v48, v62, 1 bitop3:0xa8
    v_cmp_ne_u32 s[56:57], 0, v48
    s_nop 1
    s_cmp_lg_u64 s[56:57], 0
    s_cbranch_scc1 Lrare88
Lrare88b:
    s_barrier
    ds_read_b128 v[32:35], v30 offset:0
    ds_read_b128 v[36:39], v30 offset:1024
    ds_read_b128 v[40:43], v30 offset:2048
    ds_read_b128 v[44:47], v30 offset:3072
    ds_read_b128 v[48:51], v30 offset:4096
    s_waitcnt lgkmcnt(4)
    v_mfma_f32_16x16x32_bf16 v[12:15], v[96:99], v[32:35], v[12:15]
    s_waitcnt vmcnt(4)
    ds_read2st64_b32 v[56:57], v28 offset0:128 offset1:132
    ds_read2st64_b32 v[58:59], v29 offset0:128 offset1:132
    v_mfma_f32_16x16x32_bf16 v[16:19], v[100:103], v[32:35], v[16:19]
    s_waitcnt lgkmcnt(5)
    ds_read_b128 v[52:55], v30 offset:5120
    ds_read2st64_b32 v[60:61], v28 offset0:136 offset1:140
    v_mfma_f32_16x16x32_bf16 v[12:15], v[104:107], v[36:39], v[12:15]
    ds_read2st64_b32 v[62:63], v29 offset0:136 offset1:140
    v_mfma_f32_16x16x32_bf16 v[16:19], v[108:111], v[36:39], v[16:19]
    s_waitcnt lgkmcnt(7)
    ds_read_b128 v[32:35], v30 offset:6144
    v_mfma_f32_16x16x32_bf16 v[12:15], v[112:115], v[40:43], v[12:15]
    v_mfma_f32_16x16x32_bf16 v[16:19], v[116:119], v[40:43], v[16:19]
    s_waitcnt lgkmcnt(7)
    ds_read_b128 v[36:39], v30 offset:7168
    v_mfma_f32_16x16x32_bf16 v[12:15], v[64:67], v[44:47], v[12:15]
    s_waitcnt lgkmcnt(5)
    v_bitop3_b32 v56, v56, v57, v58 bitop3:0xfe
    v_mfma_f32_16x16x32_bf16 v[16:19], v[68:71], v[44:47], v[16:19]
    ds_read_b128 v[40:43], v30 offset:8192
    s_waitcnt lgkmcnt(4)
    v_bitop3_b32 v59, v59, v60, v61 bitop3:0xfe
    s_waitcnt lgkmcnt(3)
    v_bitop3_b32 v56, v56, v59, v62 bitop3:0xfe
    v_bitop3_b32 v56, v56, v63, 1 bitop3:0xa8
    v_cmp_ne_u32 s[56:57], 0, v56
    v_mfma_f32_16x16x32_bf16 v[12:15], v[120:123], v[48:51], v[12:15]
    v_mfma_f32_16x16x32_bf16 v[16:19], v[124:127], v[48:51], v[16:19]
    ds_read_b128 v[44:47], v30 offset:9216
    v_mfma_f32_16x16x32_bf16 v[12:15], v[128:131], v[52:55], v[12:15]
    s_cmp_lg_u64 s[56:57], 0
    s_cbranch_scc1 Lrare90
Lrare90b:
    s_waitcnt vmcnt(0)
    v_mfma_f32_16x16x32_bf16 v[16:19], v[132:135], v[52:55], v[16:19]
    s_waitcnt lgkmcnt(3)
    ds_read_b128 v[48:51], v30 offset:10240
    ds_read2st64_b32 v[56:57], v28 offset0:160 offset1:164
    v_mfma_f32_16x16x32_bf16 v[12:15], v[136:139], v[32:35], v[12:15]
    ds_read2st64_b32 v[58:59], v29 offset0:160 offset1:164
    ds_read2st64_b32 v[60:61], v28 offset0:168 offset1:172
    v_mfma_f32_16x16x32_bf16 v[16:19], v[140:143], v[32:35], v[16:19]
    s_waitcnt lgkmcnt(6)
    ds_read_b128 v[52:55], v30 offset:11264
    ds_read2st64_b32 v[62:63], v29 offset0:168 offset1:172
    v_mfma_f32_16x16x32_bf16 v[12:15], v[72:75], v[36:39], v[12:15]
    v_mfma_f32_16x16x32_bf16 v[16:19], v[76:79], v[36:39], v[16:19]
    s_waitcnt lgkmcnt(7)
    ds_read_b128 v[32:35], v30 offset:12288
    v_mfma_f32_16x16x32_bf16 v[12:15], v[144:147], v[40:43], v[12:15]
    v_mfma_f32_16x16x32_bf16 v[16:19], v[148:151], v[40:43], v[16:19]
    s_waitcnt lgkmcnt(7)
    ds_read_b128 v[36:39], v30 offset:13312
    v_mfma_f32_16x16x32_bf16 v[12:15], v[152:155], v[44:47], v[12:15]
    s_waitcnt lgkmcnt(5)
    v_bitop3_b32 v56, v56, v57, v58 bitop3:0xfe
    v_mfma_f32_16x16x32_bf16 v[16:19], v[156:159], v[44:47], v[16:19]
    ds_read_b128 v[40:43], v30 offset:14336
    s_waitcnt lgkmcnt(5)
    v_bitop3_b32 v59, v59, v60, v61 bitop3:0xfe
    s_waitcnt lgkmcnt(3)
    v_bitop3_b32 v56, v56, v59, v62 bitop3:0xfe
    v_bitop3_b32 v56, v56, v63, 1 bitop3:0xa8
    v_cmp_ne_u32 s[56:57], 0, v56
    v_mfma_f32_16x16x32_bf16 v[12:15], v[160:163], v[48:51], v[12:15]
    s_lshl_b32 s30, s24, 3
    s_add_u32 s30, s30, s25
    s_cmp_ge_u32 s30, 22
    s_cselect_b32 s51, 0x40000000, s32
    s_lshl_b32 s30, s30, 13
    s_add_u32 s30, s30, s51
    s_add_u32 s30, s30, 327680
    s_mov_b32 m0, 163328
    v_mfma_f32_16x16x32_bf16 v[16:19], v[164:167], v[48:51], v[16:19]
    ds_read_b128 v[44:47], v30 offset:15360
    v_lshlrev_b32 v31, 3, v0
    v_mfma_f32_16x16x32_bf16 v[12:15], v[80:83], v[52:55], v[12:15]
    s_cmp_lg_u64 s[56:57], 0
    s_cbranch_scc1 Lrare92
Lrare92b:
    s_barrier
    v_mfma_f32_16x16x32_bf16 v[16:19], v[84:87], v[52:55], v[16:19]
    s_waitcnt lgkmcnt(3)
    ds_read_b128 v[48:51], v30 offset:32768
    v_mfma_f32_16x16x32_bf16 v[12:15], v[168:171], v[32:35], v[12:15]
    buffer_load_dword v31, s[4:7], s30 offen lds
    v_mfma_f32_16x16x32_bf16 v[16:19], v[172:175], v[32:35], v[16:19]
    s_waitcnt lgkmcnt(3)
    ds_read_b128 v[52:55], v30 offset:33792
    v_mfma_f32_16x16x32_bf16 v[12:15], v[176:179], v[36:39], v[12:15]
    v_mfma_f32_16x16x32_bf16 v[16:19], v[180:183], v[36:39], v[16:19]
    s_waitcnt lgkmcnt(3)
    ds_read_b128 v[32:35], v30 offset:34816
    v_mfma_f32_16x16x32_bf16 v[12:15], v[184:187], v[40:43], v[12:15]
    v_mfma_f32_16x16x32_bf16 v[16:19], v[188:191], v[40:43], v[16:19]
    s_waitcnt lgkmcnt(3)
    ds_read_b128 v[36:39], v30 offset:35840
    v_mfma_f32_16x16x32_bf16 v[12:15], v[88:91], v[44:47], v[12:15]
    v_mfma_f32_16x16x32_bf16 v[16:19], v[92:95], v[44:47], v[16:19]
    s_waitcnt lgkmcnt(3)
    ds_read_b128 v[40:43], v30 offset:36864
    v_mfma_f32_16x16x32_bf16 v[20:23], v[96:99], v[48:51], v[20:23]
    v_mfma_f32_16x16x32_bf16 v[24:27], v[100:103], v[48:51], v[24:27]
    s_waitcnt lgkmcnt(3)
    ds_read_b128 v[44:47], v30 offset:37888
    v_mfma_f32_16x16x32_bf16 v[20:23], v[104:107], v[52:55], v[20:23]
    v_mfma_f32_16x16x32_bf16 v[24:27], v[108:111], v[52:55], v[24:27]
    s_waitcnt lgkmcnt(3)
    ds_read_b128 v[48:51], v30 offset:38912
    v_cvt_pk_bf16_f32 v96, v12, v13
    v_mfma_f32_16x16x32_bf16 v[20:23], v[112:115], v[32:35], v[20:23]
    v_cvt_pk_bf16_f32 v97, v14, v15
    v_cvt_pk_bf16_f32 v98, v16, v17
    v_mfma_f32_16x16x32_bf16 v[24:27], v[116:119], v[32:35], v[24:27]
    s_waitcnt lgkmcnt(3)
    ds_read_b128 v[52:55], v30 offset:39936
    v_cvt_pk_bf16_f32 v99, v18, v19
    v_mfma_f32_16x16x32_bf16 v[20:23], v[64:67], v[36:39], v[20:23]
    v_or_b32 v96, 1, v96
    v_or_b32 v98, 1, v98
    v_mfma_f32_16x16x32_bf16 v[24:27], v[68:71], v[36:39], v[24:27]
    s_waitcnt lgkmcnt(3)
    ds_read_b128 v[32:35], v30 offset:40960
    s_add_u32 s35, s43, 131072
    v_mfma_f32_16x16x32_bf16 v[20:23], v[120:123], v[40:43], v[20:23]
    s_barrier
    buffer_store_dwordx4 v[96:99], v0, s[4:7], s35 offen
    v_mfma_f32_16x16x32_bf16 v[24:27], v[124:127], v[40:43], v[24:27]
    s_waitcnt lgkmcnt(3)
    ds_read_b128 v[36:39], v30 offset:41984
    v_mfma_f32_16x16x32_bf16 v[20:23], v[128:131], v[44:47], v[20:23]
    v_mfma_f32_16x16x32_bf16 v[24:27], v[132:135], v[44:47], v[24:27]
    s_waitcnt lgkmcnt(3)
    ds_read_b128 v[40:43], v30 offset:43008
    v_mfma_f32_16x16x32_bf16 v[20:23], v[136:139], v[48:51], v[20:23]
    v_add_f32 v104, v12, v13
    v_mul_f32 v105, v12, v12
    v_mfma_f32_16x16x32_bf16 v[24:27], v[140:143], v[48:51], v[24:27]
    s_waitcnt lgkmcnt(3)
    ds_read_b128 v[44:47], v30 offset:44032
    v_fmac_f32 v105, v13, v13
    v_mfma_f32_16x16x32_bf16 v[20:23], v[72:75], v[52:55], v[20:23]
    v_add_f32 v104, v104, v14
    v_fmac_f32 v105, v14, v14
    v_mfma_f32_16x16x32_bf16 v[24:27], v[76:79], v[52:55], v[24:27]
    s_waitcnt lgkmcnt(3)
    ds_read_b128 v[48:51], v30 offset:45056
    v_add_f32 v104, v104, v15
    v_mfma_f32_16x16x32_bf16 v[20:23], v[144:147], v[32:35], v[20:23]
    v_fmac_f32 v105, v15, v15
    v_add_f32 v104, v104, v16
    v_mfma_f32_16x16x32_bf16 v[24:27], v[148:151], v[32:35], v[24:27]
    s_waitcnt lgkmcnt(3)
    ds_read_b128 v[52:55], v30 offset:46080
    v_fmac_f32 v105, v16, v16
    v_mfma_f32_16x16x32_bf16 v[20:23], v[152:155], v[36:39], v[20:23]
    v_add_f32 v104, v104, v17
    v_fmac_f32 v105, v17, v17
    v_mfma_f32_16x16x32_bf16 v[24:27], v[156:159], v[36:39], v[24:27]
    s_waitcnt lgkmcnt(3)
    ds_read_b128 v[32:35], v30 offset:47104
    v_add_f32 v104, v104, v18
    v_mfma_f32_16x16x32_bf16 v[20:23], v[160:163], v[40:43], v[20:23]
    v_fmac_f32 v105, v18, v18
    v_add_f32 v104, v104, v19
    v_mfma_f32_16x16x32_bf16 v[24:27], v[164:167], v[40:43], v[24:27]
    s_waitcnt lgkmcnt(3)
    ds_read_b128 v[36:39], v30 offset:48128
    v_fmac_f32 v105, v19, v19
    v_mfma_f32_16x16x32_bf16 v[20:23], v[80:83], v[44:47], v[20:23]
    s_add_u32 s35, s44, 720896
    v_permlane16_swap_b32 v104, v105
    v_add_f32 v104, v104, v105
    v_mfma_f32_16x16x32_bf16 v[24:27], v[84:87], v[44:47], v[24:27]
    s_waitcnt lgkmcnt(3)
    v_mov_b32 v105, v104
    s_nop 1
    v_permlane32_swap_b32 v104, v105
    v_mfma_f32_16x16x32_bf16 v[20:23], v[168:171], v[48:51], v[20:23]
    v_add_f32 v104, v104, v105
    v_or_b32 v104, 1, v104
    v_mfma_f32_16x16x32_bf16 v[24:27], v[172:175], v[48:51], v[24:27]
    s_waitcnt lgkmcnt(2)
    buffer_store_dword v104, v7, s[4:7], s35 offen
    v_mfma_f32_16x16x32_bf16 v[20:23], v[176:179], v[52:55], v[20:23]
    v_mfma_f32_16x16x32_bf16 v[24:27], v[180:183], v[52:55], v[24:27]
    s_waitcnt lgkmcnt(1)
    v_mfma_f32_16x16x32_bf16 v[20:23], v[184:187], v[32:35], v[20:23]
    v_mfma_f32_16x16x32_bf16 v[24:27], v[188:191], v[32:35], v[24:27]
    s_waitcnt lgkmcnt(0)
    v_mfma_f32_16x16x32_bf16 v[20:23], v[88:91], v[36:39], v[20:23]
    v_mfma_f32_16x16x32_bf16 v[24:27], v[92:95], v[36:39], v[24:27]
    s_nop 6
    v_cvt_pk_bf16_f32 v100, v20, v21
    v_cvt_pk_bf16_f32 v101, v22, v23
    v_cvt_pk_bf16_f32 v102, v24, v25
    v_cvt_pk_bf16_f32 v103, v26, v27
    v_or_b32 v100, 1, v100
    v_or_b32 v102, 1, v102
    s_add_u32 s31, s43, 163840
    buffer_store_dwordx4 v[100:103], v0, s[4:7], s31 offen
    v_dot2_f32_bf16 v28, v100, s45, 0
    v_dot2_f32_bf16 v29, v100, v100, 0
    v_dot2_f32_bf16 v28, v101, s45, v28
    v_dot2_f32_bf16 v29, v101, v101, v29
    v_dot2_f32_bf16 v28, v102, s45, v28
    v_dot2_f32_bf16 v29, v102, v102, v29
    v_dot2_f32_bf16 v28, v103, s45, v28
    v_dot2_f32_bf16 v29, v103, v103, v29
    s_add_u32 s31, s44, 724992
    s_nop 1
    v_permlane16_swap_b32 v28, v29
    v_add_f32 v28, v28, v29
    v_mov_b32 v29, v28
    s_nop 1
    v_permlane32_swap_b32 v28, v29
    v_add_f32 v28, v28, v29
    v_or_b32 v28, 1, v28
    buffer_store_dword v28, v7, s[4:7], s31 offen
    s_add_u32 m0, s41, 0
    s_add_u32 s31, s34, 131072
    buffer_load_dwordx4 v0, s[4:7], s31 offen offset:0 sc1 lds
    buffer_load_dwordx4 v0, s[4:7], s31 offen offset:1024 sc1 lds
    buffer_load_dwordx4 v0, s[4:7], s31 offen offset:2048 sc1 lds
    buffer_load_dwordx4 v0, s[4:7], s31 offen offset:3072 sc1 lds
    s_add_u32 m0, s41, 16384
    s_add_u32 s31, s34, 147456
    buffer_load_dwordx4 v0, s[4:7], s31 offen offset:0 sc1 lds
    buffer_load_dwordx4 v0, s[4:7], s31 offen offset:1024 sc1 lds
    buffer_load_dwordx4 v0, s[4:7], s31 offen offset:2048 sc1 lds
    buffer_load_dwordx4 v0, s[4:7], s31 offen offset:3072 sc1 lds
    buffer_load_dwordx4 v[176:179], v0, s[4:7], s62 offen sc1
    buffer_load_dwordx4 v[180:183], v0, s[4:7], s62 offen offset:1024 sc1
    buffer_load_dwordx4 v[184:187], v0, s[4:7], s68 offen offset:2048 sc1
    buffer_load_dwordx4 v[188:191], v0, s[4:7], s68 offen offset:3072 sc1
    s_mul_i32 s31, s24, 192
    v_add_u32 v30, s31, v1
    s_add_u32 s31, s41, 0
    v_add_u32 v28, s31, v0
    v_add_u32 v94, 0, v0
    ds_read_b128 v[80:83], v30 offset:2048
    ds_read_b128 v[84:87], v30 offset:2112
    ds_read_b128 v[88:91], v30 offset:2176
    s_waitcnt vmcnt(8)
    ds_read_b128 v[128:131], v28 offset:0
    ds_read_b128 v[132:135], v28 offset:1024
    ds_read_b128 v[136:139], v28 offset:2048
    ds_read_b128 v[140:143], v28 offset:3072
    s_waitcnt lgkmcnt(2)
    v_bitop3_b32 v128, v128, v130, v132 bitop3:0x80
    s_waitcnt lgkmcnt(1)
    v_bitop3_b32 v134, v134, v136, v138 bitop3:0x80
    s_waitcnt lgkmcnt(0)
    v_bitop3_b32 v128, v128, v134, v140 bitop3:0x80
    v_bitop3_b32 v128, v128, v142, 1 bitop3:0x80
    v_cmp_ne_u32 s[56:57], 1, v128
    s_nop 1
    s_cmp_lg_u64 s[56:57], 0
    s_cbranch_scc1 Lrare94
Lrare94b:
    s_barrier
    ds_read_b128 v[32:35], v94 offset:0
    ds_read_b128 v[36:39], v94 offset:1024
    ds_read_b128 v[40:43], v94 offset:2048
    ds_read_b128 v[44:47], v94 offset:3072
    ds_read_b128 v[48:51], v94 offset:4096
    s_waitcnt lgkmcnt(4)
    v_mfma_f32_16x16x32_bf16 v[56:59], a[0:3], v[32:35], 0
    s_add_u32 s30, s19, 720896
    buffer_load_dwordx4 v[156:159], v0, s[4:7], s30 offen sc1
    v_mfma_f32_16x16x32_bf16 v[60:63], a[64:67], v[32:35], 0
    s_add_u32 m0, s41, 32768
    s_add_u32 s30, s34, 163840
    v_mfma_f32_16x16x32_bf16 v[64:67], a[128:131], v[32:35], 0
    s_waitcnt lgkmcnt(3)
    ds_read_b128 v[52:55], v94 offset:5120
    v_mfma_f32_16x16x32_bf16 v[56:59], a[4:7], v[36:39], v[56:59]
    v_mfma_f32_16x16x32_bf16 v[60:63], a[68:71], v[36:39], v[60:63]
    buffer_load_dwordx4 v0, s[4:7], s30 offen offset:0 sc1 lds
    v_mfma_f32_16x16x32_bf16 v[64:67], a[132:135], v[36:39], v[64:67]
    s_waitcnt lgkmcnt(3)
    ds_read_b128 v[32:35], v94 offset:6144
    v_mfma_f32_16x16x32_bf16 v[56:59], a[8:11], v[40:43], v[56:59]
    s_waitcnt vmcnt(6)
    ds_read_b128 v[128:131], v28 offset:16384
    ds_read_b128 v[132:135], v28 offset:17408
    v_mfma_f32_16x16x32_bf16 v[60:63], a[72:75], v[40:43], v[60:63]
    ds_read_b128 v[136:139], v28 offset:18432
    ds_read_b128 v[140:143], v28 offset:19456
    v_mfma_f32_16x16x32_bf16 v[64:67], a[136:139], v[40:43], v[64:67]
    s_waitcnt lgkmcnt(7)
    ds_read_b128 v[36:39], v94 offset:7168
    v_mfma_f32_16x16x32_bf16 v[56:59], a[12:15], v[44:47], v[56:59]
    buffer_load_dwordx4 v0, s[4:7], s30 offen offset:1024 sc1 lds
    v_mfma_f32_16x16x32_bf16 v[60:63], a[76:79], v[44:47], v[60:63]
    v_mfma_f32_16x16x32_bf16 v[64:67], a[140:143], v[44:47], v[64:67]
    s_waitcnt lgkmcnt(7)
    ds_read_b128 v[40:43], v94 offset:8192
    v_mfma_f32_16x16x32_bf16 v[56:59], a[16:19], v[48:51], v[56:59]
    v_mfma_f32_16x16x32_bf16 v[60:63], a[80:83], v[48:51], v[60:63]
    buffer_load_dwordx4 v0, s[4:7], s30 offen offset:2048 sc1 lds
    v_mfma_f32_16x16x32_bf16 v[64:67], a[144:147], v[48:51], v[64:67]
    s_waitcnt lgkmcnt(7)
    ds_read_b128 v[44:47], v94 offset:9216
    v_mfma_f32_16x16x32_bf16 v[56:59], a[20:23], v[52:55], v[56:59]
    s_waitcnt lgkmcnt(5)
    v_bitop3_b32 v128, v128, v130, v132 bitop3:0x80
    v_mfma_f32_16x16x32_bf16 v[60:63], a[84:87], v[52:55], v[60:63]
    s_waitcnt lgkmcnt(4)
    v_bitop3_b32 v134, v134, v136, v138 bitop3:0x80
    v_mfma_f32_16x16x32_bf16 v[64:67], a[148:151], v[52:55], v[64:67]
    ds_read_b128 v[48:51], v94 offset:10240
    v_mfma_f32_16x16x32_bf16 v[56:59], a[24:27], v[32:35], v[56:59]
    buffer_load_dwordx4 v0, s[4:7], s30 offen offset:3072 sc1 lds
    v_mfma_f32_16x16x32_bf16 v[60:63], a[88:91], v[32:35], v[60:63]
    s_add_u32 s30, s19, 724992
    s_waitcnt lgkmcnt(4)
    v_bitop3_b32 v128, v128, v134, v140 bitop3:0x80
    v_mfma_f32_16x16x32_bf16 v[64:67], a[152:155], v[32:35], v[64:67]
    s_waitcnt lgkmcnt(3)
    ds_read_b128 v[52:55], v94 offset:11264
    v_bitop3_b32 v128, v128, v142, 1 bitop3:0x80
    v_mfma_f32_16x16x32_bf16 v[56:59], a[28:31], v[36:39], v[56:59]
    v_cmp_ne_u32 s[56:57], 1, v128
    v_mfma_f32_16x16x32_bf16 v[60:63], a[92:95], v[36:39], v[60:63]
    buffer_load_dwordx4 v[160:163], v0, s[4:7], s30 offen sc1
    v_mfma_f32_16x16x32_bf16 v[64:67], a[156:159], v[36:39], v[64:67]
    s_waitcnt lgkmcnt(3)
    ds_read_b128 v[32:35], v94 offset:12288
    s_add_u32 m0, s41, 49152
    v_mfma_f32_16x16x32_bf16 v[56:59], a[32:35], v[40:43], v[56:59]
    s_add_u32 s30, s34, 180224
    v_mfma_f32_16x16x32_bf16 v[60:63], a[96:99], v[40:43], v[60:63]
    v_mfma_f32_16x16x32_bf16 v[64:67], a[160:163], v[40:43], v[64:67]
    s_waitcnt lgkmcnt(3)
    ds_read_b128 v[36:39], v94 offset:13312
    v_mfma_f32_16x16x32_bf16 v[56:59], a[36:39], v[44:47], v[56:59]
    buffer_load_dwordx4 v0, s[4:7], s30 offen offset:0 sc1 lds
    v_mfma_f32_16x16x32_bf16 v[60:63], a[100:103], v[44:47], v[60:63]
    v_mfma_f32_16x16x32_bf16 v[64:67], a[164:167], v[44:47], v[64:67]
    s_waitcnt lgkmcnt(3)
    ds_read_b128 v[40:43], v94 offset:14336
    v_mfma_f32_16x16x32_bf16 v[56:59], a[40:43], v[48:51], v[56:59]
    v_mfma_f32_16x16x32_bf16 v[60:63], a[104:107], v[48:51], v[60:63]
    buffer_load_dwordx4 v0, s[4:7], s30 offen offset:1024 sc1 lds
    v_mfma_f32_16x16x32_bf16 v[64:67], a[168:171], v[48:51], v[64:67]
    s_waitcnt lgkmcnt(3)
    ds_read_b128 v[44:47], v94 offset:15360
    v_mfma_f32_16x16x32_bf16 v[56:59], a[44:47], v[52:55], v[56:59]
    s_cmp_lg_u64 s[56:57], 0
    s_cbranch_scc1 Lrare96
Lrare96b:
    s_barrier
    v_mfma_f32_16x16x32_bf16 v[60:63], a[108:111], v[52:55], v[60:63]
    v_mfma_f32_16x16x32_bf16 v[64:67], a[172:175], v[52:55], v[64:67]
    s_waitcnt lgkmcnt(3)
    ds_read_b128 v[48:51], v94 offset:16384
    v_mfma_f32_16x16x32_bf16 v[56:59], a[48:51], v[32:35], v[56:59]
    buffer_load_dwordx4 v0, s[4:7], s30 offen offset:2048 sc1 lds
    v_mfma_f32_16x16x32_bf16 v[60:63], a[112:115], v[32:35], v[60:63]
    s_waitcnt vmcnt(8)
    v_bitop3_b32 v31, v156, v157, v158 bitop3:0x80
    v_bitop3_b32 v31, v31, v159, 1 bitop3:0x80
    v_cmp_ne_u32 vcc, 1, v31
    s_cbranch_vccnz Lrare98
Lrare98b:
    v_mfma_f32_16x16x32_bf16 v[64:67], a[176:179], v[32:35], v[64:67]
    s_waitcnt lgkmcnt(3)
    ds_read_b128 v[52:55], v94 offset:17408
    v_add_f32 v156, v156, v158
    v_mfma_f32_16x16x32_bf16 v[56:59], a[52:55], v[36:39], v[56:59]
    v_add_f32 v157, v157, v159
    s_nop 0
    v_mfma_f32_16x16x32_bf16 v[60:63], a[116:119], v[36:39], v[60:63]
    buffer_load_dwordx4 v0, s[4:7], s30 offen offset:3072 sc1 lds
    v_mfma_f32_16x16x32_bf16 v[64:67], a[180:183], v[36:39], v[64:67]
    s_waitcnt lgkmcnt(3)
    ds_read_b128 v[32:35], v94 offset:18432
    s_lshl_b32 s30, s41, 2
    v_mfma_f32_16x16x32_bf16 v[56:59], a[56:59], v[40:43], v[56:59]
    s_add_u32 m0, s30, 73728
    s_add_u32 s30, s62, 12288
    s_add_u32 s51, s68, 12288
    v_mfma_f32_16x16x32_bf16 v[60:63], a[120:123], v[40:43], v[60:63]
    v_add_f32_dpp v156, v156, v156 quad_perm:[1,0,3,2] row_mask:0xf bank_mask:0xf
    v_add_f32_dpp v157, v157, v157 quad_perm:[1,0,3,2] row_mask:0xf bank_mask:0xf
    v_mfma_f32_16x16x32_bf16 v[64:67], a[184:187], v[40:43], v[64:67]
    s_waitcnt lgkmcnt(3)
    ds_read_b128 v[36:39], v94 offset:19456
    v_add_f32_dpp v156, v156, v156 quad_perm:[2,3,0,1] row_mask:0xf bank_mask:0xf
    v_mfma_f32_16x16x32_bf16 v[56:59], a[60:63], v[44:47], v[56:59]
    buffer_load_dwordx4 v0, s[4:7], s30 offen sc1 lds
    v_mfma_f32_16x16x32_bf16 v[60:63], a[124:127], v[44:47], v[60:63]
    v_add_f32_dpp v157, v157, v157 quad_perm:[2,3,0,1] row_mask:0xf bank_mask:0xf
    v_add_f32_dpp v156, v156, v156 row_half_mirror row_mask:0xf bank_mask:0xf
    v_mfma_f32_16x16x32_bf16 v[64:67], a[188:191], v[44:47], v[64:67]
    s_waitcnt lgkmcnt(3)
    ds_read_b128 v[40:43], v94 offset:20480
    v_add_f32_dpp v157, v157, v157 row_half_mirror row_mask:0xf bank_mask:0xf
    v_mfma_f32_16x16x32_bf16 v[68:71], a[0:3], v[48:51], 0
    v_mul_f32 v156, 0xbb000000, v156
    v_mul_f32 v157, 0x3b000000, v157
    v_mfma_f32_16x16x32_bf16 v[72:75], a[64:67], v[48:51], 0
    buffer_load_dwordx4 v0, s[4:7], s30 offen offset:1024 sc1 lds
    v_mfma_f32_16x16x32_bf16 v[76:79], a[128:131], v[48:51], 0
    s_waitcnt lgkmcnt(3)
    ds_read_b128 v[44:47], v94 offset:21504
    v_fma_f32 v157, -v156, v156, v157
    v_mfma_f32_16x16x32_bf16 v[68:71], a[4:7], v[52:55], v[68:71]
    ds_write_b32 v8, v156 offset:1792
    v_mfma_f32_16x16x32_bf16 v[72:75], a[68:71], v[52:55], v[72:75]
    v_max_f32 v157, 0, v157
    v_add_f32 v157, 0x3727c5ac, v157
    v_mfma_f32_16x16x32_bf16 v[76:79], a[132:135], v[52:55], v[76:79]
    s_waitcnt lgkmcnt(4)
    ds_read_b128 v[48:51], v94 offset:22528
    v_mfma_f32_16x16x32_bf16 v[68:71], a[8:11], v[32:35], v[68:71]
    s_waitcnt vmcnt(7)
    ds_read_b128 v[128:131], v28 offset:32768
    ds_read_b128 v[132:135], v28 offset:33792
    v_mfma_f32_16x16x32_bf16 v[72:75], a[72:75], v[32:35], v[72:75]
    ds_read_b128 v[136:139], v28 offset:34816
    ds_read_b128 v[140:143], v28 offset:35840
    v_mfma_f32_16x16x32_bf16 v[76:79], a[136:139], v[32:35], v[76:79]
    s_waitcnt lgkmcnt(8)
    ds_read_b128 v[52:55], v94 offset:23552
    v_mfma_f32_16x16x32_bf16 v[68:71], a[12:15], v[36:39], v[68:71]
    buffer_load_dwordx4 v0, s[4:7], s51 offen offset:2048 sc1 lds
    v_mfma_f32_16x16x32_bf16 v[72:75], a[76:79], v[36:39], v[72:75]
    v_rsq_f32 v157, v157
    v_mfma_f32_16x16x32_bf16 v[76:79], a[140:143], v[36:39], v[76:79]
    s_waitcnt lgkmcnt(8)
    ds_read_b128 v[32:35], v94 offset:24576
    v_mul_f32 v158, v156, v157
    v_mfma_f32_16x16x32_bf16 v[68:71], a[16:19], v[40:43], v[68:71]
    ds_write_b32 v8, v157 offset:1024
    v_mfma_f32_16x16x32_bf16 v[72:75], a[80:83], v[40:43], v[72:75]
    buffer_load_dwordx4 v0, s[4:7], s51 offen offset:3072 sc1 lds
    v_mfma_f32_16x16x32_bf16 v[76:79], a[144:147], v[40:43], v[76:79]
    s_waitcnt lgkmcnt(9)
    ds_read_b128 v[36:39], v94 offset:25600
    s_lshl_b32 s30, s41, 2
    v_mfma_f32_16x16x32_bf16 v[68:71], a[20:23], v[44:47], v[68:71]
    s_add_u32 m0, s30, 77824
    s_add_u32 s30, s62, 16384
    s_add_u32 s51, s68, 16384
    v_mfma_f32_16x16x32_bf16 v[72:75], a[84:87], v[44:47], v[72:75]
    s_waitcnt lgkmcnt(6)
    v_bitop3_b32 v128, v128, v130, v132 bitop3:0x80
    v_mul_f32 v157, s50, v157
    v_mfma_f32_16x16x32_bf16 v[76:79], a[148:151], v[44:47], v[76:79]
    ds_read_b128 v[40:43], v94 offset:26624
    v_mfma_f32_16x16x32_bf16 v[68:71], a[24:27], v[48:51], v[68:71]
    buffer_load_dwordx4 v0, s[4:7], s30 offen sc1 lds
    v_mfma_f32_16x16x32_bf16 v[72:75], a[88:91], v[48:51], v[72:75]
    s_waitcnt lgkmcnt(6)
    v_bitop3_b32 v134, v134, v136, v138 bitop3:0x80
    v_mfma_f32_16x16x32_bf16 v[76:79], a[152:155], v[48:51], v[76:79]
    s_waitcnt lgkmcnt(4)
    ds_read_b128 v[44:47], v94 offset:27648
    v_bitop3_b32 v128, v128, v134, v140 bitop3:0x80
    v_mfma_f32_16x16x32_bf16 v[68:71], a[28:31], v[52:55], v[68:71]
    v_bitop3_b32 v128, v128, v142, 1 bitop3:0x80
    v_cmp_ne_u32 s[56:57], 1, v128
    v_mfma_f32_16x16x32_bf16 v[72:75], a[92:95], v[52:55], v[72:75]
    buffer_load_dwordx4 v0, s[4:7], s30 offen offset:1024 sc1 lds
    v_mfma_f32_16x16x32_bf16 v[76:79], a[156:159], v[52:55], v[76:79]
    s_waitcnt lgkmcnt(4)
    ds_read_b128 v[48:51], v94 offset:28672
    v_mfma_f32_16x16x32_bf16 v[68:71], a[32:35], v[32:35], v[68:71]
    ds_write_b32 v8, v158 offset:1280
    v_mfma_f32_16x16x32_bf16 v[72:75], a[96:99], v[32:35], v[72:75]
    ds_write_b32 v8, v157 offset:1536
    v_mfma_f32_16x16x32_bf16 v[76:79], a[160:163], v[32:35], v[76:79]
    s_waitcnt lgkmcnt(5)
    ds_read_b128 v[52:55], v94 offset:29696
    v_mfma_f32_16x16x32_bf16 v[68:71], a[36:39], v[36:39], v[68:71]
    buffer_load_dwordx4 v0, s[4:7], s51 offen offset:2048 sc1 lds
    v_mfma_f32_16x16x32_bf16 v[72:75], a[100:103], v[36:39], v[72:75]
    s_waitcnt vmcnt(11)
    v_bitop3_b32 v31, v160, v161, v162 bitop3:0x80
    v_bitop3_b32 v31, v31, v163, 1 bitop3:0x80
    v_cmp_ne_u32 vcc, 1, v31
    s_cbranch_vccnz Lrare100
Lrare100b:
    v_mfma_f32_16x16x32_bf16 v[76:79], a[164:167], v[36:39], v[76:79]
    s_waitcnt lgkmcnt(5)
    ds_read_b128 v[32:35], v94 offset:30720
    v_add_f32 v160, v160, v162
    v_mfma_f32_16x16x32_bf16 v[68:71], a[40:43], v[40:43], v[68:71]
    v_add_f32 v161, v161, v163
    s_nop 0
    v_mfma_f32_16x16x32_bf16 v[72:75], a[104:107], v[40:43], v[72:75]
    buffer_load_dwordx4 v0, s[4:7], s51 offen offset:3072 sc1 lds
    v_mfma_f32_16x16x32_bf16 v[76:79], a[168:171], v[40:43], v[76:79]
    s_waitcnt lgkmcnt(5)
    ds_read_b128 v[36:39], v94 offset:31744
    v_add_f32_dpp v160, v160, v160 quad_perm:[1,0,3,2] row_mask:0xf bank_mask:0xf
    v_mfma_f32_16x16x32_bf16 v[68:71], a[44:47], v[44:47], v[68:71]
    s_cmp_lg_u64 s[56:57], 0
    s_cbranch_scc1 Lrare102
Lrare102b:
    s_waitcnt lgkmcnt(3)
    s_barrier
    v_mfma_f32_16x16x32_bf16 v[72:75], a[108:111], v[44:47], v[72:75]
    s_add_u32 m0, s41, 0
    ds_read_b32 v92, v2 offset:1792
    s_add_u32 s30, s63, 0
    v_mfma_f32_16x16x32_bf16 v[76:79], a[172:175], v[44:47], v[76:79]
    s_add_u32 s51, s69, 0
    ds_read_b128 v[40:43], v94 offset:32768
    v_add_f32_dpp v161, v161, v161 quad_perm:[1,0,3,2] row_mask:0xf bank_mask:0xf
    v_mfma_f32_16x16x32_bf16 v[68:71], a[48:51], v[48:51], v[68:71]
    buffer_load_dwordx4 v0, s[4:7], s30 offen sc1 lds
    v_mfma_f32_16x16x32_bf16 v[72:75], a[112:115], v[48:51], v[72:75]
    s_waitcnt lgkmcnt(1)
    v_fma_f32 v56, v92, v80, v56
    v_fma_f32 v57, v92, v81, v57
    v_mfma_f32_16x16x32_bf16 v[76:79], a[176:179], v[48:51], v[76:79]
    ds_read_b128 v[44:47], v94 offset:33792
    v_fma_f32 v58, v92, v82, v58
    v_mfma_f32_16x16x32_bf16 v[68:71], a[52:55], v[52:55], v[68:71]
    v_fma_f32 v59, v92, v83, v59
    v_fma_f32 v60, v92, v84, v60
    v_mfma_f32_16x16x32_bf16 v[72:75], a[116:119], v[52:55], v[72:75]
    buffer_load_dwordx4 v0, s[4:7], s30 offen offset:1024 sc1 lds
    v_mfma_f32_16x16x32_bf16 v[76:79], a[180:183], v[52:55], v[76:79]
    ds_read_b128 v[48:51], v94 offset:34816
    v_fma_f32 v61, v92, v85, v61
    v_mfma_f32_16x16x32_bf16 v[68:71], a[56:59], v[32:35], v[68:71]
    v_fma_f32 v62, v92, v86, v62
    v_fma_f32 v63, v92, v87, v63
    v_mfma_f32_16x16x32_bf16 v[72:75], a[120:123], v[32:35], v[72:75]
    v_fma_f32 v64, v92, v88, v64
    v_fma_f32 v65, v92, v89, v65
    v_mfma_f32_16x16x32_bf16 v[76:79], a[184:187], v[32:35], v[76:79]
    ds_read_b128 v[52:55], v94 offset:35840
    v_fma_f32 v66, v92, v90, v66
    v_mfma_f32_16x16x32_bf16 v[68:71], a[60:63], v[36:39], v[68:71]
    ds_read_b32 v93, v2 offset:1856
    v_fma_f32 v67, v92, v91, v67
    v_mfma_f32_16x16x32_bf16 v[72:75], a[124:127], v[36:39], v[72:75]
    buffer_load_dwordx4 v0, s[4:7], s51 offen offset:2048 sc1 lds
    v_cvt_pk_bf16_f32 v144, v56, v57
    v_cvt_pk_bf16_f32 v145, v58, v59
    v_cvt_pk_bf16_f32 v146, v60, v61
    v_cvt_pk_bf16_f32 v147, v62, v63
    v_cvt_pk_bf16_f32 v148, v64, v65
    v_cvt_pk_bf16_f32 v149, v66, v67
    v_mfma_f32_16x16x32_bf16 v[76:79], a[188:191], v[36:39], v[76:79]
    s_waitcnt lgkmcnt(4)
    ds_read_b128 v[32:35], v94 offset:36864
    v_pk_max_i16 v144, v144, 0
    v_mfma_f32_16x16x32_bf16 v[56:59], a[0:3], v[40:43], 0
    v_pk_max_i16 v145, v145, 0
    v_pk_max_i16 v146, v146, 0
    v_mfma_f32_16x16x32_bf16 v[60:63], a[64:67], v[40:43], 0
    v_pk_max_i16 v147, v147, 0
    v_pk_max_i16 v148, v148, 0
    v_mfma_f32_16x16x32_bf16 v[64:67], a[128:131], v[40:43], 0
    s_waitcnt lgkmcnt(4)
    ds_read_b128 v[36:39], v94 offset:37888
    v_pk_max_i16 v149, v149, 0
    v_mfma_f32_16x16x32_bf16 v[56:59], a[4:7], v[44:47], v[56:59]
    s_add_u32 s35, s58, 327680
    buffer_load_dwordx4 v0, s[4:7], s51 offen offset:3072 sc1 lds
    v_mfma_f32_16x16x32_bf16 v[60:63], a[68:71], v[44:47], v[60:63]
    s_add_u32 s36, s59, 327680
    s_waitcnt vmcnt(12)
    ds_read_b128 v[128:131], v28 offset:49152
    v_mfma_f32_16x16x32_bf16 v[64:67], a[132:135], v[44:47], v[64:67]
    s_waitcnt lgkmcnt(5)
    ds_read_b128 v[40:43], v94 offset:38912
    ds_read_b128 v[132:135], v28 offset:50176
    v_mfma_f32_16x16x32_bf16 v[56:59], a[8:11], v[48:51], v[56:59]
    ds_read_b128 v[136:139], v28 offset:51200
    ds_read_b128 v[140:143], v28 offset:52224
    v_mfma_f32_16x16x32_bf16 v[60:63], a[72:75], v[48:51], v[60:63]
    buffer_store_dwordx4 v[144:147], v0, s[4:7], s35 offen
    buffer_store_dwordx2 v[148:149], v9, s[4:7], s36 offen
    v_mfma_f32_16x16x32_bf16 v[64:67], a[136:139], v[48:51], v[64:67]
    s_waitcnt lgkmcnt(8)
    ds_read_b128 v[44:47], v94 offset:39936
    v_add_f32_dpp v160, v160, v160 quad_perm:[2,3,0,1] row_mask:0xf bank_mask:0xf
    v_mfma_f32_16x16x32_bf16 v[56:59], a[12:15], v[52:55], v[56:59]
    s_waitcnt lgkmcnt(8)
    v_fma_f32 v68, v93, v80, v68
    v_fma_f32 v69, v93, v81, v69
    v_mfma_f32_16x16x32_bf16 v[60:63], a[76:79], v[52:55], v[60:63]
    v_fma_f32 v70, v93, v82, v70
    v_fma_f32 v71, v93, v83, v71
    v_mfma_f32_16x16x32_bf16 v[64:67], a[140:143], v[52:55], v[64:67]
    s_waitcnt lgkmcnt(7)
    ds_read_b128 v[48:51], v94 offset:40960
    v_fma_f32 v72, v93, v84, v72
    v_mfma_f32_16x16x32_bf16 v[56:59], a[16:19], v[32:35], v[56:59]
    v_fma_f32 v73, v93, v85, v73
    v_fma_f32 v74, v93, v86, v74
    v_mfma_f32_16x16x32_bf16 v[60:63], a[80:83], v[32:35], v[60:63]
    v_fma_f32 v75, v93, v87, v75
    v_fma_f32 v76, v93, v88, v76
    v_mfma_f32_16x16x32_bf16 v[64:67], a[144:147], v[32:35], v[64:67]
    s_waitcnt lgkmcnt(7)
    ds_read_b128 v[52:55], v94 offset:41984
    v_fma_f32 v77, v93, v89, v77
    v_mfma_f32_16x16x32_bf16 v[56:59], a[20:23], v[36:39], v[56:59]
    v_fma_f32 v78, v93, v90, v78
    v_fma_f32 v79, v93, v91, v79
    v_mfma_f32_16x16x32_bf16 v[60:63], a[84:87], v[36:39], v[60:63]
    v_cvt_pk_bf16_f32 v150, v68, v69
    v_cvt_pk_bf16_f32 v151, v70, v71
    v_mfma_f32_16x16x32_bf16 v[64:67], a[148:151], v[36:39], v[64:67]
    s_waitcnt lgkmcnt(6)
    ds_read_b128 v[32:35], v94 offset:43008
    v_cvt_pk_bf16_f32 v152, v72, v73
    v_mfma_f32_16x16x32_bf16 v[56:59], a[24:27], v[40:43], v[56:59]
    v_cvt_pk_bf16_f32 v153, v74, v75
    v_cvt_pk_bf16_f32 v154, v76, v77
    v_mfma_f32_16x16x32_bf16 v[60:63], a[88:91], v[40:43], v[60:63]
    v_cvt_pk_bf16_f32 v155, v78, v79
    v_pk_max_i16 v150, v150, 0
    v_mfma_f32_16x16x32_bf16 v[64:67], a[152:155], v[40:43], v[64:67]
    s_waitcnt lgkmcnt(3)
    ds_read_b128 v[36:39], v94 offset:44032
    v_pk_max_i16 v151, v151, 0
    v_mfma_f32_16x16x32_bf16 v[56:59], a[28:31], v[44:47], v[56:59]
    v_pk_max_i16 v152, v152, 0
    v_pk_max_i16 v153, v153, 0
    v_mfma_f32_16x16x32_bf16 v[60:63], a[92:95], v[44:47], v[60:63]
    v_pk_max_i16 v154, v154, 0
    v_pk_max_i16 v155, v155, 0
    v_mfma_f32_16x16x32_bf16 v[64:67], a[156:159], v[44:47], v[64:67]
    s_waitcnt lgkmcnt(3)
    ds_read_b128 v[40:43], v94 offset:45056
    s_add_u32 s35, s58, 371712
    v_mfma_f32_16x16x32_bf16 v[56:59], a[32:35], v[48:51], v[56:59]
    s_add_u32 s36, s59, 371712
    buffer_store_dwordx4 v[150:153], v0, s[4:7], s35 offen
    v_mfma_f32_16x16x32_bf16 v[60:63], a[96:99], v[48:51], v[60:63]
    buffer_store_dwordx2 v[154:155], v9, s[4:7], s36 offen
    v_mfma_f32_16x16x32_bf16 v[64:67], a[160:163], v[48:51], v[64:67]
    s_waitcnt lgkmcnt(3)
    ds_read_b128 v[44:47], v94 offset:46080
    v_bitop3_b32 v128, v128, v130, v132 bitop3:0x80
    v_mfma_f32_16x16x32_bf16 v[56:59], a[36:39], v[52:55], v[56:59]
    v_bitop3_b32 v134, v134, v136, v138 bitop3:0x80
    v_bitop3_b32 v128, v128, v134, v140 bitop3:0x80
    v_mfma_f32_16x16x32_bf16 v[60:63], a[100:103], v[52:55], v[60:63]
    v_bitop3_b32 v128, v128, v142, 1 bitop3:0x80
    v_cmp_ne_u32 s[56:57], 1, v128
    v_mfma_f32_16x16x32_bf16 v[64:67], a[164:167], v[52:55], v[64:67]
    s_waitcnt lgkmcnt(3)
    ds_read_b128 v[48:51], v94 offset:47104
    v_add_f32_dpp v161, v161, v161 quad_perm:[2,3,0,1] row_mask:0xf bank_mask:0xf
    v_mfma_f32_16x16x32_bf16 v[56:59], a[40:43], v[32:35], v[56:59]
    v_add_f32_dpp v160, v160, v160 row_half_mirror row_mask:0xf bank_mask:0xf
    v_add_f32_dpp v161, v161, v161 row_half_mirror row_mask:0xf bank_mask:0xf
    v_mul_f32 v160, 0xbb000000, v160
    v_mul_f32 v161, 0x3b000000, v161
    v_fma_f32 v161, -v160, v160, v161
    ds_write_b32 v8, v160 offset:1920
    v_max_f32 v161, 0, v161
    v_add_f32 v161, 0x3727c5ac, v161
    v_rsq_f32 v161, v161
    s_nop 0
    v_mul_f32 v162, v160, v161
    ds_write_b32 v8, v161 offset:1152
    v_mul_f32 v161, s50, v161
    ds_write_b32 v8, v162 offset:1408
    ds_write_b32 v8, v161 offset:1664
    v_mfma_f32_16x16x32_bf16 v[60:63], a[104:107], v[32:35], v[60:63]
    v_mfma_f32_16x16x32_bf16 v[64:67], a[168:171], v[32:35], v[64:67]
    s_waitcnt lgkmcnt(7)
    ds_read_b128 v[52:55], v94 offset:48128
    v_mfma_f32_16x16x32_bf16 v[56:59], a[44:47], v[36:39], v[56:59]
    s_cmp_lg_u64 s[56:57], 0
    s_cbranch_scc1 Lrare104
Lrare104b:
    s_waitcnt lgkmcnt(1)
    s_barrier
    v_mfma_f32_16x16x32_bf16 v[60:63], a[108:111], v[36:39], v[60:63]
    s_add_u32 m0, s41, 16384
    s_add_u32 s30, s63, 4096
    s_add_u32 s51, s69, 4096
    v_mfma_f32_16x16x32_bf16 v[64:67], a[172:175], v[36:39], v[64:67]
    ds_read_b128 v[32:35], v94 offset:49152
    v_mfma_f32_16x16x32_bf16 v[56:59], a[48:51], v[40:43], v[56:59]
    buffer_load_dwordx4 v0, s[4:7], s30 offen sc1 lds
    v_mfma_f32_16x16x32_bf16 v[60:63], a[112:115], v[40:43], v[60:63]
    v_mfma_f32_16x16x32_bf16 v[64:67], a[176:179], v[40:43], v[64:67]
    ds_read_b128 v[36:39], v94 offset:50176
    v_mfma_f32_16x16x32_bf16 v[56:59], a[52:55], v[44:47], v[56:59]
    v_mfma_f32_16x16x32_bf16 v[60:63], a[116:119], v[44:47], v[60:63]
    buffer_load_dwordx4 v0, s[4:7], s30 offen offset:1024 sc1 lds
    v_mfma_f32_16x16x32_bf16 v[64:67], a[180:183], v[44:47], v[64:67]
    ds_read_b128 v[40:43], v94 offset:51200
    v_mfma_f32_16x16x32_bf16 v[56:59], a[56:59], v[48:51], v[56:59]
    v_mfma_f32_16x16x32_bf16 v[60:63], a[120:123], v[48:51], v[60:63]
    v_mfma_f32_16x16x32_bf16 v[64:67], a[184:187], v[48:51], v[64:67]
    s_waitcnt lgkmcnt(3)
    ds_read_b128 v[44:47], v94 offset:52224
    v_mfma_f32_16x16x32_bf16 v[56:59], a[60:63], v[52:55], v[56:59]
    ds_read_b32 v92, v2 offset:1920
    v_mfma_f32_16x16x32_bf16 v[60:63], a[124:127], v[52:55], v[60:63]
    buffer_load_dwordx4 v0, s[4:7], s51 offen offset:2048 sc1 lds
    v_mfma_f32_16x16x32_bf16 v[64:67], a[188:191], v[52:55], v[64:67]
    s_waitcnt lgkmcnt(4)
    ds_read_b128 v[48:51], v94 offset:53248
    v_mfma_f32_16x16x32_bf16 v[68:71], a[0:3], v[32:35], 0
    v_mfma_f32_16x16x32_bf16 v[72:75], a[64:67], v[32:35], 0
    v_mfma_f32_16x16x32_bf16 v[76:79], a[128:131], v[32:35], 0
    s_waitcnt lgkmcnt(4)
    ds_read_b128 v[52:55], v94 offset:54272
    v_mfma_f32_16x16x32_bf16 v[68:71], a[4:7], v[36:39], v[68:71]
    buffer_load_dwordx4 v0, s[4:7], s51 offen offset:3072 sc1 lds
    v_mfma_f32_16x16x32_bf16 v[72:75], a[68:71], v[36:39], v[72:75]
    s_add_u32 s64, s60, 327680
    s_add_u32 s65, s64, s73
    v_mfma_f32_16x16x32_bf16 v[76:79], a[132:135], v[36:39], v[76:79]
    s_waitcnt lgkmcnt(4)
    ds_read_b128 v[32:35], v94 offset:55296
    v_mfma_f32_16x16x32_bf16 v[68:71], a[8:11], v[40:43], v[68:71]
    s_waitcnt lgkmcnt(3)
    v_fma_f32 v56, v92, v80, v56
    v_fma_f32 v57, v92, v81, v57
    v_mfma_f32_16x16x32_bf16 v[72:75], a[72:75], v[40:43], v[72:75]
    buffer_load_dwordx4 v[96:99], v0, s[4:7], s64 offen offset:0 sc1
    v_mfma_f32_16x16x32_bf16 v[76:79], a[136:139], v[40:43], v[76:79]
    ds_read_b128 v[36:39], v94 offset:56320
    v_fma_f32 v58, v92, v82, v58
    v_mfma_f32_16x16x32_bf16 v[68:71], a[12:15], v[44:47], v[68:71]
    s_barrier
    v_fma_f32 v59, v92, v83, v59
    v_fma_f32 v60, v92, v84, v60
    v_mfma_f32_16x16x32_bf16 v[72:75], a[76:79], v[44:47], v[72:75]
    v_fma_f32 v61, v92, v85, v61
    v_fma_f32 v62, v92, v86, v62
    v_mfma_f32_16x16x32_bf16 v[76:79], a[140:143], v[44:47], v[76:79]
    s_waitcnt lgkmcnt(3)
    ds_read_b128 v[40:43], v94 offset:57344
    v_fma_f32 v63, v92, v87, v63
    v_mfma_f32_16x16x32_bf16 v[68:71], a[16:19], v[48:51], v[68:71]
    buffer_load_dwordx4 v[100:103], v0, s[4:7], s65 offen offset:0 sc1
    v_mfma_f32_16x16x32_bf16 v[72:75], a[80:83], v[48:51], v[72:75]
    v_fma_f32 v64, v92, v88, v64
    v_fma_f32 v65, v92, v89, v65
    v_mfma_f32_16x16x32_bf16 v[76:79], a[144:147], v[48:51], v[76:79]
    s_waitcnt lgkmcnt(3)
    ds_read_b128 v[44:47], v94 offset:58368
    v_fma_f32 v66, v92, v90, v66
    v_mfma_f32_16x16x32_bf16 v[68:71], a[20:23], v[52:55], v[68:71]
    v_fma_f32 v67, v92, v91, v67
    v_cvt_pk_bf16_f32 v144, v56, v57
    v_mfma_f32_16x16x32_bf16 v[72:75], a[84:87], v[52:55], v[72:75]
    buffer_load_dwordx4 v[104:107], v0, s[4:7], s64 offen offset:1024 sc1
    v_mfma_f32_16x16x32_bf16 v[76:79], a[148:151], v[52:55], v[76:79]
    s_waitcnt lgkmcnt(3)
    ds_read_b128 v[48:51], v94 offset:59392
    v_cvt_pk_bf16_f32 v145, v58, v59
    v_mfma_f32_16x16x32_bf16 v[68:71], a[24:27], v[32:35], v[68:71]
    v_cvt_pk_bf16_f32 v146, v60, v61
    v_cvt_pk_bf16_f32 v147, v62, v63
    v_mfma_f32_16x16x32_bf16 v[72:75], a[88:91], v[32:35], v[72:75]
    v_cvt_pk_bf16_f32 v148, v64, v65
    v_cvt_pk_bf16_f32 v149, v66, v67
    v_mfma_f32_16x16x32_bf16 v[76:79], a[152:155], v[32:35], v[76:79]
    s_waitcnt lgkmcnt(3)
    ds_read_b128 v[52:55], v94 offset:60416
    v_pk_max_i16 v144, v144, 0
    v_mfma_f32_16x16x32_bf16 v[68:71], a[28:31], v[36:39], v[68:71]
    buffer_load_dwordx4 v[108:111], v0, s[4:7], s65 offen offset:1024 sc1
    v_mfma_f32_16x16x32_bf16 v[72:75], a[92:95], v[36:39], v[72:75]
    v_pk_max_i16 v145, v145, 0
    v_pk_max_i16 v146, v146, 0
    v_mfma_f32_16x16x32_bf16 v[76:79], a[156:159], v[36:39], v[76:79]
    s_waitcnt lgkmcnt(3)
    ds_read_b128 v[32:35], v94 offset:61440
    v_pk_max_i16 v147, v147, 0
    v_mfma_f32_16x16x32_bf16 v[68:71], a[32:35], v[40:43], v[68:71]
    v_pk_max_i16 v148, v148, 0
    v_pk_max_i16 v149, v149, 0
    v_mfma_f32_16x16x32_bf16 v[72:75], a[96:99], v[40:43], v[72:75]
    s_add_u32 s35, s58, 415744
    buffer_load_dwordx4 v[112:115], v0, s[4:7], s64 offen offset:2048 sc1
    v_mfma_f32_16x16x32_bf16 v[76:79], a[160:163], v[40:43], v[76:79]
    s_waitcnt lgkmcnt(3)
    ds_read_b128 v[36:39], v94 offset:62464
    s_add_u32 m0, s41, 32768
    v_mfma_f32_16x16x32_bf16 v[68:71], a[36:39], v[44:47], v[68:71]
    s_add_u32 s30, s63, 8192
    s_add_u32 s51, s69, 8192
    s_add_u32 s36, s59, 415744
    v_mfma_f32_16x16x32_bf16 v[72:75], a[100:103], v[44:47], v[72:75]
    buffer_store_dwordx4 v[144:147], v0, s[4:7], s35 offen
    v_mfma_f32_16x16x32_bf16 v[76:79], a[164:167], v[44:47], v[76:79]
    s_waitcnt lgkmcnt(3)
    ds_read_b128 v[40:43], v94 offset:63488
    v_mfma_f32_16x16x32_bf16 v[68:71], a[40:43], v[48:51], v[68:71]
    buffer_load_dwordx4 v0, s[4:7], s30 offen sc1 lds
    v_mfma_f32_16x16x32_bf16 v[72:75], a[104:107], v[48:51], v[72:75]
    buffer_store_dwordx2 v[148:149], v9, s[4:7], s36 offen
    v_mfma_f32_16x16x32_bf16 v[76:79], a[168:171], v[48:51], v[76:79]
    s_waitcnt lgkmcnt(3)
    ds_read_b128 v[44:47], v94 offset:64512
    v_mfma_f32_16x16x32_bf16 v[68:71], a[44:47], v[52:55], v[68:71]
    v_mfma_f32_16x16x32_bf16 v[72:75], a[108:111], v[52:55], v[72:75]
    buffer_load_dwordx4 v0, s[4:7], s30 offen offset:1024 sc1 lds
    v_mfma_f32_16x16x32_bf16 v[76:79], a[172:175], v[52:55], v[76:79]
    s_waitcnt lgkmcnt(3)
    v_mfma_f32_16x16x32_bf16 v[68:71], a[48:51], v[32:35], v[68:71]
    v_mfma_f32_16x16x32_bf16 v[72:75], a[112:115], v[32:35], v[72:75]
    v_mfma_f32_16x16x32_bf16 v[76:79], a[176:179], v[32:35], v[76:79]
    s_waitcnt lgkmcnt(2)
    buffer_load_dwordx4 v0, s[4:7], s51 offen offset:2048 sc1 lds
    v_mfma_f32_16x16x32_bf16 v[68:71], a[52:55], v[36:39], v[68:71]
    v_mfma_f32_16x16x32_bf16 v[72:75], a[116:119], v[36:39], v[72:75]
    v_mfma_f32_16x16x32_bf16 v[76:79], a[180:183], v[36:39], v[76:79]
    s_waitcnt lgkmcnt(1)
    v_mfma_f32_16x16x32_bf16 v[68:71], a[56:59], v[40:43], v[68:71]
    ds_read_b32 v93, v2 offset:1984
    v_mfma_f32_16x16x32_bf16 v[72:75], a[120:123], v[40:43], v[72:75]
    buffer_load_dwordx4 v0, s[4:7], s51 offen offset:3072 sc1 lds
    v_mfma_f32_16x16x32_bf16 v[76:79], a[184:187], v[40:43], v[76:79]
    s_waitcnt lgkmcnt(1)
    v_mfma_f32_16x16x32_bf16 v[68:71], a[60:63], v[44:47], v[68:71]
    v_mfma_f32_16x16x32_bf16 v[72:75], a[124:127], v[44:47], v[72:75]
    v_mfma_f32_16x16x32_bf16 v[76:79], a[188:191], v[44:47], v[76:79]
    buffer_load_dwordx4 v[116:119], v0, s[4:7], s65 offen offset:2048 sc1
    s_barrier
    s_waitcnt lgkmcnt(0)
    s_nop 2
    v_pk_fma_f32 v[68:69], v[80:81], v[92:93], v[68:69] op_sel:[0,1,0] op_sel_hi:[1,1,1]
    v_pk_fma_f32 v[70:71], v[82:83], v[92:93], v[70:71] op_sel:[0,1,0] op_sel_hi:[1,1,1]
    v_pk_fma_f32 v[72:73], v[84:85], v[92:93], v[72:73] op_sel:[0,1,0] op_sel_hi:[1,1,1]
    v_pk_fma_f32 v[74:75], v[86:87], v[92:93], v[74:75] op_sel:[0,1,0] op_sel_hi:[1,1,1]
    v_pk_fma_f32 v[76:77], v[88:89], v[92:93], v[76:77] op_sel:[0,1,0] op_sel_hi:[1,1,1]
    v_pk_fma_f32 v[78:79], v[90:91], v[92:93], v[78:79] op_sel:[0,1,0] op_sel_hi:[1,1,1]
    v_cvt_pk_bf16_f32 v150, v68, v69
    v_cvt_pk_bf16_f32 v151, v70, v71
    v_cvt_pk_bf16_f32 v152, v72, v73
    v_cvt_pk_bf16_f32 v153, v74, v75
    v_cvt_pk_bf16_f32 v154, v76, v77
    v_cvt_pk_bf16_f32 v155, v78, v79
    v_pk_max_i16 v150, v150, 0
    v_pk_max_i16 v151, v151, 0
    v_pk_max_i16 v152, v152, 0
    v_pk_max_i16 v153, v153, 0
    v_pk_max_i16 v154, v154, 0
    v_pk_max_i16 v155, v155, 0
    s_add_u32 s35, s58, 459776
    s_add_u32 s36, s59, 459776
    buffer_store_dwordx4 v[150:153], v0, s[4:7], s35 offen
    buffer_store_dwordx2 v[154:155], v9, s[4:7], s36 offen
    buffer_load_dwordx4 v[120:123], v0, s[4:7], s64 offen offset:3072 sc1
    buffer_load_dwordx4 v[124:127], v0, s[4:7], s65 offen offset:3072 sc1
    s_lshl_b32 s31, s41, 2
    s_add_u32 s31, s31, 65536
    v_add_u32 v28, s31, v0
    s_add_u32 s31, s41, 0
    v_add_u32 v29, s31, v0
    v_add_u32 v30, s16, v0
    s_waitcnt vmcnt(14)
    v_or3_b32 v31, v96, v98, v100
    v_or_b32 v31, v31, v102
    v_cmp_gt_i32 vcc, 0, v31
    s_cbranch_vccnz Lrare106
Lrare106b:
    v_mfma_f32_16x16x32_bf16 v[32:35], v[176:179], v[96:99], 0
    s_add_u32 s64, s60, 331776
    ds_read_b128 v[160:163], v28 offset:0
    ds_read_b128 v[164:167], v28 offset:1024
    v_mfma_f32_16x16x32_bf16 v[48:51], v[176:179], v[100:103], 0
    s_add_u32 s65, s64, s73
    ds_read_b128 v[168:171], v28 offset:2048
    ds_read_b128 v[172:175], v28 offset:3072
    v_mfma_f32_16x16x32_bf16 v[36:39], v[180:183], v[96:99], 0
    buffer_load_dwordx4 v[128:131], v0, s[4:7], s64 offen offset:0 sc1
    v_mfma_f32_16x16x32_bf16 v[52:55], v[180:183], v[100:103], 0
    s_waitcnt vmcnt(13)
    v_or3_b32 v31, v104, v106, v108
    v_or_b32 v31, v31, v110
    v_mfma_f32_16x16x32_bf16 v[40:43], v[184:187], v[96:99], 0
    v_cmp_gt_i32 vcc, 0, v31
    v_mfma_f32_16x16x32_bf16 v[56:59], v[184:187], v[100:103], 0
    buffer_load_dwordx4 v[132:135], v0, s[4:7], s65 offen offset:0 sc1
    v_mfma_f32_16x16x32_bf16 v[44:47], v[188:191], v[96:99], 0
    s_cbranch_vccnz Lrare108
Lrare108b:
    s_add_u32 s64, s15, 327680
    s_add_u32 s65, s64, s73
    v_mfma_f32_16x16x32_bf16 v[60:63], v[188:191], v[100:103], 0
    s_waitcnt lgkmcnt(2)
    buffer_load_dwordx4 v[136:139], v0, s[4:7], s64 offen offset:0 sc1
    v_mfma_f32_16x16x32_bf16 v[32:35], v[160:163], v[104:107], v[32:35]
    ds_read_b128 v[144:147], v28 offset:4096
    ds_read_b128 v[148:151], v28 offset:5120
    v_mfma_f32_16x16x32_bf16 v[48:51], v[160:163], v[108:111], v[48:51]
    ds_read_b128 v[152:155], v28 offset:6144
    ds_read_b128 v[156:159], v28 offset:7168
    v_mfma_f32_16x16x32_bf16 v[36:39], v[164:167], v[104:107], v[36:39]
    s_waitcnt lgkmcnt(4)
    buffer_load_dwordx4 v[140:143], v0, s[4:7], s65 offen offset:0 sc1
    v_mfma_f32_16x16x32_bf16 v[52:55], v[164:167], v[108:111], v[52:55]
    s_waitcnt vmcnt(8)
    v_or3_b32 v31, v112, v114, v116
    v_or_b32 v31, v31, v118
    v_mfma_f32_16x16x32_bf16 v[40:43], v[168:171], v[104:107], v[40:43]
    s_add_u32 s64, s20, 327680
    v_cmp_gt_i32 vcc, 0, v31
    s_add_u32 s65, s64, s73
    v_mfma_f32_16x16x32_bf16 v[56:59], v[168:171], v[108:111], v[56:59]
    buffer_load_dwordx4 v[96:99], v0, s[4:7], s64 offen offset:0 sc1
    v_mfma_f32_16x16x32_bf16 v[44:47], v[172:175], v[104:107], v[44:47]
    s_cbranch_vccnz Lrare110
Lrare110b:
    v_mfma_f32_16x16x32_bf16 v[60:63], v[172:175], v[108:111], v[60:63]
    s_waitcnt lgkmcnt(2)
    buffer_load_dwordx4 v[100:103], v0, s[4:7], s65 offen offset:0 sc1
    v_mfma_f32_16x16x32_bf16 v[32:35], v[144:147], v[112:115], v[32:35]
    s_add_u32 s64, s61, 327680
    ds_read_b128 v[160:163], v28 offset:8192
    ds_read_b128 v[164:167], v28 offset:9216
    v_mfma_f32_16x16x32_bf16 v[48:51], v[144:147], v[116:119], v[48:51]
    s_add_u32 s65, s64, s73
    ds_read_b128 v[168:171], v28 offset:10240
    ds_read_b128 v[172:175], v28 offset:11264
    v_mfma_f32_16x16x32_bf16 v[36:39], v[148:151], v[112:115], v[36:39]
    s_waitcnt lgkmcnt(4)
    buffer_load_dwordx4 v[104:107], v0, s[4:7], s64 offen offset:0 sc1
    v_mfma_f32_16x16x32_bf16 v[52:55], v[148:151], v[116:119], v[52:55]
    s_waitcnt vmcnt(7)
    v_or3_b32 v31, v120, v122, v124
    v_or_b32 v31, v31, v126
    v_mfma_f32_16x16x32_bf16 v[40:43], v[152:155], v[112:115], v[40:43]
    v_cmp_gt_i32 vcc, 0, v31
    v_mfma_f32_16x16x32_bf16 v[56:59], v[152:155], v[116:119], v[56:59]
    buffer_load_dwordx4 v[108:111], v0, s[4:7], s65 offen offset:0 sc1
    v_mfma_f32_16x16x32_bf16 v[44:47], v[156:159], v[112:115], v[44:47]
    s_cbranch_vccnz Lrare112
Lrare112b:
    s_add_u32 m0, s41, 49152
    s_add_u32 s30, s63, 12288
    v_mfma_f32_16x16x32_bf16 v[60:63], v[156:159], v[116:119], v[60:63]
    s_waitcnt lgkmcnt(2)
    s_add_u32 s51, s69, 12288
    v_mfma_f32_16x16x32_bf16 v[32:35], v[160:163], v[120:123], v[32:35]
    ds_read_b128 v[144:147], v28 offset:12288
    ds_read_b128 v[148:151], v28 offset:13312
    v_mfma_f32_16x16x32_bf16 v[48:51], v[160:163], v[124:127], v[48:51]
    ds_read_b128 v[152:155], v28 offset:14336
    ds_read_b128 v[156:159], v28 offset:15360
    v_mfma_f32_16x16x32_bf16 v[36:39], v[164:167], v[120:123], v[36:39]
    s_waitcnt lgkmcnt(4)
    buffer_load_dwordx4 v0, s[4:7], s30 offen sc1 lds
    v_mfma_f32_16x16x32_bf16 v[52:55], v[164:167], v[124:127], v[52:55]
    s_waitcnt vmcnt(7)
    v_or3_b32 v31, v128, v130, v132
    v_or_b32 v31, v31, v134
    v_mfma_f32_16x16x32_bf16 v[40:43], v[168:171], v[120:123], v[40:43]
    v_cmp_gt_i32 vcc, 0, v31
    v_mfma_f32_16x16x32_bf16 v[56:59], v[168:171], v[124:127], v[56:59]
    buffer_load_dwordx4 v0, s[4:7], s30 offen offset:1024 sc1 lds
    v_mfma_f32_16x16x32_bf16 v[44:47], v[172:175], v[120:123], v[44:47]
    s_cbranch_vccnz Lrare114
Lrare114b:
    v_mfma_f32_16x16x32_bf16 v[60:63], v[172:175], v[124:127], v[60:63]
    s_waitcnt lgkmcnt(2)
    buffer_load_dwordx4 v0, s[4:7], s51 offen offset:2048 sc1 lds
    v_mfma_f32_16x16x32_bf16 v[32:35], v[144:147], v[128:131], v[32:35]
    ds_read_b128 v[160:163], v30 offset:0
    ds_read_b128 v[164:167], v30 offset:1024
    v_mfma_f32_16x16x32_bf16 v[48:51], v[144:147], v[132:135], v[48:51]
    ds_read_b128 v[168:171], v30 offset:2048
    ds_read_b128 v[172:175], v30 offset:3072
    v_mfma_f32_16x16x32_bf16 v[36:39], v[148:151], v[128:131], v[36:39]
    s_waitcnt lgkmcnt(4)
    buffer_load_dwordx4 v0, s[4:7], s51 offen offset:3072 sc1 lds
    v_mfma_f32_16x16x32_bf16 v[52:55], v[148:151], v[132:135], v[52:55]
    s_waitcnt vmcnt(8)
    v_or3_b32 v31, v136, v138, v140
    v_or_b32 v31, v31, v142
    v_mfma_f32_16x16x32_bf16 v[40:43], v[152:155], v[128:131], v[40:43]
    v_cmp_gt_i32 vcc, 0, v31
    v_mfma_f32_16x16x32_bf16 v[56:59], v[152:155], v[132:135], v[56:59]
    buffer_load_dwordx4 v[112:115], v0, s[4:7], s64 offen offset:1024 sc1
    v_mfma_f32_16x16x32_bf16 v[44:47], v[156:159], v[128:131], v[44:47]
    s_cbranch_vccnz Lrare116
Lrare116b:
    v_mfma_f32_16x16x32_bf16 v[60:63], v[156:159], v[132:135], v[60:63]
    s_waitcnt lgkmcnt(2)
    buffer_load_dwordx4 v[116:119], v0, s[4:7], s65 offen offset:1024 sc1
    v_mfma_f32_16x16x32_bf16 v[32:35], v[160:163], v[136:139], v[32:35]
    ds_read_b128 v[144:147], v30 offset:4096
    ds_read_b128 v[148:151], v30 offset:5120
    v_mfma_f32_16x16x32_bf16 v[48:51], v[160:163], v[140:143], v[48:51]
    ds_read_b128 v[152:155], v30 offset:6144
    ds_read_b128 v[156:159], v30 offset:7168
    v_mfma_f32_16x16x32_bf16 v[36:39], v[164:167], v[136:139], v[36:39]
    s_waitcnt lgkmcnt(4)
    buffer_load_dwordx4 v[120:123], v0, s[4:7], s64 offen offset:2048 sc1
    v_mfma_f32_16x16x32_bf16 v[52:55], v[164:167], v[140:143], v[52:55]
    s_waitcnt vmcnt(9)
    v_or3_b32 v31, v96, v98, v100
    v_or_b32 v31, v31, v102
    v_mfma_f32_16x16x32_bf16 v[40:43], v[168:171], v[136:139], v[40:43]
    v_cmp_gt_i32 vcc, 0, v31
    v_mfma_f32_16x16x32_bf16 v[56:59], v[168:171], v[140:143], v[56:59]
    buffer_load_dwordx4 v[124:127], v0, s[4:7], s65 offen offset:2048 sc1
    v_mfma_f32_16x16x32_bf16 v[44:47], v[172:175], v[136:139], v[44:47]
    s_cbranch_vccnz Lrare118
Lrare118b:
    v_mfma_f32_16x16x32_bf16 v[60:63], v[172:175], v[140:143], v[60:63]
    s_waitcnt lgkmcnt(2)
    buffer_load_dwordx4 v[128:131], v0, s[4:7], s64 offen offset:3072 sc1
    v_mfma_f32_16x16x32_bf16 v[32:35], v[144:147], v[96:99], v[32:35]
    ds_read_b128 v[160:163], v29 offset:0
    ds_read_b128 v[164:167], v29 offset:1024
    v_mfma_f32_16x16x32_bf16 v[48:51], v[144:147], v[100:103], v[48:51]
    ds_read_b128 v[168:171], v29 offset:2048
    ds_read_b128 v[172:175], v29 offset:3072
    v_mfma_f32_16x16x32_bf16 v[36:39], v[148:151], v[96:99], v[36:39]
    s_waitcnt lgkmcnt(4)
    buffer_load_dwordx4 v[132:135], v0, s[4:7], s65 offen offset:3072 sc1
    v_mfma_f32_16x16x32_bf16 v[52:55], v[148:151], v[100:103], v[52:55]
    s_waitcnt vmcnt(10)
    v_or3_b32 v31, v104, v106, v108
    v_or_b32 v31, v31, v110
    v_mfma_f32_16x16x32_bf16 v[40:43], v[152:155], v[96:99], v[40:43]
    s_add_u32 s64, s60, 415744
    v_cmp_gt_i32 vcc, 0, v31
    s_add_u32 s65, s64, s73
    v_mfma_f32_16x16x32_bf16 v[56:59], v[152:155], v[100:103], v[56:59]
    buffer_load_dwordx4 v[136:139], v0, s[4:7], s64 offen offset:0 sc1
    v_mfma_f32_16x16x32_bf16 v[44:47], v[156:159], v[96:99], v[44:47]
    s_cbranch_vccnz Lrare120
Lrare120b:
    v_mfma_f32_16x16x32_bf16 v[60:63], v[156:159], v[100:103], v[60:63]
    s_waitcnt lgkmcnt(2)
    buffer_load_dwordx4 v[140:143], v0, s[4:7], s65 offen offset:0 sc1
    v_mfma_f32_16x16x32_bf16 v[32:35], v[160:163], v[104:107], v[32:35]
    ds_read_b128 v[144:147], v29 offset:16384
    ds_read_b128 v[148:151], v29 offset:17408
    v_mfma_f32_16x16x32_bf16 v[48:51], v[160:163], v[108:111], v[48:51]
    ds_read_b128 v[152:155], v29 offset:18432
    ds_read_b128 v[156:159], v29 offset:19456
    v_mfma_f32_16x16x32_bf16 v[36:39], v[164:167], v[104:107], v[36:39]
    s_waitcnt lgkmcnt(4)
    buffer_load_dwordx4 v[96:99], v0, s[4:7], s64 offen offset:1024 sc1
    v_mfma_f32_16x16x32_bf16 v[52:55], v[164:167], v[108:111], v[52:55]
    s_waitcnt vmcnt(7)
    v_or3_b32 v31, v112, v114, v116
    v_or_b32 v31, v31, v118
    v_mfma_f32_16x16x32_bf16 v[40:43], v[168:171], v[104:107], v[40:43]
    v_cmp_gt_i32 vcc, 0, v31
    s_lshr_b32 s31, s2, 3
    s_xor_b32 s31, s31, 0
    s_or_b32 s31, s31, s24
    s_cmp_lg_u32 s31, 0
    s_cbranch_scc1 Lskip122
    buffer_wbl2 sc1
Lskip122:
    v_mfma_f32_16x16x32_bf16 v[56:59], v[168:171], v[108:111], v[56:59]
    buffer_load_dwordx4 v[100:103], v0, s[4:7], s65 offen offset:1024 sc1
    v_mfma_f32_16x16x32_bf16 v[44:47], v[172:175], v[104:107], v[44:47]
    s_cbranch_vccnz Lrare123
Lrare123b:
    v_mfma_f32_16x16x32_bf16 v[60:63], v[172:175], v[108:111], v[60:63]
    s_waitcnt lgkmcnt(2)
    v_mfma_f32_16x16x32_bf16 v[32:35], v[144:147], v[112:115], v[32:35]
    ds_read_b128 v[160:163], v29 offset:32768
    ds_read_b128 v[164:167], v29 offset:33792
    v_mfma_f32_16x16x32_bf16 v[48:51], v[144:147], v[116:119], v[48:51]
    ds_read_b128 v[168:171], v29 offset:34816
    ds_read_b128 v[172:175], v29 offset:35840
    v_mfma_f32_16x16x32_bf16 v[36:39], v[148:151], v[112:115], v[36:39]
    s_waitcnt lgkmcnt(4)
    buffer_load_dwordx4 v[104:107], v0, s[4:7], s64 offen offset:2048 sc1
    v_mfma_f32_16x16x32_bf16 v[52:55], v[148:151], v[116:119], v[52:55]
    s_waitcnt vmcnt(7)
    v_or3_b32 v31, v120, v122, v124
    v_or_b32 v31, v31, v126
    v_mfma_f32_16x16x32_bf16 v[40:43], v[152:155], v[112:115], v[40:43]
    v_cmp_gt_i32 vcc, 0, v31
    v_mfma_f32_16x16x32_bf16 v[56:59], v[152:155], v[116:119], v[56:59]
    buffer_load_dwordx4 v[108:111], v0, s[4:7], s65 offen offset:2048 sc1
    v_mfma_f32_16x16x32_bf16 v[44:47], v[156:159], v[112:115], v[44:47]
    s_cbranch_vccnz Lrare125
Lrare125b:
    v_mfma_f32_16x16x32_bf16 v[60:63], v[156:159], v[116:119], v[60:63]
    s_waitcnt lgkmcnt(2)
    v_mfma_f32_16x16x32_bf16 v[32:35], v[160:163], v[120:123], v[32:35]
    ds_read_b128 v[144:147], v29 offset:49152
    ds_read_b128 v[148:151], v29 offset:50176
    v_mfma_f32_16x16x32_bf16 v[48:51], v[160:163], v[124:127], v[48:51]
    ds_read_b128 v[152:155], v29 offset:51200
    ds_read_b128 v[156:159], v29 offset:52224
    v_mfma_f32_16x16x32_bf16 v[36:39], v[164:167], v[120:123], v[36:39]
    s_waitcnt lgkmcnt(4)
    buffer_load_dwordx4 v[112:115], v0, s[4:7], s64 offen offset:3072 sc1
    v_mfma_f32_16x16x32_bf16 v[52:55], v[164:167], v[124:127], v[52:55]
    s_waitcnt vmcnt(7)
    v_or3_b32 v31, v128, v130, v132
    v_or_b32 v31, v31, v134
    v_mfma_f32_16x16x32_bf16 v[40:43], v[168:171], v[120:123], v[40:43]
    v_cmp_gt_i32 vcc, 0, v31
    v_mfma_f32_16x16x32_bf16 v[56:59], v[168:171], v[124:127], v[56:59]
    buffer_load_dwordx4 v[116:119], v0, s[4:7], s65 offen offset:3072 sc1
    v_mfma_f32_16x16x32_bf16 v[44:47], v[172:175], v[120:123], v[44:47]
    s_cbranch_vccnz Lrare127
Lrare127b:
    v_mfma_f32_16x16x32_bf16 v[60:63], v[172:175], v[124:127], v[60:63]
    s_waitcnt lgkmcnt(2)
    v_mfma_f32_16x16x32_bf16 v[32:35], v[144:147], v[128:131], v[32:35]
    s_add_u32 s64, s60, 419840
    s_add_u32 s65, s64, s73
    v_mfma_f32_16x16x32_bf16 v[48:51], v[144:147], v[132:135], v[48:51]
    buffer_load_dwordx4 v[120:123], v0, s[4:7], s64 offen offset:0 sc1
    v_mfma_f32_16x16x32_bf16 v[36:39], v[148:151], v[128:131], v[36:39]
    s_waitcnt lgkmcnt(0)
    v_mfma_f32_16x16x32_bf16 v[52:55], v[148:151], v[132:135], v[52:55]
    s_waitcnt vmcnt(7)
    v_or3_b32 v31, v136, v138, v140
    v_or_b32 v31, v31, v142
    v_mfma_f32_16x16x32_bf16 v[40:43], v[152:155], v[128:131], v[40:43]
    v_cmp_gt_i32 vcc, 0, v31
    v_mfma_f32_16x16x32_bf16 v[56:59], v[152:155], v[132:135], v[56:59]
    buffer_load_dwordx4 v[124:127], v0, s[4:7], s65 offen offset:0 sc1
    v_mfma_f32_16x16x32_bf16 v[44:47], v[156:159], v[128:131], v[44:47]
    s_cbranch_vccnz Lrare129
Lrare129b:
    v_mfma_f32_16x16x32_bf16 v[60:63], v[156:159], v[132:135], v[60:63]
    v_mfma_f32_16x16x32_bf16 v[64:67], v[176:179], v[136:139], 0
    s_add_u32 s64, s15, 415744
    ds_read_b128 v[160:163], v28 offset:0
    ds_read_b128 v[164:167], v28 offset:1024
    v_mfma_f32_16x16x32_bf16 v[80:83], v[176:179], v[140:143], 0
    s_add_u32 s65, s64, s73
    ds_read_b128 v[168:171], v28 offset:2048
    ds_read_b128 v[172:175], v28 offset:3072
    v_mfma_f32_16x16x32_bf16 v[68:71], v[180:183], v[136:139], 0
    buffer_load_dwordx4 v[128:131], v0, s[4:7], s64 offen offset:0 sc1
    v_mfma_f32_16x16x32_bf16 v[84:87], v[180:183], v[140:143], 0
    s_waitcnt vmcnt(7)
    v_or3_b32 v31, v96, v98, v100
    v_or_b32 v31, v31, v102
    v_mfma_f32_16x16x32_bf16 v[72:75], v[184:187], v[136:139], 0
    v_cmp_gt_i32 vcc, 0, v31
    v_mfma_f32_16x16x32_bf16 v[88:91], v[184:187], v[140:143], 0
    buffer_load_dwordx4 v[132:135], v0, s[4:7], s65 offen offset:0 sc1
    v_mfma_f32_16x16x32_bf16 v[76:79], v[188:191], v[136:139], 0
    s_cbranch_vccnz Lrare131
Lrare131b:
    v_mfma_f32_16x16x32_bf16 v[92:95], v[188:191], v[140:143], 0
    s_waitcnt lgkmcnt(2)
    v_mfma_f32_16x16x32_bf16 v[64:67], v[160:163], v[96:99], v[64:67]
    s_add_u32 s64, s20, 415744
    ds_read_b128 v[144:147], v28 offset:4096
    ds_read_b128 v[148:151], v28 offset:5120
    v_mfma_f32_16x16x32_bf16 v[80:83], v[160:163], v[100:103], v[80:83]
    s_add_u32 s65, s64, s73
    ds_read_b128 v[152:155], v28 offset:6144
    ds_read_b128 v[156:159], v28 offset:7168
    v_mfma_f32_16x16x32_bf16 v[68:71], v[164:167], v[96:99], v[68:71]
    s_waitcnt lgkmcnt(4)
    buffer_load_dwordx4 v[136:139], v0, s[4:7], s64 offen offset:0 sc1
    v_mfma_f32_16x16x32_bf16 v[84:87], v[164:167], v[100:103], v[84:87]
    s_waitcnt vmcnt(7)
    v_or3_b32 v31, v104, v106, v108
    v_or_b32 v31, v31, v110
    v_mfma_f32_16x16x32_bf16 v[72:75], v[168:171], v[96:99], v[72:75]
    v_cmp_gt_i32 vcc, 0, v31
    v_xor_b32 v177, 16384, v28
    v_mfma_f32_16x16x32_bf16 v[88:91], v[168:171], v[100:103], v[88:91]
    buffer_load_dwordx4 v[140:143], v0, s[4:7], s65 offen offset:0 sc1
    v_mfma_f32_16x16x32_bf16 v[76:79], v[172:175], v[96:99], v[76:79]
    s_cbranch_vccnz Lrare133
Lrare133b:
    v_xor_b32 v178, 32768, v28
    v_xor_b32 v179, 49152, v28
    v_mfma_f32_16x16x32_bf16 v[92:95], v[172:175], v[100:103], v[92:95]
    s_waitcnt lgkmcnt(2)
    s_and_b32 s35, s24, 2
    s_lshl_b32 s35, s35, 5
    v_mfma_f32_16x16x32_bf16 v[64:67], v[144:147], v[104:107], v[64:67]
    s_add_u32 s64, s61, 415744
    ds_read_b128 v[160:163], v28 offset:8192
    ds_read_b128 v[164:167], v28 offset:9216
    v_mfma_f32_16x16x32_bf16 v[80:83], v[144:147], v[108:111], v[80:83]
    s_add_u32 s65, s64, s73
    ds_read_b128 v[168:171], v28 offset:10240
    ds_read_b128 v[172:175], v28 offset:11264
    v_mfma_f32_16x16x32_bf16 v[68:71], v[148:151], v[104:107], v[68:71]
    s_waitcnt lgkmcnt(4)
    buffer_load_dwordx4 v[96:99], v0, s[4:7], s64 offen offset:0 sc1
    v_mfma_f32_16x16x32_bf16 v[84:87], v[148:151], v[108:111], v[84:87]
    s_waitcnt vmcnt(7)
    v_or3_b32 v31, v112, v114, v116
    v_or_b32 v31, v31, v118
    v_mfma_f32_16x16x32_bf16 v[72:75], v[152:155], v[104:107], v[72:75]
    v_cmp_gt_i32 vcc, 0, v31
    v_add_u32 v176, s35, v2
    v_mfma_f32_16x16x32_bf16 v[88:91], v[152:155], v[108:111], v[88:91]
    buffer_load_dwordx4 v[100:103], v0, s[4:7], s65 offen offset:0 sc1
    v_mfma_f32_16x16x32_bf16 v[76:79], v[156:159], v[104:107], v[76:79]
    s_cbranch_vccnz Lrare135
Lrare135b:
    ds_write_b128 v28, v[40:43] offset:2048
    v_mfma_f32_16x16x32_bf16 v[92:95], v[156:159], v[108:111], v[92:95]
    s_waitcnt lgkmcnt(3)
    ds_write_b128 v28, v[44:47] offset:3072
    v_mfma_f32_16x16x32_bf16 v[64:67], v[160:163], v[112:115], v[64:67]
    ds_read_b128 v[144:147], v28 offset:12288
    ds_read_b128 v[148:151], v28 offset:13312
    v_mfma_f32_16x16x32_bf16 v[80:83], v[160:163], v[116:119], v[80:83]
    ds_read_b128 v[152:155], v28 offset:14336
    ds_read_b128 v[156:159], v28 offset:15360
    v_mfma_f32_16x16x32_bf16 v[68:71], v[164:167], v[112:115], v[68:71]
    s_waitcnt lgkmcnt(6)
    buffer_load_dwordx4 v[104:107], v0, s[4:7], s64 offen offset:1024 sc1
    v_mfma_f32_16x16x32_bf16 v[84:87], v[164:167], v[116:119], v[84:87]
    s_waitcnt vmcnt(7)
    v_or3_b32 v31, v120, v122, v124
    v_or_b32 v31, v31, v126
    v_mfma_f32_16x16x32_bf16 v[72:75], v[168:171], v[112:115], v[72:75]
    v_cmp_gt_i32 vcc, 0, v31
    v_mfma_f32_16x16x32_bf16 v[88:91], v[168:171], v[116:119], v[88:91]
    buffer_load_dwordx4 v[108:111], v0, s[4:7], s65 offen offset:1024 sc1
    v_mfma_f32_16x16x32_bf16 v[76:79], v[172:175], v[112:115], v[76:79]
    s_cbranch_vccnz Lrare137
Lrare137b:
    ds_write_b128 v28, v[48:51] offset:4096
    ds_write_b128 v28, v[52:55] offset:5120
    ds_write_b128 v28, v[56:59] offset:6144
    ds_write_b128 v28, v[60:63] offset:7168
    v_mfma_f32_16x16x32_bf16 v[92:95], v[172:175], v[116:119], v[92:95]
    s_waitcnt lgkmcnt(6)
    s_waitcnt lgkmcnt(0)
    s_barrier
    v_mfma_f32_16x16x32_bf16 v[64:67], v[144:147], v[120:123], v[64:67]
    ds_read_b128 v[160:163], v30 offset:0
    ds_read_b128 v[164:167], v30 offset:1024
    v_mfma_f32_16x16x32_bf16 v[80:83], v[144:147], v[124:127], v[80:83]
    ds_read_b128 v[168:171], v30 offset:2048
    ds_read_b128 v[172:175], v30 offset:3072
    v_mfma_f32_16x16x32_bf16 v[68:71], v[148:151], v[120:123], v[68:71]
    ds_read_b32 v176, v176 offset:1024
    ds_read_b128 v[40:43], v177 offset:2048
    v_mfma_f32_16x16x32_bf16 v[84:87], v[148:151], v[124:127], v[84:87]
    s_waitcnt vmcnt(6)
    v_or3_b32 v31, v128, v130, v132
    v_or_b32 v31, v31, v134
    v_mfma_f32_16x16x32_bf16 v[72:75], v[152:155], v[120:123], v[72:75]
    v_cmp_gt_i32 vcc, 0, v31
    v_mfma_f32_16x16x32_bf16 v[88:91], v[152:155], v[124:127], v[88:91]
    ds_read_b128 v[44:47], v177 offset:3072
    ds_read_b128 v[48:51], v178 offset:4096
    v_mfma_f32_16x16x32_bf16 v[76:79], v[156:159], v[120:123], v[76:79]
    s_cbranch_vccnz Lrare139
Lrare139b:
    ds_read_b128 v[52:55], v178 offset:5120
    ds_read_b128 v[56:59], v179 offset:6144
    v_mfma_f32_16x16x32_bf16 v[92:95], v[156:159], v[124:127], v[92:95]
    s_waitcnt lgkmcnt(8)
    ds_read_b128 v[60:63], v179 offset:7168
    v_mfma_f32_16x16x32_bf16 v[64:67], v[160:163], v[128:131], v[64:67]
    ds_read_b128 v[144:147], v30 offset:4096
    ds_read_b128 v[148:151], v30 offset:5120
    v_mfma_f32_16x16x32_bf16 v[80:83], v[160:163], v[132:135], v[80:83]
    ds_read_b128 v[152:155], v30 offset:6144
    ds_read_b128 v[156:159], v30 offset:7168
    v_mfma_f32_16x16x32_bf16 v[68:71], v[164:167], v[128:131], v[68:71]
    s_waitcnt lgkmcnt(11)
    buffer_load_dwordx4 v[112:115], v0, s[4:7], s64 offen offset:2048 sc1
    v_mfma_f32_16x16x32_bf16 v[84:87], v[164:167], v[132:135], v[84:87]
    s_waitcnt vmcnt(5)
    v_or3_b32 v31, v136, v138, v140
    v_or_b32 v31, v31, v142
    v_mfma_f32_16x16x32_bf16 v[72:75], v[168:171], v[128:131], v[72:75]
    v_cmp_gt_i32 vcc, 0, v31
    v_mfma_f32_16x16x32_bf16 v[88:91], v[168:171], v[132:135], v[88:91]
    buffer_load_dwordx4 v[116:119], v0, s[4:7], s65 offen offset:2048 sc1
    v_mfma_f32_16x16x32_bf16 v[76:79], v[172:175], v[128:131], v[76:79]
    s_cbranch_vccnz Lrare141
Lrare141b:
    s_waitcnt lgkmcnt(9)
    v_add_f32 v32, v32, v40
    v_mfma_f32_16x16x32_bf16 v[92:95], v[172:175], v[132:135], v[92:95]
    s_waitcnt lgkmcnt(2)
    buffer_load_dwordx4 v[120:123], v0, s[4:7], s64 offen offset:3072 sc1
    v_mfma_f32_16x16x32_bf16 v[64:67], v[144:147], v[136:139], v[64:67]
    ds_read_b128 v[160:163], v29 offset:0
    ds_read_b128 v[164:167], v29 offset:1024
    v_mfma_f32_16x16x32_bf16 v[80:83], v[144:147], v[140:143], v[80:83]
    ds_read_b128 v[168:171], v29 offset:2048
    ds_read_b128 v[172:175], v29 offset:3072
    v_mfma_f32_16x16x32_bf16 v[68:71], v[148:151], v[136:139], v[68:71]
    s_waitcnt lgkmcnt(4)
    buffer_load_dwordx4 v[124:127], v0, s[4:7], s65 offen offset:3072 sc1
    v_mfma_f32_16x16x32_bf16 v[84:87], v[148:151], v[140:143], v[84:87]
    s_waitcnt vmcnt(6)
    v_or3_b32 v31, v96, v98, v100
    v_or_b32 v31, v31, v102
    v_mfma_f32_16x16x32_bf16 v[72:75], v[152:155], v[136:139], v[72:75]
    v_cmp_gt_i32 vcc, 0, v31
    v_add_f32 v33, v33, v41
    v_mfma_f32_16x16x32_bf16 v[88:91], v[152:155], v[140:143], v[88:91]
    v_add_f32 v34, v34, v42
    v_add_f32 v35, v35, v43
    v_mfma_f32_16x16x32_bf16 v[76:79], v[156:159], v[136:139], v[76:79]
    s_cbranch_vccnz Lrare143
Lrare143b:
    v_add_f32 v36, v36, v44
    v_add_f32 v37, v37, v45
    v_mfma_f32_16x16x32_bf16 v[92:95], v[156:159], v[140:143], v[92:95]
    s_waitcnt lgkmcnt(2)
    v_add_f32 v38, v38, v46
    v_add_f32 v39, v39, v47
    v_mfma_f32_16x16x32_bf16 v[64:67], v[160:163], v[96:99], v[64:67]
    ds_read_b128 v[144:147], v29 offset:16384
    ds_read_b128 v[148:151], v29 offset:17408
    v_mfma_f32_16x16x32_bf16 v[80:83], v[160:163], v[100:103], v[80:83]
    ds_read_b128 v[152:155], v29 offset:18432
    ds_read_b128 v[156:159], v29 offset:19456
    v_mfma_f32_16x16x32_bf16 v[68:71], v[164:167], v[96:99], v[68:71]
    s_waitcnt lgkmcnt(4)
    v_add_f32 v48, v48, v56
    v_add_f32 v49, v49, v57
    v_mfma_f32_16x16x32_bf16 v[84:87], v[164:167], v[100:103], v[84:87]
    s_waitcnt vmcnt(4)
    v_or3_b32 v31, v104, v106, v108
    v_or_b32 v31, v31, v110
    v_mfma_f32_16x16x32_bf16 v[72:75], v[168:171], v[96:99], v[72:75]
    v_cmp_gt_i32 vcc, 0, v31
    v_add_f32 v50, v50, v58
    v_mfma_f32_16x16x32_bf16 v[88:91], v[168:171], v[100:103], v[88:91]
    v_add_f32 v51, v51, v59
    v_add_f32 v52, v52, v60
    v_mfma_f32_16x16x32_bf16 v[76:79], v[172:175], v[96:99], v[76:79]
    s_cbranch_vccnz Lrare145
Lrare145b:
    v_add_f32 v53, v53, v61
    v_add_f32 v54, v54, v62
    v_mfma_f32_16x16x32_bf16 v[92:95], v[172:175], v[100:103], v[92:95]
    s_waitcnt lgkmcnt(2)
    v_add_f32 v55, v55, v63
    v_add_f32 v32, v32, v48
    v_mfma_f32_16x16x32_bf16 v[64:67], v[144:147], v[104:107], v[64:67]
    ds_read_b128 v[160:163], v29 offset:32768
    ds_read_b128 v[164:167], v29 offset:33792
    v_mfma_f32_16x16x32_bf16 v[80:83], v[144:147], v[108:111], v[80:83]
    ds_read_b128 v[168:171], v29 offset:34816
    ds_read_b128 v[172:175], v29 offset:35840
    v_mfma_f32_16x16x32_bf16 v[68:71], v[148:151], v[104:107], v[68:71]
    s_waitcnt lgkmcnt(4)
    v_add_f32 v33, v33, v49
    v_add_f32 v34, v34, v50
    v_mfma_f32_16x16x32_bf16 v[84:87], v[148:151], v[108:111], v[84:87]
    s_waitcnt vmcnt(2)
    v_or3_b32 v31, v112, v114, v116
    v_or_b32 v31, v31, v118
    v_mfma_f32_16x16x32_bf16 v[72:75], v[152:155], v[104:107], v[72:75]
    v_cmp_gt_i32 vcc, 0, v31
    v_add_f32 v35, v35, v51
    v_mfma_f32_16x16x32_bf16 v[88:91], v[152:155], v[108:111], v[88:91]
    v_add_f32 v36, v36, v52
    v_add_f32 v37, v37, v53
    v_mfma_f32_16x16x32_bf16 v[76:79], v[156:159], v[104:107], v[76:79]
    s_cbranch_vccnz Lrare147
Lrare147b:
    v_add_f32 v38, v38, v54
    v_add_f32 v39, v39, v55
    v_mfma_f32_16x16x32_bf16 v[92:95], v[156:159], v[108:111], v[92:95]
    s_waitcnt lgkmcnt(2)
    v_fma_f32 v12, v32, v176, v12
    v_fma_f32 v13, v33, v176, v13
    v_mfma_f32_16x16x32_bf16 v[64:67], v[160:163], v[112:115], v[64:67]
    ds_read_b128 v[144:147], v29 offset:49152
    ds_read_b128 v[148:151], v29 offset:50176
    v_mfma_f32_16x16x32_bf16 v[80:83], v[160:163], v[116:119], v[80:83]
    ds_read_b128 v[152:155], v29 offset:51200
    ds_read_b128 v[156:159], v29 offset:52224
    v_mfma_f32_16x16x32_bf16 v[68:71], v[164:167], v[112:115], v[68:71]
    s_waitcnt lgkmcnt(4)
    v_fma_f32 v14, v34, v176, v14
    v_fma_f32 v15, v35, v176, v15
    v_mfma_f32_16x16x32_bf16 v[84:87], v[164:167], v[116:119], v[84:87]
    s_waitcnt vmcnt(0)
    v_or3_b32 v31, v120, v122, v124
    v_or_b32 v31, v31, v126
    v_mfma_f32_16x16x32_bf16 v[72:75], v[168:171], v[112:115], v[72:75]
    v_cmp_gt_i32 vcc, 0, v31
    v_fma_f32 v16, v36, v176, v16
    v_mfma_f32_16x16x32_bf16 v[88:91], v[168:171], v[116:119], v[88:91]
    v_fma_f32 v17, v37, v176, v17
    v_fma_f32 v18, v38, v176, v18
    v_mfma_f32_16x16x32_bf16 v[76:79], v[172:175], v[112:115], v[76:79]
    s_cbranch_vccnz Lrare149
Lrare149b:
    v_fma_f32 v19, v39, v176, v19
    v_cvt_pk_bf16_f32 v40, v12, v13
    v_mfma_f32_16x16x32_bf16 v[92:95], v[172:175], v[116:119], v[92:95]
    s_waitcnt lgkmcnt(2)
    s_waitcnt lgkmcnt(1)
    v_cvt_pk_bf16_f32 v41, v14, v15
    v_mfma_f32_16x16x32_bf16 v[72:75], v[152:155], v[120:123], v[72:75]
    v_cvt_pk_bf16_f32 v42, v16, v17
    v_cvt_pk_bf16_f32 v43, v18, v19
    v_mfma_f32_16x16x32_bf16 v[88:91], v[152:155], v[124:127], v[88:91]
    s_waitcnt lgkmcnt(0)
    v_bfe_u32 v44, v0, 4, 4
    v_lshrrev_b32 v45, 8, v0
    v_mfma_f32_16x16x32_bf16 v[76:79], v[156:159], v[120:123], v[76:79]
    v_lshlrev_b32 v44, 10, v44
    v_lshl_add_u32 v44, v45, 4, v44
    v_mfma_f32_16x16x32_bf16 v[92:95], v[156:159], v[124:127], v[92:95]
    s_add_u32 s35, s70, 0
    buffer_store_dwordx4 v[40:43], v44, s[8:11], s35 offen sc1
    v_mfma_f32_16x16x32_bf16 v[80:83], v[144:147], v[124:127], v[80:83]
    v_xor_b32 v181, 16384, v28
    v_xor_b32 v182, 32768, v28
    v_mfma_f32_16x16x32_bf16 v[84:87], v[148:151], v[124:127], v[84:87]
    v_xor_b32 v183, 49152, v28
    s_and_b32 s35, s24, 2
    v_mfma_f32_16x16x32_bf16 v[64:67], v[144:147], v[120:123], v[64:67]
    s_lshl_b32 s35, s35, 5
    v_add_u32 v180, s35, v2
    v_mfma_f32_16x16x32_bf16 v[68:71], v[148:151], v[120:123], v[68:71]
    ds_write_b128 v28, v[72:75] offset:10240
    ds_write_b128 v28, v[88:91] offset:14336
    ds_write_b128 v28, v[76:79] offset:11264
    ds_write_b128 v28, v[92:95] offset:15360
    ds_write_b128 v28, v[80:83] offset:12288
    ds_write_b128 v28, v[84:87] offset:13312
    s_waitcnt lgkmcnt(0)
    s_barrier
    ds_read_b32 v180, v180 offset:1152
    ds_read_b128 v[72:75], v181 offset:10240
    ds_read_b128 v[76:79], v181 offset:11264
    ds_read_b128 v[80:83], v182 offset:12288
    ds_read_b128 v[84:87], v182 offset:13312
    ds_read_b128 v[88:91], v183 offset:14336
    ds_read_b128 v[92:95], v183 offset:15360
    s_waitcnt lgkmcnt(5)
    v_pk_add_f32 v[64:65], v[64:65], v[72:73]
    v_pk_add_f32 v[66:67], v[66:67], v[74:75]
    s_waitcnt lgkmcnt(4)
    v_pk_add_f32 v[68:69], v[68:69], v[76:77]
    v_pk_add_f32 v[70:71], v[70:71], v[78:79]
    s_waitcnt lgkmcnt(1)
    v_pk_add_f32 v[80:81], v[80:81], v[88:89]
    v_pk_add_f32 v[82:83], v[82:83], v[90:91]
    s_waitcnt lgkmcnt(0)
    v_pk_add_f32 v[84:85], v[84:85], v[92:93]
    v_pk_add_f32 v[86:87], v[86:87], v[94:95]
    v_pk_add_f32 v[64:65], v[64:65], v[80:81]
    v_pk_add_f32 v[66:67], v[66:67], v[82:83]
    v_pk_add_f32 v[68:69], v[68:69], v[84:85]
    v_pk_add_f32 v[70:71], v[70:71], v[86:87]
    v_pk_fma_f32 v[20:21], v[64:65], v[180:181], v[20:21] op_sel_hi:[1,0,1]
    v_pk_fma_f32 v[22:23], v[66:67], v[180:181], v[22:23] op_sel_hi:[1,0,1]
    v_pk_fma_f32 v[24:25], v[68:69], v[180:181], v[24:25] op_sel_hi:[1,0,1]
    v_pk_fma_f32 v[26:27], v[70:71], v[180:181], v[26:27] op_sel_hi:[1,0,1]
    v_cvt_pk_bf16_f32 v72, v20, v21
    v_cvt_pk_bf16_f32 v73, v22, v23
    v_cvt_pk_bf16_f32 v74, v24, v25
    v_cvt_pk_bf16_f32 v75, v26, v27
    v_bfe_u32 v76, v0, 4, 4
    v_lshrrev_b32 v77, 8, v0
    v_lshlrev_b32 v76, 10, v76
    v_lshl_add_u32 v76, v77, 4, v76
    s_add_u32 s31, s70, 32768
    buffer_store_dwordx4 v[72:75], v76, s[8:11], s31 offen sc1
    s_branch Lfin
Lrare10:
    s_nop 7
Lxf11:
    s_sub_u32 s66, s66, 1
    s_cbranch_scc1 Lbail
    buffer_load_dword v36, v3, s[4:7], s78 offen sc1
    s_waitcnt vmcnt(0)
    v_subrev_u32 v37, s29, v36
    v_cmp_le_u32 vcc, 16, v37
    s_cbranch_vccnz Lxf11
    s_nop 3
    s_branch Lrare10b
Lrare12:
    s_nop 7
Lpf13:
    s_sub_u32 s66, s66, 1
    s_cbranch_scc1 Lbail
    v_lshrrev_b32 v40, 2, v0
    s_lshl_b32 s31, s25, 9
    s_add_u32 s31, s31, 8192
    buffer_load_dword v38, v3, s[4:7], s31 offen sc1
    s_waitcnt vmcnt(0)
    v_cmp_ne_u32 vcc, s29, v38
    s_cbranch_vccnz Lpf13
    s_nop 3
    s_branch Lrare12b
Lrare16:
    s_nop 7
Lred17:
    s_sub_u32 s66, s66, 1
    s_cbranch_scc1 Lbail
    s_add_u32 s31, s39, 0
    buffer_load_dwordx4 v[68:71], v0, s[4:7], s31 offen offset:0 sc1
    buffer_load_dwordx4 v[72:75], v0, s[4:7], s31 offen offset:1024 sc1
    buffer_load_dwordx4 v[76:79], v0, s[4:7], s31 offen offset:2048 sc1
    buffer_load_dwordx4 v[80:83], v0, s[4:7], s31 offen offset:3072 sc1
    s_waitcnt vmcnt(3)
    v_cmp_ne_u32 s[54:55], s29, v71
    s_waitcnt vmcnt(2)
    v_cmp_ne_u32 s[56:57], s29, v75
    s_nop 0
    s_or_b64 s[54:55], s[54:55], s[56:57]
    s_waitcnt vmcnt(1)
    v_cmp_ne_u32 s[56:57], s29, v79
    s_nop 0
    s_or_b64 s[54:55], s[54:55], s[56:57]
    s_waitcnt vmcnt(0)
    v_cmp_ne_u32 s[56:57], s29, v83
    s_nop 0
    s_or_b64 s[54:55], s[54:55], s[56:57]
    s_cmp_lg_u64 s[54:55], 0
    s_cbranch_scc1 Lred17
    s_nop 3
    s_branch Lrare16b
Lrare20:
    s_nop 7
Lst2o21:
    s_sub_u32 s66, s66, 1
    s_cbranch_scc1 Lbail
    v_cmp_ne_u32 vcc, s29, v35
    s_nop 1
    s_cbranch_vccz Lskip22
    s_add_u32 s31, s40, 0
    buffer_load_dwordx4 v[32:35], v0, s[4:7], s31 offen sc1
Lskip22:
    v_cmp_ne_u32 vcc, s29, v39
    s_nop 1
    s_cbranch_vccz Lskip23
    s_add_u32 s31, s40, 1024
    buffer_load_dwordx4 v[36:39], v0, s[4:7], s31 offen sc1
Lskip23:
    v_cmp_ne_u32 vcc, s29, v43
    s_nop 1
    s_cbranch_vccz Lskip24
    s_add_u32 s31, s40, 2048
    buffer_load_dwordx4 v[40:43], v0, s[4:7], s31 offen sc1
Lskip24:
    v_cmp_ne_u32 vcc, s29, v47
    s_nop 1
    s_cbranch_vccz Lskip25
    s_add_u32 s31, s40, 3072
    buffer_load_dwordx4 v[44:47], v0, s[4:7], s31 offen sc1
Lskip25:
    v_cmp_ne_u32 vcc, s29, v51
    s_nop 1
    s_cbranch_vccz Lskip26
    s_add_u32 s31, s40, 4096
    buffer_load_dwordx4 v[48:51], v0, s[4:7], s31 offen sc1
Lskip26:
    v_cmp_ne_u32 vcc, s29, v55
    s_nop 1
    s_cbranch_vccz Lskip27
    s_add_u32 s31, s40, 5120
    buffer_load_dwordx4 v[52:55], v0, s[4:7], s31 offen sc1
Lskip27:
    v_cmp_ne_u32 vcc, s29, v59
    s_nop 1
    s_cbranch_vccz Lskip28
    s_add_u32 s31, s40, 6144
    buffer_load_dwordx4 v[56:59], v0, s[4:7], s31 offen sc1
Lskip28:
    v_cmp_ne_u32 vcc, s29, v63
    s_nop 1
    s_cbranch_vccz Lskip29
    s_add_u32 s31, s40, 7168
    buffer_load_dwordx4 v[60:63], v0, s[4:7], s31 offen sc1
Lskip29:
    s_waitcnt vmcnt(0)
    v_cmp_ne_u32 s[54:55], s29, v35
    v_cmp_ne_u32 s[56:57], s29, v39
    s_nop 0
    s_or_b64 s[54:55], s[54:55], s[56:57]
    v_cmp_ne_u32 s[56:57], s29, v43
    s_nop 0
    s_or_b64 s[54:55], s[54:55], s[56:57]
    v_cmp_ne_u32 s[56:57], s29, v47
    s_nop 0
    s_or_b64 s[54:55], s[54:55], s[56:57]
    v_cmp_ne_u32 s[56:57], s29, v51
    s_nop 0
    s_or_b64 s[54:55], s[54:55], s[56:57]
    v_cmp_ne_u32 s[56:57], s29, v55
    s_nop 0
    s_or_b64 s[54:55], s[54:55], s[56:57]
    v_cmp_ne_u32 s[56:57], s29, v59
    s_nop 0
    s_or_b64 s[54:55], s[54:55], s[56:57]
    v_cmp_ne_u32 s[56:57], s29, v63
    s_nop 0
    s_or_b64 s[54:55], s[54:55], s[56:57]
    s_cmp_lg_u64 s[54:55], 0
    s_cbranch_scc1 Lst2o21
    v_lshlrev_b32 v76, 16, v32
    v_and_b32 v77, 0xffff0000, v32
    v_lshlrev_b32 v78, 16, v33
    v_and_b32 v79, 0xffff0000, v33
    v_lshlrev_b32 v80, 16, v34
    v_and_b32 v81, 0xffff0000, v34
    v_xor_b32 v28, s29, v35
    v_dot2c_f32_bf16 v76, s46, v36
    v_dot2c_f32_bf16 v77, s47, v36
    v_dot2c_f32_bf16 v78, s46, v37
    v_dot2c_f32_bf16 v79, s47, v37
    v_dot2c_f32_bf16 v80, s46, v38
    v_dot2c_f32_bf16 v81, s47, v38
    v_bitop3_b32 v28, v5, v39, v28 bitop3:0xbe
    v_dot2c_f32_bf16 v76, s46, v40
    v_dot2c_f32_bf16 v77, s47, v40
    v_dot2c_f32_bf16 v78, s46, v41
    v_dot2c_f32_bf16 v79, s47, v41
    v_dot2c_f32_bf16 v80, s46, v42
    v_dot2c_f32_bf16 v81, s47, v42
    v_bitop3_b32 v28, v5, v43, v28 bitop3:0xbe
    v_dot2c_f32_bf16 v76, s46, v44
    v_dot2c_f32_bf16 v77, s47, v44
    v_dot2c_f32_bf16 v78, s46, v45
    v_dot2c_f32_bf16 v79, s47, v45
    v_dot2c_f32_bf16 v80, s46, v46
    v_dot2c_f32_bf16 v81, s47, v46
    v_bitop3_b32 v28, v5, v47, v28 bitop3:0xbe
    v_dot2c_f32_bf16 v76, s46, v48
    v_dot2c_f32_bf16 v77, s47, v48
    v_dot2c_f32_bf16 v78, s46, v49
    v_dot2c_f32_bf16 v79, s47, v49
    v_dot2c_f32_bf16 v80, s46, v50
    v_dot2c_f32_bf16 v81, s47, v50
    v_bitop3_b32 v28, v5, v51, v28 bitop3:0xbe
    v_dot2c_f32_bf16 v76, s46, v52
    v_dot2c_f32_bf16 v77, s47, v52
    v_dot2c_f32_bf16 v78, s46, v53
    v_dot2c_f32_bf16 v79, s47, v53
    v_dot2c_f32_bf16 v80, s46, v54
    v_dot2c_f32_bf16 v81, s47, v54
    v_bitop3_b32 v28, v5, v55, v28 bitop3:0xbe
    v_dot2c_f32_bf16 v76, s46, v56
    v_dot2c_f32_bf16 v77, s47, v56
    v_dot2c_f32_bf16 v78, s46, v57
    v_dot2c_f32_bf16 v79, s47, v57
    v_dot2c_f32_bf16 v80, s46, v58
    v_dot2c_f32_bf16 v81, s47, v58
    v_bitop3_b32 v28, v5, v59, v28 bitop3:0xbe
    v_dot2c_f32_bf16 v76, s46, v60
    v_dot2c_f32_bf16 v77, s47, v60
    v_dot2c_f32_bf16 v78, s46, v61
    v_dot2c_f32_bf16 v79, s47, v61
    v_dot2c_f32_bf16 v80, s46, v62
    v_dot2c_f32_bf16 v81, s47, v62
    v_bitop3_b32 v28, v5, v63, v28 bitop3:0xbe
    v_cmp_ne_u32 s[54:55], 0, v28
    s_nop 1
    s_nop 3
    s_branch Lrare20b
Lrare30:
    s_nop 7
Lpoll31:
    s_sub_u32 s66, s66, 1
    s_cbranch_scc1 Lbail
    buffer_load_dword v31, v3, s[4:7], s37 offen offset:0 sc1
    s_waitcnt vmcnt(0)
    v_cmp_ne_u32 vcc, s29, v31
    s_cbranch_vccnz Lpoll31
    s_nop 3
    s_branch Lrare30b
Lrare34:
    s_nop 7
    s_mov_b32 s1, m0
Lver35:
    s_sub_u32 s66, s66, 1
    s_cbranch_scc1 Lbail
    s_add_u32 m0, s42, 65536
    s_add_u32 s31, s38, 0
    buffer_load_dwordx4 v0, s[4:7], s31 offen offset:0 sc1 lds
    buffer_load_dwordx4 v0, s[4:7], s31 offen offset:1024 sc1 lds
    buffer_load_dwordx4 v0, s[4:7], s31 offen offset:2048 sc1 lds
    buffer_load_dwordx4 v0, s[4:7], s31 offen offset:3072 sc1 lds
    s_waitcnt vmcnt(0)
    ds_read_b128 v[32:35], v28 offset:0
    ds_read_b128 v[36:39], v28 offset:1024
    ds_read_b128 v[40:43], v28 offset:2048
    ds_read_b128 v[44:47], v28 offset:3072
    s_waitcnt lgkmcnt(2)
    v_bitop3_b32 v32, v32, v34, v36 bitop3:0x80
    s_waitcnt lgkmcnt(1)
    v_bitop3_b32 v38, v38, v40, v42 bitop3:0x80
    s_waitcnt lgkmcnt(0)
    v_bitop3_b32 v32, v32, v38, v44 bitop3:0x80
    v_bitop3_b32 v32, v32, v46, 1 bitop3:0x80
    v_cmp_ne_u32 s[56:57], 1, v32
    s_nop 1
    s_cmp_lg_u64 s[56:57], 0
    s_cbranch_scc1 Lver35
    s_mov_b32 m0, s1
    s_nop 3
    s_branch Lrare34b
Lrare36:
    s_nop 7
    s_mov_b32 s1, m0
Lver37:
    s_sub_u32 s66, s66, 1
    s_cbranch_scc1 Lbail
    s_add_u32 m0, s42, 73728
    s_add_u32 s31, s38, 8192
    buffer_load_dwordx4 v0, s[4:7], s31 offen offset:0 sc1 lds
    buffer_load_dwordx4 v0, s[4:7], s31 offen offset:1024 sc1 lds
    buffer_load_dwordx4 v0, s[4:7], s31 offen offset:2048 sc1 lds
    buffer_load_dwordx4 v0, s[4:7], s31 offen offset:3072 sc1 lds
    s_waitcnt vmcnt(0)
    ds_read_b128 v[48:51], v28 offset:8192
    ds_read_b128 v[52:55], v28 offset:9216
    ds_read_b128 v[56:59], v28 offset:10240
    ds_read_b128 v[60:63], v28 offset:11264
    s_waitcnt lgkmcnt(2)
    v_bitop3_b32 v48, v48, v50, v52 bitop3:0x80
    s_waitcnt lgkmcnt(1)
    v_bitop3_b32 v54, v54, v56, v58 bitop3:0x80
    s_waitcnt lgkmcnt(0)
    v_bitop3_b32 v48, v48, v54, v60 bitop3:0x80
    v_bitop3_b32 v48, v48, v62, 1 bitop3:0x80
    v_cmp_ne_u32 s[56:57], 1, v48
    s_nop 1
    s_cmp_lg_u64 s[56:57], 0
    s_cbranch_scc1 Lver37
    s_mov_b32 m0, s1
    s_nop 3
    s_branch Lrare36b
Lrare38:
    s_nop 7
    s_mov_b32 s1, m0
Lver39:
    s_sub_u32 s66, s66, 1
    s_cbranch_scc1 Lbail
    s_add_u32 m0, s42, 98304
    s_add_u32 s31, s38, 32768
    buffer_load_dwordx4 v0, s[4:7], s31 offen offset:0 sc1 lds
    buffer_load_dwordx4 v0, s[4:7], s31 offen offset:1024 sc1 lds
    buffer_load_dwordx4 v0, s[4:7], s31 offen offset:2048 sc1 lds
    buffer_load_dwordx4 v0, s[4:7], s31 offen offset:3072 sc1 lds
    s_waitcnt vmcnt(0)
    ds_read2st64_b32 v[56:57], v28 offset0:128 offset1:132
    ds_read2st64_b32 v[58:59], v29 offset0:128 offset1:132
    ds_read2st64_b32 v[60:61], v28 offset0:136 offset1:140
    ds_read2st64_b32 v[62:63], v29 offset0:136 offset1:140
    s_waitcnt lgkmcnt(2)
    v_bitop3_b32 v56, v56, v57, v58 bitop3:0x80
    s_waitcnt lgkmcnt(1)
    v_bitop3_b32 v59, v59, v60, v61 bitop3:0x80
    s_waitcnt lgkmcnt(0)
    v_bitop3_b32 v56, v56, v59, v62 bitop3:0x80
    v_bitop3_b32 v56, v56, v63, 1 bitop3:0x80
    v_cmp_ne_u32 s[56:57], 1, v56
    s_nop 1
    s_cmp_lg_u64 s[56:57], 0
    s_cbranch_scc1 Lver39
    s_mov_b32 m0, s1
    s_nop 3
    s_branch Lrare38b
Lrare40:
    s_nop 7
    s_mov_b32 s1, m0
Lver41:
    s_sub_u32 s66, s66, 1
    s_cbranch_scc1 Lbail
    s_add_u32 m0, s42, 106496
    s_add_u32 s31, s38, 40960
    buffer_load_dwordx4 v0, s[4:7], s31 offen offset:0 sc1 lds
    buffer_load_dwordx4 v0, s[4:7], s31 offen offset:1024 sc1 lds
    buffer_load_dwordx4 v0, s[4:7], s31 offen offset:2048 sc1 lds
    buffer_load_dwordx4 v0, s[4:7], s31 offen offset:3072 sc1 lds
    s_waitcnt vmcnt(0)
    ds_read2st64_b32 v[56:57], v28 offset0:160 offset1:164
    ds_read2st64_b32 v[58:59], v29 offset0:160 offset1:164
    ds_read2st64_b32 v[60:61], v28 offset0:168 offset1:172
    ds_read2st64_b32 v[62:63], v29 offset0:168 offset1:172
    s_waitcnt lgkmcnt(2)
    v_bitop3_b32 v56, v56, v57, v58 bitop3:0x80
    s_waitcnt lgkmcnt(1)
    v_bitop3_b32 v59, v59, v60, v61 bitop3:0x80
    s_waitcnt lgkmcnt(0)
    v_bitop3_b32 v56, v56, v59, v62 bitop3:0x80
    v_bitop3_b32 v56, v56, v63, 1 bitop3:0x80
    v_cmp_ne_u32 s[56:57], 1, v56
    s_nop 1
    s_cmp_lg_u64 s[56:57], 0
    s_cbranch_scc1 Lver41
    s_mov_b32 m0, s1
    s_nop 3
    s_branch Lrare40b
Lrare42:
    s_nop 7
    s_mov_b32 s1, m0
Lver43:
    s_sub_u32 s66, s66, 1
    s_cbranch_scc1 Lbail
    s_add_u32 m0, s41, 65536
    s_add_u32 s31, s34, 131072
    buffer_load_dwordx4 v0, s[4:7], s31 offen offset:0 sc1 lds
    buffer_load_dwordx4 v0, s[4:7], s31 offen offset:1024 sc1 lds
    buffer_load_dwordx4 v0, s[4:7], s31 offen offset:2048 sc1 lds
    buffer_load_dwordx4 v0, s[4:7], s31 offen offset:3072 sc1 lds
    s_waitcnt vmcnt(0)
    ds_read_b128 v[128:131], v28 offset:0
    ds_read_b128 v[132:135], v28 offset:1024
    ds_read_b128 v[136:139], v28 offset:2048
    ds_read_b128 v[140:143], v28 offset:3072
    s_waitcnt lgkmcnt(2)
    v_bitop3_b32 v128, v128, v130, v132 bitop3:0x80
    s_waitcnt lgkmcnt(1)
    v_bitop3_b32 v134, v134, v136, v138 bitop3:0x80
    s_waitcnt lgkmcnt(0)
    v_bitop3_b32 v128, v128, v134, v140 bitop3:0x80
    v_bitop3_b32 v128, v128, v142, 1 bitop3:0x80
    v_cmp_ne_u32 s[56:57], 1, v128
    s_nop 1
    s_cmp_lg_u64 s[56:57], 0
    s_cbranch_scc1 Lver43
    s_mov_b32 m0, s1
    s_nop 3
    s_branch Lrare42b
Lrare44:
    s_nop 7
    s_mov_b32 s1, m0
Lver45:
    s_sub_u32 s66, s66, 1
    s_cbranch_scc1 Lbail
    s_add_u32 m0, s41, 81920
    s_add_u32 s31, s34, 147456
    buffer_load_dwordx4 v0, s[4:7], s31 offen offset:0 sc1 lds
    buffer_load_dwordx4 v0, s[4:7], s31 offen offset:1024 sc1 lds
    buffer_load_dwordx4 v0, s[4:7], s31 offen offset:2048 sc1 lds
    buffer_load_dwordx4 v0, s[4:7], s31 offen offset:3072 sc1 lds
    s_waitcnt vmcnt(0)
    ds_read_b128 v[128:131], v28 offset:16384
    ds_read_b128 v[132:135], v28 offset:17408
    ds_read_b128 v[136:139], v28 offset:18432
    ds_read_b128 v[140:143], v28 offset:19456
    s_waitcnt lgkmcnt(2)
    v_bitop3_b32 v128, v128, v130, v132 bitop3:0x80
    s_waitcnt lgkmcnt(1)
    v_bitop3_b32 v134, v134, v136, v138 bitop3:0x80
    s_waitcnt lgkmcnt(0)
    v_bitop3_b32 v128, v128, v134, v140 bitop3:0x80
    v_bitop3_b32 v128, v128, v142, 1 bitop3:0x80
    v_cmp_ne_u32 s[56:57], 1, v128
    s_nop 1
    s_cmp_lg_u64 s[56:57], 0
    s_cbranch_scc1 Lver45
    s_mov_b32 m0, s1
    s_nop 3
    s_branch Lrare44b
Lrare46:
    s_nop 7
Lstc47:
    s_sub_u32 s66, s66, 1
    s_cbranch_scc1 Lbail
    s_add_u32 s31, s19, 720896
    buffer_load_dwordx4 v[156:159], v0, s[4:7], s31 offen sc1
    s_waitcnt vmcnt(0)
    v_bitop3_b32 v31, v156, v157, v158 bitop3:0x80
    v_bitop3_b32 v31, v31, v159, 1 bitop3:0x80
    v_cmp_ne_u32 vcc, 1, v31
    s_cbranch_vccnz Lstc47
    s_nop 3
    s_branch Lrare46b
Lrare48:
    s_nop 7
Lstc49:
    s_sub_u32 s66, s66, 1
    s_cbranch_scc1 Lbail
    s_add_u32 s31, s19, 724992
    buffer_load_dwordx4 v[160:163], v0, s[4:7], s31 offen sc1
    s_waitcnt vmcnt(0)
    v_bitop3_b32 v31, v160, v161, v162 bitop3:0x80
    v_bitop3_b32 v31, v31, v163, 1 bitop3:0x80
    v_cmp_ne_u32 vcc, 1, v31
    s_cbranch_vccnz Lstc49
    s_nop 3
    s_branch Lrare48b
Lrare50:
    s_nop 7
    s_mov_b32 s1, m0
Lver51:
    s_sub_u32 s66, s66, 1
    s_cbranch_scc1 Lbail
    s_add_u32 m0, s41, 98304
    s_add_u32 s31, s34, 163840
    buffer_load_dwordx4 v0, s[4:7], s31 offen offset:0 sc1 lds
    buffer_load_dwordx4 v0, s[4:7], s31 offen offset:1024 sc1 lds
    buffer_load_dwordx4 v0, s[4:7], s31 offen offset:2048 sc1 lds
    buffer_load_dwordx4 v0, s[4:7], s31 offen offset:3072 sc1 lds
    s_waitcnt vmcnt(0)
    ds_read_b128 v[128:131], v28 offset:32768
    ds_read_b128 v[132:135], v28 offset:33792
    ds_read_b128 v[136:139], v28 offset:34816
    ds_read_b128 v[140:143], v28 offset:35840
    s_waitcnt lgkmcnt(2)
    v_bitop3_b32 v128, v128, v130, v132 bitop3:0x80
    s_waitcnt lgkmcnt(1)
    v_bitop3_b32 v134, v134, v136, v138 bitop3:0x80
    s_waitcnt lgkmcnt(0)
    v_bitop3_b32 v128, v128, v134, v140 bitop3:0x80
    v_bitop3_b32 v128, v128, v142, 1 bitop3:0x80
    v_cmp_ne_u32 s[56:57], 1, v128
    s_nop 1
    s_cmp_lg_u64 s[56:57], 0
    s_cbranch_scc1 Lver51
    s_mov_b32 m0, s1
    s_nop 3
    s_branch Lrare50b
Lrare52:
    s_nop 7
    s_mov_b32 s1, m0
Lver53:
    s_sub_u32 s66, s66, 1
    s_cbranch_scc1 Lbail
    s_add_u32 m0, s41, 114688
    s_add_u32 s31, s34, 180224
    buffer_load_dwordx4 v0, s[4:7], s31 offen offset:0 sc1 lds
    buffer_load_dwordx4 v0, s[4:7], s31 offen offset:1024 sc1 lds
    buffer_load_dwordx4 v0, s[4:7], s31 offen offset:2048 sc1 lds
    buffer_load_dwordx4 v0, s[4:7], s31 offen offset:3072 sc1 lds
    s_waitcnt vmcnt(0)
    ds_read_b128 v[128:131], v28 offset:49152
    ds_read_b128 v[132:135], v28 offset:50176
    ds_read_b128 v[136:139], v28 offset:51200
    ds_read_b128 v[140:143], v28 offset:52224
    s_waitcnt lgkmcnt(2)
    v_bitop3_b32 v128, v128, v130, v132 bitop3:0x80
    s_waitcnt lgkmcnt(1)
    v_bitop3_b32 v134, v134, v136, v138 bitop3:0x80
    s_waitcnt lgkmcnt(0)
    v_bitop3_b32 v128, v128, v134, v140 bitop3:0x80
    v_bitop3_b32 v128, v128, v142, 1 bitop3:0x80
    v_cmp_ne_u32 s[56:57], 1, v128
    s_nop 1
    s_cmp_lg_u64 s[56:57], 0
    s_cbranch_scc1 Lver53
    s_mov_b32 m0, s1
    s_nop 3
    s_branch Lrare52b
Lrare55:
    s_nop 7
Lpoll56:
    s_sub_u32 s66, s66, 1
    s_cbranch_scc1 Lbail
    buffer_load_dword v31, v3, s[4:7], s37 offen offset:128 sc1
    s_waitcnt vmcnt(0)
    v_cmp_ne_u32 vcc, s29, v31
    s_cbranch_vccnz Lpoll56
    s_nop 3
    s_branch Lrare55b
Lrare57:
    s_nop 7
Lpoll58:
    s_sub_u32 s66, s66, 1
    s_cbranch_scc1 Lbail
    buffer_load_dword v31, v3, s[4:7], s37 offen offset:256 sc1
    s_waitcnt vmcnt(0)
    v_cmp_ne_u32 vcc, s29, v31
    s_cbranch_vccnz Lpoll58
    s_nop 3
    s_branch Lrare57b
Lrare59:
    s_nop 7
    s_mov_b32 s1, m0
Lver60:
    s_sub_u32 s66, s66, 1
    s_cbranch_scc1 Lbail
    s_add_u32 m0, s41, 65536
    s_add_u32 s31, s32, m0
    s_add_u32 s31, s31, 65536
    buffer_load_dwordx4 v0, s[4:7], s31 offen offset:0 sc1 lds
    buffer_load_dwordx4 v0, s[4:7], s31 offen offset:1024 sc1 lds
    buffer_load_dwordx4 v0, s[4:7], s31 offen offset:2048 sc1 lds
    buffer_load_dwordx4 v0, s[4:7], s31 offen offset:3072 sc1 lds
    s_waitcnt vmcnt(0)
    ds_read_b128 v[176:179], v28 offset:0
    ds_read_b128 v[180:183], v28 offset:1024
    ds_read_b128 v[184:187], v28 offset:2048
    ds_read_b128 v[188:191], v28 offset:3072
    s_waitcnt lgkmcnt(2)
    v_bitop3_b32 v176, v176, v178, v180 bitop3:0xfe
    s_waitcnt lgkmcnt(1)
    v_bitop3_b32 v182, v182, v184, v186 bitop3:0xfe
    s_waitcnt lgkmcnt(0)
    v_bitop3_b32 v176, v176, v182, v188 bitop3:0xfe
    v_bitop3_b32 v176, v176, v190, 1 bitop3:0xa8
    v_cmp_ne_u32 s[56:57], 0, v176
    s_nop 1
    s_cmp_lg_u64 s[56:57], 0
    s_cbranch_scc1 Lver60
    s_mov_b32 m0, s1
    s_nop 3
    s_branch Lrare59b
Lrare61:
    s_nop 7
Lstc62:
    s_sub_u32 s66, s66, 1
    s_cbranch_scc1 Lbail
    s_add_u32 s31, s19, 720896
    buffer_load_dwordx4 v[120:123], v0, s[4:7], s31 offen sc1
    s_waitcnt vmcnt(0)
    v_bitop3_b32 v31, v120, v121, v122 bitop3:0xfe
    v_bitop3_b32 v31, v31, v123, 1 bitop3:0xa8
    v_cmp_ne_u32 vcc, 0, v31
    s_cbranch_vccnz Lstc62
    s_nop 3
    s_branch Lrare61b
Lrare63:
    s_nop 7
    s_mov_b32 s1, m0
Lver64:
    s_sub_u32 s66, s66, 1
    s_cbranch_scc1 Lbail
    s_add_u32 m0, s41, 81920
    s_add_u32 s31, s32, m0
    s_add_u32 s31, s31, 65536
    buffer_load_dwordx4 v0, s[4:7], s31 offen offset:0 sc1 lds
    buffer_load_dwordx4 v0, s[4:7], s31 offen offset:1024 sc1 lds
    buffer_load_dwordx4 v0, s[4:7], s31 offen offset:2048 sc1 lds
    buffer_load_dwordx4 v0, s[4:7], s31 offen offset:3072 sc1 lds
    s_waitcnt vmcnt(0)
    ds_read_b128 v[176:179], v28 offset:16384
    ds_read_b128 v[180:183], v28 offset:17408
    ds_read_b128 v[184:187], v28 offset:18432
    ds_read_b128 v[188:191], v28 offset:19456
    s_waitcnt lgkmcnt(2)
    v_bitop3_b32 v176, v176, v178, v180 bitop3:0xfe
    s_waitcnt lgkmcnt(1)
    v_bitop3_b32 v182, v182, v184, v186 bitop3:0xfe
    s_waitcnt lgkmcnt(0)
    v_bitop3_b32 v176, v176, v182, v188 bitop3:0xfe
    v_bitop3_b32 v176, v176, v190, 1 bitop3:0xa8
    v_cmp_ne_u32 s[56:57], 0, v176
    s_nop 1
    s_cmp_lg_u64 s[56:57], 0
    s_cbranch_scc1 Lver64
    s_mov_b32 m0, s1
    s_nop 3
    s_branch Lrare63b
Lrare65:
    s_nop 7
    s_mov_b32 s1, m0
Lver66:
    s_sub_u32 s66, s66, 1
    s_cbranch_scc1 Lbail
    s_add_u32 m0, s41, 98304
    s_add_u32 s31, s32, m0
    s_add_u32 s31, s31, 65536
    buffer_load_dwordx4 v0, s[4:7], s31 offen offset:0 sc1 lds
    buffer_load_dwordx4 v0, s[4:7], s31 offen offset:1024 sc1 lds
    buffer_load_dwordx4 v0, s[4:7], s31 offen offset:2048 sc1 lds
    buffer_load_dwordx4 v0, s[4:7], s31 offen offset:3072 sc1 lds
    s_waitcnt vmcnt(0)
    ds_read_b128 v[176:179], v28 offset:32768
    ds_read_b128 v[180:183], v28 offset:33792
    ds_read_b128 v[184:187], v28 offset:34816
    ds_read_b128 v[188:191], v28 offset:35840
    s_waitcnt lgkmcnt(2)
    v_bitop3_b32 v176, v176, v178, v180 bitop3:0xfe
    s_waitcnt lgkmcnt(1)
    v_bitop3_b32 v182, v182, v184, v186 bitop3:0xfe
    s_waitcnt lgkmcnt(0)
    v_bitop3_b32 v176, v176, v182, v188 bitop3:0xfe
    v_bitop3_b32 v176, v176, v190, 1 bitop3:0xa8
    v_cmp_ne_u32 s[56:57], 0, v176
    s_nop 1
    s_cmp_lg_u64 s[56:57], 0
    s_cbranch_scc1 Lver66
    s_mov_b32 m0, s1
    s_nop 3
    s_branch Lrare65b
Lrare67:
    s_nop 7
Lstc68:
    s_sub_u32 s66, s66, 1
    s_cbranch_scc1 Lbail
    s_add_u32 s31, s19, 724992
    buffer_load_dwordx4 v[124:127], v0, s[4:7], s31 offen sc1
    s_waitcnt vmcnt(0)
    v_bitop3_b32 v31, v124, v125, v126 bitop3:0xfe
    v_bitop3_b32 v31, v31, v127, 1 bitop3:0xa8
    v_cmp_ne_u32 vcc, 0, v31
    s_cbranch_vccnz Lstc68
    s_nop 3
    s_branch Lrare67b
Lrare69:
    s_nop 7
    s_mov_b32 s1, m0
Lver70:
    s_sub_u32 s66, s66, 1
    s_cbranch_scc1 Lbail
    s_add_u32 m0, s41, 114688
    s_add_u32 s31, s32, m0
    s_add_u32 s31, s31, 65536
    buffer_load_dwordx4 v0, s[4:7], s31 offen offset:0 sc1 lds
    buffer_load_dwordx4 v0, s[4:7], s31 offen offset:1024 sc1 lds
    buffer_load_dwordx4 v0, s[4:7], s31 offen offset:2048 sc1 lds
    buffer_load_dwordx4 v0, s[4:7], s31 offen offset:3072 sc1 lds
    s_waitcnt vmcnt(0)
    ds_read_b128 v[176:179], v28 offset:49152
    ds_read_b128 v[180:183], v28 offset:50176
    ds_read_b128 v[184:187], v28 offset:51200
    ds_read_b128 v[188:191], v28 offset:52224
    s_waitcnt lgkmcnt(2)
    v_bitop3_b32 v176, v176, v178, v180 bitop3:0xfe
    s_waitcnt lgkmcnt(1)
    v_bitop3_b32 v182, v182, v184, v186 bitop3:0xfe
    s_waitcnt lgkmcnt(0)
    v_bitop3_b32 v176, v176, v182, v188 bitop3:0xfe
    v_bitop3_b32 v176, v176, v190, 1 bitop3:0xa8
    v_cmp_ne_u32 s[56:57], 0, v176
    s_nop 1
    s_cmp_lg_u64 s[56:57], 0
    s_cbranch_scc1 Lver70
    s_mov_b32 m0, s1
    s_nop 3
    s_branch Lrare69b
Lrare73:
    s_nop 7
Lred74:
    s_sub_u32 s66, s66, 1
    s_cbranch_scc1 Lbail
    s_add_u32 s31, s39, 1048576
    buffer_load_dwordx4 v[68:71], v0, s[4:7], s31 offen offset:0 sc1
    buffer_load_dwordx4 v[72:75], v0, s[4:7], s31 offen offset:1024 sc1
    buffer_load_dwordx4 v[76:79], v0, s[4:7], s31 offen offset:2048 sc1
    buffer_load_dwordx4 v[80:83], v0, s[4:7], s31 offen offset:3072 sc1
    s_waitcnt vmcnt(3)
    v_cmp_ne_u32 s[54:55], s29, v71
    s_waitcnt vmcnt(2)
    v_cmp_ne_u32 s[56:57], s29, v75
    s_nop 0
    s_or_b64 s[54:55], s[54:55], s[56:57]
    s_waitcnt vmcnt(1)
    v_cmp_ne_u32 s[56:57], s29, v79
    s_nop 0
    s_or_b64 s[54:55], s[54:55], s[56:57]
    s_waitcnt vmcnt(0)
    v_cmp_ne_u32 s[56:57], s29, v83
    s_nop 0
    s_or_b64 s[54:55], s[54:55], s[56:57]
    s_cmp_lg_u64 s[54:55], 0
    s_cbranch_scc1 Lred74
    s_nop 3
    s_branch Lrare73b
Lrare75:
    s_nop 7
Lst2o76:
    s_sub_u32 s66, s66, 1
    s_cbranch_scc1 Lbail
    v_cmp_ne_u32 vcc, s29, v35
    s_nop 1
    s_cbranch_vccz Lskip77
    s_add_u32 s31, s40, 262144
    buffer_load_dwordx4 v[32:35], v0, s[4:7], s31 offen sc1
Lskip77:
    v_cmp_ne_u32 vcc, s29, v39
    s_nop 1
    s_cbranch_vccz Lskip78
    s_add_u32 s31, s40, 263168
    buffer_load_dwordx4 v[36:39], v0, s[4:7], s31 offen sc1
Lskip78:
    v_cmp_ne_u32 vcc, s29, v43
    s_nop 1
    s_cbranch_vccz Lskip79
    s_add_u32 s31, s40, 264192
    buffer_load_dwordx4 v[40:43], v0, s[4:7], s31 offen sc1
Lskip79:
    v_cmp_ne_u32 vcc, s29, v47
    s_nop 1
    s_cbranch_vccz Lskip80
    s_add_u32 s31, s40, 265216
    buffer_load_dwordx4 v[44:47], v0, s[4:7], s31 offen sc1
Lskip80:
    v_cmp_ne_u32 vcc, s29, v51
    s_nop 1
    s_cbranch_vccz Lskip81
    s_add_u32 s31, s40, 266240
    buffer_load_dwordx4 v[48:51], v0, s[4:7], s31 offen sc1
Lskip81:
    v_cmp_ne_u32 vcc, s29, v55
    s_nop 1
    s_cbranch_vccz Lskip82
    s_add_u32 s31, s40, 267264
    buffer_load_dwordx4 v[52:55], v0, s[4:7], s31 offen sc1
Lskip82:
    v_cmp_ne_u32 vcc, s29, v59
    s_nop 1
    s_cbranch_vccz Lskip83
    s_add_u32 s31, s40, 268288
    buffer_load_dwordx4 v[56:59], v0, s[4:7], s31 offen sc1
Lskip83:
    v_cmp_ne_u32 vcc, s29, v63
    s_nop 1
    s_cbranch_vccz Lskip84
    s_add_u32 s31, s40, 269312
    buffer_load_dwordx4 v[60:63], v0, s[4:7], s31 offen sc1
Lskip84:
    s_waitcnt vmcnt(0)
    v_cmp_ne_u32 s[54:55], s29, v35
    v_cmp_ne_u32 s[56:57], s29, v39
    s_nop 0
    s_or_b64 s[54:55], s[54:55], s[56:57]
    v_cmp_ne_u32 s[56:57], s29, v43
    s_nop 0
    s_or_b64 s[54:55], s[54:55], s[56:57]
    v_cmp_ne_u32 s[56:57], s29, v47
    s_nop 0
    s_or_b64 s[54:55], s[54:55], s[56:57]
    v_cmp_ne_u32 s[56:57], s29, v51
    s_nop 0
    s_or_b64 s[54:55], s[54:55], s[56:57]
    v_cmp_ne_u32 s[56:57], s29, v55
    s_nop 0
    s_or_b64 s[54:55], s[54:55], s[56:57]
    v_cmp_ne_u32 s[56:57], s29, v59
    s_nop 0
    s_or_b64 s[54:55], s[54:55], s[56:57]
    v_cmp_ne_u32 s[56:57], s29, v63
    s_nop 0
    s_or_b64 s[54:55], s[54:55], s[56:57]
    s_cmp_lg_u64 s[54:55], 0
    s_cbranch_scc1 Lst2o76
    v_lshlrev_b32 v76, 16, v32
    v_and_b32 v77, 0xffff0000, v32
    v_lshlrev_b32 v78, 16, v33
    v_and_b32 v79, 0xffff0000, v33
    v_lshlrev_b32 v80, 16, v34
    v_and_b32 v81, 0xffff0000, v34
    v_xor_b32 v28, s29, v35
    v_dot2c_f32_bf16 v76, s46, v36
    v_dot2c_f32_bf16 v77, s47, v36
    v_dot2c_f32_bf16 v78, s46, v37
    v_dot2c_f32_bf16 v79, s47, v37
    v_dot2c_f32_bf16 v80, s46, v38
    v_dot2c_f32_bf16 v81, s47, v38
    v_bitop3_b32 v28, v5, v39, v28 bitop3:0xbe
    v_dot2c_f32_bf16 v76, s46, v40
    v_dot2c_f32_bf16 v77, s47, v40
    v_dot2c_f32_bf16 v78, s46, v41
    v_dot2c_f32_bf16 v79, s47, v41
    v_dot2c_f32_bf16 v80, s46, v42
    v_dot2c_f32_bf16 v81, s47, v42
    v_bitop3_b32 v28, v5, v43, v28 bitop3:0xbe
    v_dot2c_f32_bf16 v76, s46, v44
    v_dot2c_f32_bf16 v77, s47, v44
    v_dot2c_f32_bf16 v78, s46, v45
    v_dot2c_f32_bf16 v79, s47, v45
    v_dot2c_f32_bf16 v80, s46, v46
    v_dot2c_f32_bf16 v81, s47, v46
    v_bitop3_b32 v28, v5, v47, v28 bitop3:0xbe
    v_dot2c_f32_bf16 v76, s46, v48
    v_dot2c_f32_bf16 v77, s47, v48
    v_dot2c_f32_bf16 v78, s46, v49
    v_dot2c_f32_bf16 v79, s47, v49
    v_dot2c_f32_bf16 v80, s46, v50
    v_dot2c_f32_bf16 v81, s47, v50
    v_bitop3_b32 v28, v5, v51, v28 bitop3:0xbe
    v_dot2c_f32_bf16 v76, s46, v52
    v_dot2c_f32_bf16 v77, s47, v52
    v_dot2c_f32_bf16 v78, s46, v53
    v_dot2c_f32_bf16 v79, s47, v53
    v_dot2c_f32_bf16 v80, s46, v54
    v_dot2c_f32_bf16 v81, s47, v54
    v_bitop3_b32 v28, v5, v55, v28 bitop3:0xbe
    v_dot2c_f32_bf16 v76, s46, v56
    v_dot2c_f32_bf16 v77, s47, v56
    v_dot2c_f32_bf16 v78, s46, v57
    v_dot2c_f32_bf16 v79, s47, v57
    v_dot2c_f32_bf16 v80, s46, v58
    v_dot2c_f32_bf16 v81, s47, v58
    v_bitop3_b32 v28, v5, v59, v28 bitop3:0xbe
    v_dot2c_f32_bf16 v76, s46, v60
    v_dot2c_f32_bf16 v77, s47, v60
    v_dot2c_f32_bf16 v78, s46, v61
    v_dot2c_f32_bf16 v79, s47, v61
    v_dot2c_f32_bf16 v80, s46, v62
    v_dot2c_f32_bf16 v81, s47, v62
    v_bitop3_b32 v28, v5, v63, v28 bitop3:0xbe
    v_cmp_ne_u32 s[54:55], 0, v28
    s_nop 1
    s_nop 3
    s_branch Lrare75b
Lrare86:
    s_nop 7
    s_mov_b32 s1, m0
Lver87:
    s_sub_u32 s66, s66, 1
    s_cbranch_scc1 Lbail
    s_add_u32 m0, s42, 0
    s_add_u32 s31, s38, 0
    buffer_load_dwordx4 v0, s[4:7], s31 offen offset:0 sc1 lds
    buffer_load_dwordx4 v0, s[4:7], s31 offen offset:1024 sc1 lds
    buffer_load_dwordx4 v0, s[4:7], s31 offen offset:2048 sc1 lds
    buffer_load_dwordx4 v0, s[4:7], s31 offen offset:3072 sc1 lds
    s_waitcnt vmcnt(0)
    ds_read_b128 v[32:35], v28 offset:0
    ds_read_b128 v[36:39], v28 offset:1024
    ds_read_b128 v[40:43], v28 offset:2048
    ds_read_b128 v[44:47], v28 offset:3072
    s_waitcnt lgkmcnt(2)
    v_bitop3_b32 v32, v32, v34, v36 bitop3:0xfe
    s_waitcnt lgkmcnt(1)
    v_bitop3_b32 v38, v38, v40, v42 bitop3:0xfe
    s_waitcnt lgkmcnt(0)
    v_bitop3_b32 v32, v32, v38, v44 bitop3:0xfe
    v_bitop3_b32 v32, v32, v46, 1 bitop3:0xa8
    v_cmp_ne_u32 s[56:57], 0, v32
    s_nop 1
    s_cmp_lg_u64 s[56:57], 0
    s_cbranch_scc1 Lver87
    s_mov_b32 m0, s1
    s_nop 3
    s_branch Lrare86b
Lrare88:
    s_nop 7
    s_mov_b32 s1, m0
Lver89:
    s_sub_u32 s66, s66, 1
    s_cbranch_scc1 Lbail
    s_add_u32 m0, s42, 8192
    s_add_u32 s31, s38, 8192
    buffer_load_dwordx4 v0, s[4:7], s31 offen offset:0 sc1 lds
    buffer_load_dwordx4 v0, s[4:7], s31 offen offset:1024 sc1 lds
    buffer_load_dwordx4 v0, s[4:7], s31 offen offset:2048 sc1 lds
    buffer_load_dwordx4 v0, s[4:7], s31 offen offset:3072 sc1 lds
    s_waitcnt vmcnt(0)
    ds_read_b128 v[48:51], v28 offset:8192
    ds_read_b128 v[52:55], v28 offset:9216
    ds_read_b128 v[56:59], v28 offset:10240
    ds_read_b128 v[60:63], v28 offset:11264
    s_waitcnt lgkmcnt(2)
    v_bitop3_b32 v48, v48, v50, v52 bitop3:0xfe
    s_waitcnt lgkmcnt(1)
    v_bitop3_b32 v54, v54, v56, v58 bitop3:0xfe
    s_waitcnt lgkmcnt(0)
    v_bitop3_b32 v48, v48, v54, v60 bitop3:0xfe
    v_bitop3_b32 v48, v48, v62, 1 bitop3:0xa8
    v_cmp_ne_u32 s[56:57], 0, v48
    s_nop 1
    s_cmp_lg_u64 s[56:57], 0
    s_cbranch_scc1 Lver89
    s_mov_b32 m0, s1
    s_nop 3
    s_branch Lrare88b
Lrare90:
    s_nop 7
    s_mov_b32 s1, m0
Lver91:
    s_sub_u32 s66, s66, 1
    s_cbranch_scc1 Lbail
    s_add_u32 m0, s42, 32768
    s_add_u32 s31, s38, 32768
    buffer_load_dwordx4 v0, s[4:7], s31 offen offset:0 sc1 lds
    buffer_load_dwordx4 v0, s[4:7], s31 offen offset:1024 sc1 lds
    buffer_load_dwordx4 v0, s[4:7], s31 offen offset:2048 sc1 lds
    buffer_load_dwordx4 v0, s[4:7], s31 offen offset:3072 sc1 lds
    s_waitcnt vmcnt(0)
    ds_read2st64_b32 v[56:57], v28 offset0:128 offset1:132
    ds_read2st64_b32 v[58:59], v29 offset0:128 offset1:132
    ds_read2st64_b32 v[60:61], v28 offset0:136 offset1:140
    ds_read2st64_b32 v[62:63], v29 offset0:136 offset1:140
    s_waitcnt lgkmcnt(2)
    v_bitop3_b32 v56, v56, v57, v58 bitop3:0xfe
    s_waitcnt lgkmcnt(1)
    v_bitop3_b32 v59, v59, v60, v61 bitop3:0xfe
    s_waitcnt lgkmcnt(0)
    v_bitop3_b32 v56, v56, v59, v62 bitop3:0xfe
    v_bitop3_b32 v56, v56, v63, 1 bitop3:0xa8
    v_cmp_ne_u32 s[56:57], 0, v56
    s_nop 1
    s_cmp_lg_u64 s[56:57], 0
    s_cbranch_scc1 Lver91
    s_mov_b32 m0, s1
    s_nop 3
    s_branch Lrare90b
Lrare92:
    s_nop 7
    s_mov_b32 s1, m0
Lver93:
    s_sub_u32 s66, s66, 1
    s_cbranch_scc1 Lbail
    s_add_u32 m0, s42, 40960
    s_add_u32 s31, s38, 40960
    buffer_load_dwordx4 v0, s[4:7], s31 offen offset:0 sc1 lds
    buffer_load_dwordx4 v0, s[4:7], s31 offen offset:1024 sc1 lds
    buffer_load_dwordx4 v0, s[4:7], s31 offen offset:2048 sc1 lds
    buffer_load_dwordx4 v0, s[4:7], s31 offen offset:3072 sc1 lds
    s_waitcnt vmcnt(0)
    ds_read2st64_b32 v[56:57], v28 offset0:160 offset1:164
    ds_read2st64_b32 v[58:59], v29 offset0:160 offset1:164
    ds_read2st64_b32 v[60:61], v28 offset0:168 offset1:172
    ds_read2st64_b32 v[62:63], v29 offset0:168 offset1:172
    s_waitcnt lgkmcnt(2)
    v_bitop3_b32 v56, v56, v57, v58 bitop3:0xfe
    s_waitcnt lgkmcnt(1)
    v_bitop3_b32 v59, v59, v60, v61 bitop3:0xfe
    s_waitcnt lgkmcnt(0)
    v_bitop3_b32 v56, v56, v59, v62 bitop3:0xfe
    v_bitop3_b32 v56, v56, v63, 1 bitop3:0xa8
    v_cmp_ne_u32 s[56:57], 0, v56
    s_nop 1
    s_cmp_lg_u64 s[56:57], 0
    s_cbranch_scc1 Lver93
    s_mov_b32 m0, s1
    s_nop 3
    s_branch Lrare92b
Lrare94:
    s_nop 7
    s_mov_b32 s1, m0
Lver95:
    s_sub_u32 s66, s66, 1
    s_cbranch_scc1 Lbail
    s_add_u32 m0, s41, 0
    s_add_u32 s31, s34, 131072
    buffer_load_dwordx4 v0, s[4:7], s31 offen offset:0 sc1 lds
    buffer_load_dwordx4 v0, s[4:7], s31 offen offset:1024 sc1 lds
    buffer_load_dwordx4 v0, s[4:7], s31 offen offset:2048 sc1 lds
    buffer_load_dwordx4 v0, s[4:7], s31 offen offset:3072 sc1 lds
    s_waitcnt vmcnt(0)
    ds_read_b128 v[128:131], v28 offset:0
    ds_read_b128 v[132:135], v28 offset:1024
    ds_read_b128 v[136:139], v28 offset:2048
    ds_read_b128 v[140:143], v28 offset:3072
    s_waitcnt lgkmcnt(2)
    v_bitop3_b32 v128, v128, v130, v132 bitop3:0x80
    s_waitcnt lgkmcnt(1)
    v_bitop3_b32 v134, v134, v136, v138 bitop3:0x80
    s_waitcnt lgkmcnt(0)
    v_bitop3_b32 v128, v128, v134, v140 bitop3:0x80
    v_bitop3_b32 v128, v128, v142, 1 bitop3:0x80
    v_cmp_ne_u32 s[56:57], 1, v128
    s_nop 1
    s_cmp_lg_u64 s[56:57], 0
    s_cbranch_scc1 Lver95
    s_mov_b32 m0, s1
    s_nop 3
    s_branch Lrare94b
Lrare96:
    s_nop 7
    s_mov_b32 s1, m0
Lver97:
    s_sub_u32 s66, s66, 1
    s_cbranch_scc1 Lbail
    s_add_u32 m0, s41, 16384
    s_add_u32 s31, s34, 147456
    buffer_load_dwordx4 v0, s[4:7], s31 offen offset:0 sc1 lds
    buffer_load_dwordx4 v0, s[4:7], s31 offen offset:1024 sc1 lds
    buffer_load_dwordx4 v0, s[4:7], s31 offen offset:2048 sc1 lds
    buffer_load_dwordx4 v0, s[4:7], s31 offen offset:3072 sc1 lds
    s_waitcnt vmcnt(0)
    ds_read_b128 v[128:131], v28 offset:16384
    ds_read_b128 v[132:135], v28 offset:17408
    ds_read_b128 v[136:139], v28 offset:18432
    ds_read_b128 v[140:143], v28 offset:19456
    s_waitcnt lgkmcnt(2)
    v_bitop3_b32 v128, v128, v130, v132 bitop3:0x80
    s_waitcnt lgkmcnt(1)
    v_bitop3_b32 v134, v134, v136, v138 bitop3:0x80
    s_waitcnt lgkmcnt(0)
    v_bitop3_b32 v128, v128, v134, v140 bitop3:0x80
    v_bitop3_b32 v128, v128, v142, 1 bitop3:0x80
    v_cmp_ne_u32 s[56:57], 1, v128
    s_nop 1
    s_cmp_lg_u64 s[56:57], 0
    s_cbranch_scc1 Lver97
    s_mov_b32 m0, s1
    s_nop 3
    s_branch Lrare96b
Lrare98:
    s_nop 7
Lstc99:
    s_sub_u32 s66, s66, 1
    s_cbranch_scc1 Lbail
    s_add_u32 s31, s19, 720896
    buffer_load_dwordx4 v[156:159], v0, s[4:7], s31 offen sc1
    s_waitcnt vmcnt(0)
    v_bitop3_b32 v31, v156, v157, v158 bitop3:0x80
    v_bitop3_b32 v31, v31, v159, 1 bitop3:0x80
    v_cmp_ne_u32 vcc, 1, v31
    s_cbranch_vccnz Lstc99
    s_nop 3
    s_branch Lrare98b
Lrare100:
    s_nop 7
Lstc101:
    s_sub_u32 s66, s66, 1
    s_cbranch_scc1 Lbail
    s_add_u32 s31, s19, 724992
    buffer_load_dwordx4 v[160:163], v0, s[4:7], s31 offen sc1
    s_waitcnt vmcnt(0)
    v_bitop3_b32 v31, v160, v161, v162 bitop3:0x80
    v_bitop3_b32 v31, v31, v163, 1 bitop3:0x80
    v_cmp_ne_u32 vcc, 1, v31
    s_cbranch_vccnz Lstc101
    s_nop 3
    s_branch Lrare100b
Lrare102:
    s_nop 7
    s_mov_b32 s1, m0
Lver103:
    s_sub_u32 s66, s66, 1
    s_cbranch_scc1 Lbail
    s_add_u32 m0, s41, 32768
    s_add_u32 s31, s34, 163840
    buffer_load_dwordx4 v0, s[4:7], s31 offen offset:0 sc1 lds
    buffer_load_dwordx4 v0, s[4:7], s31 offen offset:1024 sc1 lds
    buffer_load_dwordx4 v0, s[4:7], s31 offen offset:2048 sc1 lds
    buffer_load_dwordx4 v0, s[4:7], s31 offen offset:3072 sc1 lds
    s_waitcnt vmcnt(0)
    ds_read_b128 v[128:131], v28 offset:32768
    ds_read_b128 v[132:135], v28 offset:33792
    ds_read_b128 v[136:139], v28 offset:34816
    ds_read_b128 v[140:143], v28 offset:35840
    s_waitcnt lgkmcnt(2)
    v_bitop3_b32 v128, v128, v130, v132 bitop3:0x80
    s_waitcnt lgkmcnt(1)
    v_bitop3_b32 v134, v134, v136, v138 bitop3:0x80
    s_waitcnt lgkmcnt(0)
    v_bitop3_b32 v128, v128, v134, v140 bitop3:0x80
    v_bitop3_b32 v128, v128, v142, 1 bitop3:0x80
    v_cmp_ne_u32 s[56:57], 1, v128
    s_nop 1
    s_cmp_lg_u64 s[56:57], 0
    s_cbranch_scc1 Lver103
    s_mov_b32 m0, s1
    s_nop 3
    s_branch Lrare102b
Lrare104:
    s_nop 7
    s_mov_b32 s1, m0
Lver105:
    s_sub_u32 s66, s66, 1
    s_cbranch_scc1 Lbail
    s_add_u32 m0, s41, 49152
    s_add_u32 s31, s34, 180224
    buffer_load_dwordx4 v0, s[4:7], s31 offen offset:0 sc1 lds
    buffer_load_dwordx4 v0, s[4:7], s31 offen offset:1024 sc1 lds
    buffer_load_dwordx4 v0, s[4:7], s31 offen offset:2048 sc1 lds
    buffer_load_dwordx4 v0, s[4:7], s31 offen offset:3072 sc1 lds
    s_waitcnt vmcnt(0)
    ds_read_b128 v[128:131], v28 offset:49152
    ds_read_b128 v[132:135], v28 offset:50176
    ds_read_b128 v[136:139], v28 offset:51200
    ds_read_b128 v[140:143], v28 offset:52224
    s_waitcnt lgkmcnt(2)
    v_bitop3_b32 v128, v128, v130, v132 bitop3:0x80
    s_waitcnt lgkmcnt(1)
    v_bitop3_b32 v134, v134, v136, v138 bitop3:0x80
    s_waitcnt lgkmcnt(0)
    v_bitop3_b32 v128, v128, v134, v140 bitop3:0x80
    v_bitop3_b32 v128, v128, v142, 1 bitop3:0x80
    v_cmp_ne_u32 s[56:57], 1, v128
    s_nop 1
    s_cmp_lg_u64 s[56:57], 0
    s_cbranch_scc1 Lver105
    s_mov_b32 m0, s1
    s_nop 3
    s_branch Lrare104b
Lrare106:
    s_nop 7
Lhv107:
    s_sub_u32 s66, s66, 1
    s_cbranch_scc1 Lbail
    s_add_u32 s31, s60, 327680
    s_add_u32 s3, s31, s73
    buffer_load_dwordx4 v[96:99], v0, s[4:7], s31 offen offset:0 sc1
    buffer_load_dwordx4 v[100:103], v0, s[4:7], s3 offen offset:0 sc1
    s_waitcnt vmcnt(0)
    v_or3_b32 v31, v96, v98, v100
    v_or_b32 v31, v31, v102
    v_cmp_gt_i32 vcc, 0, v31
    s_cbranch_vccnz Lhv107
    s_nop 3
    s_branch Lrare106b
Lrare108:
    s_nop 7
Lhv109:
    s_sub_u32 s66, s66, 1
    s_cbranch_scc1 Lbail
    s_add_u32 s31, s60, 327680
    s_add_u32 s3, s31, s73
    buffer_load_dwordx4 v[104:107], v0, s[4:7], s31 offen offset:1024 sc1
    buffer_load_dwordx4 v[108:111], v0, s[4:7], s3 offen offset:1024 sc1
    s_waitcnt vmcnt(0)
    v_or3_b32 v31, v104, v106, v108
    v_or_b32 v31, v31, v110
    v_cmp_gt_i32 vcc, 0, v31
    s_cbranch_vccnz Lhv109
    s_nop 3
    s_branch Lrare108b
Lrare110:
    s_nop 7
Lhv111:
    s_sub_u32 s66, s66, 1
    s_cbranch_scc1 Lbail
    s_add_u32 s31, s60, 327680
    s_add_u32 s3, s31, s73
    buffer_load_dwordx4 v[112:115], v0, s[4:7], s31 offen offset:2048 sc1
    buffer_load_dwordx4 v[116:119], v0, s[4:7], s3 offen offset:2048 sc1
    s_waitcnt vmcnt(0)
    v_or3_b32 v31, v112, v114, v116
    v_or_b32 v31, v31, v118
    v_cmp_gt_i32 vcc, 0, v31
    s_cbranch_vccnz Lhv111
    s_nop 3
    s_branch Lrare110b
Lrare112:
    s_nop 7
Lhv113:
    s_sub_u32 s66, s66, 1
    s_cbranch_scc1 Lbail
    s_add_u32 s31, s60, 327680
    s_add_u32 s3, s31, s73
    buffer_load_dwordx4 v[120:123], v0, s[4:7], s31 offen offset:3072 sc1
    buffer_load_dwordx4 v[124:127], v0, s[4:7], s3 offen offset:3072 sc1
    s_waitcnt vmcnt(0)
    v_or3_b32 v31, v120, v122, v124
    v_or_b32 v31, v31, v126
    v_cmp_gt_i32 vcc, 0, v31
    s_cbranch_vccnz Lhv113
    s_nop 3
    s_branch Lrare112b
Lrare114:
    s_nop 7
Lhv115:
    s_sub_u32 s66, s66, 1
    s_cbranch_scc1 Lbail
    s_add_u32 s31, s60, 331776
    s_add_u32 s3, s31, s73
    buffer_load_dwordx4 v[128:131], v0, s[4:7], s31 offen offset:0 sc1
    buffer_load_dwordx4 v[132:135], v0, s[4:7], s3 offen offset:0 sc1
    s_waitcnt vmcnt(0)
    v_or3_b32 v31, v128, v130, v132
    v_or_b32 v31, v31, v134
    v_cmp_gt_i32 vcc, 0, v31
    s_cbranch_vccnz Lhv115
    s_nop 3
    s_branch Lrare114b
Lrare116:
    s_nop 7
Lhv117:
    s_sub_u32 s66, s66, 1
    s_cbranch_scc1 Lbail
    s_add_u32 s31, s15, 327680
    s_add_u32 s3, s31, s73
    buffer_load_dwordx4 v[136:139], v0, s[4:7], s31 offen offset:0 sc1
    buffer_load_dwordx4 v[140:143], v0, s[4:7], s3 offen offset:0 sc1
    s_waitcnt vmcnt(0)
    v_or3_b32 v31, v136, v138, v140
    v_or_b32 v31, v31, v142
    v_cmp_gt_i32 vcc, 0, v31
    s_cbranch_vccnz Lhv117
    s_nop 3
    s_branch Lrare116b
Lrare118:
    s_nop 7
Lhv119:
    s_sub_u32 s66, s66, 1
    s_cbranch_scc1 Lbail
    s_add_u32 s31, s20, 327680
    s_add_u32 s3, s31, s73
    buffer_load_dwordx4 v[96:99], v0, s[4:7], s31 offen offset:0 sc1
    buffer_load_dwordx4 v[100:103], v0, s[4:7], s3 offen offset:0 sc1
    s_waitcnt vmcnt(0)
    v_or3_b32 v31, v96, v98, v100
    v_or_b32 v31, v31, v102
    v_cmp_gt_i32 vcc, 0, v31
    s_cbranch_vccnz Lhv119
    s_nop 3
    s_branch Lrare118b
Lrare120:
    s_nop 7
Lhv121:
    s_sub_u32 s66, s66, 1
    s_cbranch_scc1 Lbail
    s_add_u32 s31, s61, 327680
    s_add_u32 s3, s31, s73
    buffer_load_dwordx4 v[104:107], v0, s[4:7], s31 offen offset:0 sc1
    buffer_load_dwordx4 v[108:111], v0, s[4:7], s3 offen offset:0 sc1
    s_waitcnt vmcnt(0)
    v_or3_b32 v31, v104, v106, v108
    v_or_b32 v31, v31, v110
    v_cmp_gt_i32 vcc, 0, v31
    s_cbranch_vccnz Lhv121
    s_nop 3
    s_branch Lrare120b
Lrare123:
    s_nop 7
Lhv124:
    s_sub_u32 s66, s66, 1
    s_cbranch_scc1 Lbail
    s_add_u32 s31, s61, 327680
    s_add_u32 s3, s31, s73
    buffer_load_dwordx4 v[112:115], v0, s[4:7], s31 offen offset:1024 sc1
    buffer_load_dwordx4 v[116:119], v0, s[4:7], s3 offen offset:1024 sc1
    s_waitcnt vmcnt(0)
    v_or3_b32 v31, v112, v114, v116
    v_or_b32 v31, v31, v118
    v_cmp_gt_i32 vcc, 0, v31
    s_cbranch_vccnz Lhv124
    s_nop 3
    s_branch Lrare123b
Lrare125:
    s_nop 7
Lhv126:
    s_sub_u32 s66, s66, 1
    s_cbranch_scc1 Lbail
    s_add_u32 s31, s61, 327680
    s_add_u32 s3, s31, s73
    buffer_load_dwordx4 v[120:123], v0, s[4:7], s31 offen offset:2048 sc1
    buffer_load_dwordx4 v[124:127], v0, s[4:7], s3 offen offset:2048 sc1
    s_waitcnt vmcnt(0)
    v_or3_b32 v31, v120, v122, v124
    v_or_b32 v31, v31, v126
    v_cmp_gt_i32 vcc, 0, v31
    s_cbranch_vccnz Lhv126
    s_nop 3
    s_branch Lrare125b
Lrare127:
    s_nop 7
Lhv128:
    s_sub_u32 s66, s66, 1
    s_cbranch_scc1 Lbail
    s_add_u32 s31, s61, 327680
    s_add_u32 s3, s31, s73
    buffer_load_dwordx4 v[128:131], v0, s[4:7], s31 offen offset:3072 sc1
    buffer_load_dwordx4 v[132:135], v0, s[4:7], s3 offen offset:3072 sc1
    s_waitcnt vmcnt(0)
    v_or3_b32 v31, v128, v130, v132
    v_or_b32 v31, v31, v134
    v_cmp_gt_i32 vcc, 0, v31
    s_cbranch_vccnz Lhv128
    s_nop 3
    s_branch Lrare127b
Lrare129:
    s_nop 7
Lhv130:
    s_sub_u32 s66, s66, 1
    s_cbranch_scc1 Lbail
    s_add_u32 s31, s60, 415744
    s_add_u32 s3, s31, s73
    buffer_load_dwordx4 v[136:139], v0, s[4:7], s31 offen offset:0 sc1
    buffer_load_dwordx4 v[140:143], v0, s[4:7], s3 offen offset:0 sc1
    s_waitcnt vmcnt(0)
    v_or3_b32 v31, v136, v138, v140
    v_or_b32 v31, v31, v142
    v_cmp_gt_i32 vcc, 0, v31
    s_cbranch_vccnz Lhv130
    s_nop 3
    s_branch Lrare129b
Lrare131:
    s_nop 7
Lhv132:
    s_sub_u32 s66, s66, 1
    s_cbranch_scc1 Lbail
    s_add_u32 s31, s60, 415744
    s_add_u32 s3, s31, s73
    buffer_load_dwordx4 v[96:99], v0, s[4:7], s31 offen offset:1024 sc1
    buffer_load_dwordx4 v[100:103], v0, s[4:7], s3 offen offset:1024 sc1
    s_waitcnt vmcnt(0)
    v_or3_b32 v31, v96, v98, v100
    v_or_b32 v31, v31, v102
    v_cmp_gt_i32 vcc, 0, v31
    s_cbranch_vccnz Lhv132
    s_nop 3
    s_branch Lrare131b
Lrare133:
    s_nop 7
Lhv134:
    s_sub_u32 s66, s66, 1
    s_cbranch_scc1 Lbail
    s_add_u32 s31, s60, 415744
    s_add_u32 s3, s31, s73
    buffer_load_dwordx4 v[104:107], v0, s[4:7], s31 offen offset:2048 sc1
    buffer_load_dwordx4 v[108:111], v0, s[4:7], s3 offen offset:2048 sc1
    s_waitcnt vmcnt(0)
    v_or3_b32 v31, v104, v106, v108
    v_or_b32 v31, v31, v110
    v_cmp_gt_i32 vcc, 0, v31
    s_cbranch_vccnz Lhv134
    s_nop 3
    s_branch Lrare133b
Lrare135:
    s_nop 7
Lhv136:
    s_sub_u32 s66, s66, 1
    s_cbranch_scc1 Lbail
    s_add_u32 s31, s60, 415744
    s_add_u32 s3, s31, s73
    buffer_load_dwordx4 v[112:115], v0, s[4:7], s31 offen offset:3072 sc1
    buffer_load_dwordx4 v[116:119], v0, s[4:7], s3 offen offset:3072 sc1
    s_waitcnt vmcnt(0)
    v_or3_b32 v31, v112, v114, v116
    v_or_b32 v31, v31, v118
    v_cmp_gt_i32 vcc, 0, v31
    s_cbranch_vccnz Lhv136
    s_nop 3
    s_branch Lrare135b
Lrare137:
    s_nop 7
Lhv138:
    s_sub_u32 s66, s66, 1
    s_cbranch_scc1 Lbail
    s_add_u32 s31, s60, 419840
    s_add_u32 s3, s31, s73
    buffer_load_dwordx4 v[120:123], v0, s[4:7], s31 offen offset:0 sc1
    buffer_load_dwordx4 v[124:127], v0, s[4:7], s3 offen offset:0 sc1
    s_waitcnt vmcnt(0)
    v_or3_b32 v31, v120, v122, v124
    v_or_b32 v31, v31, v126
    v_cmp_gt_i32 vcc, 0, v31
    s_cbranch_vccnz Lhv138
    s_nop 3
    s_branch Lrare137b
Lrare139:
    s_nop 7
Lhv140:
    s_sub_u32 s66, s66, 1
    s_cbranch_scc1 Lbail
    s_add_u32 s31, s15, 415744
    s_add_u32 s3, s31, s73
    buffer_load_dwordx4 v[128:131], v0, s[4:7], s31 offen offset:0 sc1
    buffer_load_dwordx4 v[132:135], v0, s[4:7], s3 offen offset:0 sc1
    s_waitcnt vmcnt(0)
    v_or3_b32 v31, v128, v130, v132
    v_or_b32 v31, v31, v134
    v_cmp_gt_i32 vcc, 0, v31
    s_cbranch_vccnz Lhv140
    s_nop 3
    s_branch Lrare139b
Lrare141:
    s_nop 7
Lhv142:
    s_sub_u32 s66, s66, 1
    s_cbranch_scc1 Lbail
    s_add_u32 s31, s20, 415744
    s_add_u32 s3, s31, s73
    buffer_load_dwordx4 v[136:139], v0, s[4:7], s31 offen offset:0 sc1
    buffer_load_dwordx4 v[140:143], v0, s[4:7], s3 offen offset:0 sc1
    s_waitcnt vmcnt(0)
    v_or3_b32 v31, v136, v138, v140
    v_or_b32 v31, v31, v142
    v_cmp_gt_i32 vcc, 0, v31
    s_cbranch_vccnz Lhv142
    s_nop 3
    s_branch Lrare141b
Lrare143:
    s_nop 7
Lhv144:
    s_sub_u32 s66, s66, 1
    s_cbranch_scc1 Lbail
    s_add_u32 s31, s61, 415744
    s_add_u32 s3, s31, s73
    buffer_load_dwordx4 v[96:99], v0, s[4:7], s31 offen offset:0 sc1
    buffer_load_dwordx4 v[100:103], v0, s[4:7], s3 offen offset:0 sc1
    s_waitcnt vmcnt(0)
    v_or3_b32 v31, v96, v98, v100
    v_or_b32 v31, v31, v102
    v_cmp_gt_i32 vcc, 0, v31
    s_cbranch_vccnz Lhv144
    s_nop 3
    s_branch Lrare143b
Lrare145:
    s_nop 7
Lhv146:
    s_sub_u32 s66, s66, 1
    s_cbranch_scc1 Lbail
    s_add_u32 s31, s61, 415744
    s_add_u32 s3, s31, s73
    buffer_load_dwordx4 v[104:107], v0, s[4:7], s31 offen offset:1024 sc1
    buffer_load_dwordx4 v[108:111], v0, s[4:7], s3 offen offset:1024 sc1
    s_waitcnt vmcnt(0)
    v_or3_b32 v31, v104, v106, v108
    v_or_b32 v31, v31, v110
    v_cmp_gt_i32 vcc, 0, v31
    s_cbranch_vccnz Lhv146
    s_nop 3
    s_branch Lrare145b
Lrare147:
    s_nop 7
Lhv148:
    s_sub_u32 s66, s66, 1
    s_cbranch_scc1 Lbail
    s_add_u32 s31, s61, 415744
    s_add_u32 s3, s31, s73
    buffer_load_dwordx4 v[112:115], v0, s[4:7], s31 offen offset:2048 sc1
    buffer_load_dwordx4 v[116:119], v0, s[4:7], s3 offen offset:2048 sc1
    s_waitcnt vmcnt(0)
    v_or3_b32 v31, v112, v114, v116
    v_or_b32 v31, v31, v118
    v_cmp_gt_i32 vcc, 0, v31
    s_cbranch_vccnz Lhv148
    s_nop 3
    s_branch Lrare147b
Lrare149:
    s_nop 7
Lhv150:
    s_sub_u32 s66, s66, 1
    s_cbranch_scc1 Lbail
    s_add_u32 s31, s61, 415744
    s_add_u32 s3, s31, s73
    buffer_load_dwordx4 v[120:123], v0, s[4:7], s31 offen offset:3072 sc1
    buffer_load_dwordx4 v[124:127], v0, s[4:7], s3 offen offset:3072 sc1
    s_waitcnt vmcnt(0)
    v_or3_b32 v31, v120, v122, v124
    v_or_b32 v31, v31, v126
    v_cmp_gt_i32 vcc, 0, v31
    s_cbranch_vccnz Lhv150
    s_nop 3
    s_branch Lrare149b
Lslow:
    v_mov_b32 v99, v5
    s_lshl_b32 s31, s28, 10
    s_add_u32 s31, s31, s39
    s_add_u32 s31, s31, 0
    v_cvt_pk_bf16_f32 v100, v92, v93
    v_cvt_pk_bf16_f32 v101, v94, v95
    v_cvt_pk_bf16_f32 v96, v88, v89
    v_cvt_pk_bf16_f32 v97, v90, v91
    v_cndmask_b32 v98, v100, v101, s[52:53]
    buffer_store_dwordx4 v[96:99], v0, s[4:7], s31 offen sc1
    v_mov_b32 v32, 0
    v_mov_b32 v33, 0
    v_mov_b32 v34, 0
    v_mov_b32 v35, 0
    s_and_b32 s3, s24, 1
    s_lshl_b32 s3, s3, 15
    s_add_u32 s31, s67, s3
    buffer_store_dwordx4 v[32:35], v0, s[4:7], s31 offen sc1
    s_add_u32 s31, s31, 16384
    buffer_store_dwordx4 v[32:35], v0, s[4:7], s31 offen sc1
    s_add_u32 s31, s43, 131072
    buffer_store_dwordx4 v[32:35], v0, s[4:7], s31 offen sc1
    s_add_u32 s31, s43, 163840
    buffer_store_dwordx4 v[32:35], v0, s[4:7], s31 offen sc1
    s_add_u32 s31, s44, 720896
    buffer_store_dword v32, v7, s[4:7], s31 offen sc1
    s_add_u32 s31, s44, 724992
    buffer_store_dword v32, v7, s[4:7], s31 offen sc1
    s_waitcnt vmcnt(0) lgkmcnt(0)
    s_barrier
    s_sleep 2
    s_cmp_lg_u32 s24, s28
    s_cbranch_scc1 Lskip151
    s_add_u32 s31, s39, 0
    buffer_load_dwordx4 v[68:71], v0, s[4:7], s31 offen offset:0 sc1
    buffer_load_dwordx4 v[72:75], v0, s[4:7], s31 offen offset:1024 sc1
    buffer_load_dwordx4 v[76:79], v0, s[4:7], s31 offen offset:2048 sc1
    buffer_load_dwordx4 v[80:83], v0, s[4:7], s31 offen offset:3072 sc1
Lskip151:
    buffer_store_dword v5, v4, s[4:7], s18 offen offset:0 sc1
    s_cmp_lg_u32 s24, s28
    s_cbranch_scc1 Lskip152
    s_waitcnt vmcnt(4)
    v_cmp_ne_u32 s[54:55], s29, v71
    s_waitcnt vmcnt(3)
    v_cmp_ne_u32 s[56:57], s29, v75
    s_nop 0
    s_or_b64 s[54:55], s[54:55], s[56:57]
    s_waitcnt vmcnt(2)
    v_cmp_ne_u32 s[56:57], s29, v79
    s_nop 0
    s_or_b64 s[54:55], s[54:55], s[56:57]
    s_waitcnt vmcnt(1)
    v_cmp_ne_u32 s[56:57], s29, v83
    s_nop 0
    s_or_b64 s[54:55], s[54:55], s[56:57]
    s_cmp_lg_u64 s[54:55], 0
    s_cbranch_scc1 Lrare153
Lrare153b:
    v_lshlrev_b32 v84, 16, v68
    v_and_b32 v85, 0xffff0000, v68
    v_lshlrev_b32 v86, 16, v69
    v_and_b32 v87, 0xffff0000, v69
    v_lshlrev_b32 v28, 16, v70
    v_and_b32 v29, 0xffff0000, v70
    v_dot2_f32_bf16 v84, v72, s46, v84
    v_dot2_f32_bf16 v85, v72, s47, v85
    v_dot2_f32_bf16 v86, v73, s46, v86
    v_dot2_f32_bf16 v87, v73, s47, v87
    v_dot2_f32_bf16 v28, v74, s46, v28
    v_dot2_f32_bf16 v29, v74, s47, v29
    v_dot2_f32_bf16 v84, v76, s46, v84
    v_dot2_f32_bf16 v85, v76, s47, v85
    v_dot2_f32_bf16 v86, v77, s46, v86
    v_dot2_f32_bf16 v87, v77, s47, v87
    v_dot2_f32_bf16 v28, v78, s46, v28
    v_dot2_f32_bf16 v29, v78, s47, v29
    v_dot2_f32_bf16 v84, v80, s46, v84
    v_dot2_f32_bf16 v85, v80, s47, v85
    v_dot2_f32_bf16 v86, v81, s46, v86
    v_dot2_f32_bf16 v87, v81, s47, v87
    v_dot2_f32_bf16 v28, v82, s46, v28
    v_dot2_f32_bf16 v29, v82, s47, v29
    s_lshl_b32 s31, s27, 10
    s_add_u32 s31, s31, s40
    s_add_u32 s31, s31, 0
    v_cvt_pk_bf16_f32 v68, v84, v85
    v_cvt_pk_bf16_f32 v69, v86, v87
    v_cvt_pk_bf16_f32 v70, v28, v29
    buffer_store_dwordx4 v[68:71], v0, s[4:7], s31 offen sc1
Lskip152:
    s_add_u32 s30, s71, 0
    buffer_load_dwordx4 v[128:131], v0, s[4:7], s30 offen offset:0 sc1
    buffer_load_dwordx4 v[132:135], v0, s[4:7], s30 offen offset:1024 sc1
    buffer_load_dwordx4 v[136:139], v0, s[4:7], s30 offen offset:2048 sc1
    buffer_load_dwordx4 v[140:143], v0, s[4:7], s30 offen offset:3072 sc1
    s_add_u32 s30, s71, 4096
    buffer_load_dwordx4 v[144:147], v0, s[4:7], s30 offen offset:0 sc1
    buffer_load_dwordx4 v[148:151], v0, s[4:7], s30 offen offset:1024 sc1
    buffer_load_dwordx4 v[152:155], v0, s[4:7], s30 offen offset:2048 sc1
    buffer_load_dwordx4 v[156:159], v0, s[4:7], s30 offen offset:3072 sc1
    s_cmp_eq_u32 s35, 1
    s_cbranch_scc1 Lskip155
    ds_read_b64_tr_b16 a[16:17], v108 offset:0
    ds_read_b64_tr_b16 a[18:19], v108 offset:512
    ds_read_b64_tr_b16 a[20:21], v108 offset:32
    ds_read_b64_tr_b16 a[22:23], v108 offset:544
    ds_read_b64_tr_b16 a[24:25], v108 offset:64
    ds_read_b64_tr_b16 a[26:27], v108 offset:576
    ds_read_b64_tr_b16 a[28:29], v108 offset:96
    ds_read_b64_tr_b16 a[30:31], v108 offset:608
    s_waitcnt lgkmcnt(0)
Lskip155:
    s_cmp_eq_u32 s35, 1
    s_cbranch_scc0 Lskip156
    ds_read_b64_tr_b16 a[16:17], v109 offset:0
    ds_read_b64_tr_b16 a[18:19], v109 offset:2048
    ds_read_b64_tr_b16 a[20:21], v109 offset:8
    ds_read_b64_tr_b16 a[22:23], v109 offset:2056
    ds_read_b64_tr_b16 a[24:25], v109 offset:64
    ds_read_b64_tr_b16 a[26:27], v109 offset:2112
    ds_read_b64_tr_b16 a[28:29], v109 offset:72
    ds_read_b64_tr_b16 a[30:31], v109 offset:2120
    s_waitcnt lgkmcnt(0)
Lskip156:
    buffer_store_dwordx4 a[16:19], v0, s[4:7], s64 offen sc1
    s_add_u32 s64, s64, s65
    buffer_store_dwordx4 a[20:23], v0, s[4:7], s64 offen sc1
    s_add_u32 s64, s64, s65
    buffer_store_dwordx4 a[24:27], v0, s[4:7], s64 offen sc1
    s_add_u32 s64, s64, s65
    buffer_store_dwordx4 a[28:31], v0, s[4:7], s64 offen sc1
    s_add_u32 s30, s71, 8192
    buffer_load_dwordx4 v[160:163], v0, s[4:7], s30 offen offset:0 sc1
    buffer_load_dwordx4 v[164:167], v0, s[4:7], s30 offen offset:1024 sc1
    buffer_load_dwordx4 v[168:171], v0, s[4:7], s30 offen offset:2048 sc1
    buffer_load_dwordx4 v[172:175], v0, s[4:7], s30 offen offset:3072 sc1
    s_add_u32 s30, s71, 12288
    buffer_load_dwordx4 v[176:179], v0, s[4:7], s30 offen offset:0 sc1
    buffer_load_dwordx4 v[180:183], v0, s[4:7], s30 offen offset:1024 sc1
    buffer_load_dwordx4 v[184:187], v0, s[4:7], s30 offen offset:2048 sc1
    buffer_load_dwordx4 v[188:191], v0, s[4:7], s30 offen offset:3072 sc1
    s_lshl_b32 s31, s24, 6
    v_add_u32 v30, s31, v1
    ds_read_b128 v[32:35], v116 offset:0
    ds_read_b128 v[36:39], v117 offset:0
    ds_read_b128 v[40:43], v118 offset:0
    ds_read_b128 v[44:47], v119 offset:0
    ds_read_b128 v[48:51], v116 offset:4096
    ds_read_b128 v[52:55], v117 offset:4096
    ds_read_b128 v[56:59], v118 offset:4096
    ds_read_b32 v88, v2 offset:256
    ds_read_b32 v89, v2 offset:512
    ds_read_b32 v90, v2 offset:320
    ds_read_b32 v91, v2 offset:576
    s_waitcnt vmcnt(19) lgkmcnt(10)
    v_mfma_f32_16x16x32_bf16 v[96:99], v[128:131], v[32:35], 0
    s_add_u32 s51, s33, 0
    s_and_b32 s51, s51, 0x3fff
    s_lshl_b32 s30, s41, 2
    s_add_u32 s30, s30, s51
    s_add_u32 m0, s30, 65536
    s_add_u32 s30, s71, s51
    s_add_u32 s30, s30, 65536
    buffer_load_dwordx4 v0, s[4:7], s30 offen offset:0 sc1 lds
    ds_read_b128 v[60:63], v119 offset:4096
    v_mfma_f32_16x16x32_bf16 v[92:95], v[128:131], v[112:115], 0
    s_waitcnt vmcnt(19) lgkmcnt(10)
    v_mfma_f32_16x16x32_bf16 v[96:99], v[132:135], v[36:39], v[96:99]
    ds_read_b128 v[32:35], v116 offset:8192
    v_mfma_f32_16x16x32_bf16 v[92:95], v[132:135], v[112:115], v[92:95]
    s_waitcnt vmcnt(18) lgkmcnt(10)
    buffer_load_dwordx4 v0, s[4:7], s30 offen offset:1024 sc1 lds
    v_mfma_f32_16x16x32_bf16 v[96:99], v[136:139], v[40:43], v[96:99]
    ds_read_b128 v[36:39], v117 offset:8192
    v_mfma_f32_16x16x32_bf16 v[92:95], v[136:139], v[112:115], v[92:95]
    s_waitcnt vmcnt(18) lgkmcnt(10)
    v_mfma_f32_16x16x32_bf16 v[96:99], v[140:143], v[44:47], v[96:99]
    buffer_load_dwordx4 v0, s[4:7], s30 offen offset:2048 sc1 lds
    ds_read_b128 v[40:43], v118 offset:8192
    v_mfma_f32_16x16x32_bf16 v[92:95], v[140:143], v[112:115], v[92:95]
    s_waitcnt vmcnt(18) lgkmcnt(10)
    v_mfma_f32_16x16x32_bf16 v[96:99], v[144:147], v[48:51], v[96:99]
    ds_read_b128 v[44:47], v119 offset:8192
    v_mfma_f32_16x16x32_bf16 v[92:95], v[144:147], v[112:115], v[92:95]
    s_waitcnt vmcnt(17) lgkmcnt(10)
    buffer_load_dwordx4 v0, s[4:7], s30 offen offset:3072 sc1 lds
    v_mfma_f32_16x16x32_bf16 v[96:99], v[148:151], v[52:55], v[96:99]
    ds_read_b128 v[48:51], v116 offset:12288
    v_mfma_f32_16x16x32_bf16 v[92:95], v[148:151], v[112:115], v[92:95]
    s_waitcnt vmcnt(17) lgkmcnt(10)
    v_mfma_f32_16x16x32_bf16 v[96:99], v[152:155], v[56:59], v[96:99]
    s_add_u32 s51, s33, 4096
    s_and_b32 s51, s51, 0x3fff
    s_lshl_b32 s30, s41, 2
    s_add_u32 s30, s30, s51
    s_add_u32 m0, s30, 65536
    s_add_u32 s30, s71, s51
    s_add_u32 s30, s30, 65536
    buffer_load_dwordx4 v0, s[4:7], s30 offen offset:0 sc1 lds
    ds_read_b128 v[52:55], v117 offset:12288
    v_mfma_f32_16x16x32_bf16 v[92:95], v[152:155], v[112:115], v[92:95]
    s_waitcnt vmcnt(17) lgkmcnt(6)
    v_mfma_f32_16x16x32_bf16 v[96:99], v[156:159], v[60:63], v[96:99]
    ds_read_b128 v[56:59], v118 offset:12288
    v_mfma_f32_16x16x32_bf16 v[92:95], v[156:159], v[112:115], v[92:95]
    s_waitcnt vmcnt(12) lgkmcnt(6)
    buffer_load_dwordx4 v0, s[4:7], s30 offen offset:1024 sc1 lds
    v_mfma_f32_16x16x32_bf16 v[96:99], v[160:163], v[32:35], v[96:99]
    ds_read_b128 v[60:63], v119 offset:12288
    v_mfma_f32_16x16x32_bf16 v[92:95], v[160:163], v[112:115], v[92:95]
    s_waitcnt vmcnt(12) lgkmcnt(6)
    v_mfma_f32_16x16x32_bf16 v[96:99], v[164:167], v[36:39], v[96:99]
    buffer_load_dwordx4 v0, s[4:7], s30 offen offset:2048 sc1 lds
    ds_read_b128 v[32:35], v116 offset:16384
    v_mfma_f32_16x16x32_bf16 v[92:95], v[164:167], v[112:115], v[92:95]
    s_waitcnt vmcnt(12) lgkmcnt(6)
    v_mfma_f32_16x16x32_bf16 v[96:99], v[168:171], v[40:43], v[96:99]
    ds_read_b128 v[36:39], v117 offset:16384
    v_mfma_f32_16x16x32_bf16 v[92:95], v[168:171], v[112:115], v[92:95]
    s_waitcnt vmcnt(11) lgkmcnt(6)
    buffer_load_dwordx4 v0, s[4:7], s30 offen offset:3072 sc1 lds
    v_mfma_f32_16x16x32_bf16 v[96:99], v[172:175], v[44:47], v[96:99]
    ds_read_b128 v[40:43], v118 offset:16384
    v_mfma_f32_16x16x32_bf16 v[92:95], v[172:175], v[112:115], v[92:95]
    s_waitcnt vmcnt(11) lgkmcnt(6)
    v_mfma_f32_16x16x32_bf16 v[96:99], v[176:179], v[48:51], v[96:99]
    buffer_store_dword v5, v4, s[4:7], s101 offen sc1
    s_add_u32 s51, s33, 8192
    s_and_b32 s51, s51, 0x3fff
    s_lshl_b32 s30, s41, 2
    s_add_u32 s30, s30, s51
    s_add_u32 m0, s30, 65536
    s_add_u32 s30, s71, s51
    s_add_u32 s30, s30, 65536
    buffer_load_dwordx4 v0, s[4:7], s30 offen offset:0 sc1 lds
    ds_read_b128 v[44:47], v119 offset:16384
    v_mfma_f32_16x16x32_bf16 v[92:95], v[176:179], v[112:115], v[92:95]
    s_waitcnt vmcnt(12) lgkmcnt(6)
    v_mfma_f32_16x16x32_bf16 v[96:99], v[180:183], v[52:55], v[96:99]
    ds_read_b128 v[48:51], v116 offset:20480
    v_mfma_f32_16x16x32_bf16 v[92:95], v[180:183], v[112:115], v[92:95]
    s_waitcnt vmcnt(11) lgkmcnt(6)
    buffer_load_dwordx4 v0, s[4:7], s30 offen offset:1024 sc1 lds
    v_mfma_f32_16x16x32_bf16 v[96:99], v[184:187], v[56:59], v[96:99]
    ds_read_b128 v[52:55], v117 offset:20480
    v_mfma_f32_16x16x32_bf16 v[92:95], v[184:187], v[112:115], v[92:95]
    s_waitcnt vmcnt(11) lgkmcnt(6)
    v_mfma_f32_16x16x32_bf16 v[96:99], v[188:191], v[60:63], v[96:99]
    buffer_load_dwordx4 v0, s[4:7], s30 offen offset:2048 sc1 lds
    ds_read_b128 v[56:59], v118 offset:20480
    v_mfma_f32_16x16x32_bf16 v[92:95], v[188:191], v[112:115], v[92:95]
    s_waitcnt lgkmcnt(6)
    v_mfma_f32_16x16x32_bf16 v[100:103], v[128:131], v[32:35], 0
    s_waitcnt lgkmcnt(5)
    ds_read_b128 v[60:63], v119 offset:20480
    v_mfma_f32_16x16x32_bf16 v[100:103], v[132:135], v[36:39], v[100:103]
    s_waitcnt lgkmcnt(5)
    buffer_load_dwordx4 v0, s[4:7], s30 offen offset:3072 sc1 lds
    ds_read_b128 v[32:35], v116 offset:24576
    v_mfma_f32_16x16x32_bf16 v[100:103], v[136:139], v[40:43], v[100:103]
    s_waitcnt lgkmcnt(5)
    ds_read_b128 v[36:39], v117 offset:24576
    v_mfma_f32_16x16x32_bf16 v[100:103], v[140:143], v[44:47], v[100:103]
    s_waitcnt lgkmcnt(5)
    ds_read_b128 v[40:43], v118 offset:24576
    v_mul_f32 v92, s50, v92
    v_mfma_f32_16x16x32_bf16 v[100:103], v[144:147], v[48:51], v[100:103]
    s_waitcnt lgkmcnt(5)
    s_add_u32 s51, s33, 12288
    s_and_b32 s51, s51, 0x3fff
    s_lshl_b32 s30, s41, 2
    s_add_u32 s30, s30, s51
    s_add_u32 m0, s30, 65536
    s_add_u32 s30, s71, s51
    s_add_u32 s30, s30, 65536
    buffer_load_dwordx4 v0, s[4:7], s30 offen offset:0 sc1 lds
    ds_read_b128 v[44:47], v119 offset:24576
    v_mfma_f32_16x16x32_bf16 v[100:103], v[148:151], v[52:55], v[100:103]
    s_waitcnt lgkmcnt(5)
    ds_read_b128 v[48:51], v116 offset:28672
    v_mul_f32 v93, s50, v93
    v_mfma_f32_16x16x32_bf16 v[100:103], v[152:155], v[56:59], v[100:103]
    s_waitcnt lgkmcnt(5)
    ds_read_b128 v[52:55], v117 offset:28672
    v_mul_f32 v94, s50, v94
    v_mfma_f32_16x16x32_bf16 v[100:103], v[156:159], v[60:63], v[100:103]
    s_waitcnt lgkmcnt(5)
    buffer_load_dwordx4 v0, s[4:7], s30 offen offset:1024 sc1 lds
    ds_read_b128 v[56:59], v118 offset:28672
    v_mfma_f32_16x16x32_bf16 v[100:103], v[160:163], v[32:35], v[100:103]
    s_waitcnt lgkmcnt(5)
    ds_read_b128 v[60:63], v119 offset:28672
    v_mul_f32 v95, s50, v95
    v_mfma_f32_16x16x32_bf16 v[100:103], v[164:167], v[36:39], v[100:103]
    s_waitcnt lgkmcnt(5)
    ds_read_b128 v[32:35], v116 offset:32768
    v_mfma_f32_16x16x32_bf16 v[100:103], v[168:171], v[40:43], v[100:103]
    s_waitcnt lgkmcnt(5)
    buffer_load_dwordx4 v0, s[4:7], s30 offen offset:2048 sc1 lds
    ds_read_b128 v[36:39], v117 offset:32768
    v_mfma_f32_16x16x32_bf16 v[100:103], v[172:175], v[44:47], v[100:103]
    s_waitcnt lgkmcnt(5)
    ds_read_b128 v[40:43], v118 offset:32768
    v_mfma_f32_16x16x32_bf16 v[100:103], v[176:179], v[48:51], v[100:103]
    s_waitcnt lgkmcnt(5)
    ds_read_b128 v[44:47], v119 offset:32768
    v_mfma_f32_16x16x32_bf16 v[100:103], v[180:183], v[52:55], v[100:103]
    s_waitcnt lgkmcnt(5)
    buffer_load_dwordx4 v0, s[4:7], s30 offen offset:3072 sc1 lds
    ds_read_b128 v[48:51], v116 offset:36864
    v_mfma_f32_16x16x32_bf16 v[100:103], v[184:187], v[56:59], v[100:103]
    s_waitcnt lgkmcnt(5)
    ds_read_b128 v[52:55], v117 offset:36864
    v_mfma_f32_16x16x32_bf16 v[100:103], v[188:191], v[60:63], v[100:103]
    s_waitcnt lgkmcnt(5)
    ds_read_b128 v[56:59], v118 offset:36864
    v_mfma_f32_16x16x32_bf16 v[104:107], v[128:131], v[32:35], 0
    s_waitcnt lgkmcnt(5)
    s_lshl_b32 s30, s25, 13
    s_add_u32 s30, s30, s32
    s_cmp_eq_u32 s24, 1
    s_cselect_b32 s51, 131072, 0
    s_cmp_eq_u32 s24, 2
    s_cselect_b32 s51, 720896, s51
    s_add_u32 s30, s30, s51
    s_cmp_ge_u32 s25, 2
    s_cselect_b32 s51, 2, 9
    s_cmp_eq_u32 s24, s51
    s_cselect_b32 s30, 0x40000000, s30
    s_cmp_eq_u32 s24, 3
    s_cselect_b32 s30, 0x40000000, s30
    s_mov_b32 m0, 163328
    v_lshlrev_b32 v31, 3, v0
    buffer_load_dword v31, s[4:7], s30 offen lds
    ds_read_b128 v[60:63], v119 offset:36864
    v_mfma_f32_16x16x32_bf16 v[104:107], v[132:135], v[36:39], v[104:107]
    s_waitcnt lgkmcnt(5)
    ds_read_b128 v[32:35], v116 offset:40960
    ds_write_b128 v30, v[92:95] offset:2816
    v_fma_f32 v120, v88, v92, s48
    v_fma_f32 v121, v88, v93, s48
    v_fma_f32 v122, v88, v94, s48
    v_fma_f32 v123, v88, v95, s48
    v_fma_f32 v120, v96, v89, v120
    v_fma_f32 v121, v97, v89, v121
    v_fma_f32 v122, v98, v89, v122
    v_fma_f32 v123, v99, v89, v123
    v_exp_f32 v124, v120 clamp
    v_max_f32 v120, s48, v120
    v_exp_f32 v125, v121 clamp
    v_max_f32 v121, s48, v121
    v_exp_f32 v126, v122 clamp
    v_max_f32 v122, s48, v122
    v_exp_f32 v127, v123 clamp
    v_max_f32 v123, s48, v123
    v_fma_f32 v120, v120, s49, v124
    v_fma_f32 v121, v121, s49, v125
    v_fma_f32 v122, v122, s49, v126
    v_fma_f32 v123, v123, s49, v127
    v_cvt_pk_bf16_f32 v64, v120, v121
    v_cvt_pk_bf16_f32 v65, v122, v123
    ds_read_b32 v88, v2 offset:384
    ds_read_b32 v89, v2 offset:640
    v_mfma_f32_16x16x32_bf16 v[104:107], v[136:139], v[40:43], v[104:107]
    s_waitcnt lgkmcnt(8)
    ds_read_b128 v[36:39], v117 offset:40960
    v_mfma_f32_16x16x32_bf16 v[104:107], v[140:143], v[44:47], v[104:107]
    s_waitcnt lgkmcnt(8)
    ds_read_b128 v[40:43], v118 offset:40960
    v_fma_f32 v120, v90, v92, s48
    v_mfma_f32_16x16x32_bf16 v[104:107], v[144:147], v[48:51], v[104:107]
    s_waitcnt lgkmcnt(8)
    ds_read_b128 v[44:47], v119 offset:40960
    v_fma_f32 v121, v90, v93, s48
    v_mfma_f32_16x16x32_bf16 v[104:107], v[148:151], v[52:55], v[104:107]
    s_waitcnt lgkmcnt(8)
    ds_read_b128 v[48:51], v116 offset:45056
    v_fma_f32 v122, v90, v94, s48
    v_mfma_f32_16x16x32_bf16 v[104:107], v[152:155], v[56:59], v[104:107]
    s_waitcnt lgkmcnt(8)
    ds_read_b128 v[52:55], v117 offset:45056
    v_fma_f32 v123, v90, v95, s48
    v_mfma_f32_16x16x32_bf16 v[104:107], v[156:159], v[60:63], v[104:107]
    s_waitcnt lgkmcnt(8)
    ds_read_b128 v[56:59], v118 offset:45056
    v_fma_f32 v120, v100, v91, v120
    v_mfma_f32_16x16x32_bf16 v[104:107], v[160:163], v[32:35], v[104:107]
    s_waitcnt lgkmcnt(5)
    ds_read_b128 v[60:63], v119 offset:45056
    v_fma_f32 v121, v101, v91, v121
    v_mfma_f32_16x16x32_bf16 v[104:107], v[164:167], v[36:39], v[104:107]
    s_waitcnt lgkmcnt(5)
    ds_read_b128 v[32:35], v116 offset:49152
    v_fma_f32 v122, v102, v91, v122
    v_mfma_f32_16x16x32_bf16 v[104:107], v[168:171], v[40:43], v[104:107]
    s_waitcnt lgkmcnt(5)
    ds_read_b128 v[36:39], v117 offset:49152
    v_fma_f32 v123, v103, v91, v123
    v_mfma_f32_16x16x32_bf16 v[104:107], v[172:175], v[44:47], v[104:107]
    s_waitcnt lgkmcnt(5)
    ds_read_b128 v[40:43], v118 offset:49152
    v_exp_f32 v124, v120 clamp
    v_mfma_f32_16x16x32_bf16 v[104:107], v[176:179], v[48:51], v[104:107]
    s_waitcnt lgkmcnt(5)
    ds_read_b128 v[44:47], v119 offset:49152
    v_max_f32 v120, s48, v120
    v_mfma_f32_16x16x32_bf16 v[104:107], v[180:183], v[52:55], v[104:107]
    s_waitcnt lgkmcnt(5)
    ds_read_b128 v[48:51], v116 offset:53248
    v_exp_f32 v125, v121 clamp
    v_mfma_f32_16x16x32_bf16 v[104:107], v[184:187], v[56:59], v[104:107]
    s_waitcnt lgkmcnt(5)
    ds_read_b128 v[52:55], v117 offset:53248
    v_max_f32 v121, s48, v121
    v_mfma_f32_16x16x32_bf16 v[104:107], v[188:191], v[60:63], v[104:107]
    s_waitcnt lgkmcnt(5)
    ds_read_b128 v[56:59], v118 offset:53248
    v_exp_f32 v126, v122 clamp
    v_mfma_f32_16x16x32_bf16 v[108:111], v[128:131], v[32:35], 0
    s_waitcnt lgkmcnt(5)
    ds_read_b128 v[60:63], v119 offset:53248
    v_max_f32 v122, s48, v122
    v_mfma_f32_16x16x32_bf16 v[108:111], v[132:135], v[36:39], v[108:111]
    s_waitcnt lgkmcnt(5)
    ds_read_b128 v[32:35], v116 offset:57344
    v_exp_f32 v127, v123 clamp
    v_max_f32 v123, s48, v123
    v_fma_f32 v120, v120, s49, v124
    v_fma_f32 v121, v121, s49, v125
    v_fma_f32 v122, v122, s49, v126
    v_fma_f32 v123, v123, s49, v127
    v_cvt_pk_bf16_f32 v66, v120, v121
    v_cvt_pk_bf16_f32 v67, v122, v123
    ds_read_b32 v90, v2 offset:448
    ds_read_b32 v91, v2 offset:704
    v_mfma_f32_16x16x32_bf16 v[108:111], v[136:139], v[40:43], v[108:111]
    s_waitcnt lgkmcnt(7)
    ds_read_b128 v[36:39], v117 offset:57344
    v_mfma_f32_16x16x32_bf16 v[108:111], v[140:143], v[44:47], v[108:111]
    s_waitcnt lgkmcnt(7)
    ds_read_b128 v[40:43], v118 offset:57344
    v_fma_f32 v120, v88, v92, s48
    v_mfma_f32_16x16x32_bf16 v[108:111], v[144:147], v[48:51], v[108:111]
    s_waitcnt lgkmcnt(7)
    ds_read_b128 v[44:47], v119 offset:57344
    v_fma_f32 v121, v88, v93, s48
    v_mfma_f32_16x16x32_bf16 v[108:111], v[148:151], v[52:55], v[108:111]
    s_waitcnt lgkmcnt(7)
    ds_read_b128 v[48:51], v116 offset:61440
    v_fma_f32 v122, v88, v94, s48
    v_mfma_f32_16x16x32_bf16 v[108:111], v[152:155], v[56:59], v[108:111]
    s_waitcnt lgkmcnt(7)
    ds_read_b128 v[52:55], v117 offset:61440
    v_fma_f32 v123, v88, v95, s48
    v_mfma_f32_16x16x32_bf16 v[108:111], v[156:159], v[60:63], v[108:111]
    s_waitcnt lgkmcnt(7)
    ds_read_b128 v[56:59], v118 offset:61440
    v_fma_f32 v120, v104, v89, v120
    v_mfma_f32_16x16x32_bf16 v[108:111], v[160:163], v[32:35], v[108:111]
    s_waitcnt lgkmcnt(5)
    ds_read_b128 v[60:63], v119 offset:61440
    v_fma_f32 v121, v105, v89, v121
    v_mfma_f32_16x16x32_bf16 v[108:111], v[164:167], v[36:39], v[108:111]
    s_waitcnt lgkmcnt(5)
    v_fma_f32 v122, v106, v89, v122
    v_fma_f32 v123, v107, v89, v123
    v_mfma_f32_16x16x32_bf16 v[108:111], v[168:171], v[40:43], v[108:111]
    s_waitcnt lgkmcnt(4)
    v_exp_f32 v124, v120 clamp
    v_mfma_f32_16x16x32_bf16 v[108:111], v[172:175], v[44:47], v[108:111]
    s_waitcnt lgkmcnt(3)
    v_max_f32 v120, s48, v120
    v_exp_f32 v125, v121 clamp
    v_mfma_f32_16x16x32_bf16 v[108:111], v[176:179], v[48:51], v[108:111]
    s_waitcnt lgkmcnt(2)
    v_max_f32 v121, s48, v121
    v_exp_f32 v126, v122 clamp
    v_mfma_f32_16x16x32_bf16 v[108:111], v[180:183], v[52:55], v[108:111]
    s_waitcnt lgkmcnt(1)
    v_max_f32 v122, s48, v122
    v_exp_f32 v127, v123 clamp
    v_mfma_f32_16x16x32_bf16 v[108:111], v[184:187], v[56:59], v[108:111]
    s_waitcnt lgkmcnt(0)
    v_max_f32 v123, s48, v123
    v_fma_f32 v120, v120, s49, v124
    v_mfma_f32_16x16x32_bf16 v[108:111], v[188:191], v[60:63], v[108:111]
    v_fma_f32 v121, v121, s49, v125
    v_fma_f32 v122, v122, s49, v126
    v_fma_f32 v123, v123, s49, v127
    v_cvt_pk_bf16_f32 v68, v120, v121
    v_cvt_pk_bf16_f32 v69, v122, v123
    v_pk_fma_f32 v[120:121], v[92:93], v[90:91], s[48:49] op_sel_hi:[1,0,0]
    v_pk_fma_f32 v[122:123], v[94:95], v[90:91], s[48:49] op_sel_hi:[1,0,0]
    s_nop 0
    v_pk_fma_f32 v[120:121], v[108:109], v[90:91], v[120:121] op_sel:[0,1,0] op_sel_hi:[1,1,1]
    v_pk_fma_f32 v[122:123], v[110:111], v[90:91], v[122:123] op_sel:[0,1,0] op_sel_hi:[1,1,1]
    v_exp_f32 v124, v120 clamp
    v_max_f32 v120, s48, v120
    v_exp_f32 v125, v121 clamp
    v_max_f32 v121, s48, v121
    v_exp_f32 v126, v122 clamp
    v_max_f32 v122, s48, v122
    v_exp_f32 v127, v123 clamp
    v_max_f32 v123, s48, v123
    v_pk_fma_f32 v[120:121], v[120:121], s[48:49], v[124:125] op_sel:[0,1,0] op_sel_hi:[1,1,1]
    v_pk_fma_f32 v[122:123], v[122:123], s[48:49], v[126:127] op_sel:[0,1,0] op_sel_hi:[1,1,1]
    v_cvt_pk_bf16_f32 v70, v120, v121
    v_cvt_pk_bf16_f32 v71, v122, v123
    v_mov_b32 v72, 0x358637bd
    v_mov_b32 v73, 0x358637bd
    v_mov_b32 v74, 0x358637bd
    v_mov_b32 v75, 0x358637bd
    s_and_b32 s31, s24, 1
    s_lshl_b32 s31, s31, 11
    s_add_u32 s31, s31, 65536
    v_add_u32 v30, s31, v0
    s_waitcnt vmcnt(1)
    s_barrier
    buffer_load_dword v31, v3, s[4:7], s37 offen offset:0 sc1
    ds_read_b128 v[96:99], v30 offset:0
    ds_read_b128 v[100:103], v30 offset:1024
    ds_read_b128 v[104:107], v30 offset:4096
    ds_read_b128 v[108:111], v30 offset:5120
    ds_read_b128 v[112:115], v30 offset:8192
    ds_read_b128 v[116:119], v30 offset:9216
    ds_read_b128 v[120:123], v30 offset:16384
    ds_read_b128 v[124:127], v30 offset:17408
    ds_read_b128 v[128:131], v30 offset:20480
    ds_read_b128 v[132:135], v30 offset:21504
    ds_read_b128 v[136:139], v30 offset:24576
    ds_read_b128 v[140:143], v30 offset:25600
    s_sleep 6
    s_add_u32 s31, s40, 0
    buffer_load_dwordx4 v[32:35], v0, s[4:7], s31 offen offset:0 sc1
    buffer_load_dwordx4 v[36:39], v0, s[4:7], s31 offen offset:1024 sc1
    buffer_load_dwordx4 v[40:43], v0, s[4:7], s31 offen offset:2048 sc1
    buffer_load_dwordx4 v[44:47], v0, s[4:7], s31 offen offset:3072 sc1
    s_add_u32 s31, s40, 4096
    buffer_load_dwordx4 v[48:51], v0, s[4:7], s31 offen offset:0 sc1
    buffer_load_dwordx4 v[52:55], v0, s[4:7], s31 offen offset:1024 sc1
    buffer_load_dwordx4 v[56:59], v0, s[4:7], s31 offen offset:2048 sc1
    buffer_load_dwordx4 v[60:63], v0, s[4:7], s31 offen offset:3072 sc1
    ds_read_b128 v[144:147], v30 offset:32768
    ds_read_b128 v[148:151], v30 offset:33792
    ds_read_b128 v[152:155], v30 offset:36864
    ds_read_b128 v[156:159], v30 offset:37888
    ds_read_b128 v[160:163], v30 offset:40960
    ds_read_b128 v[164:167], v30 offset:41984
    ds_read_b128 v[168:171], v30 offset:49152
    ds_read_b128 v[172:175], v30 offset:50176
    ds_read_b128 v[176:179], v30 offset:53248
    ds_read_b128 v[180:183], v30 offset:54272
    ds_read_b128 v[184:187], v30 offset:57344
    ds_read_b128 v[188:191], v30 offset:58368
    s_waitcnt vmcnt(7)
    v_lshlrev_b32 v76, 16, v32
    v_and_b32 v77, 0xffff0000, v32
    v_lshlrev_b32 v78, 16, v33
    v_and_b32 v79, 0xffff0000, v33
    v_lshlrev_b32 v80, 16, v34
    v_and_b32 v81, 0xffff0000, v34
    v_xor_b32 v28, s29, v35
    s_waitcnt vmcnt(6)
    v_dot2c_f32_bf16 v76, s46, v36
    v_dot2c_f32_bf16 v77, s47, v36
    v_dot2c_f32_bf16 v78, s46, v37
    v_dot2c_f32_bf16 v79, s47, v37
    v_dot2c_f32_bf16 v80, s46, v38
    v_dot2c_f32_bf16 v81, s47, v38
    v_bitop3_b32 v28, v5, v39, v28 bitop3:0xbe
    s_waitcnt vmcnt(5)
    v_dot2c_f32_bf16 v76, s46, v40
    v_dot2c_f32_bf16 v77, s47, v40
    v_dot2c_f32_bf16 v78, s46, v41
    v_dot2c_f32_bf16 v79, s47, v41
    v_dot2c_f32_bf16 v80, s46, v42
    v_dot2c_f32_bf16 v81, s47, v42
    v_bitop3_b32 v28, v5, v43, v28 bitop3:0xbe
    s_waitcnt vmcnt(4)
    v_dot2c_f32_bf16 v76, s46, v44
    v_dot2c_f32_bf16 v77, s47, v44
    v_dot2c_f32_bf16 v78, s46, v45
    v_dot2c_f32_bf16 v79, s47, v45
    v_dot2c_f32_bf16 v80, s46, v46
    v_dot2c_f32_bf16 v81, s47, v46
    v_bitop3_b32 v28, v5, v47, v28 bitop3:0xbe
    s_waitcnt vmcnt(3)
    v_dot2c_f32_bf16 v76, s46, v48
    v_dot2c_f32_bf16 v77, s47, v48
    v_dot2c_f32_bf16 v78, s46, v49
    v_dot2c_f32_bf16 v79, s47, v49
    v_dot2c_f32_bf16 v80, s46, v50
    v_dot2c_f32_bf16 v81, s47, v50
    v_bitop3_b32 v28, v5, v51, v28 bitop3:0xbe
    s_waitcnt vmcnt(2)
    v_dot2c_f32_bf16 v76, s46, v52
    v_dot2c_f32_bf16 v77, s47, v52
    v_dot2c_f32_bf16 v78, s46, v53
    v_dot2c_f32_bf16 v79, s47, v53
    v_dot2c_f32_bf16 v80, s46, v54
    v_dot2c_f32_bf16 v81, s47, v54
    v_bitop3_b32 v28, v5, v55, v28 bitop3:0xbe
    s_waitcnt vmcnt(1)
    v_dot2c_f32_bf16 v76, s46, v56
    v_dot2c_f32_bf16 v77, s47, v56
    v_dot2c_f32_bf16 v78, s46, v57
    v_dot2c_f32_bf16 v79, s47, v57
    v_dot2c_f32_bf16 v80, s46, v58
    v_dot2c_f32_bf16 v81, s47, v58
    v_bitop3_b32 v28, v5, v59, v28 bitop3:0xbe
    s_waitcnt vmcnt(0)
    v_dot2c_f32_bf16 v76, s46, v60
    v_dot2c_f32_bf16 v77, s47, v60
    v_dot2c_f32_bf16 v78, s46, v61
    v_dot2c_f32_bf16 v79, s47, v61
    v_dot2c_f32_bf16 v80, s46, v62
    v_dot2c_f32_bf16 v81, s47, v62
    v_bitop3_b32 v28, v5, v63, v28 bitop3:0xbe
    v_cmp_ne_u32 s[54:55], 0, v28
    s_nop 1
    s_cmp_lg_u64 s[54:55], 0
    s_cbranch_scc1 Lrare157
Lrare157b:
    v_cvt_pk_bf16_f32 v86, v80, v81
    v_cvt_pk_bf16_f32 v82, v76, v77
    v_cvt_pk_bf16_f32 v83, v78, v79
    v_mov_b32_dpp v84, v86 quad_perm:[0,0,2,2] row_mask:0xf bank_mask:0xf
    v_mov_b32_dpp v85, v86 quad_perm:[1,1,3,3] row_mask:0xf bank_mask:0xf
    s_add_u32 s31, s67, 0
    s_nop 0
    v_mfma_f32_16x16x16_bf16 v[32:35], v[84:85], v[64:65], v[72:75]
    v_mfma_f32_16x16x16_bf16 v[48:51], v[82:83], v[64:65], 0
    v_mfma_f32_16x16x16_bf16 v[36:39], v[84:85], v[66:67], v[72:75]
    v_mfma_f32_16x16x16_bf16 v[52:55], v[82:83], v[66:67], 0
    v_mfma_f32_16x16x16_bf16 v[40:43], v[84:85], v[68:69], v[72:75]
    v_mfma_f32_16x16x16_bf16 v[56:59], v[82:83], v[68:69], 0
    v_mfma_f32_16x16x16_bf16 v[44:47], v[84:85], v[70:71], v[72:75]
    v_mfma_f32_16x16x16_bf16 v[60:63], v[82:83], v[70:71], 0
    s_nop 0
    v_rcp_f32 v32, v32
    s_nop 0
    v_rcp_f32 v36, v36
    v_pk_mul_f32 v[48:49], v[48:49], v[32:33] op_sel_hi:[1,0]
    v_pk_mul_f32 v[50:51], v[50:51], v[32:33] op_sel_hi:[1,0]
    v_cvt_pk_bf16_f32 v88, v48, v49
    v_cvt_pk_bf16_f32 v89, v50, v51
    v_or_b32 v88, 1, v88
    buffer_store_dwordx2 v[88:89], v9, s[4:7], s31 offen sc1
    s_add_u32 s31, s31, 16384
    v_rcp_f32 v40, v40
    v_pk_mul_f32 v[52:53], v[52:53], v[36:37] op_sel_hi:[1,0]
    v_pk_mul_f32 v[54:55], v[54:55], v[36:37] op_sel_hi:[1,0]
    v_cvt_pk_bf16_f32 v90, v52, v53
    v_cvt_pk_bf16_f32 v91, v54, v55
    v_or_b32 v90, 1, v90
    buffer_store_dwordx2 v[90:91], v9, s[4:7], s31 offen sc1
    s_add_u32 s31, s31, 16384
    v_rcp_f32 v44, v44
    v_pk_mul_f32 v[56:57], v[56:57], v[40:41] op_sel_hi:[1,0]
    v_pk_mul_f32 v[58:59], v[58:59], v[40:41] op_sel_hi:[1,0]
    v_cvt_pk_bf16_f32 v92, v56, v57
    v_cvt_pk_bf16_f32 v93, v58, v59
    v_or_b32 v92, 1, v92
    buffer_store_dwordx2 v[92:93], v9, s[4:7], s31 offen sc1
    s_add_u32 s31, s31, 16384
    v_pk_mul_f32 v[60:61], v[60:61], v[44:45] op_sel_hi:[1,0]
    v_pk_mul_f32 v[62:63], v[62:63], v[44:45] op_sel_hi:[1,0]
    v_cvt_pk_bf16_f32 v94, v60, v61
    v_cvt_pk_bf16_f32 v95, v62, v63
    v_or_b32 v94, 1, v94
    buffer_store_dwordx2 v[94:95], v9, s[4:7], s31 offen sc1
    ds_read_b128 v[64:67], v30 offset:12288
    ds_read_b128 v[68:71], v30 offset:13312
    ds_read_b128 v[72:75], v30 offset:28672
    ds_read_b128 v[76:79], v30 offset:29696
    ds_read_b128 v[80:83], v30 offset:45056
    ds_read_b128 v[84:87], v30 offset:46080
    ds_read_b128 v[88:91], v30 offset:61440
    ds_read_b128 v[92:95], v30 offset:62464
    v_cmp_ne_u32 vcc, s29, v31
    s_cbranch_vccnz Lrare167
Lrare167b:
Lpf169:
    s_sub_u32 s66, s66, 1
    s_cbranch_scc1 Lbail
    v_lshrrev_b32 v34, 2, v0
    s_lshl_b32 s31, s25, 9
    s_add_u32 s31, s31, 8192
    buffer_load_dword v32, v34, s[4:7], s31 offen offset:128 sc1
    buffer_load_dword v33, v3, s[4:7], s31 offen offset:364 sc1
    s_waitcnt vmcnt(0)
    v_cmp_ne_u32 vcc, s29, v32
    v_cmp_ne_u32 s[56:57], s29, v33
    s_nop 0
    s_or_b64 vcc, vcc, s[56:57]
    s_cbranch_vccnz Lpf169
    s_add_u32 s51, s33, 0
    s_and_b32 s51, s51, 0x3fff
    s_lshl_b32 s30, s41, 3
    s_add_u32 s30, s30, s51
    s_add_u32 s30, s30, s72
    s_add_u32 s30, s30, 0
    buffer_load_dwordx4 a[0:3], v0, s[4:7], s30 offen offset:0 sc1
    buffer_load_dwordx4 a[4:7], v0, s[4:7], s30 offen offset:1024 sc1
    buffer_load_dwordx4 a[8:11], v0, s[4:7], s30 offen offset:2048 sc1
    buffer_load_dwordx4 a[12:15], v0, s[4:7], s30 offen offset:3072 sc1
    s_add_u32 s51, s33, 0
    s_and_b32 s51, s51, 0x3fff
    s_lshl_b32 s30, s41, 3
    s_add_u32 s30, s30, s51
    s_add_u32 s30, s30, s72
    s_add_u32 s30, s30, 16384
    buffer_load_dwordx4 a[64:67], v0, s[4:7], s30 offen offset:0 sc1
    buffer_load_dwordx4 a[68:71], v0, s[4:7], s30 offen offset:1024 sc1
    buffer_load_dwordx4 a[72:75], v0, s[4:7], s30 offen offset:2048 sc1
    buffer_load_dwordx4 a[76:79], v0, s[4:7], s30 offen offset:3072 sc1
    s_add_u32 s51, s33, 0
    s_and_b32 s51, s51, 0x3fff
    s_lshl_b32 s30, s41, 2
    s_add_u32 s30, s30, s51
    s_add_u32 s30, s30, s72
    s_add_u32 s30, s30, 131072
    buffer_load_dwordx4 a[128:131], v0, s[4:7], s30 offen offset:0 sc1
    buffer_load_dwordx4 a[132:135], v0, s[4:7], s30 offen offset:1024 sc1
    buffer_load_dwordx4 a[136:139], v0, s[4:7], s30 offen offset:2048 sc1
    buffer_load_dwordx4 a[140:143], v0, s[4:7], s30 offen offset:3072 sc1
    s_add_u32 s51, s33, 4096
    s_and_b32 s51, s51, 0x3fff
    s_lshl_b32 s30, s41, 3
    s_add_u32 s30, s30, s51
    s_add_u32 s30, s30, s72
    s_add_u32 s30, s30, 0
    buffer_load_dwordx4 a[16:19], v0, s[4:7], s30 offen offset:0 sc1
    buffer_load_dwordx4 a[20:23], v0, s[4:7], s30 offen offset:1024 sc1
    buffer_load_dwordx4 a[24:27], v0, s[4:7], s30 offen offset:2048 sc1
    buffer_load_dwordx4 a[28:31], v0, s[4:7], s30 offen offset:3072 sc1
    s_waitcnt lgkmcnt(0)
    s_barrier
    v_lshlrev_b32 v28, 7, v3
    v_and_b32 v28, 0x3c00, v28
    v_and_b32 v29, 4, v3
    v_lshl_add_u32 v28, v29, 1, v28
    s_add_u32 s31, s32, 49152
Lop170:
    s_sub_u32 s66, s66, 1
    s_cbranch_scc1 Lbail
    buffer_load_dword v31, v28, s[4:7], s31 offen offset:1008 sc1
    s_waitcnt vmcnt(0)
    v_and_b32 v31, 1, v31
    v_cmp_ne_u32 vcc, 1, v31
    s_cbranch_vccnz Lop170
    s_add_u32 m0, s42, 65536
    s_add_u32 s31, s38, 0
    buffer_load_dwordx4 v0, s[4:7], s31 offen offset:0 sc1 lds
    buffer_load_dwordx4 v0, s[4:7], s31 offen offset:1024 sc1 lds
    buffer_load_dwordx4 v0, s[4:7], s31 offen offset:2048 sc1 lds
    buffer_load_dwordx4 v0, s[4:7], s31 offen offset:3072 sc1 lds
    s_add_u32 m0, s42, 73728
    s_add_u32 s31, s38, 8192
    buffer_load_dwordx4 v0, s[4:7], s31 offen offset:0 sc1 lds
    buffer_load_dwordx4 v0, s[4:7], s31 offen offset:1024 sc1 lds
    buffer_load_dwordx4 v0, s[4:7], s31 offen offset:2048 sc1 lds
    buffer_load_dwordx4 v0, s[4:7], s31 offen offset:3072 sc1 lds
    s_add_u32 m0, s42, 98304
    s_add_u32 s31, s38, 32768
    buffer_load_dwordx4 v0, s[4:7], s31 offen offset:0 sc1 lds
    buffer_load_dwordx4 v0, s[4:7], s31 offen offset:1024 sc1 lds
    buffer_load_dwordx4 v0, s[4:7], s31 offen offset:2048 sc1 lds
    buffer_load_dwordx4 v0, s[4:7], s31 offen offset:3072 sc1 lds
    s_add_u32 m0, s42, 106496
    s_add_u32 s31, s38, 40960
    buffer_load_dwordx4 v0, s[4:7], s31 offen offset:0 sc1 lds
    buffer_load_dwordx4 v0, s[4:7], s31 offen offset:1024 sc1 lds
    buffer_load_dwordx4 v0, s[4:7], s31 offen offset:2048 sc1 lds
    buffer_load_dwordx4 v0, s[4:7], s31 offen offset:3072 sc1 lds
    s_and_b32 s31, s42, 0x4000
    s_add_u32 s31, s31, 65536
    v_add_u32 v30, s31, v0
    s_add_u32 s31, s42, 65536
    v_add_u32 v28, s31, v0
    v_add_u32 v29, 8, v28
    s_waitcnt vmcnt(12)
    ds_read_b128 v[32:35], v28 offset:0
    ds_read_b128 v[36:39], v28 offset:1024
    ds_read_b128 v[40:43], v28 offset:2048
    ds_read_b128 v[44:47], v28 offset:3072
    s_waitcnt vmcnt(8)
    ds_read_b128 v[48:51], v28 offset:8192
    ds_read_b128 v[52:55], v28 offset:9216
    ds_read_b128 v[56:59], v28 offset:10240
    ds_read_b128 v[60:63], v28 offset:11264
    s_waitcnt lgkmcnt(6)
    v_bitop3_b32 v32, v32, v34, v36 bitop3:0x80
    s_waitcnt lgkmcnt(5)
    v_bitop3_b32 v38, v38, v40, v42 bitop3:0x80
    s_waitcnt lgkmcnt(4)
    v_bitop3_b32 v32, v32, v38, v44 bitop3:0x80
    v_bitop3_b32 v32, v32, v46, 1 bitop3:0x80
    v_cmp_ne_u32 s[56:57], 1, v32
    s_nop 1
    s_cmp_lg_u64 s[56:57], 0
    s_cbranch_scc1 Lrare171
Lrare171b:
    s_waitcnt lgkmcnt(2)
    v_bitop3_b32 v48, v48, v50, v52 bitop3:0x80
    s_waitcnt lgkmcnt(1)
    v_bitop3_b32 v54, v54, v56, v58 bitop3:0x80
    s_waitcnt lgkmcnt(0)
    v_bitop3_b32 v48, v48, v54, v60 bitop3:0x80
    v_bitop3_b32 v48, v48, v62, 1 bitop3:0x80
    v_cmp_ne_u32 s[56:57], 1, v48
    s_nop 1
    s_cmp_lg_u64 s[56:57], 0
    s_cbranch_scc1 Lrare173
Lrare173b:
    s_barrier
    ds_read_b128 v[32:35], v30 offset:0
    ds_read_b128 v[36:39], v30 offset:1024
    ds_read_b128 v[40:43], v30 offset:2048
    ds_read_b128 v[44:47], v30 offset:3072
    ds_read_b128 v[48:51], v30 offset:4096
    s_waitcnt lgkmcnt(4)
    v_mfma_f32_16x16x32_bf16 v[12:15], v[96:99], v[32:35], v[12:15]
    s_waitcnt vmcnt(4)
    ds_read2st64_b32 v[56:57], v28 offset0:128 offset1:132
    ds_read2st64_b32 v[58:59], v29 offset0:128 offset1:132
    v_mfma_f32_16x16x32_bf16 v[16:19], v[100:103], v[32:35], v[16:19]
    s_waitcnt lgkmcnt(5)
    ds_read_b128 v[52:55], v30 offset:5120
    ds_read2st64_b32 v[60:61], v28 offset0:136 offset1:140
    v_mfma_f32_16x16x32_bf16 v[12:15], v[104:107], v[36:39], v[12:15]
    ds_read2st64_b32 v[62:63], v29 offset0:136 offset1:140
    v_mfma_f32_16x16x32_bf16 v[16:19], v[108:111], v[36:39], v[16:19]
    s_waitcnt lgkmcnt(7)
    ds_read_b128 v[32:35], v30 offset:6144
    v_mfma_f32_16x16x32_bf16 v[12:15], v[112:115], v[40:43], v[12:15]
    v_mfma_f32_16x16x32_bf16 v[16:19], v[116:119], v[40:43], v[16:19]
    s_waitcnt lgkmcnt(7)
    ds_read_b128 v[36:39], v30 offset:7168
    v_mfma_f32_16x16x32_bf16 v[12:15], v[64:67], v[44:47], v[12:15]
    s_waitcnt lgkmcnt(5)
    v_bitop3_b32 v56, v56, v57, v58 bitop3:0x80
    v_mfma_f32_16x16x32_bf16 v[16:19], v[68:71], v[44:47], v[16:19]
    ds_read_b128 v[40:43], v30 offset:8192
    s_waitcnt lgkmcnt(4)
    v_bitop3_b32 v59, v59, v60, v61 bitop3:0x80
    s_waitcnt lgkmcnt(3)
    v_bitop3_b32 v56, v56, v59, v62 bitop3:0x80
    v_bitop3_b32 v56, v56, v63, 1 bitop3:0x80
    v_cmp_ne_u32 s[56:57], 1, v56
    v_mfma_f32_16x16x32_bf16 v[12:15], v[120:123], v[48:51], v[12:15]
    v_mfma_f32_16x16x32_bf16 v[16:19], v[124:127], v[48:51], v[16:19]
    ds_read_b128 v[44:47], v30 offset:9216
    v_mfma_f32_16x16x32_bf16 v[12:15], v[128:131], v[52:55], v[12:15]
    s_cmp_lg_u64 s[56:57], 0
    s_cbranch_scc1 Lrare175
Lrare175b:
    s_waitcnt vmcnt(0)
    v_mfma_f32_16x16x32_bf16 v[16:19], v[132:135], v[52:55], v[16:19]
    s_waitcnt lgkmcnt(3)
    ds_read_b128 v[48:51], v30 offset:10240
    ds_read2st64_b32 v[56:57], v28 offset0:160 offset1:164
    v_mfma_f32_16x16x32_bf16 v[12:15], v[136:139], v[32:35], v[12:15]
    ds_read2st64_b32 v[58:59], v29 offset0:160 offset1:164
    ds_read2st64_b32 v[60:61], v28 offset0:168 offset1:172
    v_mfma_f32_16x16x32_bf16 v[16:19], v[140:143], v[32:35], v[16:19]
    s_waitcnt lgkmcnt(6)
    ds_read_b128 v[52:55], v30 offset:11264
    ds_read2st64_b32 v[62:63], v29 offset0:168 offset1:172
    v_mfma_f32_16x16x32_bf16 v[12:15], v[72:75], v[36:39], v[12:15]
    v_mfma_f32_16x16x32_bf16 v[16:19], v[76:79], v[36:39], v[16:19]
    s_waitcnt lgkmcnt(7)
    ds_read_b128 v[32:35], v30 offset:12288
    v_mfma_f32_16x16x32_bf16 v[12:15], v[144:147], v[40:43], v[12:15]
    v_mfma_f32_16x16x32_bf16 v[16:19], v[148:151], v[40:43], v[16:19]
    s_waitcnt lgkmcnt(7)
    ds_read_b128 v[36:39], v30 offset:13312
    v_mfma_f32_16x16x32_bf16 v[12:15], v[152:155], v[44:47], v[12:15]
    s_waitcnt lgkmcnt(5)
    v_bitop3_b32 v56, v56, v57, v58 bitop3:0x80
    v_mfma_f32_16x16x32_bf16 v[16:19], v[156:159], v[44:47], v[16:19]
    ds_read_b128 v[40:43], v30 offset:14336
    s_waitcnt lgkmcnt(5)
    v_bitop3_b32 v59, v59, v60, v61 bitop3:0x80
    s_waitcnt lgkmcnt(3)
    v_bitop3_b32 v56, v56, v59, v62 bitop3:0x80
    v_bitop3_b32 v56, v56, v63, 1 bitop3:0x80
    v_cmp_ne_u32 s[56:57], 1, v56
    v_mfma_f32_16x16x32_bf16 v[12:15], v[160:163], v[48:51], v[12:15]
    s_lshl_b32 s30, s24, 3
    s_add_u32 s30, s30, s25
    s_cmp_ge_u32 s30, 22
    s_cselect_b32 s51, 0x40000000, s32
    s_lshl_b32 s30, s30, 13
    s_add_u32 s30, s30, s51
    s_add_u32 s30, s30, 327680
    s_mov_b32 m0, 163328
    v_mfma_f32_16x16x32_bf16 v[16:19], v[164:167], v[48:51], v[16:19]
    ds_read_b128 v[44:47], v30 offset:15360
    v_lshlrev_b32 v31, 3, v0
    v_mfma_f32_16x16x32_bf16 v[12:15], v[80:83], v[52:55], v[12:15]
    s_cmp_lg_u64 s[56:57], 0
    s_cbranch_scc1 Lrare177
Lrare177b:
    s_barrier
    v_mfma_f32_16x16x32_bf16 v[16:19], v[84:87], v[52:55], v[16:19]
    s_waitcnt lgkmcnt(3)
    ds_read_b128 v[48:51], v30 offset:32768
    v_mfma_f32_16x16x32_bf16 v[12:15], v[168:171], v[32:35], v[12:15]
    buffer_load_dword v31, s[4:7], s30 offen lds
    v_mfma_f32_16x16x32_bf16 v[16:19], v[172:175], v[32:35], v[16:19]
    s_waitcnt lgkmcnt(3)
    ds_read_b128 v[52:55], v30 offset:33792
    s_add_u32 s51, s33, 4096
    v_mfma_f32_16x16x32_bf16 v[12:15], v[176:179], v[36:39], v[12:15]
    s_and_b32 s51, s51, 0x3fff
    s_lshl_b32 s30, s41, 3
    s_add_u32 s30, s30, s51
    v_mfma_f32_16x16x32_bf16 v[16:19], v[180:183], v[36:39], v[16:19]
    s_waitcnt lgkmcnt(3)
    ds_read_b128 v[32:35], v30 offset:34816
    s_add_u32 s30, s30, s72
    v_mfma_f32_16x16x32_bf16 v[12:15], v[184:187], v[40:43], v[12:15]
    s_add_u32 s30, s30, 16384
    buffer_load_dwordx4 a[80:83], v0, s[4:7], s30 offen offset:0 sc1
    v_mfma_f32_16x16x32_bf16 v[16:19], v[188:191], v[40:43], v[16:19]
    s_waitcnt lgkmcnt(3)
    ds_read_b128 v[36:39], v30 offset:35840
    v_mfma_f32_16x16x32_bf16 v[12:15], v[88:91], v[44:47], v[12:15]
    v_mfma_f32_16x16x32_bf16 v[16:19], v[92:95], v[44:47], v[16:19]
    s_waitcnt lgkmcnt(3)
    ds_read_b128 v[40:43], v30 offset:36864
    v_mfma_f32_16x16x32_bf16 v[20:23], v[96:99], v[48:51], v[20:23]
    buffer_load_dwordx4 a[84:87], v0, s[4:7], s30 offen offset:1024 sc1
    v_mfma_f32_16x16x32_bf16 v[24:27], v[100:103], v[48:51], v[24:27]
    s_waitcnt lgkmcnt(3)
    ds_read_b128 v[44:47], v30 offset:37888
    v_mfma_f32_16x16x32_bf16 v[20:23], v[104:107], v[52:55], v[20:23]
    v_mfma_f32_16x16x32_bf16 v[24:27], v[108:111], v[52:55], v[24:27]
    s_waitcnt lgkmcnt(3)
    ds_read_b128 v[48:51], v30 offset:38912
    v_cvt_pk_bf16_f32 v96, v12, v13
    v_mfma_f32_16x16x32_bf16 v[20:23], v[112:115], v[32:35], v[20:23]
    v_cvt_pk_bf16_f32 v97, v14, v15
    v_cvt_pk_bf16_f32 v98, v16, v17
    v_mfma_f32_16x16x32_bf16 v[24:27], v[116:119], v[32:35], v[24:27]
    s_waitcnt lgkmcnt(3)
    ds_read_b128 v[52:55], v30 offset:39936
    v_cvt_pk_bf16_f32 v99, v18, v19
    v_mfma_f32_16x16x32_bf16 v[20:23], v[64:67], v[36:39], v[20:23]
    v_or_b32 v96, 1, v96
    v_or_b32 v98, 1, v98
    v_mfma_f32_16x16x32_bf16 v[24:27], v[68:71], v[36:39], v[24:27]
    s_waitcnt lgkmcnt(3)
    ds_read_b128 v[32:35], v30 offset:40960
    s_add_u32 s35, s43, 131072
    v_mfma_f32_16x16x32_bf16 v[20:23], v[120:123], v[40:43], v[20:23]
    s_barrier
    buffer_store_dwordx4 v[96:99], v0, s[4:7], s35 offen sc1
    v_mfma_f32_16x16x32_bf16 v[24:27], v[124:127], v[40:43], v[24:27]
    s_waitcnt lgkmcnt(3)
    ds_read_b128 v[36:39], v30 offset:41984
    v_mfma_f32_16x16x32_bf16 v[20:23], v[128:131], v[44:47], v[20:23]
    buffer_load_dwordx4 a[88:91], v0, s[4:7], s30 offen offset:2048 sc1
    v_mfma_f32_16x16x32_bf16 v[24:27], v[132:135], v[44:47], v[24:27]
    s_waitcnt lgkmcnt(3)
    ds_read_b128 v[40:43], v30 offset:43008
    v_mfma_f32_16x16x32_bf16 v[20:23], v[136:139], v[48:51], v[20:23]
    v_add_f32 v104, v12, v13
    v_mul_f32 v105, v12, v12
    v_mfma_f32_16x16x32_bf16 v[24:27], v[140:143], v[48:51], v[24:27]
    s_waitcnt lgkmcnt(3)
    ds_read_b128 v[44:47], v30 offset:44032
    v_fmac_f32 v105, v13, v13
    v_mfma_f32_16x16x32_bf16 v[20:23], v[72:75], v[52:55], v[20:23]
    buffer_load_dwordx4 a[92:95], v0, s[4:7], s30 offen offset:3072 sc1
    v_mfma_f32_16x16x32_bf16 v[24:27], v[76:79], v[52:55], v[24:27]
    s_waitcnt lgkmcnt(3)
    ds_read_b128 v[48:51], v30 offset:45056
    s_add_u32 s51, s33, 4096
    v_mfma_f32_16x16x32_bf16 v[20:23], v[144:147], v[32:35], v[20:23]
    s_and_b32 s51, s51, 0x3fff
    s_lshl_b32 s30, s41, 2
    s_add_u32 s30, s30, s51
    v_mfma_f32_16x16x32_bf16 v[24:27], v[148:151], v[32:35], v[24:27]
    s_waitcnt lgkmcnt(3)
    ds_read_b128 v[52:55], v30 offset:46080
    s_add_u32 s30, s30, s72
    v_mfma_f32_16x16x32_bf16 v[20:23], v[152:155], v[36:39], v[20:23]
    s_add_u32 s30, s30, 131072
    buffer_load_dwordx4 a[144:147], v0, s[4:7], s30 offen offset:0 sc1
    v_mfma_f32_16x16x32_bf16 v[24:27], v[156:159], v[36:39], v[24:27]
    s_waitcnt lgkmcnt(3)
    ds_read_b128 v[32:35], v30 offset:47104
    v_add_f32 v104, v104, v14
    v_mfma_f32_16x16x32_bf16 v[20:23], v[160:163], v[40:43], v[20:23]
    v_fmac_f32 v105, v14, v14
    v_add_f32 v104, v104, v15
    v_mfma_f32_16x16x32_bf16 v[24:27], v[164:167], v[40:43], v[24:27]
    s_waitcnt lgkmcnt(3)
    ds_read_b128 v[36:39], v30 offset:48128
    v_fmac_f32 v105, v15, v15
    v_mfma_f32_16x16x32_bf16 v[20:23], v[80:83], v[44:47], v[20:23]
    buffer_load_dwordx4 a[148:151], v0, s[4:7], s30 offen offset:1024 sc1
    v_mfma_f32_16x16x32_bf16 v[24:27], v[84:87], v[44:47], v[24:27]
    s_waitcnt lgkmcnt(3)
    v_add_f32 v104, v104, v16
    v_fmac_f32 v105, v16, v16
    v_mfma_f32_16x16x32_bf16 v[20:23], v[168:171], v[48:51], v[20:23]
    v_add_f32 v104, v104, v17
    v_fmac_f32 v105, v17, v17
    v_mfma_f32_16x16x32_bf16 v[24:27], v[172:175], v[48:51], v[24:27]
    s_waitcnt lgkmcnt(2)
    v_add_f32 v104, v104, v18
    v_fmac_f32 v105, v18, v18
    v_mfma_f32_16x16x32_bf16 v[20:23], v[176:179], v[52:55], v[20:23]
    buffer_load_dwordx4 a[152:155], v0, s[4:7], s30 offen offset:2048 sc1
    v_mfma_f32_16x16x32_bf16 v[24:27], v[180:183], v[52:55], v[24:27]
    s_waitcnt lgkmcnt(1)
    v_add_f32 v104, v104, v19
    v_fmac_f32 v105, v19, v19
    v_mfma_f32_16x16x32_bf16 v[20:23], v[184:187], v[32:35], v[20:23]
    s_add_u32 s35, s44, 720896
    v_permlane16_swap_b32 v104, v105
    v_add_f32 v104, v104, v105
    v_mfma_f32_16x16x32_bf16 v[24:27], v[188:191], v[32:35], v[24:27]
    s_waitcnt lgkmcnt(0)
    v_mov_b32 v105, v104
    s_nop 1
    v_permlane32_swap_b32 v104, v105
    v_mfma_f32_16x16x32_bf16 v[20:23], v[88:91], v[36:39], v[20:23]
    buffer_load_dwordx4 a[156:159], v0, s[4:7], s30 offen offset:3072 sc1
    v_mfma_f32_16x16x32_bf16 v[24:27], v[92:95], v[36:39], v[24:27]
    s_add_u32 s51, s33, 8192
    s_and_b32 s51, s51, 0x3fff
    s_lshl_b32 s30, s41, 3
    s_add_u32 s30, s30, s51
    s_add_u32 s30, s30, s72
    s_add_u32 s30, s30, 0
    buffer_load_dwordx4 a[32:35], v0, s[4:7], s30 offen offset:0 sc1
    buffer_load_dwordx4 a[36:39], v0, s[4:7], s30 offen offset:1024 sc1
    v_add_f32 v104, v104, v105
    v_or_b32 v104, 1, v104
    buffer_store_dword v104, v7, s[4:7], s35 offen sc1
    v_cvt_pk_bf16_f32 v100, v20, v21
    v_cvt_pk_bf16_f32 v101, v22, v23
    v_cvt_pk_bf16_f32 v102, v24, v25
    v_cvt_pk_bf16_f32 v103, v26, v27
    v_or_b32 v100, 1, v100
    v_or_b32 v102, 1, v102
    s_add_u32 s31, s43, 163840
    buffer_store_dwordx4 v[100:103], v0, s[4:7], s31 offen sc1
    v_dot2_f32_bf16 v28, v100, s45, 0
    v_dot2_f32_bf16 v29, v100, v100, 0
    v_dot2_f32_bf16 v28, v101, s45, v28
    v_dot2_f32_bf16 v29, v101, v101, v29
    v_dot2_f32_bf16 v28, v102, s45, v28
    v_dot2_f32_bf16 v29, v102, v102, v29
    v_dot2_f32_bf16 v28, v103, s45, v28
    v_dot2_f32_bf16 v29, v103, v103, v29
    s_add_u32 s31, s44, 724992
    s_nop 1
    v_permlane16_swap_b32 v28, v29
    v_add_f32 v28, v28, v29
    v_mov_b32 v29, v28
    s_nop 1
    v_permlane32_swap_b32 v28, v29
    v_add_f32 v28, v28, v29
    v_or_b32 v28, 1, v28
    buffer_store_dword v28, v7, s[4:7], s31 offen sc1
    s_add_u32 m0, s41, 65536
    s_add_u32 s31, s34, 131072
    buffer_load_dwordx4 v0, s[4:7], s31 offen offset:0 sc1 lds
    buffer_load_dwordx4 v0, s[4:7], s31 offen offset:1024 sc1 lds
    buffer_load_dwordx4 v0, s[4:7], s31 offen offset:2048 sc1 lds
    buffer_load_dwordx4 v0, s[4:7], s31 offen offset:3072 sc1 lds
    s_add_u32 m0, s41, 81920
    s_add_u32 s31, s34, 147456
    buffer_load_dwordx4 v0, s[4:7], s31 offen offset:0 sc1 lds
    buffer_load_dwordx4 v0, s[4:7], s31 offen offset:1024 sc1 lds
    buffer_load_dwordx4 v0, s[4:7], s31 offen offset:2048 sc1 lds
    buffer_load_dwordx4 v0, s[4:7], s31 offen offset:3072 sc1 lds
    s_add_u32 s51, s33, 8192
    s_and_b32 s51, s51, 0x3fff
    s_lshl_b32 s30, s41, 3
    s_add_u32 s30, s30, s51
    s_add_u32 s30, s30, s72
    s_add_u32 s30, s30, 0
    buffer_load_dwordx4 a[40:43], v0, s[4:7], s30 offen offset:2048 sc1
    buffer_load_dwordx4 a[44:47], v0, s[4:7], s30 offen offset:3072 sc1
    s_add_u32 s51, s33, 8192
    s_and_b32 s51, s51, 0x3fff
    s_lshl_b32 s30, s41, 3
    s_add_u32 s30, s30, s51
    s_add_u32 s30, s30, s72
    s_add_u32 s30, s30, 16384
    buffer_load_dwordx4 a[96:99], v0, s[4:7], s30 offen offset:0 sc1
    buffer_load_dwordx4 a[100:103], v0, s[4:7], s30 offen offset:1024 sc1
    buffer_load_dwordx4 a[104:107], v0, s[4:7], s30 offen offset:2048 sc1
    buffer_load_dwordx4 a[108:111], v0, s[4:7], s30 offen offset:3072 sc1
    s_add_u32 s51, s33, 8192
    s_and_b32 s51, s51, 0x3fff
    s_lshl_b32 s30, s41, 2
    s_add_u32 s30, s30, s51
    s_add_u32 s30, s30, s72
    s_add_u32 s30, s30, 131072
    buffer_load_dwordx4 a[160:163], v0, s[4:7], s30 offen offset:0 sc1
    buffer_load_dwordx4 a[164:167], v0, s[4:7], s30 offen offset:1024 sc1
    buffer_load_dwordx4 a[168:171], v0, s[4:7], s30 offen offset:2048 sc1
    buffer_load_dwordx4 a[172:175], v0, s[4:7], s30 offen offset:3072 sc1
    s_mul_i32 s31, s24, 192
    v_add_u32 v30, s31, v1
    s_add_u32 s31, s41, 65536
    v_add_u32 v28, s31, v0
    v_add_u32 v94, 65536, v0
    s_waitcnt vmcnt(14)
    ds_read_b128 v[128:131], v28 offset:0
    ds_read_b128 v[132:135], v28 offset:1024
    ds_read_b128 v[136:139], v28 offset:2048
    ds_read_b128 v[140:143], v28 offset:3072
    s_waitcnt lgkmcnt(2)
    v_bitop3_b32 v128, v128, v130, v132 bitop3:0x80
    s_waitcnt lgkmcnt(1)
    v_bitop3_b32 v134, v134, v136, v138 bitop3:0x80
    s_waitcnt lgkmcnt(0)
    v_bitop3_b32 v128, v128, v134, v140 bitop3:0x80
    v_bitop3_b32 v128, v128, v142, 1 bitop3:0x80
    v_cmp_ne_u32 s[56:57], 1, v128
    s_nop 1
    s_cmp_lg_u64 s[56:57], 0
    s_cbranch_scc1 Lrare179
Lrare179b:
    v_mov_b32 v164, s45
    v_mov_b32 v165, s45
    v_mov_b32 v166, s45
    v_mov_b32 v167, s45
    s_barrier
    ds_read_b128 v[32:35], v94 offset:0
    ds_read_b128 v[36:39], v94 offset:1024
    ds_read_b128 v[40:43], v94 offset:2048
    ds_read_b128 v[44:47], v94 offset:3072
    ds_read_b128 v[48:51], v94 offset:4096
    s_waitcnt lgkmcnt(4)
    v_mfma_f32_16x16x32_bf16 v[56:59], a[0:3], v[32:35], 0
    s_add_u32 s51, s33, 12288
    s_and_b32 s51, s51, 0x3fff
    s_lshl_b32 s30, s41, 3
    v_mfma_f32_16x16x32_bf16 v[60:63], a[64:67], v[32:35], 0
    s_add_u32 s30, s30, s51
    s_add_u32 s30, s30, s72
    s_add_u32 s30, s30, 0
    v_mfma_f32_16x16x32_bf16 v[64:67], a[128:131], v[32:35], 0
    ds_read_b128 v[52:55], v94 offset:5120
    v_mfma_f32_16x16x32_bf16 v[80:83], a[0:3], v[164:167], 0
    buffer_load_dwordx4 a[48:51], v0, s[4:7], s30 offen offset:0 sc1
    v_mfma_f32_16x16x32_bf16 v[84:87], a[64:67], v[164:167], 0
    v_mfma_f32_16x16x32_bf16 v[88:91], a[128:131], v[164:167], 0
    s_waitcnt lgkmcnt(4)
    v_mfma_f32_16x16x32_bf16 v[56:59], a[4:7], v[36:39], v[56:59]
    s_waitcnt vmcnt(11)
    ds_read_b128 v[128:131], v28 offset:16384
    ds_read_b128 v[132:135], v28 offset:17408
    v_mfma_f32_16x16x32_bf16 v[60:63], a[68:71], v[36:39], v[60:63]
    ds_read_b128 v[136:139], v28 offset:18432
    ds_read_b128 v[140:143], v28 offset:19456
    v_mfma_f32_16x16x32_bf16 v[64:67], a[132:135], v[36:39], v[64:67]
    ds_read_b128 v[32:35], v94 offset:6144
    v_mfma_f32_16x16x32_bf16 v[80:83], a[4:7], v[164:167], v[80:83]
    buffer_load_dwordx4 a[52:55], v0, s[4:7], s30 offen offset:1024 sc1
    v_mfma_f32_16x16x32_bf16 v[84:87], a[68:71], v[164:167], v[84:87]
    s_add_u32 s51, s33, 12288
    s_and_b32 s51, s51, 0x3fff
    s_lshl_b32 s30, s41, 3
    v_mfma_f32_16x16x32_bf16 v[88:91], a[132:135], v[164:167], v[88:91]
    s_waitcnt lgkmcnt(8)
    s_add_u32 s30, s30, s51
    s_add_u32 s30, s30, s72
    v_mfma_f32_16x16x32_bf16 v[56:59], a[8:11], v[40:43], v[56:59]
    s_add_u32 s30, s30, 0
    v_mfma_f32_16x16x32_bf16 v[60:63], a[72:75], v[40:43], v[60:63]
    buffer_load_dwordx4 a[56:59], v0, s[4:7], s30 offen offset:2048 sc1
    v_mfma_f32_16x16x32_bf16 v[64:67], a[136:139], v[40:43], v[64:67]
    ds_read_b128 v[36:39], v94 offset:7168
    v_mfma_f32_16x16x32_bf16 v[80:83], a[8:11], v[164:167], v[80:83]
    s_waitcnt lgkmcnt(4)
    v_bitop3_b32 v128, v128, v130, v132 bitop3:0x80
    v_mfma_f32_16x16x32_bf16 v[84:87], a[72:75], v[164:167], v[84:87]
    s_waitcnt lgkmcnt(3)
    v_bitop3_b32 v134, v134, v136, v138 bitop3:0x80
    v_mfma_f32_16x16x32_bf16 v[88:91], a[136:139], v[164:167], v[88:91]
    buffer_load_dwordx4 a[60:63], v0, s[4:7], s30 offen offset:3072 sc1
    v_mfma_f32_16x16x32_bf16 v[56:59], a[12:15], v[44:47], v[56:59]
    s_add_u32 s51, s33, 12288
    s_and_b32 s51, s51, 0x3fff
    s_lshl_b32 s30, s41, 3
    v_mfma_f32_16x16x32_bf16 v[60:63], a[76:79], v[44:47], v[60:63]
    s_add_u32 s30, s30, s51
    s_add_u32 s30, s30, s72
    s_add_u32 s30, s30, 16384
    v_mfma_f32_16x16x32_bf16 v[64:67], a[140:143], v[44:47], v[64:67]
    ds_read_b128 v[40:43], v94 offset:8192
    v_mfma_f32_16x16x32_bf16 v[80:83], a[12:15], v[164:167], v[80:83]
    buffer_load_dwordx4 a[112:115], v0, s[4:7], s30 offen offset:0 sc1
    v_mfma_f32_16x16x32_bf16 v[84:87], a[76:79], v[164:167], v[84:87]
    s_waitcnt lgkmcnt(3)
    v_bitop3_b32 v128, v128, v134, v140 bitop3:0x80
    v_bitop3_b32 v128, v128, v142, 1 bitop3:0x80
    v_mfma_f32_16x16x32_bf16 v[88:91], a[140:143], v[164:167], v[88:91]
    v_cmp_ne_u32 s[56:57], 1, v128
    v_mfma_f32_16x16x32_bf16 v[56:59], a[16:19], v[48:51], v[56:59]
    v_mfma_f32_16x16x32_bf16 v[60:63], a[80:83], v[48:51], v[60:63]
    buffer_load_dwordx4 a[116:119], v0, s[4:7], s30 offen offset:1024 sc1
    v_mfma_f32_16x16x32_bf16 v[64:67], a[144:147], v[48:51], v[64:67]
    s_add_u32 s51, s33, 12288
    ds_read_b128 v[44:47], v94 offset:9216
    s_and_b32 s51, s51, 0x3fff
    v_mfma_f32_16x16x32_bf16 v[80:83], a[16:19], v[164:167], v[80:83]
    s_lshl_b32 s30, s41, 3
    s_add_u32 s30, s30, s51
    s_add_u32 s30, s30, s72
    v_mfma_f32_16x16x32_bf16 v[84:87], a[80:83], v[164:167], v[84:87]
    s_add_u32 s30, s30, 16384
    v_mfma_f32_16x16x32_bf16 v[88:91], a[144:147], v[164:167], v[88:91]
    buffer_load_dwordx4 a[120:123], v0, s[4:7], s30 offen offset:2048 sc1
    v_mfma_f32_16x16x32_bf16 v[56:59], a[20:23], v[52:55], v[56:59]
    v_mfma_f32_16x16x32_bf16 v[60:63], a[84:87], v[52:55], v[60:63]
    v_mfma_f32_16x16x32_bf16 v[64:67], a[148:151], v[52:55], v[64:67]
    ds_read_b128 v[48:51], v94 offset:10240
    v_mfma_f32_16x16x32_bf16 v[80:83], a[20:23], v[164:167], v[80:83]
    buffer_load_dwordx4 a[124:127], v0, s[4:7], s30 offen offset:3072 sc1
    v_mfma_f32_16x16x32_bf16 v[84:87], a[84:87], v[164:167], v[84:87]
    s_add_u32 s51, s33, 12288
    s_and_b32 s51, s51, 0x3fff
    s_lshl_b32 s30, s41, 2
    v_mfma_f32_16x16x32_bf16 v[88:91], a[148:151], v[164:167], v[88:91]
    s_waitcnt lgkmcnt(4)
    s_add_u32 s30, s30, s51
    s_add_u32 s30, s30, s72
    v_mfma_f32_16x16x32_bf16 v[56:59], a[24:27], v[32:35], v[56:59]
    s_add_u32 s30, s30, 131072
    v_mfma_f32_16x16x32_bf16 v[60:63], a[88:91], v[32:35], v[60:63]
    buffer_load_dwordx4 a[176:179], v0, s[4:7], s30 offen offset:0 sc1
    v_mfma_f32_16x16x32_bf16 v[64:67], a[152:155], v[32:35], v[64:67]
    ds_read_b128 v[52:55], v94 offset:11264
    v_mfma_f32_16x16x32_bf16 v[80:83], a[24:27], v[164:167], v[80:83]
    v_mfma_f32_16x16x32_bf16 v[84:87], a[88:91], v[164:167], v[84:87]
    v_mfma_f32_16x16x32_bf16 v[88:91], a[152:155], v[164:167], v[88:91]
    s_waitcnt lgkmcnt(4)
    buffer_load_dwordx4 a[180:183], v0, s[4:7], s30 offen offset:1024 sc1
    v_mfma_f32_16x16x32_bf16 v[56:59], a[28:31], v[36:39], v[56:59]
    s_add_u32 s51, s33, 12288
    s_and_b32 s51, s51, 0x3fff
    s_lshl_b32 s30, s41, 2
    v_mfma_f32_16x16x32_bf16 v[60:63], a[92:95], v[36:39], v[60:63]
    s_add_u32 s30, s30, s51
    s_add_u32 s30, s30, s72
    s_add_u32 s30, s30, 131072
    v_mfma_f32_16x16x32_bf16 v[64:67], a[156:159], v[36:39], v[64:67]
    ds_read_b128 v[32:35], v94 offset:12288
    v_mfma_f32_16x16x32_bf16 v[80:83], a[28:31], v[164:167], v[80:83]
    buffer_load_dwordx4 a[184:187], v0, s[4:7], s30 offen offset:2048 sc1
    v_mfma_f32_16x16x32_bf16 v[84:87], a[92:95], v[164:167], v[84:87]
    v_mfma_f32_16x16x32_bf16 v[88:91], a[156:159], v[164:167], v[88:91]
    s_waitcnt lgkmcnt(4)
    v_mfma_f32_16x16x32_bf16 v[56:59], a[32:35], v[40:43], v[56:59]
    s_waitcnt vmcnt(18)
    v_mfma_f32_16x16x32_bf16 v[60:63], a[96:99], v[40:43], v[60:63]
    s_waitcnt vmcnt(14)
    buffer_load_dwordx4 a[188:191], v0, s[4:7], s30 offen offset:3072 sc1
    v_mfma_f32_16x16x32_bf16 v[64:67], a[160:163], v[40:43], v[64:67]
    s_add_u32 s30, s19, 720896
    ds_read_b128 v[36:39], v94 offset:13312
    v_mfma_f32_16x16x32_bf16 v[80:83], a[32:35], v[164:167], v[80:83]
    v_mfma_f32_16x16x32_bf16 v[84:87], a[96:99], v[164:167], v[84:87]
    v_mfma_f32_16x16x32_bf16 v[88:91], a[160:163], v[164:167], v[88:91]
    s_waitcnt lgkmcnt(4)
    buffer_load_dwordx4 v[156:159], v0, s[4:7], s30 offen sc1
    v_mfma_f32_16x16x32_bf16 v[56:59], a[36:39], v[44:47], v[56:59]
    s_add_u32 m0, s41, 98304
    s_add_u32 s30, s34, 163840
    v_mfma_f32_16x16x32_bf16 v[60:63], a[100:103], v[44:47], v[60:63]
    s_waitcnt vmcnt(15)
    v_mfma_f32_16x16x32_bf16 v[64:67], a[164:167], v[44:47], v[64:67]
    ds_read_b128 v[40:43], v94 offset:14336
    v_mfma_f32_16x16x32_bf16 v[80:83], a[36:39], v[164:167], v[80:83]
    buffer_load_dwordx4 v0, s[4:7], s30 offen offset:0 sc1 lds
    v_mfma_f32_16x16x32_bf16 v[84:87], a[100:103], v[164:167], v[84:87]
    v_mfma_f32_16x16x32_bf16 v[88:91], a[164:167], v[164:167], v[88:91]
    s_waitcnt lgkmcnt(4)
    v_mfma_f32_16x16x32_bf16 v[56:59], a[40:43], v[48:51], v[56:59]
    v_mfma_f32_16x16x32_bf16 v[60:63], a[104:107], v[48:51], v[60:63]
    s_waitcnt vmcnt(15)
    buffer_load_dwordx4 v0, s[4:7], s30 offen offset:1024 sc1 lds
    v_mfma_f32_16x16x32_bf16 v[64:67], a[168:171], v[48:51], v[64:67]
    ds_read_b128 v[44:47], v94 offset:15360
    v_mfma_f32_16x16x32_bf16 v[80:83], a[40:43], v[164:167], v[80:83]
    v_mfma_f32_16x16x32_bf16 v[84:87], a[104:107], v[164:167], v[84:87]
    v_mfma_f32_16x16x32_bf16 v[88:91], a[168:171], v[164:167], v[88:91]
    s_waitcnt lgkmcnt(4)
    buffer_load_dwordx4 v0, s[4:7], s30 offen offset:2048 sc1 lds
    v_mfma_f32_16x16x32_bf16 v[56:59], a[44:47], v[52:55], v[56:59]
    s_cmp_lg_u64 s[56:57], 0
    s_cbranch_scc1 Lrare181
Lrare181b:
    s_barrier
    v_mfma_f32_16x16x32_bf16 v[60:63], a[108:111], v[52:55], v[60:63]
    s_waitcnt vmcnt(16)
    v_mfma_f32_16x16x32_bf16 v[64:67], a[172:175], v[52:55], v[64:67]
    ds_read_b128 v[48:51], v94 offset:16384
    v_mfma_f32_16x16x32_bf16 v[80:83], a[44:47], v[164:167], v[80:83]
    buffer_load_dwordx4 v0, s[4:7], s30 offen offset:3072 sc1 lds
    v_mfma_f32_16x16x32_bf16 v[84:87], a[108:111], v[164:167], v[84:87]
    s_add_u32 s30, s19, 724992
    v_mfma_f32_16x16x32_bf16 v[88:91], a[172:175], v[164:167], v[88:91]
    s_waitcnt vmcnt(16) lgkmcnt(4)
    v_mfma_f32_16x16x32_bf16 v[56:59], a[48:51], v[32:35], v[56:59]
    s_waitcnt vmcnt(12)
    v_mfma_f32_16x16x32_bf16 v[60:63], a[112:115], v[32:35], v[60:63]
    s_waitcnt vmcnt(8)
    buffer_load_dwordx4 v[160:163], v0, s[4:7], s30 offen sc1
    v_mfma_f32_16x16x32_bf16 v[64:67], a[176:179], v[32:35], v[64:67]
    s_add_u32 m0, s41, 114688
    ds_read_b128 v[52:55], v94 offset:17408
    s_add_u32 s30, s34, 180224
    v_mfma_f32_16x16x32_bf16 v[80:83], a[48:51], v[164:167], v[80:83]
    v_mfma_f32_16x16x32_bf16 v[84:87], a[112:115], v[164:167], v[84:87]
    v_mfma_f32_16x16x32_bf16 v[88:91], a[176:179], v[164:167], v[88:91]
    s_waitcnt lgkmcnt(4)
    buffer_load_dwordx4 v0, s[4:7], s30 offen offset:0 sc1 lds
    v_mfma_f32_16x16x32_bf16 v[56:59], a[52:55], v[36:39], v[56:59]
    v_mfma_f32_16x16x32_bf16 v[60:63], a[116:119], v[36:39], v[60:63]
    s_waitcnt vmcnt(9)
    v_mfma_f32_16x16x32_bf16 v[64:67], a[180:183], v[36:39], v[64:67]
    ds_read_b128 v[32:35], v94 offset:18432
    v_mfma_f32_16x16x32_bf16 v[80:83], a[52:55], v[164:167], v[80:83]
    buffer_load_dwordx4 v0, s[4:7], s30 offen offset:1024 sc1 lds
    v_mfma_f32_16x16x32_bf16 v[84:87], a[116:119], v[164:167], v[84:87]
    v_mfma_f32_16x16x32_bf16 v[88:91], a[180:183], v[164:167], v[88:91]
    s_waitcnt lgkmcnt(4)
    v_mfma_f32_16x16x32_bf16 v[56:59], a[56:59], v[40:43], v[56:59]
    s_waitcnt vmcnt(7)
    v_bitop3_b32 v31, v156, v157, v158 bitop3:0x80
    v_bitop3_b32 v31, v31, v159, 1 bitop3:0x80
    v_cmp_ne_u32 vcc, 1, v31
    s_cbranch_vccnz Lrare183
Lrare183b:
    v_mfma_f32_16x16x32_bf16 v[60:63], a[120:123], v[40:43], v[60:63]
    buffer_load_dwordx4 v0, s[4:7], s30 offen offset:2048 sc1 lds
    v_mfma_f32_16x16x32_bf16 v[64:67], a[184:187], v[40:43], v[64:67]
    ds_read_b128 v[36:39], v94 offset:19456
    v_add_f32 v156, v156, v158
    v_mfma_f32_16x16x32_bf16 v[80:83], a[56:59], v[164:167], v[80:83]
    v_add_f32 v157, v157, v159
    s_nop 0
    v_mfma_f32_16x16x32_bf16 v[84:87], a[120:123], v[164:167], v[84:87]
    v_add_f32_dpp v156, v156, v156 quad_perm:[1,0,3,2] row_mask:0xf bank_mask:0xf
    v_add_f32_dpp v157, v157, v157 quad_perm:[1,0,3,2] row_mask:0xf bank_mask:0xf
    v_mfma_f32_16x16x32_bf16 v[88:91], a[184:187], v[164:167], v[88:91]
    s_waitcnt lgkmcnt(4)
    buffer_load_dwordx4 v0, s[4:7], s30 offen offset:3072 sc1 lds
    v_mfma_f32_16x16x32_bf16 v[56:59], a[60:63], v[44:47], v[56:59]
    s_lshl_b32 s30, s41, 2
    s_add_u32 m0, s30, 0
    s_add_u32 s30, s62, 4096
    v_mfma_f32_16x16x32_bf16 v[60:63], a[124:127], v[44:47], v[60:63]
    s_add_u32 s51, s68, 4096
    v_add_f32_dpp v156, v156, v156 quad_perm:[2,3,0,1] row_mask:0xf bank_mask:0xf
    v_add_f32_dpp v157, v157, v157 quad_perm:[2,3,0,1] row_mask:0xf bank_mask:0xf
    v_mfma_f32_16x16x32_bf16 v[64:67], a[188:191], v[44:47], v[64:67]
    ds_read_b128 v[40:43], v94 offset:20480
    v_add_f32_dpp v156, v156, v156 row_half_mirror row_mask:0xf bank_mask:0xf
    v_mfma_f32_16x16x32_bf16 v[80:83], a[60:63], v[164:167], v[80:83]
    buffer_load_dwordx4 v0, s[4:7], s30 offen sc1 lds
    v_mfma_f32_16x16x32_bf16 v[84:87], a[124:127], v[164:167], v[84:87]
    v_add_f32_dpp v157, v157, v157 row_half_mirror row_mask:0xf bank_mask:0xf
    v_mul_f32 v156, 0xbb000000, v156
    v_mfma_f32_16x16x32_bf16 v[88:91], a[188:191], v[164:167], v[88:91]
    s_waitcnt lgkmcnt(4)
    v_mul_f32 v157, 0x3b000000, v157
    v_fma_f32 v157, -v156, v156, v157
    v_mfma_f32_16x16x32_bf16 v[68:71], a[0:3], v[48:51], 0
    ds_write_b32 v8, v156 offset:1792
    v_mfma_f32_16x16x32_bf16 v[72:75], a[64:67], v[48:51], 0
    buffer_load_dwordx4 v0, s[4:7], s30 offen offset:1024 sc1 lds
    v_mfma_f32_16x16x32_bf16 v[76:79], a[128:131], v[48:51], 0
    s_waitcnt lgkmcnt(4)
    ds_read_b128 v[44:47], v94 offset:21504
    v_max_f32 v157, 0, v157
    v_mfma_f32_16x16x32_bf16 v[68:71], a[4:7], v[52:55], v[68:71]
    v_add_f32 v157, 0x3727c5ac, v157
    v_mfma_f32_16x16x32_bf16 v[72:75], a[68:71], v[52:55], v[72:75]
    v_rsq_f32 v157, v157
    v_mfma_f32_16x16x32_bf16 v[76:79], a[132:135], v[52:55], v[76:79]
    s_waitcnt lgkmcnt(4)
    ds_read_b128 v[48:51], v94 offset:22528
    v_mul_f32 v158, v156, v157
    v_mfma_f32_16x16x32_bf16 v[68:71], a[8:11], v[32:35], v[68:71]
    s_waitcnt vmcnt(7)
    ds_read_b128 v[128:131], v28 offset:32768
    ds_read_b128 v[132:135], v28 offset:33792
    v_mfma_f32_16x16x32_bf16 v[72:75], a[72:75], v[32:35], v[72:75]
    ds_read_b128 v[136:139], v28 offset:34816
    ds_read_b128 v[140:143], v28 offset:35840
    v_mfma_f32_16x16x32_bf16 v[76:79], a[136:139], v[32:35], v[76:79]
    s_waitcnt lgkmcnt(8)
    ds_read_b128 v[52:55], v94 offset:23552
    v_mfma_f32_16x16x32_bf16 v[68:71], a[12:15], v[36:39], v[68:71]
    buffer_load_dwordx4 v0, s[4:7], s51 offen offset:2048 sc1 lds
    v_mfma_f32_16x16x32_bf16 v[72:75], a[76:79], v[36:39], v[72:75]
    ds_write_b32 v8, v157 offset:1024
    v_mfma_f32_16x16x32_bf16 v[76:79], a[140:143], v[36:39], v[76:79]
    s_waitcnt lgkmcnt(9)
    ds_read_b128 v[32:35], v94 offset:24576
    v_mul_f32 v157, s50, v157
    v_mfma_f32_16x16x32_bf16 v[68:71], a[16:19], v[40:43], v[68:71]
    ds_write_b32 v8, v158 offset:1280
    v_mfma_f32_16x16x32_bf16 v[72:75], a[80:83], v[40:43], v[72:75]
    buffer_load_dwordx4 v0, s[4:7], s51 offen offset:3072 sc1 lds
    v_mfma_f32_16x16x32_bf16 v[76:79], a[144:147], v[40:43], v[76:79]
    s_waitcnt lgkmcnt(9)
    ds_read_b128 v[36:39], v94 offset:25600
    s_lshl_b32 s30, s41, 2
    v_mfma_f32_16x16x32_bf16 v[68:71], a[20:23], v[44:47], v[68:71]
    s_add_u32 m0, s30, 4096
    s_add_u32 s30, s62, 8192
    s_add_u32 s51, s68, 8192
    v_mfma_f32_16x16x32_bf16 v[72:75], a[84:87], v[44:47], v[72:75]
    s_waitcnt lgkmcnt(7)
    v_bitop3_b32 v128, v128, v130, v132 bitop3:0x80
    v_mfma_f32_16x16x32_bf16 v[76:79], a[148:151], v[44:47], v[76:79]
    ds_read_b128 v[40:43], v94 offset:26624
    v_mfma_f32_16x16x32_bf16 v[68:71], a[24:27], v[48:51], v[68:71]
    buffer_load_dwordx4 v0, s[4:7], s30 offen sc1 lds
    v_mfma_f32_16x16x32_bf16 v[72:75], a[88:91], v[48:51], v[72:75]
    s_waitcnt lgkmcnt(7)
    v_bitop3_b32 v134, v134, v136, v138 bitop3:0x80
    v_mfma_f32_16x16x32_bf16 v[76:79], a[152:155], v[48:51], v[76:79]
    s_waitcnt lgkmcnt(5)
    ds_read_b128 v[44:47], v94 offset:27648
    v_bitop3_b32 v128, v128, v134, v140 bitop3:0x80
    v_mfma_f32_16x16x32_bf16 v[68:71], a[28:31], v[52:55], v[68:71]
    v_bitop3_b32 v128, v128, v142, 1 bitop3:0x80
    v_cmp_ne_u32 s[56:57], 1, v128
    v_mfma_f32_16x16x32_bf16 v[72:75], a[92:95], v[52:55], v[72:75]
    buffer_load_dwordx4 v0, s[4:7], s30 offen offset:1024 sc1 lds
    v_mfma_f32_16x16x32_bf16 v[76:79], a[156:159], v[52:55], v[76:79]
    s_waitcnt lgkmcnt(4)
    ds_read_b128 v[48:51], v94 offset:28672
    v_mfma_f32_16x16x32_bf16 v[68:71], a[32:35], v[32:35], v[68:71]
    ds_write_b32 v8, v157 offset:1536
    v_mfma_f32_16x16x32_bf16 v[72:75], a[96:99], v[32:35], v[72:75]
    s_waitcnt vmcnt(10)
    v_bitop3_b32 v31, v160, v161, v162 bitop3:0x80
    v_bitop3_b32 v31, v31, v163, 1 bitop3:0x80
    v_cmp_ne_u32 vcc, 1, v31
    s_cbranch_vccnz Lrare185
Lrare185b:
    v_mfma_f32_16x16x32_bf16 v[76:79], a[160:163], v[32:35], v[76:79]
    s_waitcnt lgkmcnt(4)
    ds_read_b128 v[52:55], v94 offset:29696
    v_add_f32 v160, v160, v162
    v_mfma_f32_16x16x32_bf16 v[68:71], a[36:39], v[36:39], v[68:71]
    buffer_load_dwordx4 v0, s[4:7], s51 offen offset:2048 sc1 lds
    v_mfma_f32_16x16x32_bf16 v[72:75], a[100:103], v[36:39], v[72:75]
    v_add_f32 v161, v161, v163
    s_nop 0
    v_mfma_f32_16x16x32_bf16 v[76:79], a[164:167], v[36:39], v[76:79]
    s_waitcnt lgkmcnt(4)
    ds_read_b128 v[32:35], v94 offset:30720
    v_add_f32_dpp v160, v160, v160 quad_perm:[1,0,3,2] row_mask:0xf bank_mask:0xf
    v_mfma_f32_16x16x32_bf16 v[68:71], a[40:43], v[40:43], v[68:71]
    v_add_f32_dpp v161, v161, v161 quad_perm:[1,0,3,2] row_mask:0xf bank_mask:0xf
    v_add_f32_dpp v160, v160, v160 quad_perm:[2,3,0,1] row_mask:0xf bank_mask:0xf
    v_mfma_f32_16x16x32_bf16 v[72:75], a[104:107], v[40:43], v[72:75]
    buffer_load_dwordx4 v0, s[4:7], s51 offen offset:3072 sc1 lds
    v_mfma_f32_16x16x32_bf16 v[76:79], a[168:171], v[40:43], v[76:79]
    s_waitcnt lgkmcnt(4)
    ds_read_b128 v[36:39], v94 offset:31744
    s_lshl_b32 s30, s41, 2
    v_mfma_f32_16x16x32_bf16 v[68:71], a[44:47], v[44:47], v[68:71]
    s_cmp_lg_u64 s[56:57], 0
    s_cbranch_scc1 Lrare187
Lrare187b:
    s_waitcnt lgkmcnt(3)
    s_barrier
    v_mfma_f32_16x16x32_bf16 v[72:75], a[108:111], v[44:47], v[72:75]
    s_add_u32 m0, s30, 8192
    ds_read_b32 v92, v2 offset:1792
    s_add_u32 s30, s62, 12288
    v_mfma_f32_16x16x32_bf16 v[76:79], a[172:175], v[44:47], v[76:79]
    s_add_u32 s51, s68, 12288
    ds_read_b128 v[40:43], v94 offset:32768
    v_add_f32_dpp v161, v161, v161 quad_perm:[2,3,0,1] row_mask:0xf bank_mask:0xf
    v_mfma_f32_16x16x32_bf16 v[68:71], a[48:51], v[48:51], v[68:71]
    buffer_load_dwordx4 v0, s[4:7], s30 offen sc1 lds
    v_mfma_f32_16x16x32_bf16 v[72:75], a[112:115], v[48:51], v[72:75]
    s_waitcnt lgkmcnt(1)
    v_fma_f32 v56, -v92, v80, -v56
    v_fma_f32 v57, -v92, v81, -v57
    v_mfma_f32_16x16x32_bf16 v[76:79], a[176:179], v[48:51], v[76:79]
    ds_read_b128 v[44:47], v94 offset:33792
    v_fma_f32 v58, -v92, v82, -v58
    v_mfma_f32_16x16x32_bf16 v[68:71], a[52:55], v[52:55], v[68:71]
    v_fma_f32 v59, -v92, v83, -v59
    v_fma_f32 v60, -v92, v84, -v60
    v_mfma_f32_16x16x32_bf16 v[72:75], a[116:119], v[52:55], v[72:75]
    buffer_load_dwordx4 v0, s[4:7], s30 offen offset:1024 sc1 lds
    v_mfma_f32_16x16x32_bf16 v[76:79], a[180:183], v[52:55], v[76:79]
    ds_read_b128 v[48:51], v94 offset:34816
    v_fma_f32 v61, -v92, v85, -v61
    v_mfma_f32_16x16x32_bf16 v[68:71], a[56:59], v[32:35], v[68:71]
    v_fma_f32 v62, -v92, v86, -v62
    v_fma_f32 v63, -v92, v87, -v63
    v_mfma_f32_16x16x32_bf16 v[72:75], a[120:123], v[32:35], v[72:75]
    v_fma_f32 v64, -v92, v88, -v64
    v_fma_f32 v65, -v92, v89, -v65
    v_mfma_f32_16x16x32_bf16 v[76:79], a[184:187], v[32:35], v[76:79]
    ds_read_b128 v[52:55], v94 offset:35840
    v_fma_f32 v66, -v92, v90, -v66
    v_mfma_f32_16x16x32_bf16 v[68:71], a[60:63], v[36:39], v[68:71]
    ds_read_b32 v93, v2 offset:1856
    v_fma_f32 v67, -v92, v91, -v67
    v_mfma_f32_16x16x32_bf16 v[72:75], a[124:127], v[36:39], v[72:75]
    buffer_load_dwordx4 v0, s[4:7], s51 offen offset:2048 sc1 lds
    v_cvt_pk_bf16_f32 v144, v56, v57
    v_cvt_pk_bf16_f32 v145, v58, v59
    v_cvt_pk_bf16_f32 v146, v60, v61
    v_cvt_pk_bf16_f32 v147, v62, v63
    v_cvt_pk_bf16_f32 v148, v64, v65
    v_cvt_pk_bf16_f32 v149, v66, v67
    v_mfma_f32_16x16x32_bf16 v[76:79], a[188:191], v[36:39], v[76:79]
    s_waitcnt lgkmcnt(4)
    ds_read_b128 v[32:35], v94 offset:36864
    v_pk_max_u16 v144, v144, s17
    v_mfma_f32_16x16x32_bf16 v[56:59], a[0:3], v[40:43], 0
    v_pk_max_u16 v145, v145, s17
    v_pk_max_u16 v146, v146, s17
    v_mfma_f32_16x16x32_bf16 v[60:63], a[64:67], v[40:43], 0
    v_pk_max_u16 v147, v147, s17
    v_pk_max_u16 v148, v148, s17
    v_mfma_f32_16x16x32_bf16 v[64:67], a[128:131], v[40:43], 0
    s_waitcnt lgkmcnt(4)
    ds_read_b128 v[36:39], v94 offset:37888
    v_pk_max_u16 v149, v149, s17
    v_mfma_f32_16x16x32_bf16 v[56:59], a[4:7], v[44:47], v[56:59]
    s_add_u32 s35, s58, 327680
    buffer_load_dwordx4 v0, s[4:7], s51 offen offset:3072 sc1 lds
    v_mfma_f32_16x16x32_bf16 v[60:63], a[68:71], v[44:47], v[60:63]
    s_lshl_b32 s30, s41, 2
    s_waitcnt vmcnt(12)
    ds_read_b128 v[128:131], v28 offset:49152
    v_mfma_f32_16x16x32_bf16 v[64:67], a[132:135], v[44:47], v[64:67]
    s_waitcnt lgkmcnt(5)
    ds_read_b128 v[40:43], v94 offset:38912
    ds_read_b128 v[132:135], v28 offset:50176
    v_mfma_f32_16x16x32_bf16 v[56:59], a[8:11], v[48:51], v[56:59]
    s_add_u32 m0, s30, 12288
    ds_read_b128 v[136:139], v28 offset:51200
    ds_read_b128 v[140:143], v28 offset:52224
    v_mfma_f32_16x16x32_bf16 v[60:63], a[72:75], v[48:51], v[60:63]
    s_add_u32 s30, s62, 16384
    s_add_u32 s51, s68, 16384
    s_add_u32 s36, s59, 327680
    buffer_store_dwordx4 v[144:147], v0, s[4:7], s35 offen sc1
    buffer_store_dwordx2 v[148:149], v9, s[4:7], s36 offen sc1
    v_mfma_f32_16x16x32_bf16 v[64:67], a[136:139], v[48:51], v[64:67]
    s_waitcnt lgkmcnt(8)
    ds_read_b128 v[44:47], v94 offset:39936
    v_add_f32_dpp v160, v160, v160 row_half_mirror row_mask:0xf bank_mask:0xf
    v_mfma_f32_16x16x32_bf16 v[56:59], a[12:15], v[52:55], v[56:59]
    buffer_load_dwordx4 v0, s[4:7], s30 offen sc1 lds
    v_mfma_f32_16x16x32_bf16 v[60:63], a[76:79], v[52:55], v[60:63]
    s_waitcnt lgkmcnt(8)
    v_fma_f32 v68, -v93, v80, -v68
    v_fma_f32 v69, -v93, v81, -v69
    v_mfma_f32_16x16x32_bf16 v[64:67], a[140:143], v[52:55], v[64:67]
    s_waitcnt lgkmcnt(7)
    ds_read_b128 v[48:51], v94 offset:40960
    v_fma_f32 v70, -v93, v82, -v70
    v_mfma_f32_16x16x32_bf16 v[56:59], a[16:19], v[32:35], v[56:59]
    v_fma_f32 v71, -v93, v83, -v71
    v_fma_f32 v72, -v93, v84, -v72
    v_mfma_f32_16x16x32_bf16 v[60:63], a[80:83], v[32:35], v[60:63]
    buffer_load_dwordx4 v0, s[4:7], s30 offen offset:1024 sc1 lds
    v_mfma_f32_16x16x32_bf16 v[64:67], a[144:147], v[32:35], v[64:67]
    s_waitcnt lgkmcnt(7)
    ds_read_b128 v[52:55], v94 offset:41984
    v_fma_f32 v73, -v93, v85, -v73
    v_mfma_f32_16x16x32_bf16 v[56:59], a[20:23], v[36:39], v[56:59]
    v_fma_f32 v74, -v93, v86, -v74
    v_fma_f32 v75, -v93, v87, -v75
    v_mfma_f32_16x16x32_bf16 v[60:63], a[84:87], v[36:39], v[60:63]
    v_fma_f32 v76, -v93, v88, -v76
    v_fma_f32 v77, -v93, v89, -v77
    v_mfma_f32_16x16x32_bf16 v[64:67], a[148:151], v[36:39], v[64:67]
    s_waitcnt lgkmcnt(6)
    ds_read_b128 v[32:35], v94 offset:43008
    v_fma_f32 v78, -v93, v90, -v78
    v_mfma_f32_16x16x32_bf16 v[56:59], a[24:27], v[40:43], v[56:59]
    buffer_load_dwordx4 v0, s[4:7], s51 offen offset:2048 sc1 lds
    v_mfma_f32_16x16x32_bf16 v[60:63], a[88:91], v[40:43], v[60:63]
    v_fma_f32 v79, -v93, v91, -v79
    v_cvt_pk_bf16_f32 v150, v68, v69
    v_mfma_f32_16x16x32_bf16 v[64:67], a[152:155], v[40:43], v[64:67]
    s_waitcnt lgkmcnt(3)
    ds_read_b128 v[36:39], v94 offset:44032
    v_cvt_pk_bf16_f32 v151, v70, v71
    v_mfma_f32_16x16x32_bf16 v[56:59], a[28:31], v[44:47], v[56:59]
    v_cvt_pk_bf16_f32 v152, v72, v73
    v_cvt_pk_bf16_f32 v153, v74, v75
    v_mfma_f32_16x16x32_bf16 v[60:63], a[92:95], v[44:47], v[60:63]
    buffer_load_dwordx4 v0, s[4:7], s51 offen offset:3072 sc1 lds
    v_mfma_f32_16x16x32_bf16 v[64:67], a[156:159], v[44:47], v[64:67]
    s_waitcnt lgkmcnt(3)
    ds_read_b128 v[40:43], v94 offset:45056
    v_cvt_pk_bf16_f32 v154, v76, v77
    v_mfma_f32_16x16x32_bf16 v[56:59], a[32:35], v[48:51], v[56:59]
    v_cvt_pk_bf16_f32 v155, v78, v79
    v_pk_max_u16 v150, v150, s17
    v_mfma_f32_16x16x32_bf16 v[60:63], a[96:99], v[48:51], v[60:63]
    v_pk_max_u16 v151, v151, s17
    v_pk_max_u16 v152, v152, s17
    v_mfma_f32_16x16x32_bf16 v[64:67], a[160:163], v[48:51], v[64:67]
    s_waitcnt lgkmcnt(3)
    ds_read_b128 v[44:47], v94 offset:46080
    v_pk_max_u16 v153, v153, s17
    v_mfma_f32_16x16x32_bf16 v[56:59], a[36:39], v[52:55], v[56:59]
    buffer_load_dwordx4 v[176:179], v0, s[4:7], s62 offen sc1
    v_mfma_f32_16x16x32_bf16 v[60:63], a[100:103], v[52:55], v[60:63]
    v_pk_max_u16 v154, v154, s17
    v_pk_max_u16 v155, v155, s17
    v_mfma_f32_16x16x32_bf16 v[64:67], a[164:167], v[52:55], v[64:67]
    s_waitcnt lgkmcnt(3)
    ds_read_b128 v[48:51], v94 offset:47104
    s_add_u32 s35, s58, 371712
    v_mfma_f32_16x16x32_bf16 v[56:59], a[40:43], v[32:35], v[56:59]
    s_add_u32 s36, s59, 371712
    buffer_store_dwordx4 v[150:153], v0, s[4:7], s35 offen sc1
    v_add_f32_dpp v161, v161, v161 row_half_mirror row_mask:0xf bank_mask:0xf
    v_mul_f32 v160, 0xbb000000, v160
    v_mul_f32 v161, 0x3b000000, v161
    v_fma_f32 v161, -v160, v160, v161
    ds_write_b32 v8, v160 offset:1920
    v_max_f32 v161, 0, v161
    v_add_f32 v161, 0x3727c5ac, v161
    v_rsq_f32 v161, v161
    s_nop 0
    v_mul_f32 v162, v160, v161
    ds_write_b32 v8, v161 offset:1152
    v_mul_f32 v161, s50, v161
    ds_write_b32 v8, v162 offset:1408
    ds_write_b32 v8, v161 offset:1664
    v_mfma_f32_16x16x32_bf16 v[60:63], a[104:107], v[32:35], v[60:63]
    buffer_load_dwordx4 v[180:183], v0, s[4:7], s62 offen offset:1024 sc1
    v_bitop3_b32 v128, v128, v130, v132 bitop3:0x80
    v_bitop3_b32 v134, v134, v136, v138 bitop3:0x80
    v_bitop3_b32 v128, v128, v134, v140 bitop3:0x80
    v_bitop3_b32 v128, v128, v142, 1 bitop3:0x80
    v_cmp_ne_u32 s[56:57], 1, v128
    v_mfma_f32_16x16x32_bf16 v[64:67], a[168:171], v[32:35], v[64:67]
    s_waitcnt lgkmcnt(7)
    ds_read_b128 v[52:55], v94 offset:48128
    v_mfma_f32_16x16x32_bf16 v[56:59], a[44:47], v[36:39], v[56:59]
    s_cmp_lg_u64 s[56:57], 0
    s_cbranch_scc1 Lrare189
Lrare189b:
    s_waitcnt lgkmcnt(1)
    s_barrier
    v_mfma_f32_16x16x32_bf16 v[60:63], a[108:111], v[36:39], v[60:63]
    buffer_store_dwordx2 v[154:155], v9, s[4:7], s36 offen sc1
    v_mfma_f32_16x16x32_bf16 v[64:67], a[172:175], v[36:39], v[64:67]
    ds_read_b128 v[32:35], v94 offset:49152
    v_mfma_f32_16x16x32_bf16 v[56:59], a[48:51], v[40:43], v[56:59]
    buffer_load_dwordx4 v[184:187], v0, s[4:7], s68 offen offset:2048 sc1
    v_mfma_f32_16x16x32_bf16 v[60:63], a[112:115], v[40:43], v[60:63]
    ds_write_b128 v30, v[80:83] offset:2048
    v_mfma_f32_16x16x32_bf16 v[64:67], a[176:179], v[40:43], v[64:67]
    ds_read_b128 v[36:39], v94 offset:50176
    v_mfma_f32_16x16x32_bf16 v[56:59], a[52:55], v[44:47], v[56:59]
    ds_write_b128 v30, v[84:87] offset:2112
    v_mfma_f32_16x16x32_bf16 v[60:63], a[116:119], v[44:47], v[60:63]
    buffer_load_dwordx4 v[188:191], v0, s[4:7], s68 offen offset:3072 sc1
    s_cmp_eq_u32 s24, 3
    s_cbranch_scc1 Lskip191
    s_add_u32 m0, s16, 0
    s_add_u32 s30, s62, 20480
    s_add_u32 s51, s68, 20480
    buffer_load_dwordx4 v0, s[4:7], s30 offen sc1 lds
    buffer_load_dwordx4 v0, s[4:7], s30 offen offset:1024 sc1 lds
    buffer_load_dwordx4 v0, s[4:7], s51 offen offset:2048 sc1 lds
    buffer_load_dwordx4 v0, s[4:7], s51 offen offset:3072 sc1 lds
Lskip191:
    v_mfma_f32_16x16x32_bf16 v[64:67], a[180:183], v[44:47], v[64:67]
    s_add_u32 m0, s16, 4096
    ds_read_b128 v[40:43], v94 offset:51200
    s_add_u32 s30, s21, 0
    v_mfma_f32_16x16x32_bf16 v[56:59], a[56:59], v[48:51], v[56:59]
    s_add_u32 s51, s22, 0
    ds_write_b128 v30, v[88:91] offset:2176
    v_mfma_f32_16x16x32_bf16 v[60:63], a[120:123], v[48:51], v[60:63]
    v_mfma_f32_16x16x32_bf16 v[64:67], a[184:187], v[48:51], v[64:67]
    s_waitcnt lgkmcnt(6)
    ds_read_b128 v[44:47], v94 offset:52224
    v_mfma_f32_16x16x32_bf16 v[56:59], a[60:63], v[52:55], v[56:59]
    ds_read_b32 v92, v2 offset:1920
    v_mfma_f32_16x16x32_bf16 v[60:63], a[124:127], v[52:55], v[60:63]
    buffer_load_dwordx4 v0, s[4:7], s30 offen sc1 lds
    v_mfma_f32_16x16x32_bf16 v[64:67], a[188:191], v[52:55], v[64:67]
    s_waitcnt lgkmcnt(7)
    ds_read_b128 v[48:51], v94 offset:53248
    v_mfma_f32_16x16x32_bf16 v[68:71], a[0:3], v[32:35], 0
    v_mfma_f32_16x16x32_bf16 v[72:75], a[64:67], v[32:35], 0
    v_mfma_f32_16x16x32_bf16 v[76:79], a[128:131], v[32:35], 0
    s_waitcnt lgkmcnt(6)
    ds_read_b128 v[52:55], v94 offset:54272
    s_waitcnt vmcnt(3)
    v_mfma_f32_16x16x32_bf16 v[68:71], a[4:7], v[36:39], v[68:71]
    buffer_store_dword v5, v4, s[4:7], s18 offen offset:128 sc1
    v_mfma_f32_16x16x32_bf16 v[72:75], a[68:71], v[36:39], v[72:75]
    buffer_load_dwordx4 v0, s[4:7], s30 offen offset:1024 sc1 lds
    v_mfma_f32_16x16x32_bf16 v[76:79], a[132:135], v[36:39], v[76:79]
    s_waitcnt lgkmcnt(5)
    ds_read_b128 v[32:35], v94 offset:55296
    v_mfma_f32_16x16x32_bf16 v[68:71], a[8:11], v[40:43], v[68:71]
    s_waitcnt lgkmcnt(3)
    v_fma_f32 v56, -v92, v80, -v56
    v_fma_f32 v57, -v92, v81, -v57
    v_mfma_f32_16x16x32_bf16 v[72:75], a[72:75], v[40:43], v[72:75]
    v_fma_f32 v58, -v92, v82, -v58
    v_fma_f32 v59, -v92, v83, -v59
    v_mfma_f32_16x16x32_bf16 v[76:79], a[136:139], v[40:43], v[76:79]
    ds_read_b128 v[36:39], v94 offset:56320
    v_fma_f32 v60, -v92, v84, -v60
    v_mfma_f32_16x16x32_bf16 v[68:71], a[12:15], v[44:47], v[68:71]
    s_barrier
    buffer_load_dwordx4 v0, s[4:7], s51 offen offset:2048 sc1 lds
    v_mfma_f32_16x16x32_bf16 v[72:75], a[76:79], v[44:47], v[72:75]
    v_fma_f32 v61, -v92, v85, -v61
    v_fma_f32 v62, -v92, v86, -v62
    v_mfma_f32_16x16x32_bf16 v[76:79], a[140:143], v[44:47], v[76:79]
    s_waitcnt lgkmcnt(3)
    ds_read_b128 v[40:43], v94 offset:57344
    v_fma_f32 v63, -v92, v87, -v63
    v_mfma_f32_16x16x32_bf16 v[68:71], a[16:19], v[48:51], v[68:71]
    v_fma_f32 v64, -v92, v88, -v64
    v_fma_f32 v65, -v92, v89, -v65
    v_mfma_f32_16x16x32_bf16 v[72:75], a[80:83], v[48:51], v[72:75]
    buffer_load_dwordx4 v0, s[4:7], s51 offen offset:3072 sc1 lds
    v_mfma_f32_16x16x32_bf16 v[76:79], a[144:147], v[48:51], v[76:79]
    s_waitcnt lgkmcnt(3)
    ds_read_b128 v[44:47], v94 offset:58368
    s_add_u32 m0, s41, 65536
    v_mfma_f32_16x16x32_bf16 v[68:71], a[20:23], v[52:55], v[68:71]
    s_add_u32 s30, s63, 0
    s_add_u32 s51, s69, 0
    v_fma_f32 v66, -v92, v90, -v66
    v_mfma_f32_16x16x32_bf16 v[72:75], a[84:87], v[52:55], v[72:75]
    v_fma_f32 v67, -v92, v91, -v67
    v_cvt_pk_bf16_f32 v144, v56, v57
    v_mfma_f32_16x16x32_bf16 v[76:79], a[148:151], v[52:55], v[76:79]
    s_waitcnt lgkmcnt(3)
    ds_read_b128 v[48:51], v94 offset:59392
    v_cvt_pk_bf16_f32 v145, v58, v59
    v_mfma_f32_16x16x32_bf16 v[68:71], a[24:27], v[32:35], v[68:71]
    buffer_load_dwordx4 v0, s[4:7], s30 offen sc1 lds
    v_mfma_f32_16x16x32_bf16 v[72:75], a[88:91], v[32:35], v[72:75]
    v_cvt_pk_bf16_f32 v146, v60, v61
    v_cvt_pk_bf16_f32 v147, v62, v63
    v_mfma_f32_16x16x32_bf16 v[76:79], a[152:155], v[32:35], v[76:79]
    s_waitcnt lgkmcnt(3)
    ds_read_b128 v[52:55], v94 offset:60416
    v_cvt_pk_bf16_f32 v148, v64, v65
    v_mfma_f32_16x16x32_bf16 v[68:71], a[28:31], v[36:39], v[68:71]
    v_cvt_pk_bf16_f32 v149, v66, v67
    v_pk_max_u16 v144, v144, s17
    v_mfma_f32_16x16x32_bf16 v[72:75], a[92:95], v[36:39], v[72:75]
    buffer_load_dwordx4 v0, s[4:7], s30 offen offset:1024 sc1 lds
    v_mfma_f32_16x16x32_bf16 v[76:79], a[156:159], v[36:39], v[76:79]
    s_waitcnt lgkmcnt(3)
    ds_read_b128 v[32:35], v94 offset:61440
    v_pk_max_u16 v145, v145, s17
    v_mfma_f32_16x16x32_bf16 v[68:71], a[32:35], v[40:43], v[68:71]
    v_pk_max_u16 v146, v146, s17
    v_pk_max_u16 v147, v147, s17
    v_mfma_f32_16x16x32_bf16 v[72:75], a[96:99], v[40:43], v[72:75]
    v_pk_max_u16 v148, v148, s17
    v_pk_max_u16 v149, v149, s17
    v_mfma_f32_16x16x32_bf16 v[76:79], a[160:163], v[40:43], v[76:79]
    s_waitcnt lgkmcnt(3)
    ds_read_b128 v[36:39], v94 offset:62464
    s_add_u32 s35, s58, 415744
    v_mfma_f32_16x16x32_bf16 v[68:71], a[36:39], v[44:47], v[68:71]
    s_add_u32 s36, s59, 415744
    buffer_load_dwordx4 v0, s[4:7], s51 offen offset:2048 sc1 lds
    v_mfma_f32_16x16x32_bf16 v[72:75], a[100:103], v[44:47], v[72:75]
    buffer_store_dwordx4 v[144:147], v0, s[4:7], s35 offen sc1
    v_mfma_f32_16x16x32_bf16 v[76:79], a[164:167], v[44:47], v[76:79]
    s_waitcnt lgkmcnt(3)
    ds_read_b128 v[40:43], v94 offset:63488
    v_mfma_f32_16x16x32_bf16 v[68:71], a[40:43], v[48:51], v[68:71]
    buffer_store_dwordx2 v[148:149], v9, s[4:7], s36 offen sc1
    v_mfma_f32_16x16x32_bf16 v[72:75], a[104:107], v[48:51], v[72:75]
    buffer_load_dwordx4 v0, s[4:7], s51 offen offset:3072 sc1 lds
    v_mfma_f32_16x16x32_bf16 v[76:79], a[168:171], v[48:51], v[76:79]
    s_waitcnt lgkmcnt(3)
    ds_read_b128 v[44:47], v94 offset:64512
    s_add_u32 m0, s41, 81920
    v_mfma_f32_16x16x32_bf16 v[68:71], a[44:47], v[52:55], v[68:71]
    s_add_u32 s30, s63, 4096
    s_add_u32 s51, s69, 4096
    v_mfma_f32_16x16x32_bf16 v[72:75], a[108:111], v[52:55], v[72:75]
    v_mfma_f32_16x16x32_bf16 v[76:79], a[172:175], v[52:55], v[76:79]
    s_waitcnt lgkmcnt(3)
    buffer_load_dwordx4 v0, s[4:7], s30 offen sc1 lds
    v_mfma_f32_16x16x32_bf16 v[68:71], a[48:51], v[32:35], v[68:71]
    v_mfma_f32_16x16x32_bf16 v[72:75], a[112:115], v[32:35], v[72:75]
    v_mfma_f32_16x16x32_bf16 v[76:79], a[176:179], v[32:35], v[76:79]
    s_waitcnt lgkmcnt(2)
    v_mfma_f32_16x16x32_bf16 v[68:71], a[52:55], v[36:39], v[68:71]
    buffer_load_dwordx4 v0, s[4:7], s30 offen offset:1024 sc1 lds
    v_mfma_f32_16x16x32_bf16 v[72:75], a[116:119], v[36:39], v[72:75]
    v_mfma_f32_16x16x32_bf16 v[76:79], a[180:183], v[36:39], v[76:79]
    s_waitcnt lgkmcnt(1)
    v_mfma_f32_16x16x32_bf16 v[68:71], a[56:59], v[40:43], v[68:71]
    ds_read_b32 v93, v2 offset:1984
    v_mfma_f32_16x16x32_bf16 v[72:75], a[120:123], v[40:43], v[72:75]
    buffer_load_dwordx4 v0, s[4:7], s51 offen offset:2048 sc1 lds
    v_mfma_f32_16x16x32_bf16 v[76:79], a[184:187], v[40:43], v[76:79]
    s_waitcnt lgkmcnt(1)
    v_mfma_f32_16x16x32_bf16 v[68:71], a[60:63], v[44:47], v[68:71]
    v_mfma_f32_16x16x32_bf16 v[72:75], a[124:127], v[44:47], v[72:75]
    v_mfma_f32_16x16x32_bf16 v[76:79], a[188:191], v[44:47], v[76:79]
    buffer_load_dwordx4 v0, s[4:7], s51 offen offset:3072 sc1 lds
    s_waitcnt vmcnt(10)
    s_barrier
    s_waitcnt lgkmcnt(0)
    s_nop 1
    v_pk_fma_f32 v[68:69], v[80:81], v[92:93], v[68:69] op_sel:[0,1,0] op_sel_hi:[1,1,1] neg_lo:[0,1,1] neg_hi:[0,1,1]
    v_pk_fma_f32 v[70:71], v[82:83], v[92:93], v[70:71] op_sel:[0,1,0] op_sel_hi:[1,1,1] neg_lo:[0,1,1] neg_hi:[0,1,1]
    v_pk_fma_f32 v[72:73], v[84:85], v[92:93], v[72:73] op_sel:[0,1,0] op_sel_hi:[1,1,1] neg_lo:[0,1,1] neg_hi:[0,1,1]
    v_pk_fma_f32 v[74:75], v[86:87], v[92:93], v[74:75] op_sel:[0,1,0] op_sel_hi:[1,1,1] neg_lo:[0,1,1] neg_hi:[0,1,1]
    v_pk_fma_f32 v[76:77], v[88:89], v[92:93], v[76:77] op_sel:[0,1,0] op_sel_hi:[1,1,1] neg_lo:[0,1,1] neg_hi:[0,1,1]
    v_pk_fma_f32 v[78:79], v[90:91], v[92:93], v[78:79] op_sel:[0,1,0] op_sel_hi:[1,1,1] neg_lo:[0,1,1] neg_hi:[0,1,1]
    v_cvt_pk_bf16_f32 v150, v68, v69
    v_cvt_pk_bf16_f32 v151, v70, v71
    v_cvt_pk_bf16_f32 v152, v72, v73
    v_cvt_pk_bf16_f32 v153, v74, v75
    v_cvt_pk_bf16_f32 v154, v76, v77
    v_cvt_pk_bf16_f32 v155, v78, v79
    v_pk_max_u16 v150, v150, s17
    v_pk_max_u16 v151, v151, s17
    v_pk_max_u16 v152, v152, s17
    v_pk_max_u16 v153, v153, s17
    v_pk_max_u16 v154, v154, s17
    v_pk_max_u16 v155, v155, s17
    s_add_u32 s35, s58, 459776
    s_add_u32 s36, s59, 459776
    buffer_store_dwordx4 v[150:153], v0, s[4:7], s35 offen sc1
    buffer_store_dwordx2 v[154:155], v9, s[4:7], s36 offen sc1
    s_add_u32 m0, s41, 98304
    s_add_u32 s30, s63, 8192
    s_add_u32 s51, s69, 8192
    buffer_load_dwordx4 v0, s[4:7], s30 offen sc1 lds
    buffer_load_dwordx4 v0, s[4:7], s30 offen offset:1024 sc1 lds
    buffer_load_dwordx4 v0, s[4:7], s51 offen offset:2048 sc1 lds
    buffer_load_dwordx4 v0, s[4:7], s51 offen offset:3072 sc1 lds
    buffer_load_dword v31, v3, s[4:7], s37 offen offset:128 sc1
    s_waitcnt vmcnt(0)
    v_cmp_ne_u32 vcc, s29, v31
    s_cbranch_vccnz Lrare192
Lrare192b:
    s_add_u32 s64, s60, 327680
    s_add_u32 s65, s64, s73
    buffer_load_dwordx4 v[96:99], v0, s[4:7], s64 offen offset:0 sc1
    buffer_load_dwordx4 v[100:103], v0, s[4:7], s65 offen offset:0 sc1
    buffer_load_dwordx4 v[104:107], v0, s[4:7], s64 offen offset:1024 sc1
    buffer_load_dwordx4 v[108:111], v0, s[4:7], s65 offen offset:1024 sc1
    buffer_load_dwordx4 v[112:115], v0, s[4:7], s64 offen offset:2048 sc1
    buffer_load_dwordx4 v[116:119], v0, s[4:7], s65 offen offset:2048 sc1
    buffer_load_dwordx4 v[120:123], v0, s[4:7], s64 offen offset:3072 sc1
    buffer_load_dwordx4 v[124:127], v0, s[4:7], s65 offen offset:3072 sc1
    s_lshl_b32 s31, s41, 2
    s_add_u32 s31, s31, 0
    v_add_u32 v28, s31, v0
    s_add_u32 s31, s41, 65536
    v_add_u32 v29, s31, v0
    v_add_u32 v30, s16, v0
    s_waitcnt vmcnt(7)
    v_mfma_f32_16x16x32_bf16 v[32:35], v[176:179], v[96:99], 0
    s_waitcnt vmcnt(6)
    ds_read_b128 v[160:163], v28 offset:0
    ds_read_b128 v[164:167], v28 offset:1024
    v_mfma_f32_16x16x32_bf16 v[48:51], v[176:179], v[100:103], 0
    s_add_u32 s64, s60, 331776
    ds_read_b128 v[168:171], v28 offset:2048
    ds_read_b128 v[172:175], v28 offset:3072
    v_mfma_f32_16x16x32_bf16 v[36:39], v[180:183], v[96:99], 0
    s_add_u32 s65, s64, s73
    buffer_load_dwordx4 v[128:131], v0, s[4:7], s64 offen offset:0 sc1
    v_mfma_f32_16x16x32_bf16 v[52:55], v[180:183], v[100:103], 0
    v_mfma_f32_16x16x32_bf16 v[40:43], v[184:187], v[96:99], 0
    buffer_load_dwordx4 v[132:135], v0, s[4:7], s65 offen offset:0 sc1
    v_mfma_f32_16x16x32_bf16 v[56:59], v[184:187], v[100:103], 0
    s_add_u32 s64, s15, 327680
    s_add_u32 s65, s64, s73
    v_mfma_f32_16x16x32_bf16 v[44:47], v[188:191], v[96:99], 0
    buffer_load_dwordx4 v[136:139], v0, s[4:7], s64 offen offset:0 sc1
    v_mfma_f32_16x16x32_bf16 v[60:63], v[188:191], v[100:103], 0
    s_waitcnt lgkmcnt(2)
    s_waitcnt vmcnt(8)
    v_mfma_f32_16x16x32_bf16 v[32:35], v[160:163], v[104:107], v[32:35]
    s_waitcnt vmcnt(7)
    ds_read_b128 v[144:147], v28 offset:4096
    ds_read_b128 v[148:151], v28 offset:5120
    v_mfma_f32_16x16x32_bf16 v[48:51], v[160:163], v[108:111], v[48:51]
    ds_read_b128 v[152:155], v28 offset:6144
    ds_read_b128 v[156:159], v28 offset:7168
    v_mfma_f32_16x16x32_bf16 v[36:39], v[164:167], v[104:107], v[36:39]
    s_waitcnt lgkmcnt(4)
    buffer_load_dwordx4 v[140:143], v0, s[4:7], s65 offen offset:0 sc1
    v_mfma_f32_16x16x32_bf16 v[52:55], v[164:167], v[108:111], v[52:55]
    v_mfma_f32_16x16x32_bf16 v[40:43], v[168:171], v[104:107], v[40:43]
    buffer_store_dword v5, v4, s[4:7], s18 offen offset:256 sc1
    v_mfma_f32_16x16x32_bf16 v[56:59], v[168:171], v[108:111], v[56:59]
    s_add_u32 s64, s20, 327680
    s_add_u32 s65, s64, s73
    v_mfma_f32_16x16x32_bf16 v[44:47], v[172:175], v[104:107], v[44:47]
    buffer_load_dwordx4 v[96:99], v0, s[4:7], s64 offen offset:0 sc1
    v_mfma_f32_16x16x32_bf16 v[60:63], v[172:175], v[108:111], v[60:63]
    s_waitcnt lgkmcnt(2)
    s_waitcnt vmcnt(9)
    v_mfma_f32_16x16x32_bf16 v[32:35], v[144:147], v[112:115], v[32:35]
    s_waitcnt vmcnt(8)
    ds_read_b128 v[160:163], v28 offset:8192
    ds_read_b128 v[164:167], v28 offset:9216
    v_mfma_f32_16x16x32_bf16 v[48:51], v[144:147], v[116:119], v[48:51]
    ds_read_b128 v[168:171], v28 offset:10240
    ds_read_b128 v[172:175], v28 offset:11264
    v_mfma_f32_16x16x32_bf16 v[36:39], v[148:151], v[112:115], v[36:39]
    s_waitcnt lgkmcnt(4)
    buffer_load_dwordx4 v[100:103], v0, s[4:7], s65 offen offset:0 sc1
    v_mfma_f32_16x16x32_bf16 v[52:55], v[148:151], v[116:119], v[52:55]
    s_add_u32 s64, s61, 327680
    s_add_u32 s65, s64, s73
    v_mfma_f32_16x16x32_bf16 v[40:43], v[152:155], v[112:115], v[40:43]
    buffer_load_dwordx4 v[104:107], v0, s[4:7], s64 offen offset:0 sc1
    v_mfma_f32_16x16x32_bf16 v[56:59], v[152:155], v[116:119], v[56:59]
    v_mfma_f32_16x16x32_bf16 v[44:47], v[156:159], v[112:115], v[44:47]
    buffer_load_dwordx4 v[108:111], v0, s[4:7], s65 offen offset:0 sc1
    v_mfma_f32_16x16x32_bf16 v[60:63], v[156:159], v[116:119], v[60:63]
    s_waitcnt lgkmcnt(2)
    s_waitcnt vmcnt(10)
    s_add_u32 m0, s41, 114688
    v_mfma_f32_16x16x32_bf16 v[32:35], v[160:163], v[120:123], v[32:35]
    s_waitcnt vmcnt(9)
    ds_read_b128 v[144:147], v28 offset:12288
    ds_read_b128 v[148:151], v28 offset:13312
    v_mfma_f32_16x16x32_bf16 v[48:51], v[160:163], v[124:127], v[48:51]
    s_add_u32 s30, s63, 12288
    ds_read_b128 v[152:155], v28 offset:14336
    ds_read_b128 v[156:159], v28 offset:15360
    v_mfma_f32_16x16x32_bf16 v[36:39], v[164:167], v[120:123], v[36:39]
    s_waitcnt lgkmcnt(4)
    s_add_u32 s51, s69, 12288
    v_mfma_f32_16x16x32_bf16 v[52:55], v[164:167], v[124:127], v[52:55]
    buffer_load_dwordx4 v0, s[4:7], s30 offen sc1 lds
    v_mfma_f32_16x16x32_bf16 v[40:43], v[168:171], v[120:123], v[40:43]
    v_mfma_f32_16x16x32_bf16 v[56:59], v[168:171], v[124:127], v[56:59]
    buffer_load_dwordx4 v0, s[4:7], s30 offen offset:1024 sc1 lds
    v_mfma_f32_16x16x32_bf16 v[44:47], v[172:175], v[120:123], v[44:47]
    v_mfma_f32_16x16x32_bf16 v[60:63], v[172:175], v[124:127], v[60:63]
    s_waitcnt lgkmcnt(2)
    s_waitcnt vmcnt(10)
    v_mfma_f32_16x16x32_bf16 v[32:35], v[144:147], v[128:131], v[32:35]
    s_waitcnt vmcnt(9)
    ds_read_b128 v[160:163], v30 offset:0
    ds_read_b128 v[164:167], v30 offset:1024
    v_mfma_f32_16x16x32_bf16 v[48:51], v[144:147], v[132:135], v[48:51]
    ds_read_b128 v[168:171], v30 offset:2048
    ds_read_b128 v[172:175], v30 offset:3072
    v_mfma_f32_16x16x32_bf16 v[36:39], v[148:151], v[128:131], v[36:39]
    s_waitcnt lgkmcnt(4)
    buffer_load_dwordx4 v0, s[4:7], s51 offen offset:2048 sc1 lds
    v_mfma_f32_16x16x32_bf16 v[52:55], v[148:151], v[132:135], v[52:55]
    v_mfma_f32_16x16x32_bf16 v[40:43], v[152:155], v[128:131], v[40:43]
    buffer_load_dwordx4 v0, s[4:7], s51 offen offset:3072 sc1 lds
    v_mfma_f32_16x16x32_bf16 v[56:59], v[152:155], v[132:135], v[56:59]
    v_mfma_f32_16x16x32_bf16 v[44:47], v[156:159], v[128:131], v[44:47]
    buffer_load_dwordx4 v[112:115], v0, s[4:7], s64 offen offset:1024 sc1
    v_mfma_f32_16x16x32_bf16 v[60:63], v[156:159], v[132:135], v[60:63]
    s_waitcnt lgkmcnt(2)
    s_waitcnt vmcnt(11)
    v_mfma_f32_16x16x32_bf16 v[32:35], v[160:163], v[136:139], v[32:35]
    s_waitcnt vmcnt(10)
    ds_read_b128 v[144:147], v30 offset:4096
    ds_read_b128 v[148:151], v30 offset:5120
    v_mfma_f32_16x16x32_bf16 v[48:51], v[160:163], v[140:143], v[48:51]
    ds_read_b128 v[152:155], v30 offset:6144
    ds_read_b128 v[156:159], v30 offset:7168
    v_mfma_f32_16x16x32_bf16 v[36:39], v[164:167], v[136:139], v[36:39]
    s_waitcnt lgkmcnt(4)
    buffer_load_dwordx4 v[116:119], v0, s[4:7], s65 offen offset:1024 sc1
    v_mfma_f32_16x16x32_bf16 v[52:55], v[164:167], v[140:143], v[52:55]
    v_mfma_f32_16x16x32_bf16 v[40:43], v[168:171], v[136:139], v[40:43]
    buffer_load_dword v31, v3, s[4:7], s37 offen offset:256 sc1
    v_mfma_f32_16x16x32_bf16 v[56:59], v[168:171], v[140:143], v[56:59]
    v_mfma_f32_16x16x32_bf16 v[44:47], v[172:175], v[136:139], v[44:47]
    buffer_load_dwordx4 v[120:123], v0, s[4:7], s64 offen offset:2048 sc1
    v_mfma_f32_16x16x32_bf16 v[60:63], v[172:175], v[140:143], v[60:63]
    s_waitcnt lgkmcnt(2)
    s_waitcnt vmcnt(11)
    v_mfma_f32_16x16x32_bf16 v[32:35], v[144:147], v[96:99], v[32:35]
    s_waitcnt vmcnt(10)
    ds_read_b128 v[160:163], v29 offset:0
    ds_read_b128 v[164:167], v29 offset:1024
    v_mfma_f32_16x16x32_bf16 v[48:51], v[144:147], v[100:103], v[48:51]
    ds_read_b128 v[168:171], v29 offset:2048
    ds_read_b128 v[172:175], v29 offset:3072
    v_mfma_f32_16x16x32_bf16 v[36:39], v[148:151], v[96:99], v[36:39]
    s_waitcnt lgkmcnt(4)
    buffer_load_dwordx4 v[124:127], v0, s[4:7], s65 offen offset:2048 sc1
    v_mfma_f32_16x16x32_bf16 v[52:55], v[148:151], v[100:103], v[52:55]
    v_mfma_f32_16x16x32_bf16 v[40:43], v[152:155], v[96:99], v[40:43]
    buffer_load_dwordx4 v[128:131], v0, s[4:7], s64 offen offset:3072 sc1
    v_mfma_f32_16x16x32_bf16 v[56:59], v[152:155], v[100:103], v[56:59]
    v_mfma_f32_16x16x32_bf16 v[44:47], v[156:159], v[96:99], v[44:47]
    buffer_load_dwordx4 v[132:135], v0, s[4:7], s65 offen offset:3072 sc1
    s_waitcnt vmcnt(4)
    v_cmp_ne_u32 vcc, s29, v31
    s_cbranch_vccnz Lrare194
Lrare194b:
    v_mfma_f32_16x16x32_bf16 v[60:63], v[156:159], v[100:103], v[60:63]
    s_waitcnt lgkmcnt(2)
    s_add_u32 s64, s60, 415744
    s_add_u32 s65, s64, s73
    v_mfma_f32_16x16x32_bf16 v[32:35], v[160:163], v[104:107], v[32:35]
    ds_read_b128 v[144:147], v29 offset:16384
    ds_read_b128 v[148:151], v29 offset:17408
    v_mfma_f32_16x16x32_bf16 v[48:51], v[160:163], v[108:111], v[48:51]
    ds_read_b128 v[152:155], v29 offset:18432
    ds_read_b128 v[156:159], v29 offset:19456
    v_mfma_f32_16x16x32_bf16 v[36:39], v[164:167], v[104:107], v[36:39]
    s_waitcnt lgkmcnt(4)
    buffer_load_dwordx4 v[136:139], v0, s[4:7], s64 offen offset:0 sc1
    v_mfma_f32_16x16x32_bf16 v[52:55], v[164:167], v[108:111], v[52:55]
    v_mfma_f32_16x16x32_bf16 v[40:43], v[168:171], v[104:107], v[40:43]
    buffer_load_dwordx4 v[140:143], v0, s[4:7], s65 offen offset:0 sc1
    v_mfma_f32_16x16x32_bf16 v[56:59], v[168:171], v[108:111], v[56:59]
    v_mfma_f32_16x16x32_bf16 v[44:47], v[172:175], v[104:107], v[44:47]
    buffer_load_dwordx4 v[96:99], v0, s[4:7], s64 offen offset:1024 sc1
    v_mfma_f32_16x16x32_bf16 v[60:63], v[172:175], v[108:111], v[60:63]
    s_waitcnt lgkmcnt(2)
    v_mfma_f32_16x16x32_bf16 v[32:35], v[144:147], v[112:115], v[32:35]
    ds_read_b128 v[160:163], v29 offset:32768
    ds_read_b128 v[164:167], v29 offset:33792
    v_mfma_f32_16x16x32_bf16 v[48:51], v[144:147], v[116:119], v[48:51]
    ds_read_b128 v[168:171], v29 offset:34816
    ds_read_b128 v[172:175], v29 offset:35840
    v_mfma_f32_16x16x32_bf16 v[36:39], v[148:151], v[112:115], v[36:39]
    s_waitcnt lgkmcnt(4)
    buffer_load_dwordx4 v[100:103], v0, s[4:7], s65 offen offset:1024 sc1
    v_mfma_f32_16x16x32_bf16 v[52:55], v[148:151], v[116:119], v[52:55]
    v_mfma_f32_16x16x32_bf16 v[40:43], v[152:155], v[112:115], v[40:43]
    buffer_load_dwordx4 v[104:107], v0, s[4:7], s64 offen offset:2048 sc1
    v_mfma_f32_16x16x32_bf16 v[56:59], v[152:155], v[116:119], v[56:59]
    v_mfma_f32_16x16x32_bf16 v[44:47], v[156:159], v[112:115], v[44:47]
    buffer_load_dwordx4 v[108:111], v0, s[4:7], s65 offen offset:2048 sc1
    v_mfma_f32_16x16x32_bf16 v[60:63], v[156:159], v[116:119], v[60:63]
    s_waitcnt lgkmcnt(2)
    s_waitcnt vmcnt(9)
    v_mfma_f32_16x16x32_bf16 v[32:35], v[160:163], v[120:123], v[32:35]
    s_waitcnt vmcnt(8)
    ds_read_b128 v[144:147], v29 offset:49152
    ds_read_b128 v[148:151], v29 offset:50176
    v_mfma_f32_16x16x32_bf16 v[48:51], v[160:163], v[124:127], v[48:51]
    ds_read_b128 v[152:155], v29 offset:51200
    ds_read_b128 v[156:159], v29 offset:52224
    v_mfma_f32_16x16x32_bf16 v[36:39], v[164:167], v[120:123], v[36:39]
    s_waitcnt lgkmcnt(4)
    buffer_load_dwordx4 v[112:115], v0, s[4:7], s64 offen offset:3072 sc1
    v_mfma_f32_16x16x32_bf16 v[52:55], v[164:167], v[124:127], v[52:55]
    v_mfma_f32_16x16x32_bf16 v[40:43], v[168:171], v[120:123], v[40:43]
    buffer_load_dwordx4 v[116:119], v0, s[4:7], s65 offen offset:3072 sc1
    v_mfma_f32_16x16x32_bf16 v[56:59], v[168:171], v[124:127], v[56:59]
    v_mfma_f32_16x16x32_bf16 v[44:47], v[172:175], v[120:123], v[44:47]
    v_mfma_f32_16x16x32_bf16 v[60:63], v[172:175], v[124:127], v[60:63]
    s_waitcnt lgkmcnt(2)
    s_waitcnt vmcnt(9)
    v_mfma_f32_16x16x32_bf16 v[32:35], v[144:147], v[128:131], v[32:35]
    s_waitcnt vmcnt(8)
    s_add_u32 s64, s60, 419840
    s_add_u32 s65, s64, s73
    v_mfma_f32_16x16x32_bf16 v[48:51], v[144:147], v[132:135], v[48:51]
    buffer_load_dwordx4 v[120:123], v0, s[4:7], s64 offen offset:0 sc1
    v_mfma_f32_16x16x32_bf16 v[36:39], v[148:151], v[128:131], v[36:39]
    s_waitcnt lgkmcnt(0)
    v_mfma_f32_16x16x32_bf16 v[52:55], v[148:151], v[132:135], v[52:55]
    buffer_load_dwordx4 v[124:127], v0, s[4:7], s65 offen offset:0 sc1
    v_mfma_f32_16x16x32_bf16 v[40:43], v[152:155], v[128:131], v[40:43]
    v_mfma_f32_16x16x32_bf16 v[56:59], v[152:155], v[132:135], v[56:59]
    v_mfma_f32_16x16x32_bf16 v[44:47], v[156:159], v[128:131], v[44:47]
    v_mfma_f32_16x16x32_bf16 v[60:63], v[156:159], v[132:135], v[60:63]
    s_waitcnt vmcnt(9)
    v_mfma_f32_16x16x32_bf16 v[64:67], v[176:179], v[136:139], 0
    s_waitcnt vmcnt(8)
    ds_read_b128 v[160:163], v28 offset:0
    ds_read_b128 v[164:167], v28 offset:1024
    v_mfma_f32_16x16x32_bf16 v[80:83], v[176:179], v[140:143], 0
    s_add_u32 s64, s15, 415744
    ds_read_b128 v[168:171], v28 offset:2048
    ds_read_b128 v[172:175], v28 offset:3072
    v_mfma_f32_16x16x32_bf16 v[68:71], v[180:183], v[136:139], 0
    s_add_u32 s65, s64, s73
    buffer_load_dwordx4 v[128:131], v0, s[4:7], s64 offen offset:0 sc1
    v_mfma_f32_16x16x32_bf16 v[84:87], v[180:183], v[140:143], 0
    v_mfma_f32_16x16x32_bf16 v[72:75], v[184:187], v[136:139], 0
    buffer_load_dwordx4 v[132:135], v0, s[4:7], s65 offen offset:0 sc1
    v_mfma_f32_16x16x32_bf16 v[88:91], v[184:187], v[140:143], 0
    v_mfma_f32_16x16x32_bf16 v[76:79], v[188:191], v[136:139], 0
    v_mfma_f32_16x16x32_bf16 v[92:95], v[188:191], v[140:143], 0
    s_waitcnt lgkmcnt(2)
    s_waitcnt vmcnt(9)
    v_mfma_f32_16x16x32_bf16 v[64:67], v[160:163], v[96:99], v[64:67]
    s_waitcnt vmcnt(8)
    ds_read_b128 v[144:147], v28 offset:4096
    ds_read_b128 v[148:151], v28 offset:5120
    v_mfma_f32_16x16x32_bf16 v[80:83], v[160:163], v[100:103], v[80:83]
    s_add_u32 s64, s20, 415744
    ds_read_b128 v[152:155], v28 offset:6144
    ds_read_b128 v[156:159], v28 offset:7168
    v_mfma_f32_16x16x32_bf16 v[68:71], v[164:167], v[96:99], v[68:71]
    s_waitcnt lgkmcnt(4)
    s_add_u32 s65, s64, s73
    v_xor_b32 v177, 16384, v28
    v_mfma_f32_16x16x32_bf16 v[84:87], v[164:167], v[100:103], v[84:87]
    buffer_load_dwordx4 v[136:139], v0, s[4:7], s64 offen offset:0 sc1
    v_mfma_f32_16x16x32_bf16 v[72:75], v[168:171], v[96:99], v[72:75]
    v_xor_b32 v178, 32768, v28
    v_xor_b32 v179, 49152, v28
    v_mfma_f32_16x16x32_bf16 v[88:91], v[168:171], v[100:103], v[88:91]
    s_and_b32 s35, s24, 2
    buffer_load_dwordx4 v[140:143], v0, s[4:7], s65 offen offset:0 sc1
    v_mfma_f32_16x16x32_bf16 v[76:79], v[172:175], v[96:99], v[76:79]
    s_lshl_b32 s35, s35, 5
    v_add_u32 v176, s35, v2
    v_mfma_f32_16x16x32_bf16 v[92:95], v[172:175], v[100:103], v[92:95]
    s_waitcnt lgkmcnt(2)
    s_waitcnt vmcnt(9)
    v_mfma_f32_16x16x32_bf16 v[64:67], v[144:147], v[104:107], v[64:67]
    s_waitcnt vmcnt(8)
    ds_read_b128 v[160:163], v28 offset:8192
    ds_read_b128 v[164:167], v28 offset:9216
    v_mfma_f32_16x16x32_bf16 v[80:83], v[144:147], v[108:111], v[80:83]
    s_add_u32 s64, s61, 415744
    ds_read_b128 v[168:171], v28 offset:10240
    ds_read_b128 v[172:175], v28 offset:11264
    v_mfma_f32_16x16x32_bf16 v[68:71], v[148:151], v[104:107], v[68:71]
    s_waitcnt lgkmcnt(4)
    s_add_u32 s65, s64, s73
    v_mfma_f32_16x16x32_bf16 v[84:87], v[148:151], v[108:111], v[84:87]
    buffer_load_dwordx4 v[96:99], v0, s[4:7], s64 offen offset:0 sc1
    v_mfma_f32_16x16x32_bf16 v[72:75], v[152:155], v[104:107], v[72:75]
    ds_write_b128 v28, v[40:43] offset:2048
    v_mfma_f32_16x16x32_bf16 v[88:91], v[152:155], v[108:111], v[88:91]
    buffer_load_dwordx4 v[100:103], v0, s[4:7], s65 offen offset:0 sc1
    v_mfma_f32_16x16x32_bf16 v[76:79], v[156:159], v[104:107], v[76:79]
    ds_write_b128 v28, v[44:47] offset:3072
    v_mfma_f32_16x16x32_bf16 v[92:95], v[156:159], v[108:111], v[92:95]
    s_waitcnt lgkmcnt(4)
    s_waitcnt vmcnt(9)
    v_mfma_f32_16x16x32_bf16 v[64:67], v[160:163], v[112:115], v[64:67]
    s_waitcnt vmcnt(8)
    ds_read_b128 v[144:147], v28 offset:12288
    ds_read_b128 v[148:151], v28 offset:13312
    v_mfma_f32_16x16x32_bf16 v[80:83], v[160:163], v[116:119], v[80:83]
    ds_read_b128 v[152:155], v28 offset:14336
    ds_read_b128 v[156:159], v28 offset:15360
    v_mfma_f32_16x16x32_bf16 v[68:71], v[164:167], v[112:115], v[68:71]
    s_waitcnt lgkmcnt(6)
    buffer_load_dwordx4 v[104:107], v0, s[4:7], s64 offen offset:1024 sc1
    v_mfma_f32_16x16x32_bf16 v[84:87], v[164:167], v[116:119], v[84:87]
    ds_write_b128 v28, v[48:51] offset:4096
    v_mfma_f32_16x16x32_bf16 v[72:75], v[168:171], v[112:115], v[72:75]
    buffer_load_dwordx4 v[108:111], v0, s[4:7], s65 offen offset:1024 sc1
    v_mfma_f32_16x16x32_bf16 v[88:91], v[168:171], v[116:119], v[88:91]
    ds_write_b128 v28, v[52:55] offset:5120
    v_mfma_f32_16x16x32_bf16 v[76:79], v[172:175], v[112:115], v[76:79]
    ds_write_b128 v28, v[56:59] offset:6144
    ds_write_b128 v28, v[60:63] offset:7168
    v_mfma_f32_16x16x32_bf16 v[92:95], v[172:175], v[116:119], v[92:95]
    s_waitcnt lgkmcnt(6)
    s_waitcnt vmcnt(9)
    s_waitcnt lgkmcnt(0)
    s_barrier
    v_mfma_f32_16x16x32_bf16 v[64:67], v[144:147], v[120:123], v[64:67]
    s_waitcnt vmcnt(8)
    ds_read_b128 v[160:163], v30 offset:0
    ds_read_b128 v[164:167], v30 offset:1024
    v_mfma_f32_16x16x32_bf16 v[80:83], v[144:147], v[124:127], v[80:83]
    ds_read_b128 v[168:171], v30 offset:2048
    ds_read_b128 v[172:175], v30 offset:3072
    v_mfma_f32_16x16x32_bf16 v[68:71], v[148:151], v[120:123], v[68:71]
    ds_read_b32 v176, v176 offset:1024
    ds_read_b128 v[40:43], v177 offset:2048
    v_mfma_f32_16x16x32_bf16 v[84:87], v[148:151], v[124:127], v[84:87]
    ds_read_b128 v[44:47], v177 offset:3072
    ds_read_b128 v[48:51], v178 offset:4096
    v_mfma_f32_16x16x32_bf16 v[72:75], v[152:155], v[120:123], v[72:75]
    ds_read_b128 v[52:55], v178 offset:5120
    ds_read_b128 v[56:59], v179 offset:6144
    v_mfma_f32_16x16x32_bf16 v[88:91], v[152:155], v[124:127], v[88:91]
    ds_read_b128 v[60:63], v179 offset:7168
    v_mfma_f32_16x16x32_bf16 v[76:79], v[156:159], v[120:123], v[76:79]
    buffer_load_dwordx4 v[112:115], v0, s[4:7], s64 offen offset:2048 sc1
    v_mfma_f32_16x16x32_bf16 v[92:95], v[156:159], v[124:127], v[92:95]
    s_waitcnt lgkmcnt(9)
    s_waitcnt vmcnt(8)
    v_mfma_f32_16x16x32_bf16 v[64:67], v[160:163], v[128:131], v[64:67]
    s_waitcnt vmcnt(7)
    ds_read_b128 v[144:147], v30 offset:4096
    ds_read_b128 v[148:151], v30 offset:5120
    v_mfma_f32_16x16x32_bf16 v[80:83], v[160:163], v[132:135], v[80:83]
    ds_read_b128 v[152:155], v30 offset:6144
    ds_read_b128 v[156:159], v30 offset:7168
    v_mfma_f32_16x16x32_bf16 v[68:71], v[164:167], v[128:131], v[68:71]
    s_waitcnt lgkmcnt(11)
    buffer_load_dwordx4 v[116:119], v0, s[4:7], s65 offen offset:2048 sc1
    v_mfma_f32_16x16x32_bf16 v[84:87], v[164:167], v[132:135], v[84:87]
    s_waitcnt lgkmcnt(9)
    v_add_f32 v32, v32, v40
    v_add_f32 v33, v33, v41
    v_mfma_f32_16x16x32_bf16 v[72:75], v[168:171], v[128:131], v[72:75]
    buffer_load_dwordx4 v[120:123], v0, s[4:7], s64 offen offset:3072 sc1
    v_mfma_f32_16x16x32_bf16 v[88:91], v[168:171], v[132:135], v[88:91]
    v_add_f32 v34, v34, v42
    v_add_f32 v35, v35, v43
    v_mfma_f32_16x16x32_bf16 v[76:79], v[172:175], v[128:131], v[76:79]
    buffer_load_dwordx4 v[124:127], v0, s[4:7], s65 offen offset:3072 sc1
    s_add_u32 s30, s39, 1048576
    s_cmp_lg_u32 s24, s28
    s_cselect_b32 s30, 0x40000000, s30
    s_mov_b32 m0, 163328
    v_mfma_f32_16x16x32_bf16 v[92:95], v[172:175], v[132:135], v[92:95]
    s_waitcnt lgkmcnt(2)
    s_waitcnt vmcnt(9)
    v_add_f32 v36, v36, v44
    v_mfma_f32_16x16x32_bf16 v[64:67], v[144:147], v[136:139], v[64:67]
    s_waitcnt vmcnt(8)
    ds_read_b128 v[160:163], v29 offset:0
    ds_read_b128 v[164:167], v29 offset:1024
    v_mfma_f32_16x16x32_bf16 v[80:83], v[144:147], v[140:143], v[80:83]
    ds_read_b128 v[168:171], v29 offset:2048
    ds_read_b128 v[172:175], v29 offset:3072
    v_mfma_f32_16x16x32_bf16 v[68:71], v[148:151], v[136:139], v[68:71]
    s_waitcnt lgkmcnt(4)
    buffer_load_dword v6, s[4:7], s30 offen lds
    v_mfma_f32_16x16x32_bf16 v[84:87], v[148:151], v[140:143], v[84:87]
    v_add_f32 v37, v37, v45
    v_add_f32 v38, v38, v46
    v_mfma_f32_16x16x32_bf16 v[72:75], v[152:155], v[136:139], v[72:75]
    v_add_f32 v39, v39, v47
    v_add_f32 v48, v48, v56
    v_mfma_f32_16x16x32_bf16 v[88:91], v[152:155], v[140:143], v[88:91]
    v_add_f32 v49, v49, v57
    v_add_f32 v50, v50, v58
    v_mfma_f32_16x16x32_bf16 v[76:79], v[156:159], v[136:139], v[76:79]
    v_add_f32 v51, v51, v59
    v_add_f32 v52, v52, v60
    v_mfma_f32_16x16x32_bf16 v[92:95], v[156:159], v[140:143], v[92:95]
    s_waitcnt lgkmcnt(2)
    s_waitcnt vmcnt(8)
    v_add_f32 v53, v53, v61
    v_mfma_f32_16x16x32_bf16 v[64:67], v[160:163], v[96:99], v[64:67]
    s_waitcnt vmcnt(7)
    ds_read_b128 v[144:147], v29 offset:16384
    ds_read_b128 v[148:151], v29 offset:17408
    v_mfma_f32_16x16x32_bf16 v[80:83], v[160:163], v[100:103], v[80:83]
    ds_read_b128 v[152:155], v29 offset:18432
    ds_read_b128 v[156:159], v29 offset:19456
    v_mfma_f32_16x16x32_bf16 v[68:71], v[164:167], v[96:99], v[68:71]
    s_waitcnt lgkmcnt(4)
    v_add_f32 v54, v54, v62
    v_add_f32 v55, v55, v63
    v_mfma_f32_16x16x32_bf16 v[84:87], v[164:167], v[100:103], v[84:87]
    v_add_f32 v32, v32, v48
    v_add_f32 v33, v33, v49
    v_mfma_f32_16x16x32_bf16 v[72:75], v[168:171], v[96:99], v[72:75]
    v_add_f32 v34, v34, v50
    v_add_f32 v35, v35, v51
    v_mfma_f32_16x16x32_bf16 v[88:91], v[168:171], v[100:103], v[88:91]
    v_add_f32 v36, v36, v52
    v_add_f32 v37, v37, v53
    v_mfma_f32_16x16x32_bf16 v[76:79], v[172:175], v[96:99], v[76:79]
    v_add_f32 v38, v38, v54
    v_add_f32 v39, v39, v55
    v_mfma_f32_16x16x32_bf16 v[92:95], v[172:175], v[100:103], v[92:95]
    s_waitcnt lgkmcnt(2)
    s_waitcnt vmcnt(6)
    v_fma_f32 v12, -v32, v176, v12
    v_mfma_f32_16x16x32_bf16 v[64:67], v[144:147], v[104:107], v[64:67]
    s_waitcnt vmcnt(5)
    ds_read_b128 v[160:163], v29 offset:32768
    ds_read_b128 v[164:167], v29 offset:33792
    v_mfma_f32_16x16x32_bf16 v[80:83], v[144:147], v[108:111], v[80:83]
    ds_read_b128 v[168:171], v29 offset:34816
    ds_read_b128 v[172:175], v29 offset:35840
    v_mfma_f32_16x16x32_bf16 v[68:71], v[148:151], v[104:107], v[68:71]
    s_waitcnt lgkmcnt(4)
    v_fma_f32 v13, -v33, v176, v13
    v_fma_f32 v14, -v34, v176, v14
    v_mfma_f32_16x16x32_bf16 v[84:87], v[148:151], v[108:111], v[84:87]
    v_fma_f32 v15, -v35, v176, v15
    v_fma_f32 v16, -v36, v176, v16
    v_mfma_f32_16x16x32_bf16 v[72:75], v[152:155], v[104:107], v[72:75]
    v_fma_f32 v17, -v37, v176, v17
    v_fma_f32 v18, -v38, v176, v18
    v_mfma_f32_16x16x32_bf16 v[88:91], v[152:155], v[108:111], v[88:91]
    v_fma_f32 v19, -v39, v176, v19
    v_cvt_pk_bf16_f32 v40, v12, v13
    v_mfma_f32_16x16x32_bf16 v[76:79], v[156:159], v[104:107], v[76:79]
    v_cvt_pk_bf16_f32 v41, v14, v15
    v_cvt_pk_bf16_f32 v42, v16, v17
    v_mfma_f32_16x16x32_bf16 v[92:95], v[156:159], v[108:111], v[92:95]
    s_waitcnt lgkmcnt(2)
    s_waitcnt vmcnt(4)
    v_cvt_pk_bf16_f32 v43, v18, v19
    v_mfma_f32_16x16x32_bf16 v[64:67], v[160:163], v[112:115], v[64:67]
    s_waitcnt vmcnt(3)
    ds_read_b128 v[144:147], v29 offset:49152
    ds_read_b128 v[148:151], v29 offset:50176
    v_mfma_f32_16x16x32_bf16 v[80:83], v[160:163], v[116:119], v[80:83]
    ds_read_b128 v[152:155], v29 offset:51200
    ds_read_b128 v[156:159], v29 offset:52224
    v_mfma_f32_16x16x32_bf16 v[68:71], v[164:167], v[112:115], v[68:71]
    s_waitcnt lgkmcnt(4)
    v_and_b32 v40, -2, v40
    v_and_b32 v42, -2, v42
    v_mfma_f32_16x16x32_bf16 v[84:87], v[164:167], v[116:119], v[84:87]
    s_add_u32 s35, s43, 131072
    buffer_store_dwordx4 v[40:43], v0, s[4:7], s35 offen sc1
    v_mfma_f32_16x16x32_bf16 v[72:75], v[168:171], v[112:115], v[72:75]
    v_add_f32 v44, v12, v13
    v_mul_f32 v45, v12, v12
    v_mfma_f32_16x16x32_bf16 v[88:91], v[168:171], v[116:119], v[88:91]
    v_fmac_f32 v45, v13, v13
    v_add_f32 v44, v44, v14
    v_mfma_f32_16x16x32_bf16 v[76:79], v[172:175], v[112:115], v[76:79]
    v_fmac_f32 v45, v14, v14
    v_add_f32 v44, v44, v15
    v_mfma_f32_16x16x32_bf16 v[92:95], v[172:175], v[116:119], v[92:95]
    s_waitcnt lgkmcnt(2)
    s_waitcnt vmcnt(3) lgkmcnt(1)
    v_fmac_f32 v45, v15, v15
    v_mfma_f32_16x16x32_bf16 v[72:75], v[152:155], v[120:123], v[72:75]
    s_waitcnt vmcnt(2)
    v_add_f32 v44, v44, v16
    v_fmac_f32 v45, v16, v16
    v_mfma_f32_16x16x32_bf16 v[88:91], v[152:155], v[124:127], v[88:91]
    s_waitcnt lgkmcnt(0)
    v_add_f32 v44, v44, v17
    v_fmac_f32 v45, v17, v17
    v_mfma_f32_16x16x32_bf16 v[76:79], v[156:159], v[120:123], v[76:79]
    v_add_f32 v44, v44, v18
    v_fmac_f32 v45, v18, v18
    v_mfma_f32_16x16x32_bf16 v[92:95], v[156:159], v[124:127], v[92:95]
    v_add_f32 v44, v44, v19
    v_fmac_f32 v45, v19, v19
    v_mfma_f32_16x16x32_bf16 v[80:83], v[144:147], v[124:127], v[80:83]
    s_add_u32 s35, s44, 720896
    v_permlane16_swap_b32 v44, v45
    v_add_f32 v44, v44, v45
    v_mfma_f32_16x16x32_bf16 v[84:87], v[148:151], v[124:127], v[84:87]
    v_mov_b32 v45, v44
    s_nop 1
    v_permlane32_swap_b32 v44, v45
    v_mfma_f32_16x16x32_bf16 v[64:67], v[144:147], v[120:123], v[64:67]
    v_add_f32 v44, v44, v45
    v_and_b32 v44, -2, v44
    v_mfma_f32_16x16x32_bf16 v[68:71], v[148:151], v[120:123], v[68:71]
    buffer_store_dword v44, v7, s[4:7], s35 offen sc1
    v_xor_b32 v181, 16384, v28
    v_xor_b32 v182, 32768, v28
    v_xor_b32 v183, 49152, v28
    s_and_b32 s35, s24, 2
    s_lshl_b32 s35, s35, 5
    v_add_u32 v180, s35, v2
    ds_write_b128 v28, v[72:75] offset:10240
    ds_write_b128 v28, v[88:91] offset:14336
    ds_write_b128 v28, v[76:79] offset:11264
    ds_write_b128 v28, v[92:95] offset:15360
    ds_write_b128 v28, v[80:83] offset:12288
    ds_write_b128 v28, v[84:87] offset:13312
    s_waitcnt lgkmcnt(0)
    s_barrier
    ds_read_b32 v180, v180 offset:1152
    ds_read_b128 v[72:75], v181 offset:10240
    ds_read_b128 v[76:79], v181 offset:11264
    ds_read_b128 v[80:83], v182 offset:12288
    ds_read_b128 v[84:87], v182 offset:13312
    ds_read_b128 v[88:91], v183 offset:14336
    ds_read_b128 v[92:95], v183 offset:15360
    s_add_u32 m0, s41, 65536
    s_add_u32 s30, s32, m0
    s_add_u32 s30, s30, 65536
    buffer_load_dwordx4 v0, s[4:7], s30 offen offset:0 sc1 lds
    s_waitcnt lgkmcnt(5)
    v_pk_add_f32 v[64:65], v[64:65], v[72:73]
    v_pk_add_f32 v[66:67], v[66:67], v[74:75]
    s_waitcnt lgkmcnt(4)
    v_pk_add_f32 v[68:69], v[68:69], v[76:77]
    v_pk_add_f32 v[70:71], v[70:71], v[78:79]
    buffer_load_dwordx4 v0, s[4:7], s30 offen offset:1024 sc1 lds
    s_waitcnt lgkmcnt(1)
    v_pk_add_f32 v[80:81], v[80:81], v[88:89]
    v_pk_add_f32 v[82:83], v[82:83], v[90:91]
    s_waitcnt lgkmcnt(0)
    v_pk_add_f32 v[84:85], v[84:85], v[92:93]
    v_pk_add_f32 v[86:87], v[86:87], v[94:95]
    buffer_load_dwordx4 v0, s[4:7], s30 offen offset:2048 sc1 lds
    v_pk_add_f32 v[64:65], v[64:65], v[80:81]
    v_pk_add_f32 v[66:67], v[66:67], v[82:83]
    v_pk_add_f32 v[68:69], v[68:69], v[84:85]
    v_pk_add_f32 v[70:71], v[70:71], v[86:87]
    buffer_load_dwordx4 v0, s[4:7], s30 offen offset:3072 sc1 lds
    v_pk_fma_f32 v[20:21], v[64:65], v[180:181], v[20:21] op_sel_hi:[1,0,1] neg_lo:[1,0,0] neg_hi:[1,0,0]
    v_pk_fma_f32 v[22:23], v[66:67], v[180:181], v[22:23] op_sel_hi:[1,0,1] neg_lo:[1,0,0] neg_hi:[1,0,0]
    v_pk_fma_f32 v[24:25], v[68:69], v[180:181], v[24:25] op_sel_hi:[1,0,1] neg_lo:[1,0,0] neg_hi:[1,0,0]
    v_pk_fma_f32 v[26:27], v[70:71], v[180:181], v[26:27] op_sel_hi:[1,0,1] neg_lo:[1,0,0] neg_hi:[1,0,0]
    s_add_u32 s51, s19, 720896
    buffer_load_dwordx4 v[120:123], v0, s[4:7], s51 offen sc1
    v_cvt_pk_bf16_f32 v72, v20, v21
    v_cvt_pk_bf16_f32 v73, v22, v23
    v_cvt_pk_bf16_f32 v74, v24, v25
    v_cvt_pk_bf16_f32 v75, v26, v27
    s_add_u32 m0, s41, 81920
    s_add_u32 s30, s32, m0
    s_add_u32 s30, s30, 65536
    buffer_load_dwordx4 v0, s[4:7], s30 offen offset:0 sc1 lds
    v_and_b32 v72, -2, v72
    v_and_b32 v74, -2, v74
    s_add_u32 s31, s43, 163840
    buffer_store_dwordx4 v[72:75], v0, s[4:7], s31 offen sc1
    v_dot2_f32_bf16 v76, v72, s45, 0
    v_dot2_f32_bf16 v77, v72, v72, 0
    v_dot2_f32_bf16 v76, v73, s45, v76
    v_dot2_f32_bf16 v77, v73, v73, v77
    v_dot2_f32_bf16 v76, v74, s45, v76
    v_dot2_f32_bf16 v77, v74, v74, v77
    v_dot2_f32_bf16 v76, v75, s45, v76
    v_dot2_f32_bf16 v77, v75, v75, v77
    s_add_u32 s31, s44, 724992
    s_nop 1
    v_permlane16_swap_b32 v76, v77
    v_add_f32 v76, v76, v77
    v_mov_b32 v77, v76
    s_nop 1
    v_permlane32_swap_b32 v76, v77
    v_add_f32 v76, v76, v77
    v_and_b32 v76, -2, v76
    buffer_store_dword v76, v7, s[4:7], s31 offen sc1
    buffer_load_dwordx4 v0, s[4:7], s30 offen offset:1024 sc1 lds
    buffer_load_dwordx4 v0, s[4:7], s30 offen offset:2048 sc1 lds
    buffer_load_dwordx4 v0, s[4:7], s30 offen offset:3072 sc1 lds
    s_add_u32 s30, s71, 0
    buffer_load_dwordx4 v[128:131], v0, s[4:7], s30 offen offset:0 sc1
    buffer_load_dwordx4 v[132:135], v0, s[4:7], s30 offen offset:1024 sc1
    buffer_load_dwordx4 v[136:139], v0, s[4:7], s30 offen offset:2048 sc1
    buffer_load_dwordx4 v[140:143], v0, s[4:7], s30 offen offset:3072 sc1
    v_mov_b32 v112, s45
    v_mov_b32 v113, s45
    v_mov_b32 v114, s45
    v_mov_b32 v115, s45
    v_add_u32 v116, 65536, v0
    v_add_u32 v117, 66560, v0
    v_add_u32 v118, 67584, v0
    v_add_u32 v119, 68608, v0
    s_add_u32 s31, s41, 65536
    v_add_u32 v28, s31, v0
    s_waitcnt vmcnt(11)
    ds_read_b128 v[176:179], v28 offset:0
    ds_read_b128 v[180:183], v28 offset:1024
    ds_read_b128 v[184:187], v28 offset:2048
    ds_read_b128 v[188:191], v28 offset:3072
    s_waitcnt lgkmcnt(2)
    v_bitop3_b32 v176, v176, v178, v180 bitop3:0xfe
    s_waitcnt lgkmcnt(1)
    v_bitop3_b32 v182, v182, v184, v186 bitop3:0xfe
    s_waitcnt lgkmcnt(0)
    v_bitop3_b32 v176, v176, v182, v188 bitop3:0xfe
    v_bitop3_b32 v176, v176, v190, 1 bitop3:0xa8
    v_cmp_ne_u32 s[56:57], 0, v176
    s_nop 1
    s_cmp_lg_u64 s[56:57], 0
    s_cbranch_scc1 Lrare196
Lrare196b:
    s_barrier
    ds_read_b128 v[32:35], v116 offset:0
    ds_read_b128 v[36:39], v117 offset:0
    ds_read_b128 v[40:43], v118 offset:0
    ds_read_b128 v[44:47], v119 offset:0
    ds_read_b128 v[48:51], v116 offset:4096
    s_waitcnt lgkmcnt(4)
    v_mfma_f32_16x16x32_bf16 v[56:59], v[32:35], a[192:195], 0
    v_mfma_f32_16x16x32_bf16 v[60:63], v[32:35], v[192:195], 0
    s_waitcnt lgkmcnt(3)
    ds_read_b128 v[52:55], v117 offset:4096
    v_mfma_f32_16x16x32_bf16 v[56:59], v[36:39], a[196:199], v[56:59]
    s_waitcnt vmcnt(4)
    ds_read_b128 v[176:179], v28 offset:16384
    ds_read_b128 v[180:183], v28 offset:17408
    v_mfma_f32_16x16x32_bf16 v[60:63], v[36:39], v[196:199], v[60:63]
    s_waitcnt lgkmcnt(5)
    ds_read_b128 v[32:35], v118 offset:4096
    ds_read_b128 v[184:187], v28 offset:18432
    v_mfma_f32_16x16x32_bf16 v[56:59], v[40:43], a[200:203], v[56:59]
    ds_read_b128 v[188:191], v28 offset:19456
    v_bitop3_b32 v31, v120, v121, v122 bitop3:0xfe
    v_mfma_f32_16x16x32_bf16 v[60:63], v[40:43], v[200:203], v[60:63]
    s_waitcnt lgkmcnt(7)
    ds_read_b128 v[36:39], v119 offset:4096
    v_bitop3_b32 v31, v31, v123, 1 bitop3:0xa8
    v_cmp_ne_u32 vcc, 0, v31
    s_cbranch_vccnz Lrare198
Lrare198b:
    v_mfma_f32_16x16x32_bf16 v[56:59], v[44:47], a[204:207], v[56:59]
    s_add_u32 m0, s41, 98304
    s_add_u32 s30, s32, m0
    s_add_u32 s30, s30, 65536
    v_mfma_f32_16x16x32_bf16 v[60:63], v[44:47], v[204:207], v[60:63]
    s_waitcnt lgkmcnt(7)
    ds_read_b128 v[40:43], v116 offset:8192
    v_add_f32 v120, v120, v122
    v_mfma_f32_16x16x32_bf16 v[56:59], v[48:51], a[208:211], v[56:59]
    buffer_load_dwordx4 v0, s[4:7], s30 offen offset:0 sc1 lds
    v_mfma_f32_16x16x32_bf16 v[60:63], v[48:51], v[208:211], v[60:63]
    s_waitcnt lgkmcnt(7)
    ds_read_b128 v[44:47], v117 offset:8192
    v_add_f32 v121, v121, v123
    v_mfma_f32_16x16x32_bf16 v[56:59], v[52:55], a[212:215], v[56:59]
    s_nop 0
    v_add_f32_dpp v120, v120, v120 quad_perm:[1,0,3,2] row_mask:0xf bank_mask:0xf
    v_add_f32_dpp v121, v121, v121 quad_perm:[1,0,3,2] row_mask:0xf bank_mask:0xf
    v_mfma_f32_16x16x32_bf16 v[60:63], v[52:55], v[212:215], v[60:63]
    s_waitcnt lgkmcnt(5)
    ds_read_b128 v[48:51], v118 offset:8192
    v_add_f32_dpp v120, v120, v120 quad_perm:[2,3,0,1] row_mask:0xf bank_mask:0xf
    v_mfma_f32_16x16x32_bf16 v[56:59], v[32:35], a[216:219], v[56:59]
    buffer_load_dwordx4 v0, s[4:7], s30 offen offset:1024 sc1 lds
    v_mfma_f32_16x16x32_bf16 v[60:63], v[32:35], v[216:219], v[60:63]
    s_waitcnt lgkmcnt(3)
    ds_read_b128 v[52:55], v119 offset:8192
    v_add_f32_dpp v121, v121, v121 quad_perm:[2,3,0,1] row_mask:0xf bank_mask:0xf
    v_mfma_f32_16x16x32_bf16 v[56:59], v[36:39], a[220:223], v[56:59]
    v_add_f32_dpp v120, v120, v120 row_half_mirror row_mask:0xf bank_mask:0xf
    v_add_f32_dpp v121, v121, v121 row_half_mirror row_mask:0xf bank_mask:0xf
    v_mfma_f32_16x16x32_bf16 v[60:63], v[36:39], v[220:223], v[60:63]
    s_waitcnt lgkmcnt(3)
    ds_read_b128 v[32:35], v116 offset:12288
    v_mul_f32 v120, 0xbb000000, v120
    v_mfma_f32_16x16x32_bf16 v[56:59], v[40:43], a[224:227], v[56:59]
    buffer_load_dwordx4 v0, s[4:7], s30 offen offset:2048 sc1 lds
    v_mfma_f32_16x16x32_bf16 v[60:63], v[40:43], v[224:227], v[60:63]
    s_waitcnt lgkmcnt(3)
    ds_read_b128 v[36:39], v117 offset:12288
    v_mul_f32 v121, 0x3b000000, v121
    v_mfma_f32_16x16x32_bf16 v[56:59], v[44:47], a[228:231], v[56:59]
    v_fma_f32 v121, -v120, v120, v121
    v_bitop3_b32 v176, v176, v178, v180 bitop3:0xfe
    v_mfma_f32_16x16x32_bf16 v[60:63], v[44:47], v[228:231], v[60:63]
    s_waitcnt lgkmcnt(3)
    ds_read_b128 v[40:43], v118 offset:12288
    v_bitop3_b32 v182, v182, v184, v186 bitop3:0xfe
    v_mfma_f32_16x16x32_bf16 v[56:59], v[48:51], a[232:235], v[56:59]
    buffer_load_dwordx4 v0, s[4:7], s30 offen offset:3072 sc1 lds
    v_bitop3_b32 v176, v176, v182, v188 bitop3:0xfe
    v_bitop3_b32 v176, v176, v190, 1 bitop3:0xa8
    v_cmp_ne_u32 s[56:57], 0, v176
    v_mfma_f32_16x16x32_bf16 v[60:63], v[48:51], v[232:235], v[60:63]
    s_waitcnt lgkmcnt(3)
    ds_read_b128 v[44:47], v119 offset:12288
    s_add_u32 s30, s19, 724992
    v_mfma_f32_16x16x32_bf16 v[56:59], v[52:55], a[236:239], v[56:59]
    s_cmp_lg_u64 s[56:57], 0
    s_cbranch_scc1 Lrare200
Lrare200b:
    s_barrier
    v_mfma_f32_16x16x32_bf16 v[60:63], v[52:55], v[236:239], v[60:63]
    s_waitcnt lgkmcnt(3)
    ds_read_b128 v[48:51], v116 offset:16384
    v_mfma_f32_16x16x32_bf16 v[56:59], v[32:35], a[240:243], v[56:59]
    buffer_load_dwordx4 v[124:127], v0, s[4:7], s30 offen sc1
    v_mfma_f32_16x16x32_bf16 v[60:63], v[32:35], v[240:243], v[60:63]
    s_waitcnt lgkmcnt(3)
    ds_read_b128 v[52:55], v117 offset:16384
    s_add_u32 m0, s41, 114688
    ds_write_b32 v8, v120 offset:768
    v_max_f32 v121, 0, v121
    v_add_f32 v121, 0x3727c5ac, v121
    v_rsq_f32 v121, v121
    s_nop 0
    v_mul_f32 v122, v120, v121
    ds_write_b32 v8, v121 offset:0
    v_mul_f32 v121, s50, v121
    ds_write_b32 v8, v122 offset:256
    ds_write_b32 v8, v121 offset:512
    v_mfma_f32_16x16x32_bf16 v[56:59], v[36:39], a[244:247], v[56:59]
    s_add_u32 s30, s32, m0
    s_add_u32 s30, s30, 65536
    v_mfma_f32_16x16x32_bf16 v[60:63], v[36:39], v[244:247], v[60:63]
    s_waitcnt lgkmcnt(7)
    ds_read_b128 v[32:35], v118 offset:16384
    v_mfma_f32_16x16x32_bf16 v[56:59], v[40:43], a[248:251], v[56:59]
    s_waitcnt lgkmcnt(1)
    s_barrier
    ds_read_b128 v[80:83], v1 offset:256
    v_mfma_f32_16x16x32_bf16 v[60:63], v[40:43], v[248:251], v[60:63]
    ds_read_b128 v[36:39], v119 offset:16384
    ds_read_b128 v[72:75], v1 offset:512
    v_mfma_f32_16x16x32_bf16 v[56:59], v[44:47], a[252:255], v[56:59]
    ds_read_b128 v[76:79], v1 offset:0
    v_mfma_f32_16x16x32_bf16 v[60:63], v[44:47], v[252:255], v[60:63]
    ds_read_b128 v[40:43], v116 offset:20480
    v_mfma_f32_16x16x32_bf16 v[64:67], v[48:51], a[192:195], 0
    buffer_load_dwordx4 v0, s[4:7], s30 offen offset:0 sc1 lds
    v_mfma_f32_16x16x32_bf16 v[68:71], v[48:51], v[192:195], 0
    ds_read_b128 v[44:47], v117 offset:20480
    v_mfma_f32_16x16x32_bf16 v[64:67], v[52:55], a[196:199], v[64:67]
    s_waitcnt lgkmcnt(5)
    v_fma_f32 v84, v80, v10, s48
    v_fma_f32 v85, v81, v10, s48
    v_mfma_f32_16x16x32_bf16 v[68:71], v[52:55], v[196:199], v[68:71]
    ds_read_b128 v[48:51], v118 offset:20480
    v_fma_f32 v86, v82, v10, s48
    v_mfma_f32_16x16x32_bf16 v[64:67], v[32:35], a[200:203], v[64:67]
    s_waitcnt vmcnt(2)
    ds_read_b128 v[176:179], v28 offset:32768
    ds_read_b128 v[180:183], v28 offset:33792
    v_mfma_f32_16x16x32_bf16 v[68:71], v[32:35], v[200:203], v[68:71]
    s_waitcnt lgkmcnt(7)
    ds_read_b128 v[52:55], v119 offset:20480
    ds_read_b128 v[184:187], v28 offset:34816
    v_mfma_f32_16x16x32_bf16 v[64:67], v[36:39], a[204:207], v[64:67]
    ds_read_b128 v[188:191], v28 offset:35840
    v_fma_f32 v87, v83, v10, s48
    v_mfma_f32_16x16x32_bf16 v[68:71], v[36:39], v[204:207], v[68:71]
    s_waitcnt lgkmcnt(7)
    ds_read_b128 v[32:35], v116 offset:24576
    v_fma_f32 v84, v56, v72, v84
    v_mfma_f32_16x16x32_bf16 v[64:67], v[40:43], a[208:211], v[64:67]
    buffer_load_dwordx4 v0, s[4:7], s30 offen offset:1024 sc1 lds
    v_mfma_f32_16x16x32_bf16 v[68:71], v[40:43], v[208:211], v[68:71]
    s_waitcnt lgkmcnt(7)
    ds_read_b128 v[36:39], v117 offset:24576
    v_fma_f32 v85, v57, v73, v85
    v_mfma_f32_16x16x32_bf16 v[64:67], v[44:47], a[212:215], v[64:67]
    v_fma_f32 v86, v58, v74, v86
    v_fma_f32 v87, v59, v75, v87
    v_mfma_f32_16x16x32_bf16 v[68:71], v[44:47], v[212:215], v[68:71]
    s_waitcnt lgkmcnt(7)
    ds_read_b128 v[40:43], v118 offset:24576
    v_mul_f32 v92, v80, v11
    v_mfma_f32_16x16x32_bf16 v[64:67], v[48:51], a[216:219], v[64:67]
    buffer_load_dwordx4 v0, s[4:7], s30 offen offset:2048 sc1 lds
    v_mfma_f32_16x16x32_bf16 v[68:71], v[48:51], v[216:219], v[68:71]
    s_waitcnt lgkmcnt(5)
    ds_read_b128 v[44:47], v119 offset:24576
    v_bitop3_b32 v176, v176, v178, v180 bitop3:0xfe
    v_mfma_f32_16x16x32_bf16 v[64:67], v[52:55], a[220:223], v[64:67]
    s_waitcnt lgkmcnt(5)
    v_bitop3_b32 v182, v182, v184, v186 bitop3:0xfe
    v_mul_f32 v93, v81, v11
    v_mfma_f32_16x16x32_bf16 v[68:71], v[52:55], v[220:223], v[68:71]
    s_waitcnt lgkmcnt(3)
    ds_read_b128 v[48:51], v116 offset:28672
    v_bitop3_b32 v176, v176, v182, v188 bitop3:0xfe
    v_mfma_f32_16x16x32_bf16 v[64:67], v[32:35], a[224:227], v[64:67]
    buffer_load_dwordx4 v0, s[4:7], s30 offen offset:3072 sc1 lds
    v_mfma_f32_16x16x32_bf16 v[68:71], v[32:35], v[224:227], v[68:71]
    s_waitcnt lgkmcnt(3)
    ds_read_b128 v[52:55], v117 offset:28672
    s_add_u32 s30, s71, 4096
    v_mfma_f32_16x16x32_bf16 v[64:67], v[36:39], a[228:231], v[64:67]
    v_bitop3_b32 v176, v176, v190, 1 bitop3:0xa8
    v_cmp_ne_u32 s[56:57], 0, v176
    v_mfma_f32_16x16x32_bf16 v[68:71], v[36:39], v[228:231], v[68:71]
    s_waitcnt lgkmcnt(3)
    ds_read_b128 v[32:35], v118 offset:28672
    v_mul_f32 v94, v82, v11
    v_mfma_f32_16x16x32_bf16 v[64:67], v[40:43], a[232:235], v[64:67]
    buffer_load_dwordx4 v[144:147], v0, s[4:7], s30 offen offset:0 sc1
    v_mfma_f32_16x16x32_bf16 v[68:71], v[40:43], v[232:235], v[68:71]
    s_waitcnt lgkmcnt(3)
    ds_read_b128 v[36:39], v119 offset:28672
    v_mul_f32 v95, v83, v11
    v_mfma_f32_16x16x32_bf16 v[64:67], v[44:47], a[236:239], v[64:67]
    s_cmp_lg_u64 s[56:57], 0
    s_cbranch_scc1 Lrare202
Lrare202b:
    s_barrier
    v_mfma_f32_16x16x32_bf16 v[68:71], v[44:47], v[236:239], v[68:71]
    s_waitcnt lgkmcnt(3)
    ds_read_b128 v[40:43], v116 offset:32768
    v_fma_f32 v92, v60, v76, v92
    v_mfma_f32_16x16x32_bf16 v[64:67], v[48:51], a[240:243], v[64:67]
    buffer_load_dwordx4 v[148:151], v0, s[4:7], s30 offen offset:1024 sc1
    v_mfma_f32_16x16x32_bf16 v[68:71], v[48:51], v[240:243], v[68:71]
    s_waitcnt lgkmcnt(3)
    ds_read_b128 v[44:47], v117 offset:32768
    v_fma_f32 v93, v61, v77, v93
    v_mfma_f32_16x16x32_bf16 v[64:67], v[52:55], a[244:247], v[64:67]
    s_waitcnt vmcnt(6)
    v_bitop3_b32 v31, v124, v125, v126 bitop3:0xfe
    v_bitop3_b32 v31, v31, v127, 1 bitop3:0xa8
    v_cmp_ne_u32 vcc, 0, v31
    s_cbranch_vccnz Lrare204
Lrare204b:
    v_mfma_f32_16x16x32_bf16 v[68:71], v[52:55], v[244:247], v[68:71]
    s_waitcnt lgkmcnt(3)
    ds_read_b128 v[48:51], v118 offset:32768
    v_add_f32 v124, v124, v126
    v_mfma_f32_16x16x32_bf16 v[64:67], v[32:35], a[248:251], v[64:67]
    s_waitcnt vmcnt(2)
    ds_read_b128 v[176:179], v28 offset:49152
    ds_read_b128 v[180:183], v28 offset:50176
    v_mfma_f32_16x16x32_bf16 v[68:71], v[32:35], v[248:251], v[68:71]
    s_waitcnt lgkmcnt(5)
    ds_read_b128 v[52:55], v119 offset:32768
    ds_read_b128 v[184:187], v28 offset:51200
    v_exp_f32 v88, v84 clamp
    v_max_f32 v84, s48, v84
    v_exp_f32 v89, v85 clamp
    v_max_f32 v85, s48, v85
    v_exp_f32 v90, v86 clamp
    v_max_f32 v86, s48, v86
    v_exp_f32 v91, v87 clamp
    v_max_f32 v87, s48, v87
    v_fma_f32 v84, v84, s49, v88
    v_fma_f32 v85, v85, s49, v89
    v_fma_f32 v86, v86, s49, v90
    v_fma_f32 v87, v87, s49, v91
    v_cvt_pk_bf16_f32 v96, v84, v85
    v_cvt_pk_bf16_f32 v97, v86, v87
    v_fma_f32 v94, v62, v78, v94
    v_fma_f32 v95, v63, v79, v95
    v_cvt_pk_bf16_f32 v100, v92, v93
    v_cvt_pk_bf16_f32 v101, v94, v95
    v_mfma_f32_16x16x32_bf16 v[64:67], v[36:39], a[252:255], v[64:67]
    ds_read_b128 v[188:191], v28 offset:52224
    v_add_f32 v125, v125, v127
    v_mfma_f32_16x16x32_bf16 v[68:71], v[36:39], v[252:255], v[68:71]
    s_waitcnt lgkmcnt(7)
    ds_read_b128 v[32:35], v116 offset:36864
    ds_read_b128 v[80:83], v1 offset:320
    v_mfma_f32_16x16x32_bf16 v[56:59], v[40:43], a[192:195], 0
    ds_read_b128 v[72:75], v1 offset:576
    ds_read_b128 v[76:79], v1 offset:64
    v_mfma_f32_16x16x32_bf16 v[60:63], v[40:43], v[192:195], 0
    s_waitcnt lgkmcnt(10)
    ds_read_b128 v[36:39], v117 offset:36864
    s_nop 0
    v_mfma_f32_16x16x32_bf16 v[56:59], v[44:47], a[196:199], v[56:59]
    buffer_load_dwordx4 v[152:155], v0, s[4:7], s30 offen offset:2048 sc1
    v_mfma_f32_16x16x32_bf16 v[60:63], v[44:47], v[196:199], v[60:63]
    s_waitcnt lgkmcnt(10)
    ds_read_b128 v[40:43], v118 offset:36864
    v_add_f32_dpp v124, v124, v124 quad_perm:[1,0,3,2] row_mask:0xf bank_mask:0xf
    v_mfma_f32_16x16x32_bf16 v[56:59], v[48:51], a[200:203], v[56:59]
    s_waitcnt lgkmcnt(9)
    v_bitop3_b32 v176, v176, v178, v180 bitop3:0xfe
    v_add_f32_dpp v125, v125, v125 quad_perm:[1,0,3,2] row_mask:0xf bank_mask:0xf
    v_mfma_f32_16x16x32_bf16 v[60:63], v[48:51], v[200:203], v[60:63]
    s_waitcnt lgkmcnt(8)
    ds_read_b128 v[44:47], v119 offset:36864
    v_add_f32_dpp v124, v124, v124 quad_perm:[2,3,0,1] row_mask:0xf bank_mask:0xf
    v_mfma_f32_16x16x32_bf16 v[56:59], v[52:55], a[204:207], v[56:59]
    buffer_load_dwordx4 v[156:159], v0, s[4:7], s30 offen offset:3072 sc1
    v_mfma_f32_16x16x32_bf16 v[60:63], v[52:55], v[204:207], v[60:63]
    s_waitcnt lgkmcnt(6)
    ds_read_b128 v[48:51], v116 offset:40960
    s_add_u32 s30, s71, 8192
    v_mfma_f32_16x16x32_bf16 v[56:59], v[32:35], a[208:211], v[56:59]
    v_bitop3_b32 v182, v182, v184, v186 bitop3:0xfe
    v_bitop3_b32 v176, v176, v182, v188 bitop3:0xfe
    v_mfma_f32_16x16x32_bf16 v[60:63], v[32:35], v[208:211], v[60:63]
    s_waitcnt lgkmcnt(3)
    ds_read_b128 v[52:55], v117 offset:40960
    v_bitop3_b32 v176, v176, v190, 1 bitop3:0xa8
    v_mfma_f32_16x16x32_bf16 v[56:59], v[36:39], a[212:215], v[56:59]
    buffer_load_dwordx4 v[160:163], v0, s[4:7], s30 offen offset:0 sc1
    v_mfma_f32_16x16x32_bf16 v[60:63], v[36:39], v[212:215], v[60:63]
    s_waitcnt lgkmcnt(3)
    ds_read_b128 v[32:35], v118 offset:40960
    v_cmp_ne_u32 s[56:57], 0, v176
    v_mfma_f32_16x16x32_bf16 v[56:59], v[40:43], a[216:219], v[56:59]
    v_add_f32_dpp v125, v125, v125 quad_perm:[2,3,0,1] row_mask:0xf bank_mask:0xf
    v_add_f32_dpp v124, v124, v124 row_half_mirror row_mask:0xf bank_mask:0xf
    v_mfma_f32_16x16x32_bf16 v[60:63], v[40:43], v[216:219], v[60:63]
    s_waitcnt lgkmcnt(3)
    ds_read_b128 v[36:39], v119 offset:40960
    v_add_f32_dpp v125, v125, v125 row_half_mirror row_mask:0xf bank_mask:0xf
    v_mfma_f32_16x16x32_bf16 v[56:59], v[44:47], a[220:223], v[56:59]
    buffer_load_dwordx4 v[164:167], v0, s[4:7], s30 offen offset:1024 sc1
    v_mfma_f32_16x16x32_bf16 v[60:63], v[44:47], v[220:223], v[60:63]
    s_waitcnt lgkmcnt(3)
    ds_read_b128 v[40:43], v116 offset:45056
    v_mul_f32 v124, 0xbb000000, v124
    v_mfma_f32_16x16x32_bf16 v[56:59], v[48:51], a[224:227], v[56:59]
    v_mul_f32 v125, 0x3b000000, v125
    v_fma_f32 v125, -v124, v124, v125
    v_mfma_f32_16x16x32_bf16 v[60:63], v[48:51], v[224:227], v[60:63]
    s_waitcnt lgkmcnt(3)
    ds_read_b128 v[44:47], v117 offset:45056
    v_fma_f32 v84, v80, v10, s48
    v_mfma_f32_16x16x32_bf16 v[56:59], v[52:55], a[228:231], v[56:59]
    buffer_load_dwordx4 v[168:171], v0, s[4:7], s30 offen offset:2048 sc1
    v_mfma_f32_16x16x32_bf16 v[60:63], v[52:55], v[228:231], v[60:63]
    s_waitcnt lgkmcnt(3)
    ds_read_b128 v[48:51], v118 offset:45056
    v_fma_f32 v85, v81, v10, s48
    v_mfma_f32_16x16x32_bf16 v[56:59], v[32:35], a[232:235], v[56:59]
    ds_write_b32 v8, v124 offset:896
    v_mfma_f32_16x16x32_bf16 v[60:63], v[32:35], v[232:235], v[60:63]
    s_waitcnt lgkmcnt(4)
    ds_read_b128 v[52:55], v119 offset:45056
    v_max_f32 v125, 0, v125
    v_add_f32 v125, 0x3727c5ac, v125
    v_rsq_f32 v125, v125
    s_nop 0
    v_mul_f32 v126, v124, v125
    ds_write_b32 v8, v125 offset:128
    v_mul_f32 v125, s50, v125
    ds_write_b32 v8, v126 offset:384
    ds_write_b32 v8, v125 offset:640
    v_mfma_f32_16x16x32_bf16 v[56:59], v[36:39], a[236:239], v[56:59]
    s_cmp_lg_u64 s[56:57], 0
    s_cbranch_scc1 Lrare206
Lrare206b:
    s_waitcnt lgkmcnt(0)
    s_barrier
    v_mfma_f32_16x16x32_bf16 v[60:63], v[36:39], v[236:239], v[60:63]
    ds_read_b128 v[32:35], v116 offset:49152
    v_fma_f32 v86, v82, v10, s48
    v_mfma_f32_16x16x32_bf16 v[56:59], v[40:43], a[240:243], v[56:59]
    buffer_load_dwordx4 v[172:175], v0, s[4:7], s30 offen offset:3072 sc1
    v_mfma_f32_16x16x32_bf16 v[60:63], v[40:43], v[240:243], v[60:63]
    s_add_u32 s51, s33, 0
    ds_read_b128 v[36:39], v117 offset:49152
    s_and_b32 s51, s51, 0x3fff
    v_mfma_f32_16x16x32_bf16 v[56:59], v[44:47], a[244:247], v[56:59]
    s_lshl_b32 s30, s41, 2
    s_add_u32 s30, s30, s51
    s_add_u32 m0, s30, 0
    v_mfma_f32_16x16x32_bf16 v[60:63], v[44:47], v[244:247], v[60:63]
    s_add_u32 s30, s71, s51
    ds_read_b128 v[40:43], v118 offset:49152
    s_add_u32 s30, s30, 65536
    v_mfma_f32_16x16x32_bf16 v[56:59], v[48:51], a[248:251], v[56:59]
    buffer_load_dwordx4 v0, s[4:7], s30 offen offset:0 sc1 lds
    v_mfma_f32_16x16x32_bf16 v[60:63], v[48:51], v[248:251], v[60:63]
    ds_read_b128 v[44:47], v119 offset:49152
    v_fma_f32 v87, v83, v10, s48
    v_fma_f32 v84, v64, v72, v84
    v_fma_f32 v85, v65, v73, v85
    v_fma_f32 v86, v66, v74, v86
    v_fma_f32 v87, v67, v75, v87
    v_exp_f32 v88, v84 clamp
    v_max_f32 v84, s48, v84
    v_exp_f32 v89, v85 clamp
    v_max_f32 v85, s48, v85
    v_exp_f32 v90, v86 clamp
    v_max_f32 v86, s48, v86
    v_exp_f32 v91, v87 clamp
    v_max_f32 v87, s48, v87
    v_fma_f32 v84, v84, s49, v88
    v_fma_f32 v85, v85, s49, v89
    v_fma_f32 v86, v86, s49, v90
    v_fma_f32 v87, v87, s49, v91
    v_cvt_pk_bf16_f32 v98, v84, v85
    v_cvt_pk_bf16_f32 v99, v86, v87
    v_mul_f32 v92, v80, v11
    v_mul_f32 v93, v81, v11
    v_mul_f32 v94, v82, v11
    v_mul_f32 v95, v83, v11
    v_fma_f32 v92, v68, v76, v92
    v_fma_f32 v93, v69, v77, v93
    v_fma_f32 v94, v70, v78, v94
    v_fma_f32 v95, v71, v79, v95
    v_cvt_pk_bf16_f32 v102, v92, v93
    v_cvt_pk_bf16_f32 v103, v94, v95
    v_mfma_f32_16x16x32_bf16 v[56:59], v[52:55], a[252:255], v[56:59]
    v_mfma_f32_16x16x32_bf16 v[108:111], v[96:99], v[112:115], 0
    v_mfma_f32_16x16x32_bf16 v[104:107], v[96:99], v[100:103], 0
    v_mfma_f32_16x16x32_bf16 v[60:63], v[52:55], v[252:255], v[60:63]
    s_waitcnt lgkmcnt(3)
    ds_read_b128 v[48:51], v116 offset:53248
    ds_read_b128 v[80:83], v1 offset:384
    v_mfma_f32_16x16x32_bf16 v[64:67], v[32:35], a[192:195], 0
    ds_read_b128 v[72:75], v1 offset:640
    ds_read_b128 v[76:79], v1 offset:128
    v_mfma_f32_16x16x32_bf16 v[68:71], v[32:35], v[192:195], 0
    s_waitcnt lgkmcnt(6)
    ds_read_b128 v[52:55], v117 offset:53248
    v_mfma_f32_16x16x32_bf16 v[64:67], v[36:39], a[196:199], v[64:67]
    buffer_load_dwordx4 v0, s[4:7], s30 offen offset:1024 sc1 lds
    v_mfma_f32_16x16x32_bf16 v[68:71], v[36:39], v[196:199], v[68:71]
    s_waitcnt lgkmcnt(6)
    ds_read_b128 v[32:35], v118 offset:53248
    v_mfma_f32_16x16x32_bf16 v[64:67], v[40:43], a[200:203], v[64:67]
    s_waitcnt lgkmcnt(4)
    v_fma_f32 v84, v80, v10, s48
    v_fma_f32 v85, v81, v10, s48
    v_mfma_f32_16x16x32_bf16 v[68:71], v[40:43], v[200:203], v[68:71]
    ds_read_b128 v[36:39], v119 offset:53248
    v_fma_f32 v86, v82, v10, s48
    v_mfma_f32_16x16x32_bf16 v[64:67], v[44:47], a[204:207], v[64:67]
    buffer_load_dwordx4 v0, s[4:7], s30 offen offset:2048 sc1 lds
    v_mfma_f32_16x16x32_bf16 v[68:71], v[44:47], v[204:207], v[68:71]
    ds_read_b128 v[40:43], v116 offset:57344
    v_fma_f32 v87, v83, v10, s48
    v_mfma_f32_16x16x32_bf16 v[64:67], v[48:51], a[208:211], v[64:67]
    s_waitcnt lgkmcnt(5)
    v_fma_f32 v84, v56, v72, v84
    v_fma_f32 v85, v57, v73, v85
    v_mfma_f32_16x16x32_bf16 v[68:71], v[48:51], v[208:211], v[68:71]
    s_waitcnt lgkmcnt(3)
    ds_read_b128 v[44:47], v117 offset:57344
    v_fma_f32 v86, v58, v74, v86
    v_mfma_f32_16x16x32_bf16 v[64:67], v[52:55], a[212:215], v[64:67]
    buffer_load_dwordx4 v0, s[4:7], s30 offen offset:3072 sc1 lds
    v_mfma_f32_16x16x32_bf16 v[68:71], v[52:55], v[212:215], v[68:71]
    s_waitcnt lgkmcnt(3)
    ds_read_b128 v[48:51], v118 offset:57344
    s_add_u32 s30, s71, 12288
    v_mfma_f32_16x16x32_bf16 v[64:67], v[32:35], a[216:219], v[64:67]
    v_fma_f32 v87, v59, v75, v87
    v_mul_f32 v92, v80, v11
    v_mfma_f32_16x16x32_bf16 v[68:71], v[32:35], v[216:219], v[68:71]
    s_waitcnt lgkmcnt(3)
    ds_read_b128 v[52:55], v119 offset:57344
    v_mul_f32 v93, v81, v11
    v_mfma_f32_16x16x32_bf16 v[64:67], v[36:39], a[220:223], v[64:67]
    buffer_load_dwordx4 v[176:179], v0, s[4:7], s30 offen offset:0 sc1
    v_mfma_f32_16x16x32_bf16 v[68:71], v[36:39], v[220:223], v[68:71]
    s_waitcnt lgkmcnt(3)
    ds_read_b128 v[32:35], v116 offset:61440
    v_mul_f32 v94, v82, v11
    v_mfma_f32_16x16x32_bf16 v[64:67], v[40:43], a[224:227], v[64:67]
    v_exp_f32 v88, v84 clamp
    v_mfma_f32_16x16x32_bf16 v[68:71], v[40:43], v[224:227], v[68:71]
    s_waitcnt lgkmcnt(3)
    ds_read_b128 v[36:39], v117 offset:61440
    v_max_f32 v84, s48, v84
    v_mfma_f32_16x16x32_bf16 v[64:67], v[44:47], a[228:231], v[64:67]
    buffer_load_dwordx4 v[180:183], v0, s[4:7], s30 offen offset:1024 sc1
    v_mfma_f32_16x16x32_bf16 v[68:71], v[44:47], v[228:231], v[68:71]
    s_waitcnt lgkmcnt(3)
    ds_read_b128 v[40:43], v118 offset:61440
    v_mul_f32 v95, v83, v11
    v_mfma_f32_16x16x32_bf16 v[64:67], v[48:51], a[232:235], v[64:67]
    v_exp_f32 v89, v85 clamp
    v_mfma_f32_16x16x32_bf16 v[68:71], v[48:51], v[232:235], v[68:71]
    s_waitcnt lgkmcnt(3)
    ds_read_b128 v[44:47], v119 offset:61440
    v_max_f32 v85, s48, v85
    v_mfma_f32_16x16x32_bf16 v[64:67], v[52:55], a[236:239], v[64:67]
    buffer_load_dwordx4 v[184:187], v0, s[4:7], s30 offen offset:2048 sc1
    v_mfma_f32_16x16x32_bf16 v[68:71], v[52:55], v[236:239], v[68:71]
    s_waitcnt lgkmcnt(3)
    v_exp_f32 v90, v86 clamp
    v_mfma_f32_16x16x32_bf16 v[64:67], v[32:35], a[240:243], v[64:67]
    v_max_f32 v86, s48, v86
    v_fma_f32 v92, v60, v76, v92
    v_mfma_f32_16x16x32_bf16 v[68:71], v[32:35], v[240:243], v[68:71]
    s_waitcnt lgkmcnt(2)
    buffer_load_dwordx4 v[188:191], v0, s[4:7], s30 offen offset:3072 sc1
    v_mfma_f32_16x16x32_bf16 v[64:67], v[36:39], a[244:247], v[64:67]
    v_exp_f32 v91, v87 clamp
    v_mfma_f32_16x16x32_bf16 v[68:71], v[36:39], v[244:247], v[68:71]
    s_waitcnt lgkmcnt(1)
    v_max_f32 v87, s48, v87
    v_fma_f32 v84, v84, s49, v88
    v_mfma_f32_16x16x32_bf16 v[64:67], v[40:43], a[248:251], v[64:67]
    v_fma_f32 v85, v85, s49, v89
    v_fma_f32 v86, v86, s49, v90
    v_mfma_f32_16x16x32_bf16 v[68:71], v[40:43], v[248:251], v[68:71]
    s_waitcnt lgkmcnt(0)
    v_fma_f32 v87, v87, s49, v91
    v_cvt_pk_bf16_f32 v96, v84, v85
    v_cvt_pk_bf16_f32 v97, v86, v87
    v_fma_f32 v93, v61, v77, v93
    v_fma_f32 v94, v62, v78, v94
    v_fma_f32 v95, v63, v79, v95
    v_cvt_pk_bf16_f32 v100, v92, v93
    v_cvt_pk_bf16_f32 v101, v94, v95
    v_mfma_f32_16x16x32_bf16 v[64:67], v[44:47], a[252:255], v[64:67]
    ds_read_b128 v[80:83], v1 offset:448
    ds_read_b128 v[72:75], v1 offset:704
    v_mfma_f32_16x16x32_bf16 v[68:71], v[44:47], v[252:255], v[68:71]
    ds_read_b128 v[76:79], v1 offset:192
    s_waitcnt lgkmcnt(2)
    v_pk_fma_f32 v[84:85], v[80:81], v[10:11], s[48:49] op_sel_hi:[1,0,0]
    v_pk_fma_f32 v[86:87], v[82:83], v[10:11], s[48:49] op_sel_hi:[1,0,0]
    v_pk_mul_f32 v[92:93], v[80:81], v[10:11] op_sel:[0,1] op_sel_hi:[1,1]
    v_pk_mul_f32 v[94:95], v[82:83], v[10:11] op_sel:[0,1] op_sel_hi:[1,1]
    s_waitcnt lgkmcnt(1)
    v_pk_fma_f32 v[84:85], v[64:65], v[72:73], v[84:85]
    v_pk_fma_f32 v[86:87], v[66:67], v[74:75], v[86:87]
    v_exp_f32 v88, v84 clamp
    v_max_f32 v84, s48, v84
    v_exp_f32 v89, v85 clamp
    v_max_f32 v85, s48, v85
    v_exp_f32 v90, v86 clamp
    v_max_f32 v86, s48, v86
    v_exp_f32 v91, v87 clamp
    v_max_f32 v87, s48, v87
    s_waitcnt lgkmcnt(0)
    v_pk_fma_f32 v[92:93], v[68:69], v[76:77], v[92:93]
    v_pk_fma_f32 v[94:95], v[70:71], v[78:79], v[94:95]
    v_pk_fma_f32 v[84:85], v[84:85], s[48:49], v[88:89] op_sel:[0,1,0] op_sel_hi:[1,1,1]
    v_pk_fma_f32 v[86:87], v[86:87], s[48:49], v[90:91] op_sel:[0,1,0] op_sel_hi:[1,1,1]
    v_cvt_pk_bf16_f32 v102, v92, v93
    v_cvt_pk_bf16_f32 v103, v94, v95
    v_cvt_pk_bf16_f32 v98, v84, v85
    v_cvt_pk_bf16_f32 v99, v86, v87
    s_nop 1
    v_mfma_f32_16x16x32_bf16 v[108:111], v[96:99], v[112:115], v[108:111]
    v_mfma_f32_16x16x32_bf16 v[104:107], v[96:99], v[100:103], v[104:107]
    v_mov_b32 v87, v5
    s_lshl_b32 s31, s28, 10
    s_add_u32 s31, s31, s39
    s_add_u32 s31, s31, 1048576
    s_nop 2
    v_cvt_pk_bf16_f32 v88, v108, v109
    v_cvt_pk_bf16_f32 v89, v110, v111
    v_cvt_pk_bf16_f32 v84, v104, v105
    v_cvt_pk_bf16_f32 v85, v106, v107
    v_cndmask_b32 v86, v88, v89, s[52:53]
    buffer_store_dwordx4 v[84:87], v0, s[4:7], s31 offen sc1
    s_lshl_b32 s31, s24, 6
    v_add_u32 v30, s31, v1
    ds_read_b128 v[92:95], v30 offset:2816
    ds_read_b128 v[32:35], v116 offset:0
    ds_read_b128 v[36:39], v117 offset:0
    ds_read_b128 v[40:43], v118 offset:0
    ds_read_b128 v[44:47], v119 offset:0
    ds_read_b128 v[48:51], v116 offset:4096
    ds_read_b128 v[52:55], v117 offset:4096
    ds_read_b128 v[56:59], v118 offset:4096
    ds_read_b32 v88, v2 offset:256
    ds_read_b32 v89, v2 offset:512
    ds_read_b32 v90, v2 offset:320
    ds_read_b32 v91, v2 offset:576
    s_waitcnt lgkmcnt(10)
    v_mfma_f32_16x16x32_bf16 v[96:99], v[128:131], v[32:35], 0
    s_waitcnt lgkmcnt(9)
    ds_read_b128 v[60:63], v119 offset:4096
    v_mfma_f32_16x16x32_bf16 v[96:99], v[132:135], v[36:39], v[96:99]
    s_waitcnt lgkmcnt(9)
    s_lshl_b32 s30, s25, 13
    s_add_u32 s30, s30, s32
    s_cmp_eq_u32 s24, 1
    s_cselect_b32 s51, 131072, 0
    s_cmp_eq_u32 s24, 2
    s_cselect_b32 s51, 720896, s51
    s_add_u32 s30, s30, s51
    s_cmp_ge_u32 s25, 2
    s_cselect_b32 s51, 2, 9
    s_cmp_eq_u32 s24, s51
    s_cselect_b32 s30, 0x40000000, s30
    s_cmp_eq_u32 s24, 3
    s_cselect_b32 s30, 0x40000000, s30
    s_mov_b32 m0, 163328
    v_lshlrev_b32 v31, 3, v0
    buffer_load_dword v31, s[4:7], s30 offen lds
    ds_read_b128 v[32:35], v116 offset:8192
    v_mfma_f32_16x16x32_bf16 v[96:99], v[136:139], v[40:43], v[96:99]
    s_waitcnt lgkmcnt(9)
    ds_read_b128 v[36:39], v117 offset:8192
    v_mfma_f32_16x16x32_bf16 v[96:99], v[140:143], v[44:47], v[96:99]
    s_waitcnt vmcnt(17) lgkmcnt(9)
    ds_read_b128 v[40:43], v118 offset:8192
    v_mfma_f32_16x16x32_bf16 v[96:99], v[144:147], v[48:51], v[96:99]
    s_waitcnt vmcnt(16) lgkmcnt(9)
    s_cmp_lg_u32 s24, s28
    s_cbranch_scc1 Lskip208
    s_add_u32 s31, s39, 1048576
    buffer_load_dwordx4 v[68:71], v0, s[4:7], s31 offen offset:0 sc1
    buffer_load_dwordx4 v[72:75], v0, s[4:7], s31 offen offset:1024 sc1
    buffer_load_dwordx4 v[76:79], v0, s[4:7], s31 offen offset:2048 sc1
    buffer_load_dwordx4 v[80:83], v0, s[4:7], s31 offen offset:3072 sc1
Lskip208:
    ds_read_b128 v[44:47], v119 offset:8192
    v_mfma_f32_16x16x32_bf16 v[96:99], v[148:151], v[52:55], v[96:99]
    s_waitcnt vmcnt(15) lgkmcnt(9)
    s_add_u32 s51, s33, 4096
    s_and_b32 s51, s51, 0x3fff
    s_lshl_b32 s30, s41, 2
    s_add_u32 s30, s30, s51
    s_add_u32 m0, s30, 0
    s_add_u32 s30, s71, s51
    s_add_u32 s30, s30, 65536
    buffer_load_dwordx4 v0, s[4:7], s30 offen offset:0 sc1 lds
    ds_read_b128 v[48:51], v116 offset:12288
    v_mfma_f32_16x16x32_bf16 v[96:99], v[152:155], v[56:59], v[96:99]
    s_waitcnt vmcnt(15) lgkmcnt(5)
    ds_read_b128 v[52:55], v117 offset:12288
    v_mfma_f32_16x16x32_bf16 v[96:99], v[156:159], v[60:63], v[96:99]
    s_waitcnt vmcnt(14) lgkmcnt(5)
    ds_read_b128 v[56:59], v118 offset:12288
    v_mfma_f32_16x16x32_bf16 v[96:99], v[160:163], v[32:35], v[96:99]
    s_waitcnt vmcnt(13) lgkmcnt(5)
    ds_read_b128 v[60:63], v119 offset:12288
    v_mfma_f32_16x16x32_bf16 v[96:99], v[164:167], v[36:39], v[96:99]
    s_waitcnt vmcnt(12) lgkmcnt(5)
    buffer_load_dwordx4 v0, s[4:7], s30 offen offset:1024 sc1 lds
    ds_read_b128 v[32:35], v116 offset:16384
    v_mfma_f32_16x16x32_bf16 v[96:99], v[168:171], v[40:43], v[96:99]
    s_waitcnt vmcnt(12) lgkmcnt(5)
    ds_read_b128 v[36:39], v117 offset:16384
    v_mfma_f32_16x16x32_bf16 v[96:99], v[172:175], v[44:47], v[96:99]
    s_waitcnt vmcnt(7) lgkmcnt(5)
    ds_read_b128 v[40:43], v118 offset:16384
    v_mfma_f32_16x16x32_bf16 v[96:99], v[176:179], v[48:51], v[96:99]
    s_waitcnt vmcnt(6) lgkmcnt(5)
    ds_read_b128 v[44:47], v119 offset:16384
    v_mfma_f32_16x16x32_bf16 v[96:99], v[180:183], v[52:55], v[96:99]
    s_waitcnt vmcnt(5) lgkmcnt(5)
    buffer_load_dwordx4 v0, s[4:7], s30 offen offset:2048 sc1 lds
    ds_read_b128 v[48:51], v116 offset:20480
    v_mfma_f32_16x16x32_bf16 v[96:99], v[184:187], v[56:59], v[96:99]
    s_waitcnt vmcnt(5) lgkmcnt(5)
    ds_read_b128 v[52:55], v117 offset:20480
    v_mfma_f32_16x16x32_bf16 v[96:99], v[188:191], v[60:63], v[96:99]
    s_waitcnt lgkmcnt(5)
    ds_read_b128 v[56:59], v118 offset:20480
    v_mfma_f32_16x16x32_bf16 v[100:103], v[128:131], v[32:35], 0
    s_waitcnt lgkmcnt(5)
    ds_read_b128 v[60:63], v119 offset:20480
    v_mfma_f32_16x16x32_bf16 v[100:103], v[132:135], v[36:39], v[100:103]
    s_waitcnt lgkmcnt(5)
    buffer_load_dwordx4 v0, s[4:7], s30 offen offset:3072 sc1 lds
    ds_read_b128 v[32:35], v116 offset:24576
    v_mfma_f32_16x16x32_bf16 v[100:103], v[136:139], v[40:43], v[100:103]
    s_waitcnt lgkmcnt(5)
    ds_read_b128 v[36:39], v117 offset:24576
    v_mfma_f32_16x16x32_bf16 v[100:103], v[140:143], v[44:47], v[100:103]
    s_waitcnt lgkmcnt(5)
    ds_read_b128 v[40:43], v118 offset:24576
    v_fma_f32 v120, v88, v92, s48
    v_mfma_f32_16x16x32_bf16 v[100:103], v[144:147], v[48:51], v[100:103]
    s_waitcnt lgkmcnt(5)
    ds_read_b128 v[44:47], v119 offset:24576
    v_fma_f32 v121, v88, v93, s48
    v_mfma_f32_16x16x32_bf16 v[100:103], v[148:151], v[52:55], v[100:103]
    s_waitcnt lgkmcnt(5)
    s_add_u32 s51, s33, 8192
    s_and_b32 s51, s51, 0x3fff
    s_lshl_b32 s30, s41, 2
    s_add_u32 s30, s30, s51
    s_add_u32 m0, s30, 0
    s_add_u32 s30, s71, s51
    s_add_u32 s30, s30, 65536
    buffer_load_dwordx4 v0, s[4:7], s30 offen offset:0 sc1 lds
    ds_read_b128 v[48:51], v116 offset:28672
    v_mfma_f32_16x16x32_bf16 v[100:103], v[152:155], v[56:59], v[100:103]
    s_waitcnt lgkmcnt(5)
    s_cmp_lg_u32 s24, s28
    s_cbranch_scc1 Lskip209
    s_waitcnt vmcnt(8)
    v_cmp_ne_u32 s[54:55], s29, v71
    s_waitcnt vmcnt(7)
    v_cmp_ne_u32 s[56:57], s29, v75
    s_nop 0
    s_or_b64 s[54:55], s[54:55], s[56:57]
    s_waitcnt vmcnt(6)
    v_cmp_ne_u32 s[56:57], s29, v79
    s_nop 0
    s_or_b64 s[54:55], s[54:55], s[56:57]
    s_waitcnt vmcnt(5)
    v_cmp_ne_u32 s[56:57], s29, v83
    s_nop 0
    s_or_b64 s[54:55], s[54:55], s[56:57]
    s_cmp_lg_u64 s[54:55], 0
    s_cbranch_scc1 Lrare210
Lrare210b:
    v_lshlrev_b32 v84, 16, v68
    v_and_b32 v85, 0xffff0000, v68
    v_lshlrev_b32 v86, 16, v69
    v_and_b32 v87, 0xffff0000, v69
    v_lshlrev_b32 v28, 16, v70
    v_and_b32 v29, 0xffff0000, v70
    v_dot2_f32_bf16 v84, v72, s46, v84
    v_dot2_f32_bf16 v85, v72, s47, v85
    v_dot2_f32_bf16 v86, v73, s46, v86
    v_dot2_f32_bf16 v87, v73, s47, v87
    v_dot2_f32_bf16 v28, v74, s46, v28
    v_dot2_f32_bf16 v29, v74, s47, v29
    v_dot2_f32_bf16 v84, v76, s46, v84
    v_dot2_f32_bf16 v85, v76, s47, v85
    v_dot2_f32_bf16 v86, v77, s46, v86
    v_dot2_f32_bf16 v87, v77, s47, v87
    v_dot2_f32_bf16 v28, v78, s46, v28
    v_dot2_f32_bf16 v29, v78, s47, v29
    v_dot2_f32_bf16 v84, v80, s46, v84
    v_dot2_f32_bf16 v85, v80, s47, v85
    v_dot2_f32_bf16 v86, v81, s46, v86
    v_dot2_f32_bf16 v87, v81, s47, v87
    v_dot2_f32_bf16 v28, v82, s46, v28
    v_dot2_f32_bf16 v29, v82, s47, v29
    s_lshl_b32 s31, s27, 10
    s_add_u32 s31, s31, s40
    s_add_u32 s31, s31, 262144
    v_cvt_pk_bf16_f32 v68, v84, v85
    v_cvt_pk_bf16_f32 v69, v86, v87
    v_cvt_pk_bf16_f32 v70, v28, v29
    buffer_store_dwordx4 v[68:71], v0, s[4:7], s31 offen sc1
Lskip209:
    ds_read_b128 v[52:55], v117 offset:28672
    v_mfma_f32_16x16x32_bf16 v[100:103], v[156:159], v[60:63], v[100:103]
    s_waitcnt lgkmcnt(5)
    ds_read_b128 v[56:59], v118 offset:28672
    v_fma_f32 v122, v88, v94, s48
    v_mfma_f32_16x16x32_bf16 v[100:103], v[160:163], v[32:35], v[100:103]
    s_waitcnt lgkmcnt(5)
    ds_read_b128 v[60:63], v119 offset:28672
    v_fma_f32 v123, v88, v95, s48
    v_mfma_f32_16x16x32_bf16 v[100:103], v[164:167], v[36:39], v[100:103]
    s_waitcnt lgkmcnt(5)
    buffer_load_dwordx4 v0, s[4:7], s30 offen offset:1024 sc1 lds
    ds_read_b128 v[32:35], v116 offset:32768
    v_mfma_f32_16x16x32_bf16 v[100:103], v[168:171], v[40:43], v[100:103]
    s_waitcnt lgkmcnt(5)
    ds_read_b128 v[36:39], v117 offset:32768
    v_fma_f32 v120, v96, v89, v120
    v_mfma_f32_16x16x32_bf16 v[100:103], v[172:175], v[44:47], v[100:103]
    s_waitcnt lgkmcnt(5)
    ds_read_b128 v[40:43], v118 offset:32768
    v_fma_f32 v121, v97, v89, v121
    v_mfma_f32_16x16x32_bf16 v[100:103], v[176:179], v[48:51], v[100:103]
    s_waitcnt lgkmcnt(5)
    ds_read_b128 v[44:47], v119 offset:32768
    v_fma_f32 v122, v98, v89, v122
    v_mfma_f32_16x16x32_bf16 v[100:103], v[180:183], v[52:55], v[100:103]
    s_waitcnt lgkmcnt(5)
    buffer_load_dwordx4 v0, s[4:7], s30 offen offset:2048 sc1 lds
    ds_read_b128 v[48:51], v116 offset:36864
    v_mfma_f32_16x16x32_bf16 v[100:103], v[184:187], v[56:59], v[100:103]
    s_waitcnt lgkmcnt(5)
    ds_read_b128 v[52:55], v117 offset:36864
    v_fma_f32 v123, v99, v89, v123
    v_mfma_f32_16x16x32_bf16 v[100:103], v[188:191], v[60:63], v[100:103]
    s_waitcnt lgkmcnt(5)
    ds_read_b128 v[56:59], v118 offset:36864
    v_exp_f32 v124, v120 clamp
    v_mfma_f32_16x16x32_bf16 v[104:107], v[128:131], v[32:35], 0
    s_waitcnt lgkmcnt(5)
    ds_read_b128 v[60:63], v119 offset:36864
    v_max_f32 v120, s48, v120
    v_mfma_f32_16x16x32_bf16 v[104:107], v[132:135], v[36:39], v[104:107]
    s_waitcnt lgkmcnt(5)
    buffer_load_dwordx4 v0, s[4:7], s30 offen offset:3072 sc1 lds
    ds_read_b128 v[32:35], v116 offset:40960
    v_exp_f32 v125, v121 clamp
    v_max_f32 v121, s48, v121
    v_exp_f32 v126, v122 clamp
    v_max_f32 v122, s48, v122
    v_exp_f32 v127, v123 clamp
    v_max_f32 v123, s48, v123
    v_fma_f32 v120, v120, s49, v124
    v_fma_f32 v121, v121, s49, v125
    v_fma_f32 v122, v122, s49, v126
    v_fma_f32 v123, v123, s49, v127
    v_cvt_pk_bf16_f32 v64, v120, v121
    v_cvt_pk_bf16_f32 v65, v122, v123
    ds_read_b32 v88, v2 offset:384
    ds_read_b32 v89, v2 offset:640
    v_mfma_f32_16x16x32_bf16 v[104:107], v[136:139], v[40:43], v[104:107]
    s_waitcnt lgkmcnt(7)
    ds_read_b128 v[36:39], v117 offset:40960
    v_mfma_f32_16x16x32_bf16 v[104:107], v[140:143], v[44:47], v[104:107]
    s_waitcnt lgkmcnt(7)
    ds_read_b128 v[40:43], v118 offset:40960
    v_fma_f32 v120, v90, v92, s48
    v_mfma_f32_16x16x32_bf16 v[104:107], v[144:147], v[48:51], v[104:107]
    s_waitcnt lgkmcnt(7)
    ds_read_b128 v[44:47], v119 offset:40960
    v_fma_f32 v121, v90, v93, s48
    v_mfma_f32_16x16x32_bf16 v[104:107], v[148:151], v[52:55], v[104:107]
    s_waitcnt lgkmcnt(7)
    s_add_u32 s51, s33, 12288
    s_and_b32 s51, s51, 0x3fff
    s_lshl_b32 s30, s41, 2
    s_add_u32 s30, s30, s51
    s_add_u32 m0, s30, 0
    s_add_u32 s30, s71, s51
    s_add_u32 s30, s30, 65536
    buffer_load_dwordx4 v0, s[4:7], s30 offen offset:0 sc1 lds
    ds_read_b128 v[48:51], v116 offset:45056
    v_mfma_f32_16x16x32_bf16 v[104:107], v[152:155], v[56:59], v[104:107]
    s_waitcnt lgkmcnt(7)
    ds_read_b128 v[52:55], v117 offset:45056
    v_fma_f32 v122, v90, v94, s48
    v_mfma_f32_16x16x32_bf16 v[104:107], v[156:159], v[60:63], v[104:107]
    s_waitcnt lgkmcnt(7)
    ds_read_b128 v[56:59], v118 offset:45056
    v_fma_f32 v123, v90, v95, s48
    v_mfma_f32_16x16x32_bf16 v[104:107], v[160:163], v[32:35], v[104:107]
    s_waitcnt lgkmcnt(5)
    ds_read_b128 v[60:63], v119 offset:45056
    v_fma_f32 v120, v100, v91, v120
    v_mfma_f32_16x16x32_bf16 v[104:107], v[164:167], v[36:39], v[104:107]
    s_waitcnt lgkmcnt(5)
    buffer_load_dwordx4 v0, s[4:7], s30 offen offset:1024 sc1 lds
    ds_read_b128 v[32:35], v116 offset:49152
    v_mfma_f32_16x16x32_bf16 v[104:107], v[168:171], v[40:43], v[104:107]
    s_waitcnt lgkmcnt(5)
    ds_read_b128 v[36:39], v117 offset:49152
    v_fma_f32 v121, v101, v91, v121
    v_mfma_f32_16x16x32_bf16 v[104:107], v[172:175], v[44:47], v[104:107]
    s_waitcnt lgkmcnt(5)
    ds_read_b128 v[40:43], v118 offset:49152
    v_fma_f32 v122, v102, v91, v122
    v_mfma_f32_16x16x32_bf16 v[104:107], v[176:179], v[48:51], v[104:107]
    s_waitcnt lgkmcnt(5)
    ds_read_b128 v[44:47], v119 offset:49152
    v_fma_f32 v123, v103, v91, v123
    v_mfma_f32_16x16x32_bf16 v[104:107], v[180:183], v[52:55], v[104:107]
    s_waitcnt lgkmcnt(5)
    buffer_load_dwordx4 v0, s[4:7], s30 offen offset:2048 sc1 lds
    ds_read_b128 v[48:51], v116 offset:53248
    v_mfma_f32_16x16x32_bf16 v[104:107], v[184:187], v[56:59], v[104:107]
    s_waitcnt lgkmcnt(5)
    ds_read_b128 v[52:55], v117 offset:53248
    v_exp_f32 v124, v120 clamp
    v_mfma_f32_16x16x32_bf16 v[104:107], v[188:191], v[60:63], v[104:107]
    s_waitcnt lgkmcnt(5)
    ds_read_b128 v[56:59], v118 offset:53248
    v_max_f32 v120, s48, v120
    v_mfma_f32_16x16x32_bf16 v[108:111], v[128:131], v[32:35], 0
    s_waitcnt lgkmcnt(5)
    ds_read_b128 v[60:63], v119 offset:53248
    v_exp_f32 v125, v121 clamp
    v_mfma_f32_16x16x32_bf16 v[108:111], v[132:135], v[36:39], v[108:111]
    s_waitcnt lgkmcnt(5)
    buffer_load_dwordx4 v0, s[4:7], s30 offen offset:3072 sc1 lds
    ds_read_b128 v[32:35], v116 offset:57344
    v_max_f32 v121, s48, v121
    v_exp_f32 v126, v122 clamp
    v_max_f32 v122, s48, v122
    v_exp_f32 v127, v123 clamp
    v_max_f32 v123, s48, v123
    v_fma_f32 v120, v120, s49, v124
    v_fma_f32 v121, v121, s49, v125
    v_fma_f32 v122, v122, s49, v126
    v_fma_f32 v123, v123, s49, v127
    v_cvt_pk_bf16_f32 v66, v120, v121
    v_cvt_pk_bf16_f32 v67, v122, v123
    ds_read_b32 v90, v2 offset:448
    ds_read_b32 v91, v2 offset:704
    v_mfma_f32_16x16x32_bf16 v[108:111], v[136:139], v[40:43], v[108:111]
    s_waitcnt lgkmcnt(7)
    ds_read_b128 v[36:39], v117 offset:57344
    v_mfma_f32_16x16x32_bf16 v[108:111], v[140:143], v[44:47], v[108:111]
    s_waitcnt lgkmcnt(7)
    ds_read_b128 v[40:43], v118 offset:57344
    v_fma_f32 v120, v88, v92, s48
    v_mfma_f32_16x16x32_bf16 v[108:111], v[144:147], v[48:51], v[108:111]
    s_waitcnt lgkmcnt(7)
    ds_read_b128 v[44:47], v119 offset:57344
    v_fma_f32 v121, v88, v93, s48
    v_mfma_f32_16x16x32_bf16 v[108:111], v[148:151], v[52:55], v[108:111]
    s_waitcnt lgkmcnt(7)
    ds_read_b128 v[48:51], v116 offset:61440
    v_fma_f32 v122, v88, v94, s48
    v_mfma_f32_16x16x32_bf16 v[108:111], v[152:155], v[56:59], v[108:111]
    s_waitcnt lgkmcnt(7)
    ds_read_b128 v[52:55], v117 offset:61440
    v_fma_f32 v123, v88, v95, s48
    v_mfma_f32_16x16x32_bf16 v[108:111], v[156:159], v[60:63], v[108:111]
    s_waitcnt lgkmcnt(7)
    ds_read_b128 v[56:59], v118 offset:61440
    v_fma_f32 v120, v104, v89, v120
    v_mfma_f32_16x16x32_bf16 v[108:111], v[160:163], v[32:35], v[108:111]
    s_waitcnt lgkmcnt(5)
    ds_read_b128 v[60:63], v119 offset:61440
    v_fma_f32 v121, v105, v89, v121
    v_mfma_f32_16x16x32_bf16 v[108:111], v[164:167], v[36:39], v[108:111]
    s_waitcnt lgkmcnt(5)
    v_fma_f32 v122, v106, v89, v122
    v_fma_f32 v123, v107, v89, v123
    v_mfma_f32_16x16x32_bf16 v[108:111], v[168:171], v[40:43], v[108:111]
    s_waitcnt lgkmcnt(4)
    v_exp_f32 v124, v120 clamp
    v_mfma_f32_16x16x32_bf16 v[108:111], v[172:175], v[44:47], v[108:111]
    s_waitcnt lgkmcnt(3)
    v_max_f32 v120, s48, v120
    v_exp_f32 v125, v121 clamp
    v_mfma_f32_16x16x32_bf16 v[108:111], v[176:179], v[48:51], v[108:111]
    s_waitcnt lgkmcnt(2)
    v_max_f32 v121, s48, v121
    v_exp_f32 v126, v122 clamp
    v_mfma_f32_16x16x32_bf16 v[108:111], v[180:183], v[52:55], v[108:111]
    s_waitcnt lgkmcnt(1)
    v_max_f32 v122, s48, v122
    v_exp_f32 v127, v123 clamp
    v_mfma_f32_16x16x32_bf16 v[108:111], v[184:187], v[56:59], v[108:111]
    s_waitcnt lgkmcnt(0)
    v_max_f32 v123, s48, v123
    v_fma_f32 v120, v120, s49, v124
    v_mfma_f32_16x16x32_bf16 v[108:111], v[188:191], v[60:63], v[108:111]
    v_fma_f32 v121, v121, s49, v125
    v_fma_f32 v122, v122, s49, v126
    v_fma_f32 v123, v123, s49, v127
    s_waitcnt vmcnt(15)
    v_cvt_pk_bf16_f32 v68, v120, v121
    v_cvt_pk_bf16_f32 v69, v122, v123
    v_pk_fma_f32 v[120:121], v[92:93], v[90:91], s[48:49] op_sel_hi:[1,0,0]
    v_pk_fma_f32 v[122:123], v[94:95], v[90:91], s[48:49] op_sel_hi:[1,0,0]
    v_pk_fma_f32 v[120:121], v[108:109], v[90:91], v[120:121] op_sel:[0,1,0] op_sel_hi:[1,1,1]
    v_pk_fma_f32 v[122:123], v[110:111], v[90:91], v[122:123] op_sel:[0,1,0] op_sel_hi:[1,1,1]
    v_exp_f32 v124, v120 clamp
    v_max_f32 v120, s48, v120
    v_exp_f32 v125, v121 clamp
    v_max_f32 v121, s48, v121
    v_exp_f32 v126, v122 clamp
    v_max_f32 v122, s48, v122
    v_exp_f32 v127, v123 clamp
    v_max_f32 v123, s48, v123
    v_pk_fma_f32 v[120:121], v[120:121], s[48:49], v[124:125] op_sel:[0,1,0] op_sel_hi:[1,1,1]
    v_pk_fma_f32 v[122:123], v[122:123], s[48:49], v[126:127] op_sel:[0,1,0] op_sel_hi:[1,1,1]
    v_cvt_pk_bf16_f32 v70, v120, v121
    v_cvt_pk_bf16_f32 v71, v122, v123
    s_waitcnt vmcnt(14)
    v_mov_b32 v72, 0x358637bd
    v_mov_b32 v73, 0x358637bd
    v_mov_b32 v74, 0x358637bd
    v_mov_b32 v75, 0x358637bd
    s_and_b32 s31, s24, 1
    s_lshl_b32 s31, s31, 11
    s_add_u32 s31, s31, 0
    v_add_u32 v30, s31, v0
    s_waitcnt vmcnt(0)
    s_barrier
    s_lshl_b32 s30, s41, 2
    s_add_u32 m0, s30, 65536
    s_add_u32 s30, s62, 4096
    s_add_u32 s51, s68, 4096
    buffer_load_dwordx4 v0, s[4:7], s30 offen sc1 lds
    buffer_load_dwordx4 v0, s[4:7], s30 offen offset:1024 sc1 lds
    buffer_load_dwordx4 v0, s[4:7], s51 offen offset:2048 sc1 lds
    buffer_load_dwordx4 v0, s[4:7], s51 offen offset:3072 sc1 lds
    s_lshl_b32 s30, s41, 2
    s_add_u32 m0, s30, 69632
    s_add_u32 s30, s62, 8192
    s_add_u32 s51, s68, 8192
    buffer_load_dwordx4 v0, s[4:7], s30 offen sc1 lds
    buffer_load_dwordx4 v0, s[4:7], s30 offen offset:1024 sc1 lds
    buffer_load_dwordx4 v0, s[4:7], s51 offen offset:2048 sc1 lds
    buffer_load_dwordx4 v0, s[4:7], s51 offen offset:3072 sc1 lds
    ds_read_b128 v[96:99], v30 offset:0
    ds_read_b128 v[100:103], v30 offset:1024
    ds_read_b128 v[104:107], v30 offset:4096
    ds_read_b128 v[108:111], v30 offset:5120
    ds_read_b128 v[112:115], v30 offset:8192
    ds_read_b128 v[116:119], v30 offset:9216
    ds_read_b128 v[120:123], v30 offset:16384
    ds_read_b128 v[124:127], v30 offset:17408
    ds_read_b128 v[128:131], v30 offset:20480
    ds_read_b128 v[132:135], v30 offset:21504
    ds_read_b128 v[136:139], v30 offset:24576
    ds_read_b128 v[140:143], v30 offset:25600
    s_sleep 6
    s_add_u32 s31, s40, 262144
    buffer_load_dwordx4 v[32:35], v0, s[4:7], s31 offen offset:0 sc1
    buffer_load_dwordx4 v[36:39], v0, s[4:7], s31 offen offset:1024 sc1
    buffer_load_dwordx4 v[40:43], v0, s[4:7], s31 offen offset:2048 sc1
    buffer_load_dwordx4 v[44:47], v0, s[4:7], s31 offen offset:3072 sc1
    s_add_u32 s31, s40, 266240
    buffer_load_dwordx4 v[48:51], v0, s[4:7], s31 offen offset:0 sc1
    buffer_load_dwordx4 v[52:55], v0, s[4:7], s31 offen offset:1024 sc1
    buffer_load_dwordx4 v[56:59], v0, s[4:7], s31 offen offset:2048 sc1
    buffer_load_dwordx4 v[60:63], v0, s[4:7], s31 offen offset:3072 sc1
    ds_read_b128 v[144:147], v30 offset:32768
    ds_read_b128 v[148:151], v30 offset:33792
    ds_read_b128 v[152:155], v30 offset:36864
    ds_read_b128 v[156:159], v30 offset:37888
    ds_read_b128 v[160:163], v30 offset:40960
    ds_read_b128 v[164:167], v30 offset:41984
    ds_read_b128 v[168:171], v30 offset:49152
    ds_read_b128 v[172:175], v30 offset:50176
    ds_read_b128 v[176:179], v30 offset:53248
    ds_read_b128 v[180:183], v30 offset:54272
    ds_read_b128 v[184:187], v30 offset:57344
    ds_read_b128 v[188:191], v30 offset:58368
    s_waitcnt vmcnt(7)
    v_lshlrev_b32 v76, 16, v32
    v_and_b32 v77, 0xffff0000, v32
    v_lshlrev_b32 v78, 16, v33
    v_and_b32 v79, 0xffff0000, v33
    v_lshlrev_b32 v80, 16, v34
    v_and_b32 v81, 0xffff0000, v34
    v_xor_b32 v28, s29, v35
    s_waitcnt vmcnt(6)
    v_dot2c_f32_bf16 v76, s46, v36
    v_dot2c_f32_bf16 v77, s47, v36
    v_dot2c_f32_bf16 v78, s46, v37
    v_dot2c_f32_bf16 v79, s47, v37
    v_dot2c_f32_bf16 v80, s46, v38
    v_dot2c_f32_bf16 v81, s47, v38
    v_bitop3_b32 v28, v5, v39, v28 bitop3:0xbe
    s_waitcnt vmcnt(5)
    v_dot2c_f32_bf16 v76, s46, v40
    v_dot2c_f32_bf16 v77, s47, v40
    v_dot2c_f32_bf16 v78, s46, v41
    v_dot2c_f32_bf16 v79, s47, v41
    v_dot2c_f32_bf16 v80, s46, v42
    v_dot2c_f32_bf16 v81, s47, v42
    v_bitop3_b32 v28, v5, v43, v28 bitop3:0xbe
    s_waitcnt vmcnt(4)
    v_dot2c_f32_bf16 v76, s46, v44
    v_dot2c_f32_bf16 v77, s47, v44
    v_dot2c_f32_bf16 v78, s46, v45
    v_dot2c_f32_bf16 v79, s47, v45
    v_dot2c_f32_bf16 v80, s46, v46
    v_dot2c_f32_bf16 v81, s47, v46
    v_bitop3_b32 v28, v5, v47, v28 bitop3:0xbe
    s_waitcnt vmcnt(3)
    v_dot2c_f32_bf16 v76, s46, v48
    v_dot2c_f32_bf16 v77, s47, v48
    v_dot2c_f32_bf16 v78, s46, v49
    v_dot2c_f32_bf16 v79, s47, v49
    v_dot2c_f32_bf16 v80, s46, v50
    v_dot2c_f32_bf16 v81, s47, v50
    v_bitop3_b32 v28, v5, v51, v28 bitop3:0xbe
    s_waitcnt vmcnt(2)
    v_dot2c_f32_bf16 v76, s46, v52
    v_dot2c_f32_bf16 v77, s47, v52
    v_dot2c_f32_bf16 v78, s46, v53
    v_dot2c_f32_bf16 v79, s47, v53
    v_dot2c_f32_bf16 v80, s46, v54
    v_dot2c_f32_bf16 v81, s47, v54
    v_bitop3_b32 v28, v5, v55, v28 bitop3:0xbe
    s_waitcnt vmcnt(1)
    v_dot2c_f32_bf16 v76, s46, v56
    v_dot2c_f32_bf16 v77, s47, v56
    v_dot2c_f32_bf16 v78, s46, v57
    v_dot2c_f32_bf16 v79, s47, v57
    v_dot2c_f32_bf16 v80, s46, v58
    v_dot2c_f32_bf16 v81, s47, v58
    v_bitop3_b32 v28, v5, v59, v28 bitop3:0xbe
    s_waitcnt vmcnt(0)
    v_dot2c_f32_bf16 v76, s46, v60
    v_dot2c_f32_bf16 v77, s47, v60
    v_dot2c_f32_bf16 v78, s46, v61
    v_dot2c_f32_bf16 v79, s47, v61
    v_dot2c_f32_bf16 v80, s46, v62
    v_dot2c_f32_bf16 v81, s47, v62
    v_bitop3_b32 v28, v5, v63, v28 bitop3:0xbe
    v_cmp_ne_u32 s[54:55], 0, v28
    s_nop 1
    s_cmp_lg_u64 s[54:55], 0
    s_cbranch_scc1 Lrare212
Lrare212b:
    v_cvt_pk_bf16_f32 v86, v80, v81
    v_cvt_pk_bf16_f32 v82, v76, v77
    v_cvt_pk_bf16_f32 v83, v78, v79
    v_mov_b32_dpp v84, v86 quad_perm:[0,0,2,2] row_mask:0xf bank_mask:0xf
    v_mov_b32_dpp v85, v86 quad_perm:[1,1,3,3] row_mask:0xf bank_mask:0xf
    s_add_u32 s31, s67, 0
    s_nop 0
    v_mfma_f32_16x16x16_bf16 v[32:35], v[84:85], v[64:65], v[72:75]
    v_mfma_f32_16x16x16_bf16 v[48:51], v[82:83], v[64:65], 0
    v_mfma_f32_16x16x16_bf16 v[36:39], v[84:85], v[66:67], v[72:75]
    v_mfma_f32_16x16x16_bf16 v[52:55], v[82:83], v[66:67], 0
    v_mfma_f32_16x16x16_bf16 v[40:43], v[84:85], v[68:69], v[72:75]
    v_mfma_f32_16x16x16_bf16 v[56:59], v[82:83], v[68:69], 0
    v_mfma_f32_16x16x16_bf16 v[44:47], v[84:85], v[70:71], v[72:75]
    v_mfma_f32_16x16x16_bf16 v[60:63], v[82:83], v[70:71], 0
    s_nop 0
    v_rcp_f32 v32, v32
    s_nop 0
    v_rcp_f32 v36, v36
    v_pk_mul_f32 v[48:49], v[48:49], v[32:33] op_sel_hi:[1,0]
    v_pk_mul_f32 v[50:51], v[50:51], v[32:33] op_sel_hi:[1,0]
    v_cvt_pk_bf16_f32 v88, v48, v49
    v_cvt_pk_bf16_f32 v89, v50, v51
    v_and_b32 v88, -2, v88
    buffer_store_dwordx2 v[88:89], v9, s[4:7], s31 offen sc1
    s_add_u32 s31, s31, 16384
    v_rcp_f32 v40, v40
    v_pk_mul_f32 v[52:53], v[52:53], v[36:37] op_sel_hi:[1,0]
    v_pk_mul_f32 v[54:55], v[54:55], v[36:37] op_sel_hi:[1,0]
    v_cvt_pk_bf16_f32 v90, v52, v53
    v_cvt_pk_bf16_f32 v91, v54, v55
    v_and_b32 v90, -2, v90
    buffer_store_dwordx2 v[90:91], v9, s[4:7], s31 offen sc1
    s_add_u32 s31, s31, 16384
    v_rcp_f32 v44, v44
    v_pk_mul_f32 v[56:57], v[56:57], v[40:41] op_sel_hi:[1,0]
    v_pk_mul_f32 v[58:59], v[58:59], v[40:41] op_sel_hi:[1,0]
    v_cvt_pk_bf16_f32 v92, v56, v57
    v_cvt_pk_bf16_f32 v93, v58, v59
    v_and_b32 v92, -2, v92
    buffer_store_dwordx2 v[92:93], v9, s[4:7], s31 offen sc1
    s_add_u32 s31, s31, 16384
    v_pk_mul_f32 v[60:61], v[60:61], v[44:45] op_sel_hi:[1,0]
    v_pk_mul_f32 v[62:63], v[62:63], v[44:45] op_sel_hi:[1,0]
    v_cvt_pk_bf16_f32 v94, v60, v61
    v_cvt_pk_bf16_f32 v95, v62, v63
    v_and_b32 v94, -2, v94
    buffer_store_dwordx2 v[94:95], v9, s[4:7], s31 offen sc1
    ds_read_b128 v[64:67], v30 offset:12288
    ds_read_b128 v[68:71], v30 offset:13312
    ds_read_b128 v[72:75], v30 offset:28672
    ds_read_b128 v[76:79], v30 offset:29696
    ds_read_b128 v[80:83], v30 offset:45056
    ds_read_b128 v[84:87], v30 offset:46080
    ds_read_b128 v[88:91], v30 offset:61440
    ds_read_b128 v[92:95], v30 offset:62464
    s_waitcnt lgkmcnt(0)
    s_barrier
    v_lshlrev_b32 v28, 7, v3
    v_and_b32 v28, 0x3c00, v28
    v_and_b32 v29, 4, v3
    v_lshl_add_u32 v28, v29, 1, v28
    s_add_u32 s31, s32, 49152
Lop222:
    s_sub_u32 s66, s66, 1
    s_cbranch_scc1 Lbail
    buffer_load_dword v31, v28, s[4:7], s31 offen offset:1008 sc1
    s_waitcnt vmcnt(0)
    v_and_b32 v31, 1, v31
    v_cmp_ne_u32 vcc, 0, v31
    s_cbranch_vccnz Lop222
    s_add_u32 m0, s42, 0
    s_add_u32 s31, s38, 0
    buffer_load_dwordx4 v0, s[4:7], s31 offen offset:0 sc1 lds
    buffer_load_dwordx4 v0, s[4:7], s31 offen offset:1024 sc1 lds
    buffer_load_dwordx4 v0, s[4:7], s31 offen offset:2048 sc1 lds
    buffer_load_dwordx4 v0, s[4:7], s31 offen offset:3072 sc1 lds
    s_add_u32 m0, s42, 8192
    s_add_u32 s31, s38, 8192
    buffer_load_dwordx4 v0, s[4:7], s31 offen offset:0 sc1 lds
    buffer_load_dwordx4 v0, s[4:7], s31 offen offset:1024 sc1 lds
    buffer_load_dwordx4 v0, s[4:7], s31 offen offset:2048 sc1 lds
    buffer_load_dwordx4 v0, s[4:7], s31 offen offset:3072 sc1 lds
    s_add_u32 m0, s42, 32768
    s_add_u32 s31, s38, 32768
    buffer_load_dwordx4 v0, s[4:7], s31 offen offset:0 sc1 lds
    buffer_load_dwordx4 v0, s[4:7], s31 offen offset:1024 sc1 lds
    buffer_load_dwordx4 v0, s[4:7], s31 offen offset:2048 sc1 lds
    buffer_load_dwordx4 v0, s[4:7], s31 offen offset:3072 sc1 lds
    s_add_u32 m0, s42, 40960
    s_add_u32 s31, s38, 40960
    buffer_load_dwordx4 v0, s[4:7], s31 offen offset:0 sc1 lds
    buffer_load_dwordx4 v0, s[4:7], s31 offen offset:1024 sc1 lds
    buffer_load_dwordx4 v0, s[4:7], s31 offen offset:2048 sc1 lds
    buffer_load_dwordx4 v0, s[4:7], s31 offen offset:3072 sc1 lds
    s_and_b32 s31, s42, 0x4000
    s_add_u32 s31, s31, 0
    v_add_u32 v30, s31, v0
    s_add_u32 s31, s42, 0
    v_add_u32 v28, s31, v0
    v_add_u32 v29, 8, v28
    s_waitcnt vmcnt(12)
    ds_read_b128 v[32:35], v28 offset:0
    ds_read_b128 v[36:39], v28 offset:1024
    ds_read_b128 v[40:43], v28 offset:2048
    ds_read_b128 v[44:47], v28 offset:3072
    s_waitcnt vmcnt(8)
    ds_read_b128 v[48:51], v28 offset:8192
    ds_read_b128 v[52:55], v28 offset:9216
    ds_read_b128 v[56:59], v28 offset:10240
    ds_read_b128 v[60:63], v28 offset:11264
    s_waitcnt lgkmcnt(6)
    v_bitop3_b32 v32, v32, v34, v36 bitop3:0xfe
    s_waitcnt lgkmcnt(5)
    v_bitop3_b32 v38, v38, v40, v42 bitop3:0xfe
    s_waitcnt lgkmcnt(4)
    v_bitop3_b32 v32, v32, v38, v44 bitop3:0xfe
    v_bitop3_b32 v32, v32, v46, 1 bitop3:0xa8
    v_cmp_ne_u32 s[56:57], 0, v32
    s_nop 1
    s_cmp_lg_u64 s[56:57], 0
    s_cbranch_scc1 Lrare223
Lrare223b:
    s_waitcnt lgkmcnt(2)
    v_bitop3_b32 v48, v48, v50, v52 bitop3:0xfe
    s_waitcnt lgkmcnt(1)
    v_bitop3_b32 v54, v54, v56, v58 bitop3:0xfe
    s_waitcnt lgkmcnt(0)
    v_bitop3_b32 v48, v48, v54, v60 bitop3:0xfe
    v_bitop3_b32 v48, v48, v62, 1 bitop3:0xa8
    v_cmp_ne_u32 s[56:57], 0, v48
    s_nop 1
    s_cmp_lg_u64 s[56:57], 0
    s_cbranch_scc1 Lrare225
Lrare225b:
    s_barrier
    ds_read_b128 v[32:35], v30 offset:0
    ds_read_b128 v[36:39], v30 offset:1024
    ds_read_b128 v[40:43], v30 offset:2048
    ds_read_b128 v[44:47], v30 offset:3072
    ds_read_b128 v[48:51], v30 offset:4096
    s_waitcnt lgkmcnt(4)
    v_mfma_f32_16x16x32_bf16 v[12:15], v[96:99], v[32:35], v[12:15]
    s_waitcnt vmcnt(4)
    ds_read2st64_b32 v[56:57], v28 offset0:128 offset1:132
    ds_read2st64_b32 v[58:59], v29 offset0:128 offset1:132
    v_mfma_f32_16x16x32_bf16 v[16:19], v[100:103], v[32:35], v[16:19]
    s_waitcnt lgkmcnt(5)
    ds_read_b128 v[52:55], v30 offset:5120
    ds_read2st64_b32 v[60:61], v28 offset0:136 offset1:140
    v_mfma_f32_16x16x32_bf16 v[12:15], v[104:107], v[36:39], v[12:15]
    ds_read2st64_b32 v[62:63], v29 offset0:136 offset1:140
    v_mfma_f32_16x16x32_bf16 v[16:19], v[108:111], v[36:39], v[16:19]
    s_waitcnt lgkmcnt(7)
    ds_read_b128 v[32:35], v30 offset:6144
    v_mfma_f32_16x16x32_bf16 v[12:15], v[112:115], v[40:43], v[12:15]
    v_mfma_f32_16x16x32_bf16 v[16:19], v[116:119], v[40:43], v[16:19]
    s_waitcnt lgkmcnt(7)
    ds_read_b128 v[36:39], v30 offset:7168
    v_mfma_f32_16x16x32_bf16 v[12:15], v[64:67], v[44:47], v[12:15]
    s_waitcnt lgkmcnt(5)
    v_bitop3_b32 v56, v56, v57, v58 bitop3:0xfe
    v_mfma_f32_16x16x32_bf16 v[16:19], v[68:71], v[44:47], v[16:19]
    ds_read_b128 v[40:43], v30 offset:8192
    s_waitcnt lgkmcnt(4)
    v_bitop3_b32 v59, v59, v60, v61 bitop3:0xfe
    s_waitcnt lgkmcnt(3)
    v_bitop3_b32 v56, v56, v59, v62 bitop3:0xfe
    v_bitop3_b32 v56, v56, v63, 1 bitop3:0xa8
    v_cmp_ne_u32 s[56:57], 0, v56
    v_mfma_f32_16x16x32_bf16 v[12:15], v[120:123], v[48:51], v[12:15]
    v_mfma_f32_16x16x32_bf16 v[16:19], v[124:127], v[48:51], v[16:19]
    ds_read_b128 v[44:47], v30 offset:9216
    v_mfma_f32_16x16x32_bf16 v[12:15], v[128:131], v[52:55], v[12:15]
    s_cmp_lg_u64 s[56:57], 0
    s_cbranch_scc1 Lrare227
Lrare227b:
    s_waitcnt vmcnt(0)
    v_mfma_f32_16x16x32_bf16 v[16:19], v[132:135], v[52:55], v[16:19]
    s_waitcnt lgkmcnt(3)
    ds_read_b128 v[48:51], v30 offset:10240
    ds_read2st64_b32 v[56:57], v28 offset0:160 offset1:164
    v_mfma_f32_16x16x32_bf16 v[12:15], v[136:139], v[32:35], v[12:15]
    ds_read2st64_b32 v[58:59], v29 offset0:160 offset1:164
    ds_read2st64_b32 v[60:61], v28 offset0:168 offset1:172
    v_mfma_f32_16x16x32_bf16 v[16:19], v[140:143], v[32:35], v[16:19]
    s_waitcnt lgkmcnt(6)
    ds_read_b128 v[52:55], v30 offset:11264
    ds_read2st64_b32 v[62:63], v29 offset0:168 offset1:172
    v_mfma_f32_16x16x32_bf16 v[12:15], v[72:75], v[36:39], v[12:15]
    v_mfma_f32_16x16x32_bf16 v[16:19], v[76:79], v[36:39], v[16:19]
    s_waitcnt lgkmcnt(7)
    ds_read_b128 v[32:35], v30 offset:12288
    v_mfma_f32_16x16x32_bf16 v[12:15], v[144:147], v[40:43], v[12:15]
    v_mfma_f32_16x16x32_bf16 v[16:19], v[148:151], v[40:43], v[16:19]
    s_waitcnt lgkmcnt(7)
    ds_read_b128 v[36:39], v30 offset:13312
    v_mfma_f32_16x16x32_bf16 v[12:15], v[152:155], v[44:47], v[12:15]
    s_waitcnt lgkmcnt(5)
    v_bitop3_b32 v56, v56, v57, v58 bitop3:0xfe
    v_mfma_f32_16x16x32_bf16 v[16:19], v[156:159], v[44:47], v[16:19]
    ds_read_b128 v[40:43], v30 offset:14336
    s_waitcnt lgkmcnt(5)
    v_bitop3_b32 v59, v59, v60, v61 bitop3:0xfe
    s_waitcnt lgkmcnt(3)
    v_bitop3_b32 v56, v56, v59, v62 bitop3:0xfe
    v_bitop3_b32 v56, v56, v63, 1 bitop3:0xa8
    v_cmp_ne_u32 s[56:57], 0, v56
    v_mfma_f32_16x16x32_bf16 v[12:15], v[160:163], v[48:51], v[12:15]
    s_lshl_b32 s30, s24, 3
    s_add_u32 s30, s30, s25
    s_cmp_ge_u32 s30, 22
    s_cselect_b32 s51, 0x40000000, s32
    s_lshl_b32 s30, s30, 13
    s_add_u32 s30, s30, s51
    s_add_u32 s30, s30, 327680
    s_mov_b32 m0, 163328
    v_mfma_f32_16x16x32_bf16 v[16:19], v[164:167], v[48:51], v[16:19]
    ds_read_b128 v[44:47], v30 offset:15360
    v_lshlrev_b32 v31, 3, v0
    v_mfma_f32_16x16x32_bf16 v[12:15], v[80:83], v[52:55], v[12:15]
    s_cmp_lg_u64 s[56:57], 0
    s_cbranch_scc1 Lrare229
Lrare229b:
    s_barrier
    v_mfma_f32_16x16x32_bf16 v[16:19], v[84:87], v[52:55], v[16:19]
    s_waitcnt lgkmcnt(3)
    ds_read_b128 v[48:51], v30 offset:32768
    v_mfma_f32_16x16x32_bf16 v[12:15], v[168:171], v[32:35], v[12:15]
    buffer_load_dword v31, s[4:7], s30 offen lds
    v_mfma_f32_16x16x32_bf16 v[16:19], v[172:175], v[32:35], v[16:19]
    s_waitcnt lgkmcnt(3)
    ds_read_b128 v[52:55], v30 offset:33792
    v_mfma_f32_16x16x32_bf16 v[12:15], v[176:179], v[36:39], v[12:15]
    v_mfma_f32_16x16x32_bf16 v[16:19], v[180:183], v[36:39], v[16:19]
    s_waitcnt lgkmcnt(3)
    ds_read_b128 v[32:35], v30 offset:34816
    v_mfma_f32_16x16x32_bf16 v[12:15], v[184:187], v[40:43], v[12:15]
    v_mfma_f32_16x16x32_bf16 v[16:19], v[188:191], v[40:43], v[16:19]
    s_waitcnt lgkmcnt(3)
    ds_read_b128 v[36:39], v30 offset:35840
    v_mfma_f32_16x16x32_bf16 v[12:15], v[88:91], v[44:47], v[12:15]
    v_mfma_f32_16x16x32_bf16 v[16:19], v[92:95], v[44:47], v[16:19]
    s_waitcnt lgkmcnt(3)
    ds_read_b128 v[40:43], v30 offset:36864
    v_mfma_f32_16x16x32_bf16 v[20:23], v[96:99], v[48:51], v[20:23]
    v_mfma_f32_16x16x32_bf16 v[24:27], v[100:103], v[48:51], v[24:27]
    s_waitcnt lgkmcnt(3)
    ds_read_b128 v[44:47], v30 offset:37888
    v_mfma_f32_16x16x32_bf16 v[20:23], v[104:107], v[52:55], v[20:23]
    v_mfma_f32_16x16x32_bf16 v[24:27], v[108:111], v[52:55], v[24:27]
    s_waitcnt lgkmcnt(3)
    ds_read_b128 v[48:51], v30 offset:38912
    v_cvt_pk_bf16_f32 v96, v12, v13
    v_mfma_f32_16x16x32_bf16 v[20:23], v[112:115], v[32:35], v[20:23]
    v_cvt_pk_bf16_f32 v97, v14, v15
    v_cvt_pk_bf16_f32 v98, v16, v17
    v_mfma_f32_16x16x32_bf16 v[24:27], v[116:119], v[32:35], v[24:27]
    s_waitcnt lgkmcnt(3)
    ds_read_b128 v[52:55], v30 offset:39936
    v_cvt_pk_bf16_f32 v99, v18, v19
    v_mfma_f32_16x16x32_bf16 v[20:23], v[64:67], v[36:39], v[20:23]
    v_or_b32 v96, 1, v96
    v_or_b32 v98, 1, v98
    v_mfma_f32_16x16x32_bf16 v[24:27], v[68:71], v[36:39], v[24:27]
    s_waitcnt lgkmcnt(3)
    ds_read_b128 v[32:35], v30 offset:40960
    s_add_u32 s35, s43, 131072
    v_mfma_f32_16x16x32_bf16 v[20:23], v[120:123], v[40:43], v[20:23]
    s_barrier
    buffer_store_dwordx4 v[96:99], v0, s[4:7], s35 offen sc1
    v_mfma_f32_16x16x32_bf16 v[24:27], v[124:127], v[40:43], v[24:27]
    s_waitcnt lgkmcnt(3)
    ds_read_b128 v[36:39], v30 offset:41984
    v_mfma_f32_16x16x32_bf16 v[20:23], v[128:131], v[44:47], v[20:23]
    v_mfma_f32_16x16x32_bf16 v[24:27], v[132:135], v[44:47], v[24:27]
    s_waitcnt lgkmcnt(3)
    ds_read_b128 v[40:43], v30 offset:43008
    v_mfma_f32_16x16x32_bf16 v[20:23], v[136:139], v[48:51], v[20:23]
    v_add_f32 v104, v12, v13
    v_mul_f32 v105, v12, v12
    v_mfma_f32_16x16x32_bf16 v[24:27], v[140:143], v[48:51], v[24:27]
    s_waitcnt lgkmcnt(3)
    ds_read_b128 v[44:47], v30 offset:44032
    v_fmac_f32 v105, v13, v13
    v_mfma_f32_16x16x32_bf16 v[20:23], v[72:75], v[52:55], v[20:23]
    v_add_f32 v104, v104, v14
    v_fmac_f32 v105, v14, v14
    v_mfma_f32_16x16x32_bf16 v[24:27], v[76:79], v[52:55], v[24:27]
    s_waitcnt lgkmcnt(3)
    ds_read_b128 v[48:51], v30 offset:45056
    v_add_f32 v104, v104, v15
    v_mfma_f32_16x16x32_bf16 v[20:23], v[144:147], v[32:35], v[20:23]
    v_fmac_f32 v105, v15, v15
    v_add_f32 v104, v104, v16
    v_mfma_f32_16x16x32_bf16 v[24:27], v[148:151], v[32:35], v[24:27]
    s_waitcnt lgkmcnt(3)
    ds_read_b128 v[52:55], v30 offset:46080
    v_fmac_f32 v105, v16, v16
    v_mfma_f32_16x16x32_bf16 v[20:23], v[152:155], v[36:39], v[20:23]
    v_add_f32 v104, v104, v17
    v_fmac_f32 v105, v17, v17
    v_mfma_f32_16x16x32_bf16 v[24:27], v[156:159], v[36:39], v[24:27]
    s_waitcnt lgkmcnt(3)
    ds_read_b128 v[32:35], v30 offset:47104
    v_add_f32 v104, v104, v18
    v_mfma_f32_16x16x32_bf16 v[20:23], v[160:163], v[40:43], v[20:23]
    v_fmac_f32 v105, v18, v18
    v_add_f32 v104, v104, v19
    v_mfma_f32_16x16x32_bf16 v[24:27], v[164:167], v[40:43], v[24:27]
    s_waitcnt lgkmcnt(3)
    ds_read_b128 v[36:39], v30 offset:48128
    v_fmac_f32 v105, v19, v19
    v_mfma_f32_16x16x32_bf16 v[20:23], v[80:83], v[44:47], v[20:23]
    s_add_u32 s35, s44, 720896
    v_permlane16_swap_b32 v104, v105
    v_add_f32 v104, v104, v105
    v_mfma_f32_16x16x32_bf16 v[24:27], v[84:87], v[44:47], v[24:27]
    s_waitcnt lgkmcnt(3)
    v_mov_b32 v105, v104
    s_nop 1
    v_permlane32_swap_b32 v104, v105
    v_mfma_f32_16x16x32_bf16 v[20:23], v[168:171], v[48:51], v[20:23]
    v_add_f32 v104, v104, v105
    v_or_b32 v104, 1, v104
    v_mfma_f32_16x16x32_bf16 v[24:27], v[172:175], v[48:51], v[24:27]
    s_waitcnt lgkmcnt(2)
    buffer_store_dword v104, v7, s[4:7], s35 offen sc1
    v_mfma_f32_16x16x32_bf16 v[20:23], v[176:179], v[52:55], v[20:23]
    v_mfma_f32_16x16x32_bf16 v[24:27], v[180:183], v[52:55], v[24:27]
    s_waitcnt lgkmcnt(1)
    v_mfma_f32_16x16x32_bf16 v[20:23], v[184:187], v[32:35], v[20:23]
    v_mfma_f32_16x16x32_bf16 v[24:27], v[188:191], v[32:35], v[24:27]
    s_waitcnt lgkmcnt(0)
    v_mfma_f32_16x16x32_bf16 v[20:23], v[88:91], v[36:39], v[20:23]
    v_mfma_f32_16x16x32_bf16 v[24:27], v[92:95], v[36:39], v[24:27]
    s_nop 6
    v_cvt_pk_bf16_f32 v100, v20, v21
    v_cvt_pk_bf16_f32 v101, v22, v23
    v_cvt_pk_bf16_f32 v102, v24, v25
    v_cvt_pk_bf16_f32 v103, v26, v27
    v_or_b32 v100, 1, v100
    v_or_b32 v102, 1, v102
    s_add_u32 s31, s43, 163840
    buffer_store_dwordx4 v[100:103], v0, s[4:7], s31 offen sc1
    v_dot2_f32_bf16 v28, v100, s45, 0
    v_dot2_f32_bf16 v29, v100, v100, 0
    v_dot2_f32_bf16 v28, v101, s45, v28
    v_dot2_f32_bf16 v29, v101, v101, v29
    v_dot2_f32_bf16 v28, v102, s45, v28
    v_dot2_f32_bf16 v29, v102, v102, v29
    v_dot2_f32_bf16 v28, v103, s45, v28
    v_dot2_f32_bf16 v29, v103, v103, v29
    s_add_u32 s31, s44, 724992
    s_nop 1
    v_permlane16_swap_b32 v28, v29
    v_add_f32 v28, v28, v29
    v_mov_b32 v29, v28
    s_nop 1
    v_permlane32_swap_b32 v28, v29
    v_add_f32 v28, v28, v29
    v_or_b32 v28, 1, v28
    buffer_store_dword v28, v7, s[4:7], s31 offen sc1
    s_add_u32 m0, s41, 0
    s_add_u32 s31, s34, 131072
    buffer_load_dwordx4 v0, s[4:7], s31 offen offset:0 sc1 lds
    buffer_load_dwordx4 v0, s[4:7], s31 offen offset:1024 sc1 lds
    buffer_load_dwordx4 v0, s[4:7], s31 offen offset:2048 sc1 lds
    buffer_load_dwordx4 v0, s[4:7], s31 offen offset:3072 sc1 lds
    s_add_u32 m0, s41, 16384
    s_add_u32 s31, s34, 147456
    buffer_load_dwordx4 v0, s[4:7], s31 offen offset:0 sc1 lds
    buffer_load_dwordx4 v0, s[4:7], s31 offen offset:1024 sc1 lds
    buffer_load_dwordx4 v0, s[4:7], s31 offen offset:2048 sc1 lds
    buffer_load_dwordx4 v0, s[4:7], s31 offen offset:3072 sc1 lds
    buffer_load_dwordx4 v[176:179], v0, s[4:7], s62 offen sc1
    buffer_load_dwordx4 v[180:183], v0, s[4:7], s62 offen offset:1024 sc1
    buffer_load_dwordx4 v[184:187], v0, s[4:7], s68 offen offset:2048 sc1
    buffer_load_dwordx4 v[188:191], v0, s[4:7], s68 offen offset:3072 sc1
    s_mul_i32 s31, s24, 192
    v_add_u32 v30, s31, v1
    s_add_u32 s31, s41, 0
    v_add_u32 v28, s31, v0
    v_add_u32 v94, 0, v0
    ds_read_b128 v[80:83], v30 offset:2048
    ds_read_b128 v[84:87], v30 offset:2112
    ds_read_b128 v[88:91], v30 offset:2176
    s_waitcnt vmcnt(8)
    ds_read_b128 v[128:131], v28 offset:0
    ds_read_b128 v[132:135], v28 offset:1024
    ds_read_b128 v[136:139], v28 offset:2048
    ds_read_b128 v[140:143], v28 offset:3072
    s_waitcnt lgkmcnt(2)
    v_bitop3_b32 v128, v128, v130, v132 bitop3:0x80
    s_waitcnt lgkmcnt(1)
    v_bitop3_b32 v134, v134, v136, v138 bitop3:0x80
    s_waitcnt lgkmcnt(0)
    v_bitop3_b32 v128, v128, v134, v140 bitop3:0x80
    v_bitop3_b32 v128, v128, v142, 1 bitop3:0x80
    v_cmp_ne_u32 s[56:57], 1, v128
    s_nop 1
    s_cmp_lg_u64 s[56:57], 0
    s_cbranch_scc1 Lrare231
Lrare231b:
    s_barrier
    ds_read_b128 v[32:35], v94 offset:0
    ds_read_b128 v[36:39], v94 offset:1024
    ds_read_b128 v[40:43], v94 offset:2048
    ds_read_b128 v[44:47], v94 offset:3072
    ds_read_b128 v[48:51], v94 offset:4096
    s_waitcnt lgkmcnt(4)
    v_mfma_f32_16x16x32_bf16 v[56:59], a[0:3], v[32:35], 0
    s_add_u32 s30, s19, 720896
    buffer_load_dwordx4 v[156:159], v0, s[4:7], s30 offen sc1
    v_mfma_f32_16x16x32_bf16 v[60:63], a[64:67], v[32:35], 0
    s_add_u32 m0, s41, 32768
    s_add_u32 s30, s34, 163840
    v_mfma_f32_16x16x32_bf16 v[64:67], a[128:131], v[32:35], 0
    s_waitcnt lgkmcnt(3)
    ds_read_b128 v[52:55], v94 offset:5120
    v_mfma_f32_16x16x32_bf16 v[56:59], a[4:7], v[36:39], v[56:59]
    v_mfma_f32_16x16x32_bf16 v[60:63], a[68:71], v[36:39], v[60:63]
    buffer_load_dwordx4 v0, s[4:7], s30 offen offset:0 sc1 lds
    v_mfma_f32_16x16x32_bf16 v[64:67], a[132:135], v[36:39], v[64:67]
    s_waitcnt lgkmcnt(3)
    ds_read_b128 v[32:35], v94 offset:6144
    v_mfma_f32_16x16x32_bf16 v[56:59], a[8:11], v[40:43], v[56:59]
    s_waitcnt vmcnt(6)
    ds_read_b128 v[128:131], v28 offset:16384
    ds_read_b128 v[132:135], v28 offset:17408
    v_mfma_f32_16x16x32_bf16 v[60:63], a[72:75], v[40:43], v[60:63]
    ds_read_b128 v[136:139], v28 offset:18432
    ds_read_b128 v[140:143], v28 offset:19456
    v_mfma_f32_16x16x32_bf16 v[64:67], a[136:139], v[40:43], v[64:67]
    s_waitcnt lgkmcnt(7)
    ds_read_b128 v[36:39], v94 offset:7168
    v_mfma_f32_16x16x32_bf16 v[56:59], a[12:15], v[44:47], v[56:59]
    buffer_load_dwordx4 v0, s[4:7], s30 offen offset:1024 sc1 lds
    v_mfma_f32_16x16x32_bf16 v[60:63], a[76:79], v[44:47], v[60:63]
    v_mfma_f32_16x16x32_bf16 v[64:67], a[140:143], v[44:47], v[64:67]
    s_waitcnt lgkmcnt(7)
    ds_read_b128 v[40:43], v94 offset:8192
    v_mfma_f32_16x16x32_bf16 v[56:59], a[16:19], v[48:51], v[56:59]
    v_mfma_f32_16x16x32_bf16 v[60:63], a[80:83], v[48:51], v[60:63]
    buffer_load_dwordx4 v0, s[4:7], s30 offen offset:2048 sc1 lds
    v_mfma_f32_16x16x32_bf16 v[64:67], a[144:147], v[48:51], v[64:67]
    s_waitcnt lgkmcnt(7)
    ds_read_b128 v[44:47], v94 offset:9216
    v_mfma_f32_16x16x32_bf16 v[56:59], a[20:23], v[52:55], v[56:59]
    s_waitcnt lgkmcnt(5)
    v_bitop3_b32 v128, v128, v130, v132 bitop3:0x80
    v_mfma_f32_16x16x32_bf16 v[60:63], a[84:87], v[52:55], v[60:63]
    s_waitcnt lgkmcnt(4)
    v_bitop3_b32 v134, v134, v136, v138 bitop3:0x80
    v_mfma_f32_16x16x32_bf16 v[64:67], a[148:151], v[52:55], v[64:67]
    ds_read_b128 v[48:51], v94 offset:10240
    v_mfma_f32_16x16x32_bf16 v[56:59], a[24:27], v[32:35], v[56:59]
    buffer_load_dwordx4 v0, s[4:7], s30 offen offset:3072 sc1 lds
    v_mfma_f32_16x16x32_bf16 v[60:63], a[88:91], v[32:35], v[60:63]
    s_add_u32 s30, s19, 724992
    s_waitcnt lgkmcnt(4)
    v_bitop3_b32 v128, v128, v134, v140 bitop3:0x80
    v_mfma_f32_16x16x32_bf16 v[64:67], a[152:155], v[32:35], v[64:67]
    s_waitcnt lgkmcnt(3)
    ds_read_b128 v[52:55], v94 offset:11264
    v_bitop3_b32 v128, v128, v142, 1 bitop3:0x80
    v_mfma_f32_16x16x32_bf16 v[56:59], a[28:31], v[36:39], v[56:59]
    v_cmp_ne_u32 s[56:57], 1, v128
    v_mfma_f32_16x16x32_bf16 v[60:63], a[92:95], v[36:39], v[60:63]
    buffer_load_dwordx4 v[160:163], v0, s[4:7], s30 offen sc1
    v_mfma_f32_16x16x32_bf16 v[64:67], a[156:159], v[36:39], v[64:67]
    s_waitcnt lgkmcnt(3)
    ds_read_b128 v[32:35], v94 offset:12288
    s_add_u32 m0, s41, 49152
    v_mfma_f32_16x16x32_bf16 v[56:59], a[32:35], v[40:43], v[56:59]
    s_add_u32 s30, s34, 180224
    v_mfma_f32_16x16x32_bf16 v[60:63], a[96:99], v[40:43], v[60:63]
    v_mfma_f32_16x16x32_bf16 v[64:67], a[160:163], v[40:43], v[64:67]
    s_waitcnt lgkmcnt(3)
    ds_read_b128 v[36:39], v94 offset:13312
    v_mfma_f32_16x16x32_bf16 v[56:59], a[36:39], v[44:47], v[56:59]
    buffer_load_dwordx4 v0, s[4:7], s30 offen offset:0 sc1 lds
    v_mfma_f32_16x16x32_bf16 v[60:63], a[100:103], v[44:47], v[60:63]
    v_mfma_f32_16x16x32_bf16 v[64:67], a[164:167], v[44:47], v[64:67]
    s_waitcnt lgkmcnt(3)
    ds_read_b128 v[40:43], v94 offset:14336
    v_mfma_f32_16x16x32_bf16 v[56:59], a[40:43], v[48:51], v[56:59]
    v_mfma_f32_16x16x32_bf16 v[60:63], a[104:107], v[48:51], v[60:63]
    buffer_load_dwordx4 v0, s[4:7], s30 offen offset:1024 sc1 lds
    v_mfma_f32_16x16x32_bf16 v[64:67], a[168:171], v[48:51], v[64:67]
    s_waitcnt lgkmcnt(3)
    ds_read_b128 v[44:47], v94 offset:15360
    v_mfma_f32_16x16x32_bf16 v[56:59], a[44:47], v[52:55], v[56:59]
    s_cmp_lg_u64 s[56:57], 0
    s_cbranch_scc1 Lrare233
Lrare233b:
    s_barrier
    v_mfma_f32_16x16x32_bf16 v[60:63], a[108:111], v[52:55], v[60:63]
    v_mfma_f32_16x16x32_bf16 v[64:67], a[172:175], v[52:55], v[64:67]
    s_waitcnt lgkmcnt(3)
    ds_read_b128 v[48:51], v94 offset:16384
    v_mfma_f32_16x16x32_bf16 v[56:59], a[48:51], v[32:35], v[56:59]
    buffer_load_dwordx4 v0, s[4:7], s30 offen offset:2048 sc1 lds
    v_mfma_f32_16x16x32_bf16 v[60:63], a[112:115], v[32:35], v[60:63]
    s_waitcnt vmcnt(8)
    v_bitop3_b32 v31, v156, v157, v158 bitop3:0x80
    v_bitop3_b32 v31, v31, v159, 1 bitop3:0x80
    v_cmp_ne_u32 vcc, 1, v31
    s_cbranch_vccnz Lrare235
Lrare235b:
    v_mfma_f32_16x16x32_bf16 v[64:67], a[176:179], v[32:35], v[64:67]
    s_waitcnt lgkmcnt(3)
    ds_read_b128 v[52:55], v94 offset:17408
    v_add_f32 v156, v156, v158
    v_mfma_f32_16x16x32_bf16 v[56:59], a[52:55], v[36:39], v[56:59]
    v_add_f32 v157, v157, v159
    s_nop 0
    v_mfma_f32_16x16x32_bf16 v[60:63], a[116:119], v[36:39], v[60:63]
    buffer_load_dwordx4 v0, s[4:7], s30 offen offset:3072 sc1 lds
    v_mfma_f32_16x16x32_bf16 v[64:67], a[180:183], v[36:39], v[64:67]
    s_waitcnt lgkmcnt(3)
    ds_read_b128 v[32:35], v94 offset:18432
    s_lshl_b32 s30, s41, 2
    v_mfma_f32_16x16x32_bf16 v[56:59], a[56:59], v[40:43], v[56:59]
    s_add_u32 m0, s30, 73728
    s_add_u32 s30, s62, 12288
    s_add_u32 s51, s68, 12288
    v_mfma_f32_16x16x32_bf16 v[60:63], a[120:123], v[40:43], v[60:63]
    v_add_f32_dpp v156, v156, v156 quad_perm:[1,0,3,2] row_mask:0xf bank_mask:0xf
    v_add_f32_dpp v157, v157, v157 quad_perm:[1,0,3,2] row_mask:0xf bank_mask:0xf
    v_mfma_f32_16x16x32_bf16 v[64:67], a[184:187], v[40:43], v[64:67]
    s_waitcnt lgkmcnt(3)
    ds_read_b128 v[36:39], v94 offset:19456
    v_add_f32_dpp v156, v156, v156 quad_perm:[2,3,0,1] row_mask:0xf bank_mask:0xf
    v_mfma_f32_16x16x32_bf16 v[56:59], a[60:63], v[44:47], v[56:59]
    buffer_load_dwordx4 v0, s[4:7], s30 offen sc1 lds
    v_mfma_f32_16x16x32_bf16 v[60:63], a[124:127], v[44:47], v[60:63]
    v_add_f32_dpp v157, v157, v157 quad_perm:[2,3,0,1] row_mask:0xf bank_mask:0xf
    v_add_f32_dpp v156, v156, v156 row_half_mirror row_mask:0xf bank_mask:0xf
    v_mfma_f32_16x16x32_bf16 v[64:67], a[188:191], v[44:47], v[64:67]
    s_waitcnt lgkmcnt(3)
    ds_read_b128 v[40:43], v94 offset:20480
    v_add_f32_dpp v157, v157, v157 row_half_mirror row_mask:0xf bank_mask:0xf
    v_mfma_f32_16x16x32_bf16 v[68:71], a[0:3], v[48:51], 0
    v_mul_f32 v156, 0xbb000000, v156
    v_mul_f32 v157, 0x3b000000, v157
    v_mfma_f32_16x16x32_bf16 v[72:75], a[64:67], v[48:51], 0
    buffer_load_dwordx4 v0, s[4:7], s30 offen offset:1024 sc1 lds
    v_mfma_f32_16x16x32_bf16 v[76:79], a[128:131], v[48:51], 0
    s_waitcnt lgkmcnt(3)
    ds_read_b128 v[44:47], v94 offset:21504
    v_fma_f32 v157, -v156, v156, v157
    v_mfma_f32_16x16x32_bf16 v[68:71], a[4:7], v[52:55], v[68:71]
    ds_write_b32 v8, v156 offset:1792
    v_mfma_f32_16x16x32_bf16 v[72:75], a[68:71], v[52:55], v[72:75]
    v_max_f32 v157, 0, v157
    v_add_f32 v157, 0x3727c5ac, v157
    v_mfma_f32_16x16x32_bf16 v[76:79], a[132:135], v[52:55], v[76:79]
    s_waitcnt lgkmcnt(4)
    ds_read_b128 v[48:51], v94 offset:22528
    v_mfma_f32_16x16x32_bf16 v[68:71], a[8:11], v[32:35], v[68:71]
    s_waitcnt vmcnt(7)
    ds_read_b128 v[128:131], v28 offset:32768
    ds_read_b128 v[132:135], v28 offset:33792
    v_mfma_f32_16x16x32_bf16 v[72:75], a[72:75], v[32:35], v[72:75]
    ds_read_b128 v[136:139], v28 offset:34816
    ds_read_b128 v[140:143], v28 offset:35840
    v_mfma_f32_16x16x32_bf16 v[76:79], a[136:139], v[32:35], v[76:79]
    s_waitcnt lgkmcnt(8)
    ds_read_b128 v[52:55], v94 offset:23552
    v_mfma_f32_16x16x32_bf16 v[68:71], a[12:15], v[36:39], v[68:71]
    buffer_load_dwordx4 v0, s[4:7], s51 offen offset:2048 sc1 lds
    v_mfma_f32_16x16x32_bf16 v[72:75], a[76:79], v[36:39], v[72:75]
    v_rsq_f32 v157, v157
    v_mfma_f32_16x16x32_bf16 v[76:79], a[140:143], v[36:39], v[76:79]
    s_waitcnt lgkmcnt(8)
    ds_read_b128 v[32:35], v94 offset:24576
    v_mul_f32 v158, v156, v157
    v_mfma_f32_16x16x32_bf16 v[68:71], a[16:19], v[40:43], v[68:71]
    ds_write_b32 v8, v157 offset:1024
    v_mfma_f32_16x16x32_bf16 v[72:75], a[80:83], v[40:43], v[72:75]
    buffer_load_dwordx4 v0, s[4:7], s51 offen offset:3072 sc1 lds
    v_mfma_f32_16x16x32_bf16 v[76:79], a[144:147], v[40:43], v[76:79]
    s_waitcnt lgkmcnt(9)
    ds_read_b128 v[36:39], v94 offset:25600
    s_lshl_b32 s30, s41, 2
    v_mfma_f32_16x16x32_bf16 v[68:71], a[20:23], v[44:47], v[68:71]
    s_add_u32 m0, s30, 77824
    s_add_u32 s30, s62, 16384
    s_add_u32 s51, s68, 16384
    v_mfma_f32_16x16x32_bf16 v[72:75], a[84:87], v[44:47], v[72:75]
    s_waitcnt lgkmcnt(6)
    v_bitop3_b32 v128, v128, v130, v132 bitop3:0x80
    v_mul_f32 v157, s50, v157
    v_mfma_f32_16x16x32_bf16 v[76:79], a[148:151], v[44:47], v[76:79]
    ds_read_b128 v[40:43], v94 offset:26624
    v_mfma_f32_16x16x32_bf16 v[68:71], a[24:27], v[48:51], v[68:71]
    buffer_load_dwordx4 v0, s[4:7], s30 offen sc1 lds
    v_mfma_f32_16x16x32_bf16 v[72:75], a[88:91], v[48:51], v[72:75]
    s_waitcnt lgkmcnt(6)
    v_bitop3_b32 v134, v134, v136, v138 bitop3:0x80
    v_mfma_f32_16x16x32_bf16 v[76:79], a[152:155], v[48:51], v[76:79]
    s_waitcnt lgkmcnt(4)
    ds_read_b128 v[44:47], v94 offset:27648
    v_bitop3_b32 v128, v128, v134, v140 bitop3:0x80
    v_mfma_f32_16x16x32_bf16 v[68:71], a[28:31], v[52:55], v[68:71]
    v_bitop3_b32 v128, v128, v142, 1 bitop3:0x80
    v_cmp_ne_u32 s[56:57], 1, v128
    v_mfma_f32_16x16x32_bf16 v[72:75], a[92:95], v[52:55], v[72:75]
    buffer_load_dwordx4 v0, s[4:7], s30 offen offset:1024 sc1 lds
    v_mfma_f32_16x16x32_bf16 v[76:79], a[156:159], v[52:55], v[76:79]
    s_waitcnt lgkmcnt(4)
    ds_read_b128 v[48:51], v94 offset:28672
    v_mfma_f32_16x16x32_bf16 v[68:71], a[32:35], v[32:35], v[68:71]
    ds_write_b32 v8, v158 offset:1280
    v_mfma_f32_16x16x32_bf16 v[72:75], a[96:99], v[32:35], v[72:75]
    ds_write_b32 v8, v157 offset:1536
    v_mfma_f32_16x16x32_bf16 v[76:79], a[160:163], v[32:35], v[76:79]
    s_waitcnt lgkmcnt(5)
    ds_read_b128 v[52:55], v94 offset:29696
    v_mfma_f32_16x16x32_bf16 v[68:71], a[36:39], v[36:39], v[68:71]
    buffer_load_dwordx4 v0, s[4:7], s51 offen offset:2048 sc1 lds
    v_mfma_f32_16x16x32_bf16 v[72:75], a[100:103], v[36:39], v[72:75]
    s_waitcnt vmcnt(11)
    v_bitop3_b32 v31, v160, v161, v162 bitop3:0x80
    v_bitop3_b32 v31, v31, v163, 1 bitop3:0x80
    v_cmp_ne_u32 vcc, 1, v31
    s_cbranch_vccnz Lrare237
Lrare237b:
    v_mfma_f32_16x16x32_bf16 v[76:79], a[164:167], v[36:39], v[76:79]
    s_waitcnt lgkmcnt(5)
    ds_read_b128 v[32:35], v94 offset:30720
    v_add_f32 v160, v160, v162
    v_mfma_f32_16x16x32_bf16 v[68:71], a[40:43], v[40:43], v[68:71]
    v_add_f32 v161, v161, v163
    s_nop 0
    v_mfma_f32_16x16x32_bf16 v[72:75], a[104:107], v[40:43], v[72:75]
    buffer_load_dwordx4 v0, s[4:7], s51 offen offset:3072 sc1 lds
    v_mfma_f32_16x16x32_bf16 v[76:79], a[168:171], v[40:43], v[76:79]
    s_waitcnt lgkmcnt(5)
    ds_read_b128 v[36:39], v94 offset:31744
    v_add_f32_dpp v160, v160, v160 quad_perm:[1,0,3,2] row_mask:0xf bank_mask:0xf
    v_mfma_f32_16x16x32_bf16 v[68:71], a[44:47], v[44:47], v[68:71]
    s_cmp_lg_u64 s[56:57], 0
    s_cbranch_scc1 Lrare239
Lrare239b:
    s_waitcnt lgkmcnt(3)
    s_barrier
    v_mfma_f32_16x16x32_bf16 v[72:75], a[108:111], v[44:47], v[72:75]
    s_add_u32 m0, s41, 0
    ds_read_b32 v92, v2 offset:1792
    s_add_u32 s30, s63, 0
    v_mfma_f32_16x16x32_bf16 v[76:79], a[172:175], v[44:47], v[76:79]
    s_add_u32 s51, s69, 0
    ds_read_b128 v[40:43], v94 offset:32768
    v_add_f32_dpp v161, v161, v161 quad_perm:[1,0,3,2] row_mask:0xf bank_mask:0xf
    v_mfma_f32_16x16x32_bf16 v[68:71], a[48:51], v[48:51], v[68:71]
    buffer_load_dwordx4 v0, s[4:7], s30 offen sc1 lds
    v_mfma_f32_16x16x32_bf16 v[72:75], a[112:115], v[48:51], v[72:75]
    s_waitcnt lgkmcnt(1)
    v_fma_f32 v56, v92, v80, v56
    v_fma_f32 v57, v92, v81, v57
    v_mfma_f32_16x16x32_bf16 v[76:79], a[176:179], v[48:51], v[76:79]
    ds_read_b128 v[44:47], v94 offset:33792
    v_fma_f32 v58, v92, v82, v58
    v_mfma_f32_16x16x32_bf16 v[68:71], a[52:55], v[52:55], v[68:71]
    v_fma_f32 v59, v92, v83, v59
    v_fma_f32 v60, v92, v84, v60
    v_mfma_f32_16x16x32_bf16 v[72:75], a[116:119], v[52:55], v[72:75]
    buffer_load_dwordx4 v0, s[4:7], s30 offen offset:1024 sc1 lds
    v_mfma_f32_16x16x32_bf16 v[76:79], a[180:183], v[52:55], v[76:79]
    ds_read_b128 v[48:51], v94 offset:34816
    v_fma_f32 v61, v92, v85, v61
    v_mfma_f32_16x16x32_bf16 v[68:71], a[56:59], v[32:35], v[68:71]
    v_fma_f32 v62, v92, v86, v62
    v_fma_f32 v63, v92, v87, v63
    v_mfma_f32_16x16x32_bf16 v[72:75], a[120:123], v[32:35], v[72:75]
    v_fma_f32 v64, v92, v88, v64
    v_fma_f32 v65, v92, v89, v65
    v_mfma_f32_16x16x32_bf16 v[76:79], a[184:187], v[32:35], v[76:79]
    ds_read_b128 v[52:55], v94 offset:35840
    v_fma_f32 v66, v92, v90, v66
    v_mfma_f32_16x16x32_bf16 v[68:71], a[60:63], v[36:39], v[68:71]
    ds_read_b32 v93, v2 offset:1856
    v_fma_f32 v67, v92, v91, v67
    v_mfma_f32_16x16x32_bf16 v[72:75], a[124:127], v[36:39], v[72:75]
    buffer_load_dwordx4 v0, s[4:7], s51 offen offset:2048 sc1 lds
    v_cvt_pk_bf16_f32 v144, v56, v57
    v_cvt_pk_bf16_f32 v145, v58, v59
    v_cvt_pk_bf16_f32 v146, v60, v61
    v_cvt_pk_bf16_f32 v147, v62, v63
    v_cvt_pk_bf16_f32 v148, v64, v65
    v_cvt_pk_bf16_f32 v149, v66, v67
    v_mfma_f32_16x16x32_bf16 v[76:79], a[188:191], v[36:39], v[76:79]
    s_waitcnt lgkmcnt(4)
    ds_read_b128 v[32:35], v94 offset:36864
    v_pk_max_i16 v144, v144, 0
    v_mfma_f32_16x16x32_bf16 v[56:59], a[0:3], v[40:43], 0
    v_pk_max_i16 v145, v145, 0
    v_pk_max_i16 v146, v146, 0
    v_mfma_f32_16x16x32_bf16 v[60:63], a[64:67], v[40:43], 0
    v_pk_max_i16 v147, v147, 0
    v_pk_max_i16 v148, v148, 0
    v_mfma_f32_16x16x32_bf16 v[64:67], a[128:131], v[40:43], 0
    s_waitcnt lgkmcnt(4)
    ds_read_b128 v[36:39], v94 offset:37888
    v_pk_max_i16 v149, v149, 0
    v_mfma_f32_16x16x32_bf16 v[56:59], a[4:7], v[44:47], v[56:59]
    s_add_u32 s35, s58, 327680
    buffer_load_dwordx4 v0, s[4:7], s51 offen offset:3072 sc1 lds
    v_mfma_f32_16x16x32_bf16 v[60:63], a[68:71], v[44:47], v[60:63]
    s_add_u32 s36, s59, 327680
    s_waitcnt vmcnt(12)
    ds_read_b128 v[128:131], v28 offset:49152
    v_mfma_f32_16x16x32_bf16 v[64:67], a[132:135], v[44:47], v[64:67]
    s_waitcnt lgkmcnt(5)
    ds_read_b128 v[40:43], v94 offset:38912
    ds_read_b128 v[132:135], v28 offset:50176
    v_mfma_f32_16x16x32_bf16 v[56:59], a[8:11], v[48:51], v[56:59]
    ds_read_b128 v[136:139], v28 offset:51200
    ds_read_b128 v[140:143], v28 offset:52224
    v_mfma_f32_16x16x32_bf16 v[60:63], a[72:75], v[48:51], v[60:63]
    buffer_store_dwordx4 v[144:147], v0, s[4:7], s35 offen sc1
    buffer_store_dwordx2 v[148:149], v9, s[4:7], s36 offen sc1
    v_mfma_f32_16x16x32_bf16 v[64:67], a[136:139], v[48:51], v[64:67]
    s_waitcnt lgkmcnt(8)
    ds_read_b128 v[44:47], v94 offset:39936
    v_add_f32_dpp v160, v160, v160 quad_perm:[2,3,0,1] row_mask:0xf bank_mask:0xf
    v_mfma_f32_16x16x32_bf16 v[56:59], a[12:15], v[52:55], v[56:59]
    s_waitcnt lgkmcnt(8)
    v_fma_f32 v68, v93, v80, v68
    v_fma_f32 v69, v93, v81, v69
    v_mfma_f32_16x16x32_bf16 v[60:63], a[76:79], v[52:55], v[60:63]
    v_fma_f32 v70, v93, v82, v70
    v_fma_f32 v71, v93, v83, v71
    v_mfma_f32_16x16x32_bf16 v[64:67], a[140:143], v[52:55], v[64:67]
    s_waitcnt lgkmcnt(7)
    ds_read_b128 v[48:51], v94 offset:40960
    v_fma_f32 v72, v93, v84, v72
    v_mfma_f32_16x16x32_bf16 v[56:59], a[16:19], v[32:35], v[56:59]
    v_fma_f32 v73, v93, v85, v73
    v_fma_f32 v74, v93, v86, v74
    v_mfma_f32_16x16x32_bf16 v[60:63], a[80:83], v[32:35], v[60:63]
    v_fma_f32 v75, v93, v87, v75
    v_fma_f32 v76, v93, v88, v76
    v_mfma_f32_16x16x32_bf16 v[64:67], a[144:147], v[32:35], v[64:67]
    s_waitcnt lgkmcnt(7)
    ds_read_b128 v[52:55], v94 offset:41984
    v_fma_f32 v77, v93, v89, v77
    v_mfma_f32_16x16x32_bf16 v[56:59], a[20:23], v[36:39], v[56:59]
    v_fma_f32 v78, v93, v90, v78
    v_fma_f32 v79, v93, v91, v79
    v_mfma_f32_16x16x32_bf16 v[60:63], a[84:87], v[36:39], v[60:63]
    v_cvt_pk_bf16_f32 v150, v68, v69
    v_cvt_pk_bf16_f32 v151, v70, v71
    v_mfma_f32_16x16x32_bf16 v[64:67], a[148:151], v[36:39], v[64:67]
    s_waitcnt lgkmcnt(6)
    ds_read_b128 v[32:35], v94 offset:43008
    v_cvt_pk_bf16_f32 v152, v72, v73
    v_mfma_f32_16x16x32_bf16 v[56:59], a[24:27], v[40:43], v[56:59]
    v_cvt_pk_bf16_f32 v153, v74, v75
    v_cvt_pk_bf16_f32 v154, v76, v77
    v_mfma_f32_16x16x32_bf16 v[60:63], a[88:91], v[40:43], v[60:63]
    v_cvt_pk_bf16_f32 v155, v78, v79
    v_pk_max_i16 v150, v150, 0
    v_mfma_f32_16x16x32_bf16 v[64:67], a[152:155], v[40:43], v[64:67]
    s_waitcnt lgkmcnt(3)
    ds_read_b128 v[36:39], v94 offset:44032
    v_pk_max_i16 v151, v151, 0
    v_mfma_f32_16x16x32_bf16 v[56:59], a[28:31], v[44:47], v[56:59]
    v_pk_max_i16 v152, v152, 0
    v_pk_max_i16 v153, v153, 0
    v_mfma_f32_16x16x32_bf16 v[60:63], a[92:95], v[44:47], v[60:63]
    v_pk_max_i16 v154, v154, 0
    v_pk_max_i16 v155, v155, 0
    v_mfma_f32_16x16x32_bf16 v[64:67], a[156:159], v[44:47], v[64:67]
    s_waitcnt lgkmcnt(3)
    ds_read_b128 v[40:43], v94 offset:45056
    s_add_u32 s35, s58, 371712
    v_mfma_f32_16x16x32_bf16 v[56:59], a[32:35], v[48:51], v[56:59]
    s_add_u32 s36, s59, 371712
    buffer_store_dwordx4 v[150:153], v0, s[4:7], s35 offen sc1
    v_mfma_f32_16x16x32_bf16 v[60:63], a[96:99], v[48:51], v[60:63]
    buffer_store_dwordx2 v[154:155], v9, s[4:7], s36 offen sc1
    v_mfma_f32_16x16x32_bf16 v[64:67], a[160:163], v[48:51], v[64:67]
    s_waitcnt lgkmcnt(3)
    ds_read_b128 v[44:47], v94 offset:46080
    v_bitop3_b32 v128, v128, v130, v132 bitop3:0x80
    v_mfma_f32_16x16x32_bf16 v[56:59], a[36:39], v[52:55], v[56:59]
    v_bitop3_b32 v134, v134, v136, v138 bitop3:0x80
    v_bitop3_b32 v128, v128, v134, v140 bitop3:0x80
    v_mfma_f32_16x16x32_bf16 v[60:63], a[100:103], v[52:55], v[60:63]
    v_bitop3_b32 v128, v128, v142, 1 bitop3:0x80
    v_cmp_ne_u32 s[56:57], 1, v128
    v_mfma_f32_16x16x32_bf16 v[64:67], a[164:167], v[52:55], v[64:67]
    s_waitcnt lgkmcnt(3)
    ds_read_b128 v[48:51], v94 offset:47104
    v_add_f32_dpp v161, v161, v161 quad_perm:[2,3,0,1] row_mask:0xf bank_mask:0xf
    v_mfma_f32_16x16x32_bf16 v[56:59], a[40:43], v[32:35], v[56:59]
    v_add_f32_dpp v160, v160, v160 row_half_mirror row_mask:0xf bank_mask:0xf
    v_add_f32_dpp v161, v161, v161 row_half_mirror row_mask:0xf bank_mask:0xf
    v_mul_f32 v160, 0xbb000000, v160
    v_mul_f32 v161, 0x3b000000, v161
    v_fma_f32 v161, -v160, v160, v161
    ds_write_b32 v8, v160 offset:1920
    v_max_f32 v161, 0, v161
    v_add_f32 v161, 0x3727c5ac, v161
    v_rsq_f32 v161, v161
    s_nop 0
    v_mul_f32 v162, v160, v161
    ds_write_b32 v8, v161 offset:1152
    v_mul_f32 v161, s50, v161
    ds_write_b32 v8, v162 offset:1408
    ds_write_b32 v8, v161 offset:1664
    v_mfma_f32_16x16x32_bf16 v[60:63], a[104:107], v[32:35], v[60:63]
    v_mfma_f32_16x16x32_bf16 v[64:67], a[168:171], v[32:35], v[64:67]
    s_waitcnt lgkmcnt(7)
    ds_read_b128 v[52:55], v94 offset:48128
    v_mfma_f32_16x16x32_bf16 v[56:59], a[44:47], v[36:39], v[56:59]
    s_cmp_lg_u64 s[56:57], 0
    s_cbranch_scc1 Lrare241
Lrare241b:
    s_waitcnt lgkmcnt(1)
    s_barrier
    v_mfma_f32_16x16x32_bf16 v[60:63], a[108:111], v[36:39], v[60:63]
    s_add_u32 m0, s41, 16384
    s_add_u32 s30, s63, 4096
    s_add_u32 s51, s69, 4096
    v_mfma_f32_16x16x32_bf16 v[64:67], a[172:175], v[36:39], v[64:67]
    ds_read_b128 v[32:35], v94 offset:49152
    v_mfma_f32_16x16x32_bf16 v[56:59], a[48:51], v[40:43], v[56:59]
    buffer_load_dwordx4 v0, s[4:7], s30 offen sc1 lds
    v_mfma_f32_16x16x32_bf16 v[60:63], a[112:115], v[40:43], v[60:63]
    v_mfma_f32_16x16x32_bf16 v[64:67], a[176:179], v[40:43], v[64:67]
    ds_read_b128 v[36:39], v94 offset:50176
    v_mfma_f32_16x16x32_bf16 v[56:59], a[52:55], v[44:47], v[56:59]
    v_mfma_f32_16x16x32_bf16 v[60:63], a[116:119], v[44:47], v[60:63]
    buffer_load_dwordx4 v0, s[4:7], s30 offen offset:1024 sc1 lds
    v_mfma_f32_16x16x32_bf16 v[64:67], a[180:183], v[44:47], v[64:67]
    ds_read_b128 v[40:43], v94 offset:51200
    v_mfma_f32_16x16x32_bf16 v[56:59], a[56:59], v[48:51], v[56:59]
    v_mfma_f32_16x16x32_bf16 v[60:63], a[120:123], v[48:51], v[60:63]
    v_mfma_f32_16x16x32_bf16 v[64:67], a[184:187], v[48:51], v[64:67]
    s_waitcnt lgkmcnt(3)
    ds_read_b128 v[44:47], v94 offset:52224
    v_mfma_f32_16x16x32_bf16 v[56:59], a[60:63], v[52:55], v[56:59]
    ds_read_b32 v92, v2 offset:1920
    v_mfma_f32_16x16x32_bf16 v[60:63], a[124:127], v[52:55], v[60:63]
    buffer_load_dwordx4 v0, s[4:7], s51 offen offset:2048 sc1 lds
    v_mfma_f32_16x16x32_bf16 v[64:67], a[188:191], v[52:55], v[64:67]
    s_waitcnt lgkmcnt(4)
    ds_read_b128 v[48:51], v94 offset:53248
    v_mfma_f32_16x16x32_bf16 v[68:71], a[0:3], v[32:35], 0
    v_mfma_f32_16x16x32_bf16 v[72:75], a[64:67], v[32:35], 0
    v_mfma_f32_16x16x32_bf16 v[76:79], a[128:131], v[32:35], 0
    s_waitcnt lgkmcnt(4)
    ds_read_b128 v[52:55], v94 offset:54272
    v_mfma_f32_16x16x32_bf16 v[68:71], a[4:7], v[36:39], v[68:71]
    buffer_load_dwordx4 v0, s[4:7], s51 offen offset:3072 sc1 lds
    v_mfma_f32_16x16x32_bf16 v[72:75], a[68:71], v[36:39], v[72:75]
    s_add_u32 s64, s60, 327680
    s_add_u32 s65, s64, s73
    v_mfma_f32_16x16x32_bf16 v[76:79], a[132:135], v[36:39], v[76:79]
    s_waitcnt lgkmcnt(4)
    ds_read_b128 v[32:35], v94 offset:55296
    v_mfma_f32_16x16x32_bf16 v[68:71], a[8:11], v[40:43], v[68:71]
    s_waitcnt lgkmcnt(3)
    v_fma_f32 v56, v92, v80, v56
    v_fma_f32 v57, v92, v81, v57
    v_mfma_f32_16x16x32_bf16 v[72:75], a[72:75], v[40:43], v[72:75]
    buffer_load_dwordx4 v[96:99], v0, s[4:7], s64 offen offset:0 sc1
    v_mfma_f32_16x16x32_bf16 v[76:79], a[136:139], v[40:43], v[76:79]
    ds_read_b128 v[36:39], v94 offset:56320
    v_fma_f32 v58, v92, v82, v58
    v_mfma_f32_16x16x32_bf16 v[68:71], a[12:15], v[44:47], v[68:71]
    s_barrier
    v_fma_f32 v59, v92, v83, v59
    v_fma_f32 v60, v92, v84, v60
    v_mfma_f32_16x16x32_bf16 v[72:75], a[76:79], v[44:47], v[72:75]
    v_fma_f32 v61, v92, v85, v61
    v_fma_f32 v62, v92, v86, v62
    v_mfma_f32_16x16x32_bf16 v[76:79], a[140:143], v[44:47], v[76:79]
    s_waitcnt lgkmcnt(3)
    ds_read_b128 v[40:43], v94 offset:57344
    v_fma_f32 v63, v92, v87, v63
    v_mfma_f32_16x16x32_bf16 v[68:71], a[16:19], v[48:51], v[68:71]
    buffer_load_dwordx4 v[100:103], v0, s[4:7], s65 offen offset:0 sc1
    v_mfma_f32_16x16x32_bf16 v[72:75], a[80:83], v[48:51], v[72:75]
    v_fma_f32 v64, v92, v88, v64
    v_fma_f32 v65, v92, v89, v65
    v_mfma_f32_16x16x32_bf16 v[76:79], a[144:147], v[48:51], v[76:79]
    s_waitcnt lgkmcnt(3)
    ds_read_b128 v[44:47], v94 offset:58368
    v_fma_f32 v66, v92, v90, v66
    v_mfma_f32_16x16x32_bf16 v[68:71], a[20:23], v[52:55], v[68:71]
    v_fma_f32 v67, v92, v91, v67
    v_cvt_pk_bf16_f32 v144, v56, v57
    v_mfma_f32_16x16x32_bf16 v[72:75], a[84:87], v[52:55], v[72:75]
    buffer_load_dwordx4 v[104:107], v0, s[4:7], s64 offen offset:1024 sc1
    v_mfma_f32_16x16x32_bf16 v[76:79], a[148:151], v[52:55], v[76:79]
    s_waitcnt lgkmcnt(3)
    ds_read_b128 v[48:51], v94 offset:59392
    v_cvt_pk_bf16_f32 v145, v58, v59
    v_mfma_f32_16x16x32_bf16 v[68:71], a[24:27], v[32:35], v[68:71]
    v_cvt_pk_bf16_f32 v146, v60, v61
    v_cvt_pk_bf16_f32 v147, v62, v63
    v_mfma_f32_16x16x32_bf16 v[72:75], a[88:91], v[32:35], v[72:75]
    v_cvt_pk_bf16_f32 v148, v64, v65
    v_cvt_pk_bf16_f32 v149, v66, v67
    v_mfma_f32_16x16x32_bf16 v[76:79], a[152:155], v[32:35], v[76:79]
    s_waitcnt lgkmcnt(3)
    ds_read_b128 v[52:55], v94 offset:60416
    v_pk_max_i16 v144, v144, 0
    v_mfma_f32_16x16x32_bf16 v[68:71], a[28:31], v[36:39], v[68:71]
    buffer_load_dwordx4 v[108:111], v0, s[4:7], s65 offen offset:1024 sc1
    v_mfma_f32_16x16x32_bf16 v[72:75], a[92:95], v[36:39], v[72:75]
    v_pk_max_i16 v145, v145, 0
    v_pk_max_i16 v146, v146, 0
    v_mfma_f32_16x16x32_bf16 v[76:79], a[156:159], v[36:39], v[76:79]
    s_waitcnt lgkmcnt(3)
    ds_read_b128 v[32:35], v94 offset:61440
    v_pk_max_i16 v147, v147, 0
    v_mfma_f32_16x16x32_bf16 v[68:71], a[32:35], v[40:43], v[68:71]
    v_pk_max_i16 v148, v148, 0
    v_pk_max_i16 v149, v149, 0
    v_mfma_f32_16x16x32_bf16 v[72:75], a[96:99], v[40:43], v[72:75]
    s_add_u32 s35, s58, 415744
    buffer_load_dwordx4 v[112:115], v0, s[4:7], s64 offen offset:2048 sc1
    v_mfma_f32_16x16x32_bf16 v[76:79], a[160:163], v[40:43], v[76:79]
    s_waitcnt lgkmcnt(3)
    ds_read_b128 v[36:39], v94 offset:62464
    s_add_u32 m0, s41, 32768
    v_mfma_f32_16x16x32_bf16 v[68:71], a[36:39], v[44:47], v[68:71]
    s_add_u32 s30, s63, 8192
    s_add_u32 s51, s69, 8192
    s_add_u32 s36, s59, 415744
    v_mfma_f32_16x16x32_bf16 v[72:75], a[100:103], v[44:47], v[72:75]
    buffer_store_dwordx4 v[144:147], v0, s[4:7], s35 offen sc1
    v_mfma_f32_16x16x32_bf16 v[76:79], a[164:167], v[44:47], v[76:79]
    s_waitcnt lgkmcnt(3)
    ds_read_b128 v[40:43], v94 offset:63488
    v_mfma_f32_16x16x32_bf16 v[68:71], a[40:43], v[48:51], v[68:71]
    buffer_load_dwordx4 v0, s[4:7], s30 offen sc1 lds
    v_mfma_f32_16x16x32_bf16 v[72:75], a[104:107], v[48:51], v[72:75]
    buffer_store_dwordx2 v[148:149], v9, s[4:7], s36 offen sc1
    v_mfma_f32_16x16x32_bf16 v[76:79], a[168:171], v[48:51], v[76:79]
    s_waitcnt lgkmcnt(3)
    ds_read_b128 v[44:47], v94 offset:64512
    v_mfma_f32_16x16x32_bf16 v[68:71], a[44:47], v[52:55], v[68:71]
    v_mfma_f32_16x16x32_bf16 v[72:75], a[108:111], v[52:55], v[72:75]
    buffer_load_dwordx4 v0, s[4:7], s30 offen offset:1024 sc1 lds
    v_mfma_f32_16x16x32_bf16 v[76:79], a[172:175], v[52:55], v[76:79]
    s_waitcnt lgkmcnt(3)
    v_mfma_f32_16x16x32_bf16 v[68:71], a[48:51], v[32:35], v[68:71]
    v_mfma_f32_16x16x32_bf16 v[72:75], a[112:115], v[32:35], v[72:75]
    v_mfma_f32_16x16x32_bf16 v[76:79], a[176:179], v[32:35], v[76:79]
    s_waitcnt lgkmcnt(2)
    buffer_load_dwordx4 v0, s[4:7], s51 offen offset:2048 sc1 lds
    v_mfma_f32_16x16x32_bf16 v[68:71], a[52:55], v[36:39], v[68:71]
    v_mfma_f32_16x16x32_bf16 v[72:75], a[116:119], v[36:39], v[72:75]
    v_mfma_f32_16x16x32_bf16 v[76:79], a[180:183], v[36:39], v[76:79]
    s_waitcnt lgkmcnt(1)
    v_mfma_f32_16x16x32_bf16 v[68:71], a[56:59], v[40:43], v[68:71]
    ds_read_b32 v93, v2 offset:1984
    v_mfma_f32_16x16x32_bf16 v[72:75], a[120:123], v[40:43], v[72:75]
    buffer_load_dwordx4 v0, s[4:7], s51 offen offset:3072 sc1 lds
    v_mfma_f32_16x16x32_bf16 v[76:79], a[184:187], v[40:43], v[76:79]
    s_waitcnt lgkmcnt(1)
    v_mfma_f32_16x16x32_bf16 v[68:71], a[60:63], v[44:47], v[68:71]
    v_mfma_f32_16x16x32_bf16 v[72:75], a[124:127], v[44:47], v[72:75]
    v_mfma_f32_16x16x32_bf16 v[76:79], a[188:191], v[44:47], v[76:79]
    buffer_load_dwordx4 v[116:119], v0, s[4:7], s65 offen offset:2048 sc1
    s_barrier
    s_waitcnt lgkmcnt(0)
    s_nop 2
    v_pk_fma_f32 v[68:69], v[80:81], v[92:93], v[68:69] op_sel:[0,1,0] op_sel_hi:[1,1,1]
    v_pk_fma_f32 v[70:71], v[82:83], v[92:93], v[70:71] op_sel:[0,1,0] op_sel_hi:[1,1,1]
    v_pk_fma_f32 v[72:73], v[84:85], v[92:93], v[72:73] op_sel:[0,1,0] op_sel_hi:[1,1,1]
    v_pk_fma_f32 v[74:75], v[86:87], v[92:93], v[74:75] op_sel:[0,1,0] op_sel_hi:[1,1,1]
    v_pk_fma_f32 v[76:77], v[88:89], v[92:93], v[76:77] op_sel:[0,1,0] op_sel_hi:[1,1,1]
    v_pk_fma_f32 v[78:79], v[90:91], v[92:93], v[78:79] op_sel:[0,1,0] op_sel_hi:[1,1,1]
    v_cvt_pk_bf16_f32 v150, v68, v69
    v_cvt_pk_bf16_f32 v151, v70, v71
    v_cvt_pk_bf16_f32 v152, v72, v73
    v_cvt_pk_bf16_f32 v153, v74, v75
    v_cvt_pk_bf16_f32 v154, v76, v77
    v_cvt_pk_bf16_f32 v155, v78, v79
    v_pk_max_i16 v150, v150, 0
    v_pk_max_i16 v151, v151, 0
    v_pk_max_i16 v152, v152, 0
    v_pk_max_i16 v153, v153, 0
    v_pk_max_i16 v154, v154, 0
    v_pk_max_i16 v155, v155, 0
    s_add_u32 s35, s58, 459776
    s_add_u32 s36, s59, 459776
    buffer_store_dwordx4 v[150:153], v0, s[4:7], s35 offen sc1
    buffer_store_dwordx2 v[154:155], v9, s[4:7], s36 offen sc1
    buffer_load_dwordx4 v[120:123], v0, s[4:7], s64 offen offset:3072 sc1
    buffer_load_dwordx4 v[124:127], v0, s[4:7], s65 offen offset:3072 sc1
    s_lshl_b32 s31, s41, 2
    s_add_u32 s31, s31, 65536
    v_add_u32 v28, s31, v0
    s_add_u32 s31, s41, 0
    v_add_u32 v29, s31, v0
    v_add_u32 v30, s16, v0
    s_waitcnt vmcnt(14)
    v_or3_b32 v31, v96, v98, v100
    v_or_b32 v31, v31, v102
    v_cmp_gt_i32 vcc, 0, v31
    s_cbranch_vccnz Lrare243
Lrare243b:
    v_mfma_f32_16x16x32_bf16 v[32:35], v[176:179], v[96:99], 0
    s_add_u32 s64, s60, 331776
    ds_read_b128 v[160:163], v28 offset:0
    ds_read_b128 v[164:167], v28 offset:1024
    v_mfma_f32_16x16x32_bf16 v[48:51], v[176:179], v[100:103], 0
    s_add_u32 s65, s64, s73
    ds_read_b128 v[168:171], v28 offset:2048
    ds_read_b128 v[172:175], v28 offset:3072
    v_mfma_f32_16x16x32_bf16 v[36:39], v[180:183], v[96:99], 0
    buffer_load_dwordx4 v[128:131], v0, s[4:7], s64 offen offset:0 sc1
    v_mfma_f32_16x16x32_bf16 v[52:55], v[180:183], v[100:103], 0
    s_waitcnt vmcnt(13)
    v_or3_b32 v31, v104, v106, v108
    v_or_b32 v31, v31, v110
    v_mfma_f32_16x16x32_bf16 v[40:43], v[184:187], v[96:99], 0
    v_cmp_gt_i32 vcc, 0, v31
    v_mfma_f32_16x16x32_bf16 v[56:59], v[184:187], v[100:103], 0
    buffer_load_dwordx4 v[132:135], v0, s[4:7], s65 offen offset:0 sc1
    v_mfma_f32_16x16x32_bf16 v[44:47], v[188:191], v[96:99], 0
    s_cbranch_vccnz Lrare245
Lrare245b:
    s_add_u32 s64, s15, 327680
    s_add_u32 s65, s64, s73
    v_mfma_f32_16x16x32_bf16 v[60:63], v[188:191], v[100:103], 0
    s_waitcnt lgkmcnt(2)
    buffer_load_dwordx4 v[136:139], v0, s[4:7], s64 offen offset:0 sc1
    v_mfma_f32_16x16x32_bf16 v[32:35], v[160:163], v[104:107], v[32:35]
    ds_read_b128 v[144:147], v28 offset:4096
    ds_read_b128 v[148:151], v28 offset:5120
    v_mfma_f32_16x16x32_bf16 v[48:51], v[160:163], v[108:111], v[48:51]
    ds_read_b128 v[152:155], v28 offset:6144
    ds_read_b128 v[156:159], v28 offset:7168
    v_mfma_f32_16x16x32_bf16 v[36:39], v[164:167], v[104:107], v[36:39]
    s_waitcnt lgkmcnt(4)
    buffer_load_dwordx4 v[140:143], v0, s[4:7], s65 offen offset:0 sc1
    v_mfma_f32_16x16x32_bf16 v[52:55], v[164:167], v[108:111], v[52:55]
    s_waitcnt vmcnt(8)
    v_or3_b32 v31, v112, v114, v116
    v_or_b32 v31, v31, v118
    v_mfma_f32_16x16x32_bf16 v[40:43], v[168:171], v[104:107], v[40:43]
    s_add_u32 s64, s20, 327680
    v_cmp_gt_i32 vcc, 0, v31
    s_add_u32 s65, s64, s73
    v_mfma_f32_16x16x32_bf16 v[56:59], v[168:171], v[108:111], v[56:59]
    buffer_load_dwordx4 v[96:99], v0, s[4:7], s64 offen offset:0 sc1
    v_mfma_f32_16x16x32_bf16 v[44:47], v[172:175], v[104:107], v[44:47]
    s_cbranch_vccnz Lrare247
Lrare247b:
    v_mfma_f32_16x16x32_bf16 v[60:63], v[172:175], v[108:111], v[60:63]
    s_waitcnt lgkmcnt(2)
    buffer_load_dwordx4 v[100:103], v0, s[4:7], s65 offen offset:0 sc1
    v_mfma_f32_16x16x32_bf16 v[32:35], v[144:147], v[112:115], v[32:35]
    s_add_u32 s64, s61, 327680
    ds_read_b128 v[160:163], v28 offset:8192
    ds_read_b128 v[164:167], v28 offset:9216
    v_mfma_f32_16x16x32_bf16 v[48:51], v[144:147], v[116:119], v[48:51]
    s_add_u32 s65, s64, s73
    ds_read_b128 v[168:171], v28 offset:10240
    ds_read_b128 v[172:175], v28 offset:11264
    v_mfma_f32_16x16x32_bf16 v[36:39], v[148:151], v[112:115], v[36:39]
    s_waitcnt lgkmcnt(4)
    buffer_load_dwordx4 v[104:107], v0, s[4:7], s64 offen offset:0 sc1
    v_mfma_f32_16x16x32_bf16 v[52:55], v[148:151], v[116:119], v[52:55]
    s_waitcnt vmcnt(7)
    v_or3_b32 v31, v120, v122, v124
    v_or_b32 v31, v31, v126
    v_mfma_f32_16x16x32_bf16 v[40:43], v[152:155], v[112:115], v[40:43]
    v_cmp_gt_i32 vcc, 0, v31
    v_mfma_f32_16x16x32_bf16 v[56:59], v[152:155], v[116:119], v[56:59]
    buffer_load_dwordx4 v[108:111], v0, s[4:7], s65 offen offset:0 sc1
    v_mfma_f32_16x16x32_bf16 v[44:47], v[156:159], v[112:115], v[44:47]
    s_cbranch_vccnz Lrare249
Lrare249b:
    s_add_u32 m0, s41, 49152
    s_add_u32 s30, s63, 12288
    v_mfma_f32_16x16x32_bf16 v[60:63], v[156:159], v[116:119], v[60:63]
    s_waitcnt lgkmcnt(2)
    s_add_u32 s51, s69, 12288
    v_mfma_f32_16x16x32_bf16 v[32:35], v[160:163], v[120:123], v[32:35]
    ds_read_b128 v[144:147], v28 offset:12288
    ds_read_b128 v[148:151], v28 offset:13312
    v_mfma_f32_16x16x32_bf16 v[48:51], v[160:163], v[124:127], v[48:51]
    ds_read_b128 v[152:155], v28 offset:14336
    ds_read_b128 v[156:159], v28 offset:15360
    v_mfma_f32_16x16x32_bf16 v[36:39], v[164:167], v[120:123], v[36:39]
    s_waitcnt lgkmcnt(4)
    buffer_load_dwordx4 v0, s[4:7], s30 offen sc1 lds
    v_mfma_f32_16x16x32_bf16 v[52:55], v[164:167], v[124:127], v[52:55]
    s_waitcnt vmcnt(7)
    v_or3_b32 v31, v128, v130, v132
    v_or_b32 v31, v31, v134
    v_mfma_f32_16x16x32_bf16 v[40:43], v[168:171], v[120:123], v[40:43]
    v_cmp_gt_i32 vcc, 0, v31
    v_mfma_f32_16x16x32_bf16 v[56:59], v[168:171], v[124:127], v[56:59]
    buffer_load_dwordx4 v0, s[4:7], s30 offen offset:1024 sc1 lds
    v_mfma_f32_16x16x32_bf16 v[44:47], v[172:175], v[120:123], v[44:47]
    s_cbranch_vccnz Lrare251
Lrare251b:
    v_mfma_f32_16x16x32_bf16 v[60:63], v[172:175], v[124:127], v[60:63]
    s_waitcnt lgkmcnt(2)
    buffer_load_dwordx4 v0, s[4:7], s51 offen offset:2048 sc1 lds
    v_mfma_f32_16x16x32_bf16 v[32:35], v[144:147], v[128:131], v[32:35]
    ds_read_b128 v[160:163], v30 offset:0
    ds_read_b128 v[164:167], v30 offset:1024
    v_mfma_f32_16x16x32_bf16 v[48:51], v[144:147], v[132:135], v[48:51]
    ds_read_b128 v[168:171], v30 offset:2048
    ds_read_b128 v[172:175], v30 offset:3072
    v_mfma_f32_16x16x32_bf16 v[36:39], v[148:151], v[128:131], v[36:39]
    s_waitcnt lgkmcnt(4)
    buffer_load_dwordx4 v0, s[4:7], s51 offen offset:3072 sc1 lds
    v_mfma_f32_16x16x32_bf16 v[52:55], v[148:151], v[132:135], v[52:55]
    s_waitcnt vmcnt(8)
    v_or3_b32 v31, v136, v138, v140
    v_or_b32 v31, v31, v142
    v_mfma_f32_16x16x32_bf16 v[40:43], v[152:155], v[128:131], v[40:43]
    v_cmp_gt_i32 vcc, 0, v31
    v_mfma_f32_16x16x32_bf16 v[56:59], v[152:155], v[132:135], v[56:59]
    buffer_load_dwordx4 v[112:115], v0, s[4:7], s64 offen offset:1024 sc1
    v_mfma_f32_16x16x32_bf16 v[44:47], v[156:159], v[128:131], v[44:47]
    s_cbranch_vccnz Lrare253
Lrare253b:
    v_mfma_f32_16x16x32_bf16 v[60:63], v[156:159], v[132:135], v[60:63]
    s_waitcnt lgkmcnt(2)
    buffer_load_dwordx4 v[116:119], v0, s[4:7], s65 offen offset:1024 sc1
    v_mfma_f32_16x16x32_bf16 v[32:35], v[160:163], v[136:139], v[32:35]
    ds_read_b128 v[144:147], v30 offset:4096
    ds_read_b128 v[148:151], v30 offset:5120
    v_mfma_f32_16x16x32_bf16 v[48:51], v[160:163], v[140:143], v[48:51]
    ds_read_b128 v[152:155], v30 offset:6144
    ds_read_b128 v[156:159], v30 offset:7168
    v_mfma_f32_16x16x32_bf16 v[36:39], v[164:167], v[136:139], v[36:39]
    s_waitcnt lgkmcnt(4)
    buffer_load_dwordx4 v[120:123], v0, s[4:7], s64 offen offset:2048 sc1
    v_mfma_f32_16x16x32_bf16 v[52:55], v[164:167], v[140:143], v[52:55]
    s_waitcnt vmcnt(9)
    v_or3_b32 v31, v96, v98, v100
    v_or_b32 v31, v31, v102
    v_mfma_f32_16x16x32_bf16 v[40:43], v[168:171], v[136:139], v[40:43]
    v_cmp_gt_i32 vcc, 0, v31
    v_mfma_f32_16x16x32_bf16 v[56:59], v[168:171], v[140:143], v[56:59]
    buffer_load_dwordx4 v[124:127], v0, s[4:7], s65 offen offset:2048 sc1
    v_mfma_f32_16x16x32_bf16 v[44:47], v[172:175], v[136:139], v[44:47]
    s_cbranch_vccnz Lrare255
Lrare255b:
    v_mfma_f32_16x16x32_bf16 v[60:63], v[172:175], v[140:143], v[60:63]
    s_waitcnt lgkmcnt(2)
    buffer_load_dwordx4 v[128:131], v0, s[4:7], s64 offen offset:3072 sc1
    v_mfma_f32_16x16x32_bf16 v[32:35], v[144:147], v[96:99], v[32:35]
    ds_read_b128 v[160:163], v29 offset:0
    ds_read_b128 v[164:167], v29 offset:1024
    v_mfma_f32_16x16x32_bf16 v[48:51], v[144:147], v[100:103], v[48:51]
    ds_read_b128 v[168:171], v29 offset:2048
    ds_read_b128 v[172:175], v29 offset:3072
    v_mfma_f32_16x16x32_bf16 v[36:39], v[148:151], v[96:99], v[36:39]
    s_waitcnt lgkmcnt(4)
    buffer_load_dwordx4 v[132:135], v0, s[4:7], s65 offen offset:3072 sc1
    v_mfma_f32_16x16x32_bf16 v[52:55], v[148:151], v[100:103], v[52:55]
    s_waitcnt vmcnt(10)
    v_or3_b32 v31, v104, v106, v108
    v_or_b32 v31, v31, v110
    v_mfma_f32_16x16x32_bf16 v[40:43], v[152:155], v[96:99], v[40:43]
    s_add_u32 s64, s60, 415744
    v_cmp_gt_i32 vcc, 0, v31
    s_add_u32 s65, s64, s73
    v_mfma_f32_16x16x32_bf16 v[56:59], v[152:155], v[100:103], v[56:59]
    buffer_load_dwordx4 v[136:139], v0, s[4:7], s64 offen offset:0 sc1
    v_mfma_f32_16x16x32_bf16 v[44:47], v[156:159], v[96:99], v[44:47]
    s_cbranch_vccnz Lrare257
Lrare257b:
    v_mfma_f32_16x16x32_bf16 v[60:63], v[156:159], v[100:103], v[60:63]
    s_waitcnt lgkmcnt(2)
    buffer_load_dwordx4 v[140:143], v0, s[4:7], s65 offen offset:0 sc1
    v_mfma_f32_16x16x32_bf16 v[32:35], v[160:163], v[104:107], v[32:35]
    ds_read_b128 v[144:147], v29 offset:16384
    ds_read_b128 v[148:151], v29 offset:17408
    v_mfma_f32_16x16x32_bf16 v[48:51], v[160:163], v[108:111], v[48:51]
    ds_read_b128 v[152:155], v29 offset:18432
    ds_read_b128 v[156:159], v29 offset:19456
    v_mfma_f32_16x16x32_bf16 v[36:39], v[164:167], v[104:107], v[36:39]
    s_waitcnt lgkmcnt(4)
    buffer_load_dwordx4 v[96:99], v0, s[4:7], s64 offen offset:1024 sc1
    v_mfma_f32_16x16x32_bf16 v[52:55], v[164:167], v[108:111], v[52:55]
    s_waitcnt vmcnt(7)
    v_or3_b32 v31, v112, v114, v116
    v_or_b32 v31, v31, v118
    v_mfma_f32_16x16x32_bf16 v[40:43], v[168:171], v[104:107], v[40:43]
    v_cmp_gt_i32 vcc, 0, v31
    s_lshr_b32 s31, s2, 3
    s_xor_b32 s31, s31, 0
    s_or_b32 s31, s31, s24
    s_cmp_lg_u32 s31, 0
    s_cbranch_scc1 Lskip259
    buffer_wbl2 sc1
Lskip259:
    v_mfma_f32_16x16x32_bf16 v[56:59], v[168:171], v[108:111], v[56:59]
    buffer_load_dwordx4 v[100:103], v0, s[4:7], s65 offen offset:1024 sc1
    v_mfma_f32_16x16x32_bf16 v[44:47], v[172:175], v[104:107], v[44:47]
    s_cbranch_vccnz Lrare260
Lrare260b:
    v_mfma_f32_16x16x32_bf16 v[60:63], v[172:175], v[108:111], v[60:63]
    s_waitcnt lgkmcnt(2)
    v_mfma_f32_16x16x32_bf16 v[32:35], v[144:147], v[112:115], v[32:35]
    ds_read_b128 v[160:163], v29 offset:32768
    ds_read_b128 v[164:167], v29 offset:33792
    v_mfma_f32_16x16x32_bf16 v[48:51], v[144:147], v[116:119], v[48:51]
    ds_read_b128 v[168:171], v29 offset:34816
    ds_read_b128 v[172:175], v29 offset:35840
    v_mfma_f32_16x16x32_bf16 v[36:39], v[148:151], v[112:115], v[36:39]
    s_waitcnt lgkmcnt(4)
    buffer_load_dwordx4 v[104:107], v0, s[4:7], s64 offen offset:2048 sc1
    v_mfma_f32_16x16x32_bf16 v[52:55], v[148:151], v[116:119], v[52:55]
    s_waitcnt vmcnt(7)
    v_or3_b32 v31, v120, v122, v124
    v_or_b32 v31, v31, v126
    v_mfma_f32_16x16x32_bf16 v[40:43], v[152:155], v[112:115], v[40:43]
    v_cmp_gt_i32 vcc, 0, v31
    v_mfma_f32_16x16x32_bf16 v[56:59], v[152:155], v[116:119], v[56:59]
    buffer_load_dwordx4 v[108:111], v0, s[4:7], s65 offen offset:2048 sc1
    v_mfma_f32_16x16x32_bf16 v[44:47], v[156:159], v[112:115], v[44:47]
    s_cbranch_vccnz Lrare262
Lrare262b:
    v_mfma_f32_16x16x32_bf16 v[60:63], v[156:159], v[116:119], v[60:63]
    s_waitcnt lgkmcnt(2)
    v_mfma_f32_16x16x32_bf16 v[32:35], v[160:163], v[120:123], v[32:35]
    ds_read_b128 v[144:147], v29 offset:49152
    ds_read_b128 v[148:151], v29 offset:50176
    v_mfma_f32_16x16x32_bf16 v[48:51], v[160:163], v[124:127], v[48:51]
    ds_read_b128 v[152:155], v29 offset:51200
    ds_read_b128 v[156:159], v29 offset:52224
    v_mfma_f32_16x16x32_bf16 v[36:39], v[164:167], v[120:123], v[36:39]
    s_waitcnt lgkmcnt(4)
    buffer_load_dwordx4 v[112:115], v0, s[4:7], s64 offen offset:3072 sc1
    v_mfma_f32_16x16x32_bf16 v[52:55], v[164:167], v[124:127], v[52:55]
    s_waitcnt vmcnt(7)
    v_or3_b32 v31, v128, v130, v132
    v_or_b32 v31, v31, v134
    v_mfma_f32_16x16x32_bf16 v[40:43], v[168:171], v[120:123], v[40:43]
    v_cmp_gt_i32 vcc, 0, v31
    v_mfma_f32_16x16x32_bf16 v[56:59], v[168:171], v[124:127], v[56:59]
    buffer_load_dwordx4 v[116:119], v0, s[4:7], s65 offen offset:3072 sc1
    v_mfma_f32_16x16x32_bf16 v[44:47], v[172:175], v[120:123], v[44:47]
    s_cbranch_vccnz Lrare264
Lrare264b:
    v_mfma_f32_16x16x32_bf16 v[60:63], v[172:175], v[124:127], v[60:63]
    s_waitcnt lgkmcnt(2)
    v_mfma_f32_16x16x32_bf16 v[32:35], v[144:147], v[128:131], v[32:35]
    s_add_u32 s64, s60, 419840
    s_add_u32 s65, s64, s73
    v_mfma_f32_16x16x32_bf16 v[48:51], v[144:147], v[132:135], v[48:51]
    buffer_load_dwordx4 v[120:123], v0, s[4:7], s64 offen offset:0 sc1
    v_mfma_f32_16x16x32_bf16 v[36:39], v[148:151], v[128:131], v[36:39]
    s_waitcnt lgkmcnt(0)
    v_mfma_f32_16x16x32_bf16 v[52:55], v[148:151], v[132:135], v[52:55]
    s_waitcnt vmcnt(7)
    v_or3_b32 v31, v136, v138, v140
    v_or_b32 v31, v31, v142
    v_mfma_f32_16x16x32_bf16 v[40:43], v[152:155], v[128:131], v[40:43]
    v_cmp_gt_i32 vcc, 0, v31
    v_mfma_f32_16x16x32_bf16 v[56:59], v[152:155], v[132:135], v[56:59]
    buffer_load_dwordx4 v[124:127], v0, s[4:7], s65 offen offset:0 sc1
    v_mfma_f32_16x16x32_bf16 v[44:47], v[156:159], v[128:131], v[44:47]
    s_cbranch_vccnz Lrare266
Lrare266b:
    v_mfma_f32_16x16x32_bf16 v[60:63], v[156:159], v[132:135], v[60:63]
    v_mfma_f32_16x16x32_bf16 v[64:67], v[176:179], v[136:139], 0
    s_add_u32 s64, s15, 415744
    ds_read_b128 v[160:163], v28 offset:0
    ds_read_b128 v[164:167], v28 offset:1024
    v_mfma_f32_16x16x32_bf16 v[80:83], v[176:179], v[140:143], 0
    s_add_u32 s65, s64, s73
    ds_read_b128 v[168:171], v28 offset:2048
    ds_read_b128 v[172:175], v28 offset:3072
    v_mfma_f32_16x16x32_bf16 v[68:71], v[180:183], v[136:139], 0
    buffer_load_dwordx4 v[128:131], v0, s[4:7], s64 offen offset:0 sc1
    v_mfma_f32_16x16x32_bf16 v[84:87], v[180:183], v[140:143], 0
    s_waitcnt vmcnt(7)
    v_or3_b32 v31, v96, v98, v100
    v_or_b32 v31, v31, v102
    v_mfma_f32_16x16x32_bf16 v[72:75], v[184:187], v[136:139], 0
    v_cmp_gt_i32 vcc, 0, v31
    v_mfma_f32_16x16x32_bf16 v[88:91], v[184:187], v[140:143], 0
    buffer_load_dwordx4 v[132:135], v0, s[4:7], s65 offen offset:0 sc1
    v_mfma_f32_16x16x32_bf16 v[76:79], v[188:191], v[136:139], 0
    s_cbranch_vccnz Lrare268
Lrare268b:
    v_mfma_f32_16x16x32_bf16 v[92:95], v[188:191], v[140:143], 0
    s_waitcnt lgkmcnt(2)
    v_mfma_f32_16x16x32_bf16 v[64:67], v[160:163], v[96:99], v[64:67]
    s_add_u32 s64, s20, 415744
    ds_read_b128 v[144:147], v28 offset:4096
    ds_read_b128 v[148:151], v28 offset:5120
    v_mfma_f32_16x16x32_bf16 v[80:83], v[160:163], v[100:103], v[80:83]
    s_add_u32 s65, s64, s73
    ds_read_b128 v[152:155], v28 offset:6144
    ds_read_b128 v[156:159], v28 offset:7168
    v_mfma_f32_16x16x32_bf16 v[68:71], v[164:167], v[96:99], v[68:71]
    s_waitcnt lgkmcnt(4)
    buffer_load_dwordx4 v[136:139], v0, s[4:7], s64 offen offset:0 sc1
    v_mfma_f32_16x16x32_bf16 v[84:87], v[164:167], v[100:103], v[84:87]
    s_waitcnt vmcnt(7)
    v_or3_b32 v31, v104, v106, v108
    v_or_b32 v31, v31, v110
    v_mfma_f32_16x16x32_bf16 v[72:75], v[168:171], v[96:99], v[72:75]
    v_cmp_gt_i32 vcc, 0, v31
    v_xor_b32 v177, 16384, v28
    v_mfma_f32_16x16x32_bf16 v[88:91], v[168:171], v[100:103], v[88:91]
    buffer_load_dwordx4 v[140:143], v0, s[4:7], s65 offen offset:0 sc1
    v_mfma_f32_16x16x32_bf16 v[76:79], v[172:175], v[96:99], v[76:79]
    s_cbranch_vccnz Lrare270
Lrare270b:
    v_xor_b32 v178, 32768, v28
    v_xor_b32 v179, 49152, v28
    v_mfma_f32_16x16x32_bf16 v[92:95], v[172:175], v[100:103], v[92:95]
    s_waitcnt lgkmcnt(2)
    s_and_b32 s35, s24, 2
    s_lshl_b32 s35, s35, 5
    v_mfma_f32_16x16x32_bf16 v[64:67], v[144:147], v[104:107], v[64:67]
    s_add_u32 s64, s61, 415744
    ds_read_b128 v[160:163], v28 offset:8192
    ds_read_b128 v[164:167], v28 offset:9216
    v_mfma_f32_16x16x32_bf16 v[80:83], v[144:147], v[108:111], v[80:83]
    s_add_u32 s65, s64, s73
    ds_read_b128 v[168:171], v28 offset:10240
    ds_read_b128 v[172:175], v28 offset:11264
    v_mfma_f32_16x16x32_bf16 v[68:71], v[148:151], v[104:107], v[68:71]
    s_waitcnt lgkmcnt(4)
    buffer_load_dwordx4 v[96:99], v0, s[4:7], s64 offen offset:0 sc1
    v_mfma_f32_16x16x32_bf16 v[84:87], v[148:151], v[108:111], v[84:87]
    s_waitcnt vmcnt(7)
    v_or3_b32 v31, v112, v114, v116
    v_or_b32 v31, v31, v118
    v_mfma_f32_16x16x32_bf16 v[72:75], v[152:155], v[104:107], v[72:75]
    v_cmp_gt_i32 vcc, 0, v31
    v_add_u32 v176, s35, v2
    v_mfma_f32_16x16x32_bf16 v[88:91], v[152:155], v[108:111], v[88:91]
    buffer_load_dwordx4 v[100:103], v0, s[4:7], s65 offen offset:0 sc1
    v_mfma_f32_16x16x32_bf16 v[76:79], v[156:159], v[104:107], v[76:79]
    s_cbranch_vccnz Lrare272
Lrare272b:
    ds_write_b128 v28, v[40:43] offset:2048
    v_mfma_f32_16x16x32_bf16 v[92:95], v[156:159], v[108:111], v[92:95]
    s_waitcnt lgkmcnt(3)
    ds_write_b128 v28, v[44:47] offset:3072
    v_mfma_f32_16x16x32_bf16 v[64:67], v[160:163], v[112:115], v[64:67]
    ds_read_b128 v[144:147], v28 offset:12288
    ds_read_b128 v[148:151], v28 offset:13312
    v_mfma_f32_16x16x32_bf16 v[80:83], v[160:163], v[116:119], v[80:83]
    ds_read_b128 v[152:155], v28 offset:14336
    ds_read_b128 v[156:159], v28 offset:15360
    v_mfma_f32_16x16x32_bf16 v[68:71], v[164:167], v[112:115], v[68:71]
    s_waitcnt lgkmcnt(6)
    buffer_load_dwordx4 v[104:107], v0, s[4:7], s64 offen offset:1024 sc1
    v_mfma_f32_16x16x32_bf16 v[84:87], v[164:167], v[116:119], v[84:87]
    s_waitcnt vmcnt(7)
    v_or3_b32 v31, v120, v122, v124
    v_or_b32 v31, v31, v126
    v_mfma_f32_16x16x32_bf16 v[72:75], v[168:171], v[112:115], v[72:75]
    v_cmp_gt_i32 vcc, 0, v31
    v_mfma_f32_16x16x32_bf16 v[88:91], v[168:171], v[116:119], v[88:91]
    buffer_load_dwordx4 v[108:111], v0, s[4:7], s65 offen offset:1024 sc1
    v_mfma_f32_16x16x32_bf16 v[76:79], v[172:175], v[112:115], v[76:79]
    s_cbranch_vccnz Lrare274
Lrare274b:
    ds_write_b128 v28, v[48:51] offset:4096
    ds_write_b128 v28, v[52:55] offset:5120
    ds_write_b128 v28, v[56:59] offset:6144
    ds_write_b128 v28, v[60:63] offset:7168
    v_mfma_f32_16x16x32_bf16 v[92:95], v[172:175], v[116:119], v[92:95]
    s_waitcnt lgkmcnt(6)
    s_waitcnt lgkmcnt(0)
    s_barrier
    v_mfma_f32_16x16x32_bf16 v[64:67], v[144:147], v[120:123], v[64:67]
    ds_read_b128 v[160:163], v30 offset:0
    ds_read_b128 v[164:167], v30 offset:1024
    v_mfma_f32_16x16x32_bf16 v[80:83], v[144:147], v[124:127], v[80:83]
    ds_read_b128 v[168:171], v30 offset:2048
    ds_read_b128 v[172:175], v30 offset:3072
    v_mfma_f32_16x16x32_bf16 v[68:71], v[148:151], v[120:123], v[68:71]
    ds_read_b32 v176, v176 offset:1024
    ds_read_b128 v[40:43], v177 offset:2048
    v_mfma_f32_16x16x32_bf16 v[84:87], v[148:151], v[124:127], v[84:87]
    s_waitcnt vmcnt(6)
    v_or3_b32 v31, v128, v130, v132
    v_or_b32 v31, v31, v134
    v_mfma_f32_16x16x32_bf16 v[72:75], v[152:155], v[120:123], v[72:75]
    v_cmp_gt_i32 vcc, 0, v31
    v_mfma_f32_16x16x32_bf16 v[88:91], v[152:155], v[124:127], v[88:91]
    ds_read_b128 v[44:47], v177 offset:3072
    ds_read_b128 v[48:51], v178 offset:4096
    v_mfma_f32_16x16x32_bf16 v[76:79], v[156:159], v[120:123], v[76:79]
    s_cbranch_vccnz Lrare276
Lrare276b:
    ds_read_b128 v[52:55], v178 offset:5120
    ds_read_b128 v[56:59], v179 offset:6144
    v_mfma_f32_16x16x32_bf16 v[92:95], v[156:159], v[124:127], v[92:95]
    s_waitcnt lgkmcnt(8)
    ds_read_b128 v[60:63], v179 offset:7168
    v_mfma_f32_16x16x32_bf16 v[64:67], v[160:163], v[128:131], v[64:67]
    ds_read_b128 v[144:147], v30 offset:4096
    ds_read_b128 v[148:151], v30 offset:5120
    v_mfma_f32_16x16x32_bf16 v[80:83], v[160:163], v[132:135], v[80:83]
    ds_read_b128 v[152:155], v30 offset:6144
    ds_read_b128 v[156:159], v30 offset:7168
    v_mfma_f32_16x16x32_bf16 v[68:71], v[164:167], v[128:131], v[68:71]
    s_waitcnt lgkmcnt(11)
    buffer_load_dwordx4 v[112:115], v0, s[4:7], s64 offen offset:2048 sc1
    v_mfma_f32_16x16x32_bf16 v[84:87], v[164:167], v[132:135], v[84:87]
    s_waitcnt vmcnt(5)
    v_or3_b32 v31, v136, v138, v140
    v_or_b32 v31, v31, v142
    v_mfma_f32_16x16x32_bf16 v[72:75], v[168:171], v[128:131], v[72:75]
    v_cmp_gt_i32 vcc, 0, v31
    v_mfma_f32_16x16x32_bf16 v[88:91], v[168:171], v[132:135], v[88:91]
    buffer_load_dwordx4 v[116:119], v0, s[4:7], s65 offen offset:2048 sc1
    v_mfma_f32_16x16x32_bf16 v[76:79], v[172:175], v[128:131], v[76:79]
    s_cbranch_vccnz Lrare278
Lrare278b:
    s_waitcnt lgkmcnt(9)
    v_add_f32 v32, v32, v40
    v_mfma_f32_16x16x32_bf16 v[92:95], v[172:175], v[132:135], v[92:95]
    s_waitcnt lgkmcnt(2)
    buffer_load_dwordx4 v[120:123], v0, s[4:7], s64 offen offset:3072 sc1
    v_mfma_f32_16x16x32_bf16 v[64:67], v[144:147], v[136:139], v[64:67]
    ds_read_b128 v[160:163], v29 offset:0
    ds_read_b128 v[164:167], v29 offset:1024
    v_mfma_f32_16x16x32_bf16 v[80:83], v[144:147], v[140:143], v[80:83]
    ds_read_b128 v[168:171], v29 offset:2048
    ds_read_b128 v[172:175], v29 offset:3072
    v_mfma_f32_16x16x32_bf16 v[68:71], v[148:151], v[136:139], v[68:71]
    s_waitcnt lgkmcnt(4)
    buffer_load_dwordx4 v[124:127], v0, s[4:7], s65 offen offset:3072 sc1
    v_mfma_f32_16x16x32_bf16 v[84:87], v[148:151], v[140:143], v[84:87]
    s_waitcnt vmcnt(6)
    v_or3_b32 v31, v96, v98, v100
    v_or_b32 v31, v31, v102
    v_mfma_f32_16x16x32_bf16 v[72:75], v[152:155], v[136:139], v[72:75]
    v_cmp_gt_i32 vcc, 0, v31
    v_add_f32 v33, v33, v41
    v_mfma_f32_16x16x32_bf16 v[88:91], v[152:155], v[140:143], v[88:91]
    v_add_f32 v34, v34, v42
    v_add_f32 v35, v35, v43
    v_mfma_f32_16x16x32_bf16 v[76:79], v[156:159], v[136:139], v[76:79]
    s_cbranch_vccnz Lrare280
Lrare280b:
    v_add_f32 v36, v36, v44
    v_add_f32 v37, v37, v45
    v_mfma_f32_16x16x32_bf16 v[92:95], v[156:159], v[140:143], v[92:95]
    s_waitcnt lgkmcnt(2)
    v_add_f32 v38, v38, v46
    v_add_f32 v39, v39, v47
    v_mfma_f32_16x16x32_bf16 v[64:67], v[160:163], v[96:99], v[64:67]
    ds_read_b128 v[144:147], v29 offset:16384
    ds_read_b128 v[148:151], v29 offset:17408
    v_mfma_f32_16x16x32_bf16 v[80:83], v[160:163], v[100:103], v[80:83]
    ds_read_b128 v[152:155], v29 offset:18432
    ds_read_b128 v[156:159], v29 offset:19456
    v_mfma_f32_16x16x32_bf16 v[68:71], v[164:167], v[96:99], v[68:71]
    s_waitcnt lgkmcnt(4)
    v_add_f32 v48, v48, v56
    v_add_f32 v49, v49, v57
    v_mfma_f32_16x16x32_bf16 v[84:87], v[164:167], v[100:103], v[84:87]
    s_waitcnt vmcnt(4)
    v_or3_b32 v31, v104, v106, v108
    v_or_b32 v31, v31, v110
    v_mfma_f32_16x16x32_bf16 v[72:75], v[168:171], v[96:99], v[72:75]
    v_cmp_gt_i32 vcc, 0, v31
    v_add_f32 v50, v50, v58
    v_mfma_f32_16x16x32_bf16 v[88:91], v[168:171], v[100:103], v[88:91]
    v_add_f32 v51, v51, v59
    v_add_f32 v52, v52, v60
    v_mfma_f32_16x16x32_bf16 v[76:79], v[172:175], v[96:99], v[76:79]
    s_cbranch_vccnz Lrare282
Lrare282b:
    v_add_f32 v53, v53, v61
    v_add_f32 v54, v54, v62
    v_mfma_f32_16x16x32_bf16 v[92:95], v[172:175], v[100:103], v[92:95]
    s_waitcnt lgkmcnt(2)
    v_add_f32 v55, v55, v63
    v_add_f32 v32, v32, v48
    v_mfma_f32_16x16x32_bf16 v[64:67], v[144:147], v[104:107], v[64:67]
    ds_read_b128 v[160:163], v29 offset:32768
    ds_read_b128 v[164:167], v29 offset:33792
    v_mfma_f32_16x16x32_bf16 v[80:83], v[144:147], v[108:111], v[80:83]
    ds_read_b128 v[168:171], v29 offset:34816
    ds_read_b128 v[172:175], v29 offset:35840
    v_mfma_f32_16x16x32_bf16 v[68:71], v[148:151], v[104:107], v[68:71]
    s_waitcnt lgkmcnt(4)
    v_add_f32 v33, v33, v49
    v_add_f32 v34, v34, v50
    v_mfma_f32_16x16x32_bf16 v[84:87], v[148:151], v[108:111], v[84:87]
    s_waitcnt vmcnt(2)
    v_or3_b32 v31, v112, v114, v116
    v_or_b32 v31, v31, v118
    v_mfma_f32_16x16x32_bf16 v[72:75], v[152:155], v[104:107], v[72:75]
    v_cmp_gt_i32 vcc, 0, v31
    v_add_f32 v35, v35, v51
    v_mfma_f32_16x16x32_bf16 v[88:91], v[152:155], v[108:111], v[88:91]
    v_add_f32 v36, v36, v52
    v_add_f32 v37, v37, v53
    v_mfma_f32_16x16x32_bf16 v[76:79], v[156:159], v[104:107], v[76:79]
    s_cbranch_vccnz Lrare284
Lrare284b:
    v_add_f32 v38, v38, v54
    v_add_f32 v39, v39, v55
    v_mfma_f32_16x16x32_bf16 v[92:95], v[156:159], v[108:111], v[92:95]
    s_waitcnt lgkmcnt(2)
    v_fma_f32 v12, v32, v176, v12
    v_fma_f32 v13, v33, v176, v13
    v_mfma_f32_16x16x32_bf16 v[64:67], v[160:163], v[112:115], v[64:67]
    ds_read_b128 v[144:147], v29 offset:49152
    ds_read_b128 v[148:151], v29 offset:50176
    v_mfma_f32_16x16x32_bf16 v[80:83], v[160:163], v[116:119], v[80:83]
    ds_read_b128 v[152:155], v29 offset:51200
    ds_read_b128 v[156:159], v29 offset:52224
    v_mfma_f32_16x16x32_bf16 v[68:71], v[164:167], v[112:115], v[68:71]
    s_waitcnt lgkmcnt(4)
    v_fma_f32 v14, v34, v176, v14
    v_fma_f32 v15, v35, v176, v15
    v_mfma_f32_16x16x32_bf16 v[84:87], v[164:167], v[116:119], v[84:87]
    s_waitcnt vmcnt(0)
    v_or3_b32 v31, v120, v122, v124
    v_or_b32 v31, v31, v126
    v_mfma_f32_16x16x32_bf16 v[72:75], v[168:171], v[112:115], v[72:75]
    v_cmp_gt_i32 vcc, 0, v31
    v_fma_f32 v16, v36, v176, v16
    v_mfma_f32_16x16x32_bf16 v[88:91], v[168:171], v[116:119], v[88:91]
    v_fma_f32 v17, v37, v176, v17
    v_fma_f32 v18, v38, v176, v18
    v_mfma_f32_16x16x32_bf16 v[76:79], v[172:175], v[112:115], v[76:79]
    s_cbranch_vccnz Lrare286
Lrare286b:
    v_fma_f32 v19, v39, v176, v19
    v_cvt_pk_bf16_f32 v40, v12, v13
    v_mfma_f32_16x16x32_bf16 v[92:95], v[172:175], v[116:119], v[92:95]
    s_waitcnt lgkmcnt(2)
    s_waitcnt lgkmcnt(1)
    v_cvt_pk_bf16_f32 v41, v14, v15
    v_mfma_f32_16x16x32_bf16 v[72:75], v[152:155], v[120:123], v[72:75]
    v_cvt_pk_bf16_f32 v42, v16, v17
    v_cvt_pk_bf16_f32 v43, v18, v19
    v_mfma_f32_16x16x32_bf16 v[88:91], v[152:155], v[124:127], v[88:91]
    s_waitcnt lgkmcnt(0)
    v_bfe_u32 v44, v0, 4, 4
    v_lshrrev_b32 v45, 8, v0
    v_mfma_f32_16x16x32_bf16 v[76:79], v[156:159], v[120:123], v[76:79]
    v_lshlrev_b32 v44, 10, v44
    v_lshl_add_u32 v44, v45, 4, v44
    v_mfma_f32_16x16x32_bf16 v[92:95], v[156:159], v[124:127], v[92:95]
    s_add_u32 s35, s70, 0
    buffer_store_dwordx4 v[40:43], v44, s[8:11], s35 offen sc1
    v_mfma_f32_16x16x32_bf16 v[80:83], v[144:147], v[124:127], v[80:83]
    v_xor_b32 v181, 16384, v28
    v_xor_b32 v182, 32768, v28
    v_mfma_f32_16x16x32_bf16 v[84:87], v[148:151], v[124:127], v[84:87]
    v_xor_b32 v183, 49152, v28
    s_and_b32 s35, s24, 2
    v_mfma_f32_16x16x32_bf16 v[64:67], v[144:147], v[120:123], v[64:67]
    s_lshl_b32 s35, s35, 5
    v_add_u32 v180, s35, v2
    v_mfma_f32_16x16x32_bf16 v[68:71], v[148:151], v[120:123], v[68:71]
    ds_write_b128 v28, v[72:75] offset:10240
    ds_write_b128 v28, v[88:91] offset:14336
    ds_write_b128 v28, v[76:79] offset:11264
    ds_write_b128 v28, v[92:95] offset:15360
    ds_write_b128 v28, v[80:83] offset:12288
    ds_write_b128 v28, v[84:87] offset:13312
    s_waitcnt lgkmcnt(0)
    s_barrier
    ds_read_b32 v180, v180 offset:1152
    ds_read_b128 v[72:75], v181 offset:10240
    ds_read_b128 v[76:79], v181 offset:11264
    ds_read_b128 v[80:83], v182 offset:12288
    ds_read_b128 v[84:87], v182 offset:13312
    ds_read_b128 v[88:91], v183 offset:14336
    ds_read_b128 v[92:95], v183 offset:15360
    s_waitcnt lgkmcnt(5)
    v_pk_add_f32 v[64:65], v[64:65], v[72:73]
    v_pk_add_f32 v[66:67], v[66:67], v[74:75]
    s_waitcnt lgkmcnt(4)
    v_pk_add_f32 v[68:69], v[68:69], v[76:77]
    v_pk_add_f32 v[70:71], v[70:71], v[78:79]
    s_waitcnt lgkmcnt(1)
    v_pk_add_f32 v[80:81], v[80:81], v[88:89]
    v_pk_add_f32 v[82:83], v[82:83], v[90:91]
    s_waitcnt lgkmcnt(0)
    v_pk_add_f32 v[84:85], v[84:85], v[92:93]
    v_pk_add_f32 v[86:87], v[86:87], v[94:95]
    v_pk_add_f32 v[64:65], v[64:65], v[80:81]
    v_pk_add_f32 v[66:67], v[66:67], v[82:83]
    v_pk_add_f32 v[68:69], v[68:69], v[84:85]
    v_pk_add_f32 v[70:71], v[70:71], v[86:87]
    v_pk_fma_f32 v[20:21], v[64:65], v[180:181], v[20:21] op_sel_hi:[1,0,1]
    v_pk_fma_f32 v[22:23], v[66:67], v[180:181], v[22:23] op_sel_hi:[1,0,1]
    v_pk_fma_f32 v[24:25], v[68:69], v[180:181], v[24:25] op_sel_hi:[1,0,1]
    v_pk_fma_f32 v[26:27], v[70:71], v[180:181], v[26:27] op_sel_hi:[1,0,1]
    v_cvt_pk_bf16_f32 v72, v20, v21
    v_cvt_pk_bf16_f32 v73, v22, v23
    v_cvt_pk_bf16_f32 v74, v24, v25
    v_cvt_pk_bf16_f32 v75, v26, v27
    v_bfe_u32 v76, v0, 4, 4
    v_lshrrev_b32 v77, 8, v0
    v_lshlrev_b32 v76, 10, v76
    v_lshl_add_u32 v76, v77, 4, v76
    s_add_u32 s31, s70, 32768
    buffer_store_dwordx4 v[72:75], v76, s[8:11], s31 offen sc1
    s_branch Lfin
Lfin:
    s_or_b32 s31, s2, s24
    s_cmp_lg_u32 s31, 0
    s_cbranch_scc1 Lskip288
    buffer_store_dword v5, v4, s[4:7], 0 offen sc1
Lskip288:
Lbail:
Lend:
    s_endpgm
Lrare153:
    s_nop 7
Lred154:
    s_sub_u32 s66, s66, 1
    s_cbranch_scc1 Lbail
    s_add_u32 s31, s39, 0
    buffer_load_dwordx4 v[68:71], v0, s[4:7], s31 offen offset:0 sc1
    buffer_load_dwordx4 v[72:75], v0, s[4:7], s31 offen offset:1024 sc1
    buffer_load_dwordx4 v[76:79], v0, s[4:7], s31 offen offset:2048 sc1
    buffer_load_dwordx4 v[80:83], v0, s[4:7], s31 offen offset:3072 sc1
    s_waitcnt vmcnt(3)
    v_cmp_ne_u32 s[54:55], s29, v71
    s_waitcnt vmcnt(2)
    v_cmp_ne_u32 s[56:57], s29, v75
    s_nop 0
    s_or_b64 s[54:55], s[54:55], s[56:57]
    s_waitcnt vmcnt(1)
    v_cmp_ne_u32 s[56:57], s29, v79
    s_nop 0
    s_or_b64 s[54:55], s[54:55], s[56:57]
    s_waitcnt vmcnt(0)
    v_cmp_ne_u32 s[56:57], s29, v83
    s_nop 0
    s_or_b64 s[54:55], s[54:55], s[56:57]
    s_cmp_lg_u64 s[54:55], 0
    s_cbranch_scc1 Lred154
    s_nop 3
    s_branch Lrare153b
Lrare157:
    s_nop 7
Lst2o158:
    s_sub_u32 s66, s66, 1
    s_cbranch_scc1 Lbail
    v_cmp_ne_u32 vcc, s29, v35
    s_nop 1
    s_cbranch_vccz Lskip159
    s_add_u32 s31, s40, 0
    buffer_load_dwordx4 v[32:35], v0, s[4:7], s31 offen sc1
Lskip159:
    v_cmp_ne_u32 vcc, s29, v39
    s_nop 1
    s_cbranch_vccz Lskip160
    s_add_u32 s31, s40, 1024
    buffer_load_dwordx4 v[36:39], v0, s[4:7], s31 offen sc1
Lskip160:
    v_cmp_ne_u32 vcc, s29, v43
    s_nop 1
    s_cbranch_vccz Lskip161
    s_add_u32 s31, s40, 2048
    buffer_load_dwordx4 v[40:43], v0, s[4:7], s31 offen sc1
Lskip161:
    v_cmp_ne_u32 vcc, s29, v47
    s_nop 1
    s_cbranch_vccz Lskip162
    s_add_u32 s31, s40, 3072
    buffer_load_dwordx4 v[44:47], v0, s[4:7], s31 offen sc1
Lskip162:
    v_cmp_ne_u32 vcc, s29, v51
    s_nop 1
    s_cbranch_vccz Lskip163
    s_add_u32 s31, s40, 4096
    buffer_load_dwordx4 v[48:51], v0, s[4:7], s31 offen sc1
Lskip163:
    v_cmp_ne_u32 vcc, s29, v55
    s_nop 1
    s_cbranch_vccz Lskip164
    s_add_u32 s31, s40, 5120
    buffer_load_dwordx4 v[52:55], v0, s[4:7], s31 offen sc1
Lskip164:
    v_cmp_ne_u32 vcc, s29, v59
    s_nop 1
    s_cbranch_vccz Lskip165
    s_add_u32 s31, s40, 6144
    buffer_load_dwordx4 v[56:59], v0, s[4:7], s31 offen sc1
Lskip165:
    v_cmp_ne_u32 vcc, s29, v63
    s_nop 1
    s_cbranch_vccz Lskip166
    s_add_u32 s31, s40, 7168
    buffer_load_dwordx4 v[60:63], v0, s[4:7], s31 offen sc1
Lskip166:
    s_waitcnt vmcnt(0)
    v_cmp_ne_u32 s[54:55], s29, v35
    v_cmp_ne_u32 s[56:57], s29, v39
    s_nop 0
    s_or_b64 s[54:55], s[54:55], s[56:57]
    v_cmp_ne_u32 s[56:57], s29, v43
    s_nop 0
    s_or_b64 s[54:55], s[54:55], s[56:57]
    v_cmp_ne_u32 s[56:57], s29, v47
    s_nop 0
    s_or_b64 s[54:55], s[54:55], s[56:57]
    v_cmp_ne_u32 s[56:57], s29, v51
    s_nop 0
    s_or_b64 s[54:55], s[54:55], s[56:57]
    v_cmp_ne_u32 s[56:57], s29, v55
    s_nop 0
    s_or_b64 s[54:55], s[54:55], s[56:57]
    v_cmp_ne_u32 s[56:57], s29, v59
    s_nop 0
    s_or_b64 s[54:55], s[54:55], s[56:57]
    v_cmp_ne_u32 s[56:57], s29, v63
    s_nop 0
    s_or_b64 s[54:55], s[54:55], s[56:57]
    s_cmp_lg_u64 s[54:55], 0
    s_cbranch_scc1 Lst2o158
    v_lshlrev_b32 v76, 16, v32
    v_and_b32 v77, 0xffff0000, v32
    v_lshlrev_b32 v78, 16, v33
    v_and_b32 v79, 0xffff0000, v33
    v_lshlrev_b32 v80, 16, v34
    v_and_b32 v81, 0xffff0000, v34
    v_xor_b32 v28, s29, v35
    v_dot2c_f32_bf16 v76, s46, v36
    v_dot2c_f32_bf16 v77, s47, v36
    v_dot2c_f32_bf16 v78, s46, v37
    v_dot2c_f32_bf16 v79, s47, v37
    v_dot2c_f32_bf16 v80, s46, v38
    v_dot2c_f32_bf16 v81, s47, v38
    v_bitop3_b32 v28, v5, v39, v28 bitop3:0xbe
    v_dot2c_f32_bf16 v76, s46, v40
    v_dot2c_f32_bf16 v77, s47, v40
    v_dot2c_f32_bf16 v78, s46, v41
    v_dot2c_f32_bf16 v79, s47, v41
    v_dot2c_f32_bf16 v80, s46, v42
    v_dot2c_f32_bf16 v81, s47, v42
    v_bitop3_b32 v28, v5, v43, v28 bitop3:0xbe
    v_dot2c_f32_bf16 v76, s46, v44
    v_dot2c_f32_bf16 v77, s47, v44
    v_dot2c_f32_bf16 v78, s46, v45
    v_dot2c_f32_bf16 v79, s47, v45
    v_dot2c_f32_bf16 v80, s46, v46
    v_dot2c_f32_bf16 v81, s47, v46
    v_bitop3_b32 v28, v5, v47, v28 bitop3:0xbe
    v_dot2c_f32_bf16 v76, s46, v48
    v_dot2c_f32_bf16 v77, s47, v48
    v_dot2c_f32_bf16 v78, s46, v49
    v_dot2c_f32_bf16 v79, s47, v49
    v_dot2c_f32_bf16 v80, s46, v50
    v_dot2c_f32_bf16 v81, s47, v50
    v_bitop3_b32 v28, v5, v51, v28 bitop3:0xbe
    v_dot2c_f32_bf16 v76, s46, v52
    v_dot2c_f32_bf16 v77, s47, v52
    v_dot2c_f32_bf16 v78, s46, v53
    v_dot2c_f32_bf16 v79, s47, v53
    v_dot2c_f32_bf16 v80, s46, v54
    v_dot2c_f32_bf16 v81, s47, v54
    v_bitop3_b32 v28, v5, v55, v28 bitop3:0xbe
    v_dot2c_f32_bf16 v76, s46, v56
    v_dot2c_f32_bf16 v77, s47, v56
    v_dot2c_f32_bf16 v78, s46, v57
    v_dot2c_f32_bf16 v79, s47, v57
    v_dot2c_f32_bf16 v80, s46, v58
    v_dot2c_f32_bf16 v81, s47, v58
    v_bitop3_b32 v28, v5, v59, v28 bitop3:0xbe
    v_dot2c_f32_bf16 v76, s46, v60
    v_dot2c_f32_bf16 v77, s47, v60
    v_dot2c_f32_bf16 v78, s46, v61
    v_dot2c_f32_bf16 v79, s47, v61
    v_dot2c_f32_bf16 v80, s46, v62
    v_dot2c_f32_bf16 v81, s47, v62
    v_bitop3_b32 v28, v5, v63, v28 bitop3:0xbe
    v_cmp_ne_u32 s[54:55], 0, v28
    s_nop 1
    s_nop 3
    s_branch Lrare157b
Lrare167:
    s_nop 7
Lpoll168:
    s_sub_u32 s66, s66, 1
    s_cbranch_scc1 Lbail
    buffer_load_dword v31, v3, s[4:7], s37 offen offset:0 sc1
    s_waitcnt vmcnt(0)
    v_cmp_ne_u32 vcc, s29, v31
    s_cbranch_vccnz Lpoll168
    s_nop 3
    s_branch Lrare167b
Lrare171:
    s_nop 7
    s_mov_b32 s1, m0
Lver172:
    s_sub_u32 s66, s66, 1
    s_cbranch_scc1 Lbail
    s_add_u32 m0, s42, 65536
    s_add_u32 s31, s38, 0
    buffer_load_dwordx4 v0, s[4:7], s31 offen offset:0 sc1 lds
    buffer_load_dwordx4 v0, s[4:7], s31 offen offset:1024 sc1 lds
    buffer_load_dwordx4 v0, s[4:7], s31 offen offset:2048 sc1 lds
    buffer_load_dwordx4 v0, s[4:7], s31 offen offset:3072 sc1 lds
    s_waitcnt vmcnt(0)
    ds_read_b128 v[32:35], v28 offset:0
    ds_read_b128 v[36:39], v28 offset:1024
    ds_read_b128 v[40:43], v28 offset:2048
    ds_read_b128 v[44:47], v28 offset:3072
    s_waitcnt lgkmcnt(2)
    v_bitop3_b32 v32, v32, v34, v36 bitop3:0x80
    s_waitcnt lgkmcnt(1)
    v_bitop3_b32 v38, v38, v40, v42 bitop3:0x80
    s_waitcnt lgkmcnt(0)
    v_bitop3_b32 v32, v32, v38, v44 bitop3:0x80
    v_bitop3_b32 v32, v32, v46, 1 bitop3:0x80
    v_cmp_ne_u32 s[56:57], 1, v32
    s_nop 1
    s_cmp_lg_u64 s[56:57], 0
    s_cbranch_scc1 Lver172
    s_mov_b32 m0, s1
    s_nop 3
    s_branch Lrare171b
Lrare173:
    s_nop 7
    s_mov_b32 s1, m0
Lver174:
    s_sub_u32 s66, s66, 1
    s_cbranch_scc1 Lbail
    s_add_u32 m0, s42, 73728
    s_add_u32 s31, s38, 8192
    buffer_load_dwordx4 v0, s[4:7], s31 offen offset:0 sc1 lds
    buffer_load_dwordx4 v0, s[4:7], s31 offen offset:1024 sc1 lds
    buffer_load_dwordx4 v0, s[4:7], s31 offen offset:2048 sc1 lds
    buffer_load_dwordx4 v0, s[4:7], s31 offen offset:3072 sc1 lds
    s_waitcnt vmcnt(0)
    ds_read_b128 v[48:51], v28 offset:8192
    ds_read_b128 v[52:55], v28 offset:9216
    ds_read_b128 v[56:59], v28 offset:10240
    ds_read_b128 v[60:63], v28 offset:11264
    s_waitcnt lgkmcnt(2)
    v_bitop3_b32 v48, v48, v50, v52 bitop3:0x80
    s_waitcnt lgkmcnt(1)
    v_bitop3_b32 v54, v54, v56, v58 bitop3:0x80
    s_waitcnt lgkmcnt(0)
    v_bitop3_b32 v48, v48, v54, v60 bitop3:0x80
    v_bitop3_b32 v48, v48, v62, 1 bitop3:0x80
    v_cmp_ne_u32 s[56:57], 1, v48
    s_nop 1
    s_cmp_lg_u64 s[56:57], 0
    s_cbranch_scc1 Lver174
    s_mov_b32 m0, s1
    s_nop 3
    s_branch Lrare173b
Lrare175:
    s_nop 7
    s_mov_b32 s1, m0
Lver176:
    s_sub_u32 s66, s66, 1
    s_cbranch_scc1 Lbail
    s_add_u32 m0, s42, 98304
    s_add_u32 s31, s38, 32768
    buffer_load_dwordx4 v0, s[4:7], s31 offen offset:0 sc1 lds
    buffer_load_dwordx4 v0, s[4:7], s31 offen offset:1024 sc1 lds
    buffer_load_dwordx4 v0, s[4:7], s31 offen offset:2048 sc1 lds
    buffer_load_dwordx4 v0, s[4:7], s31 offen offset:3072 sc1 lds
    s_waitcnt vmcnt(0)
    ds_read2st64_b32 v[56:57], v28 offset0:128 offset1:132
    ds_read2st64_b32 v[58:59], v29 offset0:128 offset1:132
    ds_read2st64_b32 v[60:61], v28 offset0:136 offset1:140
    ds_read2st64_b32 v[62:63], v29 offset0:136 offset1:140
    s_waitcnt lgkmcnt(2)
    v_bitop3_b32 v56, v56, v57, v58 bitop3:0x80
    s_waitcnt lgkmcnt(1)
    v_bitop3_b32 v59, v59, v60, v61 bitop3:0x80
    s_waitcnt lgkmcnt(0)
    v_bitop3_b32 v56, v56, v59, v62 bitop3:0x80
    v_bitop3_b32 v56, v56, v63, 1 bitop3:0x80
    v_cmp_ne_u32 s[56:57], 1, v56
    s_nop 1
    s_cmp_lg_u64 s[56:57], 0
    s_cbranch_scc1 Lver176
    s_mov_b32 m0, s1
    s_nop 3
    s_branch Lrare175b
Lrare177:
    s_nop 7
    s_mov_b32 s1, m0
Lver178:
    s_sub_u32 s66, s66, 1
    s_cbranch_scc1 Lbail
    s_add_u32 m0, s42, 106496
    s_add_u32 s31, s38, 40960
    buffer_load_dwordx4 v0, s[4:7], s31 offen offset:0 sc1 lds
    buffer_load_dwordx4 v0, s[4:7], s31 offen offset:1024 sc1 lds
    buffer_load_dwordx4 v0, s[4:7], s31 offen offset:2048 sc1 lds
    buffer_load_dwordx4 v0, s[4:7], s31 offen offset:3072 sc1 lds
    s_waitcnt vmcnt(0)
    ds_read2st64_b32 v[56:57], v28 offset0:160 offset1:164
    ds_read2st64_b32 v[58:59], v29 offset0:160 offset1:164
    ds_read2st64_b32 v[60:61], v28 offset0:168 offset1:172
    ds_read2st64_b32 v[62:63], v29 offset0:168 offset1:172
    s_waitcnt lgkmcnt(2)
    v_bitop3_b32 v56, v56, v57, v58 bitop3:0x80
    s_waitcnt lgkmcnt(1)
    v_bitop3_b32 v59, v59, v60, v61 bitop3:0x80
    s_waitcnt lgkmcnt(0)
    v_bitop3_b32 v56, v56, v59, v62 bitop3:0x80
    v_bitop3_b32 v56, v56, v63, 1 bitop3:0x80
    v_cmp_ne_u32 s[56:57], 1, v56
    s_nop 1
    s_cmp_lg_u64 s[56:57], 0
    s_cbranch_scc1 Lver178
    s_mov_b32 m0, s1
    s_nop 3
    s_branch Lrare177b
Lrare179:
    s_nop 7
    s_mov_b32 s1, m0
Lver180:
    s_sub_u32 s66, s66, 1
    s_cbranch_scc1 Lbail
    s_add_u32 m0, s41, 65536
    s_add_u32 s31, s34, 131072
    buffer_load_dwordx4 v0, s[4:7], s31 offen offset:0 sc1 lds
    buffer_load_dwordx4 v0, s[4:7], s31 offen offset:1024 sc1 lds
    buffer_load_dwordx4 v0, s[4:7], s31 offen offset:2048 sc1 lds
    buffer_load_dwordx4 v0, s[4:7], s31 offen offset:3072 sc1 lds
    s_waitcnt vmcnt(0)
    ds_read_b128 v[128:131], v28 offset:0
    ds_read_b128 v[132:135], v28 offset:1024
    ds_read_b128 v[136:139], v28 offset:2048
    ds_read_b128 v[140:143], v28 offset:3072
    s_waitcnt lgkmcnt(2)
    v_bitop3_b32 v128, v128, v130, v132 bitop3:0x80
    s_waitcnt lgkmcnt(1)
    v_bitop3_b32 v134, v134, v136, v138 bitop3:0x80
    s_waitcnt lgkmcnt(0)
    v_bitop3_b32 v128, v128, v134, v140 bitop3:0x80
    v_bitop3_b32 v128, v128, v142, 1 bitop3:0x80
    v_cmp_ne_u32 s[56:57], 1, v128
    s_nop 1
    s_cmp_lg_u64 s[56:57], 0
    s_cbranch_scc1 Lver180
    s_mov_b32 m0, s1
    s_nop 3
    s_branch Lrare179b
Lrare181:
    s_nop 7
    s_mov_b32 s1, m0
Lver182:
    s_sub_u32 s66, s66, 1
    s_cbranch_scc1 Lbail
    s_add_u32 m0, s41, 81920
    s_add_u32 s31, s34, 147456
    buffer_load_dwordx4 v0, s[4:7], s31 offen offset:0 sc1 lds
    buffer_load_dwordx4 v0, s[4:7], s31 offen offset:1024 sc1 lds
    buffer_load_dwordx4 v0, s[4:7], s31 offen offset:2048 sc1 lds
    buffer_load_dwordx4 v0, s[4:7], s31 offen offset:3072 sc1 lds
    s_waitcnt vmcnt(0)
    ds_read_b128 v[128:131], v28 offset:16384
    ds_read_b128 v[132:135], v28 offset:17408
    ds_read_b128 v[136:139], v28 offset:18432
    ds_read_b128 v[140:143], v28 offset:19456
    s_waitcnt lgkmcnt(2)
    v_bitop3_b32 v128, v128, v130, v132 bitop3:0x80
    s_waitcnt lgkmcnt(1)
    v_bitop3_b32 v134, v134, v136, v138 bitop3:0x80
    s_waitcnt lgkmcnt(0)
    v_bitop3_b32 v128, v128, v134, v140 bitop3:0x80
    v_bitop3_b32 v128, v128, v142, 1 bitop3:0x80
    v_cmp_ne_u32 s[56:57], 1, v128
    s_nop 1
    s_cmp_lg_u64 s[56:57], 0
    s_cbranch_scc1 Lver182
    s_mov_b32 m0, s1
    s_nop 3
    s_branch Lrare181b
Lrare183:
    s_nop 7
Lstc184:
    s_sub_u32 s66, s66, 1
    s_cbranch_scc1 Lbail
    s_add_u32 s31, s19, 720896
    buffer_load_dwordx4 v[156:159], v0, s[4:7], s31 offen sc1
    s_waitcnt vmcnt(0)
    v_bitop3_b32 v31, v156, v157, v158 bitop3:0x80
    v_bitop3_b32 v31, v31, v159, 1 bitop3:0x80
    v_cmp_ne_u32 vcc, 1, v31
    s_cbranch_vccnz Lstc184
    s_nop 3
    s_branch Lrare183b
Lrare185:
    s_nop 7
Lstc186:
    s_sub_u32 s66, s66, 1
    s_cbranch_scc1 Lbail
    s_add_u32 s31, s19, 724992
    buffer_load_dwordx4 v[160:163], v0, s[4:7], s31 offen sc1
    s_waitcnt vmcnt(0)
    v_bitop3_b32 v31, v160, v161, v162 bitop3:0x80
    v_bitop3_b32 v31, v31, v163, 1 bitop3:0x80
    v_cmp_ne_u32 vcc, 1, v31
    s_cbranch_vccnz Lstc186
    s_nop 3
    s_branch Lrare185b
Lrare187:
    s_nop 7
    s_mov_b32 s1, m0
Lver188:
    s_sub_u32 s66, s66, 1
    s_cbranch_scc1 Lbail
    s_add_u32 m0, s41, 98304
    s_add_u32 s31, s34, 163840
    buffer_load_dwordx4 v0, s[4:7], s31 offen offset:0 sc1 lds
    buffer_load_dwordx4 v0, s[4:7], s31 offen offset:1024 sc1 lds
    buffer_load_dwordx4 v0, s[4:7], s31 offen offset:2048 sc1 lds
    buffer_load_dwordx4 v0, s[4:7], s31 offen offset:3072 sc1 lds
    s_waitcnt vmcnt(0)
    ds_read_b128 v[128:131], v28 offset:32768
    ds_read_b128 v[132:135], v28 offset:33792
    ds_read_b128 v[136:139], v28 offset:34816
    ds_read_b128 v[140:143], v28 offset:35840
    s_waitcnt lgkmcnt(2)
    v_bitop3_b32 v128, v128, v130, v132 bitop3:0x80
    s_waitcnt lgkmcnt(1)
    v_bitop3_b32 v134, v134, v136, v138 bitop3:0x80
    s_waitcnt lgkmcnt(0)
    v_bitop3_b32 v128, v128, v134, v140 bitop3:0x80
    v_bitop3_b32 v128, v128, v142, 1 bitop3:0x80
    v_cmp_ne_u32 s[56:57], 1, v128
    s_nop 1
    s_cmp_lg_u64 s[56:57], 0
    s_cbranch_scc1 Lver188
    s_mov_b32 m0, s1
    s_nop 3
    s_branch Lrare187b
Lrare189:
    s_nop 7
    s_mov_b32 s1, m0
Lver190:
    s_sub_u32 s66, s66, 1
    s_cbranch_scc1 Lbail
    s_add_u32 m0, s41, 114688
    s_add_u32 s31, s34, 180224
    buffer_load_dwordx4 v0, s[4:7], s31 offen offset:0 sc1 lds
    buffer_load_dwordx4 v0, s[4:7], s31 offen offset:1024 sc1 lds
    buffer_load_dwordx4 v0, s[4:7], s31 offen offset:2048 sc1 lds
    buffer_load_dwordx4 v0, s[4:7], s31 offen offset:3072 sc1 lds
    s_waitcnt vmcnt(0)
    ds_read_b128 v[128:131], v28 offset:49152
    ds_read_b128 v[132:135], v28 offset:50176
    ds_read_b128 v[136:139], v28 offset:51200
    ds_read_b128 v[140:143], v28 offset:52224
    s_waitcnt lgkmcnt(2)
    v_bitop3_b32 v128, v128, v130, v132 bitop3:0x80
    s_waitcnt lgkmcnt(1)
    v_bitop3_b32 v134, v134, v136, v138 bitop3:0x80
    s_waitcnt lgkmcnt(0)
    v_bitop3_b32 v128, v128, v134, v140 bitop3:0x80
    v_bitop3_b32 v128, v128, v142, 1 bitop3:0x80
    v_cmp_ne_u32 s[56:57], 1, v128
    s_nop 1
    s_cmp_lg_u64 s[56:57], 0
    s_cbranch_scc1 Lver190
    s_mov_b32 m0, s1
    s_nop 3
    s_branch Lrare189b
Lrare192:
    s_nop 7
Lpoll193:
    s_sub_u32 s66, s66, 1
    s_cbranch_scc1 Lbail
    buffer_load_dword v31, v3, s[4:7], s37 offen offset:128 sc1
    s_waitcnt vmcnt(0)
    v_cmp_ne_u32 vcc, s29, v31
    s_cbranch_vccnz Lpoll193
    s_nop 3
    s_branch Lrare192b
Lrare194:
    s_nop 7
Lpoll195:
    s_sub_u32 s66, s66, 1
    s_cbranch_scc1 Lbail
    buffer_load_dword v31, v3, s[4:7], s37 offen offset:256 sc1
    s_waitcnt vmcnt(0)
    v_cmp_ne_u32 vcc, s29, v31
    s_cbranch_vccnz Lpoll195
    s_nop 3
    s_branch Lrare194b
Lrare196:
    s_nop 7
    s_mov_b32 s1, m0
Lver197:
    s_sub_u32 s66, s66, 1
    s_cbranch_scc1 Lbail
    s_add_u32 m0, s41, 65536
    s_add_u32 s31, s32, m0
    s_add_u32 s31, s31, 65536
    buffer_load_dwordx4 v0, s[4:7], s31 offen offset:0 sc1 lds
    buffer_load_dwordx4 v0, s[4:7], s31 offen offset:1024 sc1 lds
    buffer_load_dwordx4 v0, s[4:7], s31 offen offset:2048 sc1 lds
    buffer_load_dwordx4 v0, s[4:7], s31 offen offset:3072 sc1 lds
    s_waitcnt vmcnt(0)
    ds_read_b128 v[176:179], v28 offset:0
    ds_read_b128 v[180:183], v28 offset:1024
    ds_read_b128 v[184:187], v28 offset:2048
    ds_read_b128 v[188:191], v28 offset:3072
    s_waitcnt lgkmcnt(2)
    v_bitop3_b32 v176, v176, v178, v180 bitop3:0xfe
    s_waitcnt lgkmcnt(1)
    v_bitop3_b32 v182, v182, v184, v186 bitop3:0xfe
    s_waitcnt lgkmcnt(0)
    v_bitop3_b32 v176, v176, v182, v188 bitop3:0xfe
    v_bitop3_b32 v176, v176, v190, 1 bitop3:0xa8
    v_cmp_ne_u32 s[56:57], 0, v176
    s_nop 1
    s_cmp_lg_u64 s[56:57], 0
    s_cbranch_scc1 Lver197
    s_mov_b32 m0, s1
    s_nop 3
    s_branch Lrare196b
Lrare198:
    s_nop 7
Lstc199:
    s_sub_u32 s66, s66, 1
    s_cbranch_scc1 Lbail
    s_add_u32 s31, s19, 720896
    buffer_load_dwordx4 v[120:123], v0, s[4:7], s31 offen sc1
    s_waitcnt vmcnt(0)
    v_bitop3_b32 v31, v120, v121, v122 bitop3:0xfe
    v_bitop3_b32 v31, v31, v123, 1 bitop3:0xa8
    v_cmp_ne_u32 vcc, 0, v31
    s_cbranch_vccnz Lstc199
    s_nop 3
    s_branch Lrare198b
Lrare200:
    s_nop 7
    s_mov_b32 s1, m0
Lver201:
    s_sub_u32 s66, s66, 1
    s_cbranch_scc1 Lbail
    s_add_u32 m0, s41, 81920
    s_add_u32 s31, s32, m0
    s_add_u32 s31, s31, 65536
    buffer_load_dwordx4 v0, s[4:7], s31 offen offset:0 sc1 lds
    buffer_load_dwordx4 v0, s[4:7], s31 offen offset:1024 sc1 lds
    buffer_load_dwordx4 v0, s[4:7], s31 offen offset:2048 sc1 lds
    buffer_load_dwordx4 v0, s[4:7], s31 offen offset:3072 sc1 lds
    s_waitcnt vmcnt(0)
    ds_read_b128 v[176:179], v28 offset:16384
    ds_read_b128 v[180:183], v28 offset:17408
    ds_read_b128 v[184:187], v28 offset:18432
    ds_read_b128 v[188:191], v28 offset:19456
    s_waitcnt lgkmcnt(2)
    v_bitop3_b32 v176, v176, v178, v180 bitop3:0xfe
    s_waitcnt lgkmcnt(1)
    v_bitop3_b32 v182, v182, v184, v186 bitop3:0xfe
    s_waitcnt lgkmcnt(0)
    v_bitop3_b32 v176, v176, v182, v188 bitop3:0xfe
    v_bitop3_b32 v176, v176, v190, 1 bitop3:0xa8
    v_cmp_ne_u32 s[56:57], 0, v176
    s_nop 1
    s_cmp_lg_u64 s[56:57], 0
    s_cbranch_scc1 Lver201
    s_mov_b32 m0, s1
    s_nop 3
    s_branch Lrare200b
Lrare202:
    s_nop 7
    s_mov_b32 s1, m0
Lver203:
    s_sub_u32 s66, s66, 1
    s_cbranch_scc1 Lbail
    s_add_u32 m0, s41, 98304
    s_add_u32 s31, s32, m0
    s_add_u32 s31, s31, 65536
    buffer_load_dwordx4 v0, s[4:7], s31 offen offset:0 sc1 lds
    buffer_load_dwordx4 v0, s[4:7], s31 offen offset:1024 sc1 lds
    buffer_load_dwordx4 v0, s[4:7], s31 offen offset:2048 sc1 lds
    buffer_load_dwordx4 v0, s[4:7], s31 offen offset:3072 sc1 lds
    s_waitcnt vmcnt(0)
    ds_read_b128 v[176:179], v28 offset:32768
    ds_read_b128 v[180:183], v28 offset:33792
    ds_read_b128 v[184:187], v28 offset:34816
    ds_read_b128 v[188:191], v28 offset:35840
    s_waitcnt lgkmcnt(2)
    v_bitop3_b32 v176, v176, v178, v180 bitop3:0xfe
    s_waitcnt lgkmcnt(1)
    v_bitop3_b32 v182, v182, v184, v186 bitop3:0xfe
    s_waitcnt lgkmcnt(0)
    v_bitop3_b32 v176, v176, v182, v188 bitop3:0xfe
    v_bitop3_b32 v176, v176, v190, 1 bitop3:0xa8
    v_cmp_ne_u32 s[56:57], 0, v176
    s_nop 1
    s_cmp_lg_u64 s[56:57], 0
    s_cbranch_scc1 Lver203
    s_mov_b32 m0, s1
    s_nop 3
    s_branch Lrare202b
Lrare204:
    s_nop 7
Lstc205:
    s_sub_u32 s66, s66, 1
    s_cbranch_scc1 Lbail
    s_add_u32 s31, s19, 724992
    buffer_load_dwordx4 v[124:127], v0, s[4:7], s31 offen sc1
    s_waitcnt vmcnt(0)
    v_bitop3_b32 v31, v124, v125, v126 bitop3:0xfe
    v_bitop3_b32 v31, v31, v127, 1 bitop3:0xa8
    v_cmp_ne_u32 vcc, 0, v31
    s_cbranch_vccnz Lstc205
    s_nop 3
    s_branch Lrare204b
Lrare206:
    s_nop 7
    s_mov_b32 s1, m0
Lver207:
    s_sub_u32 s66, s66, 1
    s_cbranch_scc1 Lbail
    s_add_u32 m0, s41, 114688
    s_add_u32 s31, s32, m0
    s_add_u32 s31, s31, 65536
    buffer_load_dwordx4 v0, s[4:7], s31 offen offset:0 sc1 lds
    buffer_load_dwordx4 v0, s[4:7], s31 offen offset:1024 sc1 lds
    buffer_load_dwordx4 v0, s[4:7], s31 offen offset:2048 sc1 lds
    buffer_load_dwordx4 v0, s[4:7], s31 offen offset:3072 sc1 lds
    s_waitcnt vmcnt(0)
    ds_read_b128 v[176:179], v28 offset:49152
    ds_read_b128 v[180:183], v28 offset:50176
    ds_read_b128 v[184:187], v28 offset:51200
    ds_read_b128 v[188:191], v28 offset:52224
    s_waitcnt lgkmcnt(2)
    v_bitop3_b32 v176, v176, v178, v180 bitop3:0xfe
    s_waitcnt lgkmcnt(1)
    v_bitop3_b32 v182, v182, v184, v186 bitop3:0xfe
    s_waitcnt lgkmcnt(0)
    v_bitop3_b32 v176, v176, v182, v188 bitop3:0xfe
    v_bitop3_b32 v176, v176, v190, 1 bitop3:0xa8
    v_cmp_ne_u32 s[56:57], 0, v176
    s_nop 1
    s_cmp_lg_u64 s[56:57], 0
    s_cbranch_scc1 Lver207
    s_mov_b32 m0, s1
    s_nop 3
    s_branch Lrare206b
Lrare210:
    s_nop 7
Lred211:
    s_sub_u32 s66, s66, 1
    s_cbranch_scc1 Lbail
    s_add_u32 s31, s39, 1048576
    buffer_load_dwordx4 v[68:71], v0, s[4:7], s31 offen offset:0 sc1
    buffer_load_dwordx4 v[72:75], v0, s[4:7], s31 offen offset:1024 sc1
    buffer_load_dwordx4 v[76:79], v0, s[4:7], s31 offen offset:2048 sc1
    buffer_load_dwordx4 v[80:83], v0, s[4:7], s31 offen offset:3072 sc1
    s_waitcnt vmcnt(3)
    v_cmp_ne_u32 s[54:55], s29, v71
    s_waitcnt vmcnt(2)
    v_cmp_ne_u32 s[56:57], s29, v75
    s_nop 0
    s_or_b64 s[54:55], s[54:55], s[56:57]
    s_waitcnt vmcnt(1)
    v_cmp_ne_u32 s[56:57], s29, v79
    s_nop 0
    s_or_b64 s[54:55], s[54:55], s[56:57]
    s_waitcnt vmcnt(0)
    v_cmp_ne_u32 s[56:57], s29, v83
    s_nop 0
    s_or_b64 s[54:55], s[54:55], s[56:57]
    s_cmp_lg_u64 s[54:55], 0
    s_cbranch_scc1 Lred211
    s_nop 3
    s_branch Lrare210b
Lrare212:
    s_nop 7
Lst2o213:
    s_sub_u32 s66, s66, 1
    s_cbranch_scc1 Lbail
    v_cmp_ne_u32 vcc, s29, v35
    s_nop 1
    s_cbranch_vccz Lskip214
    s_add_u32 s31, s40, 262144
    buffer_load_dwordx4 v[32:35], v0, s[4:7], s31 offen sc1
Lskip214:
    v_cmp_ne_u32 vcc, s29, v39
    s_nop 1
    s_cbranch_vccz Lskip215
    s_add_u32 s31, s40, 263168
    buffer_load_dwordx4 v[36:39], v0, s[4:7], s31 offen sc1
Lskip215:
    v_cmp_ne_u32 vcc, s29, v43
    s_nop 1
    s_cbranch_vccz Lskip216
    s_add_u32 s31, s40, 264192
    buffer_load_dwordx4 v[40:43], v0, s[4:7], s31 offen sc1
Lskip216:
    v_cmp_ne_u32 vcc, s29, v47
    s_nop 1
    s_cbranch_vccz Lskip217
    s_add_u32 s31, s40, 265216
    buffer_load_dwordx4 v[44:47], v0, s[4:7], s31 offen sc1
Lskip217:
    v_cmp_ne_u32 vcc, s29, v51
    s_nop 1
    s_cbranch_vccz Lskip218
    s_add_u32 s31, s40, 266240
    buffer_load_dwordx4 v[48:51], v0, s[4:7], s31 offen sc1
Lskip218:
    v_cmp_ne_u32 vcc, s29, v55
    s_nop 1
    s_cbranch_vccz Lskip219
    s_add_u32 s31, s40, 267264
    buffer_load_dwordx4 v[52:55], v0, s[4:7], s31 offen sc1
Lskip219:
    v_cmp_ne_u32 vcc, s29, v59
    s_nop 1
    s_cbranch_vccz Lskip220
    s_add_u32 s31, s40, 268288
    buffer_load_dwordx4 v[56:59], v0, s[4:7], s31 offen sc1
Lskip220:
    v_cmp_ne_u32 vcc, s29, v63
    s_nop 1
    s_cbranch_vccz Lskip221
    s_add_u32 s31, s40, 269312
    buffer_load_dwordx4 v[60:63], v0, s[4:7], s31 offen sc1
Lskip221:
    s_waitcnt vmcnt(0)
    v_cmp_ne_u32 s[54:55], s29, v35
    v_cmp_ne_u32 s[56:57], s29, v39
    s_nop 0
    s_or_b64 s[54:55], s[54:55], s[56:57]
    v_cmp_ne_u32 s[56:57], s29, v43
    s_nop 0
    s_or_b64 s[54:55], s[54:55], s[56:57]
    v_cmp_ne_u32 s[56:57], s29, v47
    s_nop 0
    s_or_b64 s[54:55], s[54:55], s[56:57]
    v_cmp_ne_u32 s[56:57], s29, v51
    s_nop 0
    s_or_b64 s[54:55], s[54:55], s[56:57]
    v_cmp_ne_u32 s[56:57], s29, v55
    s_nop 0
    s_or_b64 s[54:55], s[54:55], s[56:57]
    v_cmp_ne_u32 s[56:57], s29, v59
    s_nop 0
    s_or_b64 s[54:55], s[54:55], s[56:57]
    v_cmp_ne_u32 s[56:57], s29, v63
    s_nop 0
    s_or_b64 s[54:55], s[54:55], s[56:57]
    s_cmp_lg_u64 s[54:55], 0
    s_cbranch_scc1 Lst2o213
    v_lshlrev_b32 v76, 16, v32
    v_and_b32 v77, 0xffff0000, v32
    v_lshlrev_b32 v78, 16, v33
    v_and_b32 v79, 0xffff0000, v33
    v_lshlrev_b32 v80, 16, v34
    v_and_b32 v81, 0xffff0000, v34
    v_xor_b32 v28, s29, v35
    v_dot2c_f32_bf16 v76, s46, v36
    v_dot2c_f32_bf16 v77, s47, v36
    v_dot2c_f32_bf16 v78, s46, v37
    v_dot2c_f32_bf16 v79, s47, v37
    v_dot2c_f32_bf16 v80, s46, v38
    v_dot2c_f32_bf16 v81, s47, v38
    v_bitop3_b32 v28, v5, v39, v28 bitop3:0xbe
    v_dot2c_f32_bf16 v76, s46, v40
    v_dot2c_f32_bf16 v77, s47, v40
    v_dot2c_f32_bf16 v78, s46, v41
    v_dot2c_f32_bf16 v79, s47, v41
    v_dot2c_f32_bf16 v80, s46, v42
    v_dot2c_f32_bf16 v81, s47, v42
    v_bitop3_b32 v28, v5, v43, v28 bitop3:0xbe
    v_dot2c_f32_bf16 v76, s46, v44
    v_dot2c_f32_bf16 v77, s47, v44
    v_dot2c_f32_bf16 v78, s46, v45
    v_dot2c_f32_bf16 v79, s47, v45
    v_dot2c_f32_bf16 v80, s46, v46
    v_dot2c_f32_bf16 v81, s47, v46
    v_bitop3_b32 v28, v5, v47, v28 bitop3:0xbe
    v_dot2c_f32_bf16 v76, s46, v48
    v_dot2c_f32_bf16 v77, s47, v48
    v_dot2c_f32_bf16 v78, s46, v49
    v_dot2c_f32_bf16 v79, s47, v49
    v_dot2c_f32_bf16 v80, s46, v50
    v_dot2c_f32_bf16 v81, s47, v50
    v_bitop3_b32 v28, v5, v51, v28 bitop3:0xbe
    v_dot2c_f32_bf16 v76, s46, v52
    v_dot2c_f32_bf16 v77, s47, v52
    v_dot2c_f32_bf16 v78, s46, v53
    v_dot2c_f32_bf16 v79, s47, v53
    v_dot2c_f32_bf16 v80, s46, v54
    v_dot2c_f32_bf16 v81, s47, v54
    v_bitop3_b32 v28, v5, v55, v28 bitop3:0xbe
    v_dot2c_f32_bf16 v76, s46, v56
    v_dot2c_f32_bf16 v77, s47, v56
    v_dot2c_f32_bf16 v78, s46, v57
    v_dot2c_f32_bf16 v79, s47, v57
    v_dot2c_f32_bf16 v80, s46, v58
    v_dot2c_f32_bf16 v81, s47, v58
    v_bitop3_b32 v28, v5, v59, v28 bitop3:0xbe
    v_dot2c_f32_bf16 v76, s46, v60
    v_dot2c_f32_bf16 v77, s47, v60
    v_dot2c_f32_bf16 v78, s46, v61
    v_dot2c_f32_bf16 v79, s47, v61
    v_dot2c_f32_bf16 v80, s46, v62
    v_dot2c_f32_bf16 v81, s47, v62
    v_bitop3_b32 v28, v5, v63, v28 bitop3:0xbe
    v_cmp_ne_u32 s[54:55], 0, v28
    s_nop 1
    s_nop 3
    s_branch Lrare212b
Lrare223:
    s_nop 7
    s_mov_b32 s1, m0
Lver224:
    s_sub_u32 s66, s66, 1
    s_cbranch_scc1 Lbail
    s_add_u32 m0, s42, 0
    s_add_u32 s31, s38, 0
    buffer_load_dwordx4 v0, s[4:7], s31 offen offset:0 sc1 lds
    buffer_load_dwordx4 v0, s[4:7], s31 offen offset:1024 sc1 lds
    buffer_load_dwordx4 v0, s[4:7], s31 offen offset:2048 sc1 lds
    buffer_load_dwordx4 v0, s[4:7], s31 offen offset:3072 sc1 lds
    s_waitcnt vmcnt(0)
    ds_read_b128 v[32:35], v28 offset:0
    ds_read_b128 v[36:39], v28 offset:1024
    ds_read_b128 v[40:43], v28 offset:2048
    ds_read_b128 v[44:47], v28 offset:3072
    s_waitcnt lgkmcnt(2)
    v_bitop3_b32 v32, v32, v34, v36 bitop3:0xfe
    s_waitcnt lgkmcnt(1)
    v_bitop3_b32 v38, v38, v40, v42 bitop3:0xfe
    s_waitcnt lgkmcnt(0)
    v_bitop3_b32 v32, v32, v38, v44 bitop3:0xfe
    v_bitop3_b32 v32, v32, v46, 1 bitop3:0xa8
    v_cmp_ne_u32 s[56:57], 0, v32
    s_nop 1
    s_cmp_lg_u64 s[56:57], 0
    s_cbranch_scc1 Lver224
    s_mov_b32 m0, s1
    s_nop 3
    s_branch Lrare223b
Lrare225:
    s_nop 7
    s_mov_b32 s1, m0
Lver226:
    s_sub_u32 s66, s66, 1
    s_cbranch_scc1 Lbail
    s_add_u32 m0, s42, 8192
    s_add_u32 s31, s38, 8192
    buffer_load_dwordx4 v0, s[4:7], s31 offen offset:0 sc1 lds
    buffer_load_dwordx4 v0, s[4:7], s31 offen offset:1024 sc1 lds
    buffer_load_dwordx4 v0, s[4:7], s31 offen offset:2048 sc1 lds
    buffer_load_dwordx4 v0, s[4:7], s31 offen offset:3072 sc1 lds
    s_waitcnt vmcnt(0)
    ds_read_b128 v[48:51], v28 offset:8192
    ds_read_b128 v[52:55], v28 offset:9216
    ds_read_b128 v[56:59], v28 offset:10240
    ds_read_b128 v[60:63], v28 offset:11264
    s_waitcnt lgkmcnt(2)
    v_bitop3_b32 v48, v48, v50, v52 bitop3:0xfe
    s_waitcnt lgkmcnt(1)
    v_bitop3_b32 v54, v54, v56, v58 bitop3:0xfe
    s_waitcnt lgkmcnt(0)
    v_bitop3_b32 v48, v48, v54, v60 bitop3:0xfe
    v_bitop3_b32 v48, v48, v62, 1 bitop3:0xa8
    v_cmp_ne_u32 s[56:57], 0, v48
    s_nop 1
    s_cmp_lg_u64 s[56:57], 0
    s_cbranch_scc1 Lver226
    s_mov_b32 m0, s1
    s_nop 3
    s_branch Lrare225b
Lrare227:
    s_nop 7
    s_mov_b32 s1, m0
Lver228:
    s_sub_u32 s66, s66, 1
    s_cbranch_scc1 Lbail
    s_add_u32 m0, s42, 32768
    s_add_u32 s31, s38, 32768
    buffer_load_dwordx4 v0, s[4:7], s31 offen offset:0 sc1 lds
    buffer_load_dwordx4 v0, s[4:7], s31 offen offset:1024 sc1 lds
    buffer_load_dwordx4 v0, s[4:7], s31 offen offset:2048 sc1 lds
    buffer_load_dwordx4 v0, s[4:7], s31 offen offset:3072 sc1 lds
    s_waitcnt vmcnt(0)
    ds_read2st64_b32 v[56:57], v28 offset0:128 offset1:132
    ds_read2st64_b32 v[58:59], v29 offset0:128 offset1:132
    ds_read2st64_b32 v[60:61], v28 offset0:136 offset1:140
    ds_read2st64_b32 v[62:63], v29 offset0:136 offset1:140
    s_waitcnt lgkmcnt(2)
    v_bitop3_b32 v56, v56, v57, v58 bitop3:0xfe
    s_waitcnt lgkmcnt(1)
    v_bitop3_b32 v59, v59, v60, v61 bitop3:0xfe
    s_waitcnt lgkmcnt(0)
    v_bitop3_b32 v56, v56, v59, v62 bitop3:0xfe
    v_bitop3_b32 v56, v56, v63, 1 bitop3:0xa8
    v_cmp_ne_u32 s[56:57], 0, v56
    s_nop 1
    s_cmp_lg_u64 s[56:57], 0
    s_cbranch_scc1 Lver228
    s_mov_b32 m0, s1
    s_nop 3
    s_branch Lrare227b
Lrare229:
    s_nop 7
    s_mov_b32 s1, m0
Lver230:
    s_sub_u32 s66, s66, 1
    s_cbranch_scc1 Lbail
    s_add_u32 m0, s42, 40960
    s_add_u32 s31, s38, 40960
    buffer_load_dwordx4 v0, s[4:7], s31 offen offset:0 sc1 lds
    buffer_load_dwordx4 v0, s[4:7], s31 offen offset:1024 sc1 lds
    buffer_load_dwordx4 v0, s[4:7], s31 offen offset:2048 sc1 lds
    buffer_load_dwordx4 v0, s[4:7], s31 offen offset:3072 sc1 lds
    s_waitcnt vmcnt(0)
    ds_read2st64_b32 v[56:57], v28 offset0:160 offset1:164
    ds_read2st64_b32 v[58:59], v29 offset0:160 offset1:164
    ds_read2st64_b32 v[60:61], v28 offset0:168 offset1:172
    ds_read2st64_b32 v[62:63], v29 offset0:168 offset1:172
    s_waitcnt lgkmcnt(2)
    v_bitop3_b32 v56, v56, v57, v58 bitop3:0xfe
    s_waitcnt lgkmcnt(1)
    v_bitop3_b32 v59, v59, v60, v61 bitop3:0xfe
    s_waitcnt lgkmcnt(0)
    v_bitop3_b32 v56, v56, v59, v62 bitop3:0xfe
    v_bitop3_b32 v56, v56, v63, 1 bitop3:0xa8
    v_cmp_ne_u32 s[56:57], 0, v56
    s_nop 1
    s_cmp_lg_u64 s[56:57], 0
    s_cbranch_scc1 Lver230
    s_mov_b32 m0, s1
    s_nop 3
    s_branch Lrare229b
Lrare231:
    s_nop 7
    s_mov_b32 s1, m0
Lver232:
    s_sub_u32 s66, s66, 1
    s_cbranch_scc1 Lbail
    s_add_u32 m0, s41, 0
    s_add_u32 s31, s34, 131072
    buffer_load_dwordx4 v0, s[4:7], s31 offen offset:0 sc1 lds
    buffer_load_dwordx4 v0, s[4:7], s31 offen offset:1024 sc1 lds
    buffer_load_dwordx4 v0, s[4:7], s31 offen offset:2048 sc1 lds
    buffer_load_dwordx4 v0, s[4:7], s31 offen offset:3072 sc1 lds
    s_waitcnt vmcnt(0)
    ds_read_b128 v[128:131], v28 offset:0
    ds_read_b128 v[132:135], v28 offset:1024
    ds_read_b128 v[136:139], v28 offset:2048
    ds_read_b128 v[140:143], v28 offset:3072
    s_waitcnt lgkmcnt(2)
    v_bitop3_b32 v128, v128, v130, v132 bitop3:0x80
    s_waitcnt lgkmcnt(1)
    v_bitop3_b32 v134, v134, v136, v138 bitop3:0x80
    s_waitcnt lgkmcnt(0)
    v_bitop3_b32 v128, v128, v134, v140 bitop3:0x80
    v_bitop3_b32 v128, v128, v142, 1 bitop3:0x80
    v_cmp_ne_u32 s[56:57], 1, v128
    s_nop 1
    s_cmp_lg_u64 s[56:57], 0
    s_cbranch_scc1 Lver232
    s_mov_b32 m0, s1
    s_nop 3
    s_branch Lrare231b
Lrare233:
    s_nop 7
    s_mov_b32 s1, m0
Lver234:
    s_sub_u32 s66, s66, 1
    s_cbranch_scc1 Lbail
    s_add_u32 m0, s41, 16384
    s_add_u32 s31, s34, 147456
    buffer_load_dwordx4 v0, s[4:7], s31 offen offset:0 sc1 lds
    buffer_load_dwordx4 v0, s[4:7], s31 offen offset:1024 sc1 lds
    buffer_load_dwordx4 v0, s[4:7], s31 offen offset:2048 sc1 lds
    buffer_load_dwordx4 v0, s[4:7], s31 offen offset:3072 sc1 lds
    s_waitcnt vmcnt(0)
    ds_read_b128 v[128:131], v28 offset:16384
    ds_read_b128 v[132:135], v28 offset:17408
    ds_read_b128 v[136:139], v28 offset:18432
    ds_read_b128 v[140:143], v28 offset:19456
    s_waitcnt lgkmcnt(2)
    v_bitop3_b32 v128, v128, v130, v132 bitop3:0x80
    s_waitcnt lgkmcnt(1)
    v_bitop3_b32 v134, v134, v136, v138 bitop3:0x80
    s_waitcnt lgkmcnt(0)
    v_bitop3_b32 v128, v128, v134, v140 bitop3:0x80
    v_bitop3_b32 v128, v128, v142, 1 bitop3:0x80
    v_cmp_ne_u32 s[56:57], 1, v128
    s_nop 1
    s_cmp_lg_u64 s[56:57], 0
    s_cbranch_scc1 Lver234
    s_mov_b32 m0, s1
    s_nop 3
    s_branch Lrare233b
Lrare235:
    s_nop 7
Lstc236:
    s_sub_u32 s66, s66, 1
    s_cbranch_scc1 Lbail
    s_add_u32 s31, s19, 720896
    buffer_load_dwordx4 v[156:159], v0, s[4:7], s31 offen sc1
    s_waitcnt vmcnt(0)
    v_bitop3_b32 v31, v156, v157, v158 bitop3:0x80
    v_bitop3_b32 v31, v31, v159, 1 bitop3:0x80
    v_cmp_ne_u32 vcc, 1, v31
    s_cbranch_vccnz Lstc236
    s_nop 3
    s_branch Lrare235b
Lrare237:
    s_nop 7
Lstc238:
    s_sub_u32 s66, s66, 1
    s_cbranch_scc1 Lbail
    s_add_u32 s31, s19, 724992
    buffer_load_dwordx4 v[160:163], v0, s[4:7], s31 offen sc1
    s_waitcnt vmcnt(0)
    v_bitop3_b32 v31, v160, v161, v162 bitop3:0x80
    v_bitop3_b32 v31, v31, v163, 1 bitop3:0x80
    v_cmp_ne_u32 vcc, 1, v31
    s_cbranch_vccnz Lstc238
    s_nop 3
    s_branch Lrare237b
Lrare239:
    s_nop 7
    s_mov_b32 s1, m0
Lver240:
    s_sub_u32 s66, s66, 1
    s_cbranch_scc1 Lbail
    s_add_u32 m0, s41, 32768
    s_add_u32 s31, s34, 163840
    buffer_load_dwordx4 v0, s[4:7], s31 offen offset:0 sc1 lds
    buffer_load_dwordx4 v0, s[4:7], s31 offen offset:1024 sc1 lds
    buffer_load_dwordx4 v0, s[4:7], s31 offen offset:2048 sc1 lds
    buffer_load_dwordx4 v0, s[4:7], s31 offen offset:3072 sc1 lds
    s_waitcnt vmcnt(0)
    ds_read_b128 v[128:131], v28 offset:32768
    ds_read_b128 v[132:135], v28 offset:33792
    ds_read_b128 v[136:139], v28 offset:34816
    ds_read_b128 v[140:143], v28 offset:35840
    s_waitcnt lgkmcnt(2)
    v_bitop3_b32 v128, v128, v130, v132 bitop3:0x80
    s_waitcnt lgkmcnt(1)
    v_bitop3_b32 v134, v134, v136, v138 bitop3:0x80
    s_waitcnt lgkmcnt(0)
    v_bitop3_b32 v128, v128, v134, v140 bitop3:0x80
    v_bitop3_b32 v128, v128, v142, 1 bitop3:0x80
    v_cmp_ne_u32 s[56:57], 1, v128
    s_nop 1
    s_cmp_lg_u64 s[56:57], 0
    s_cbranch_scc1 Lver240
    s_mov_b32 m0, s1
    s_nop 3
    s_branch Lrare239b
Lrare241:
    s_nop 7
    s_mov_b32 s1, m0
Lver242:
    s_sub_u32 s66, s66, 1
    s_cbranch_scc1 Lbail
    s_add_u32 m0, s41, 49152
    s_add_u32 s31, s34, 180224
    buffer_load_dwordx4 v0, s[4:7], s31 offen offset:0 sc1 lds
    buffer_load_dwordx4 v0, s[4:7], s31 offen offset:1024 sc1 lds
    buffer_load_dwordx4 v0, s[4:7], s31 offen offset:2048 sc1 lds
    buffer_load_dwordx4 v0, s[4:7], s31 offen offset:3072 sc1 lds
    s_waitcnt vmcnt(0)
    ds_read_b128 v[128:131], v28 offset:49152
    ds_read_b128 v[132:135], v28 offset:50176
    ds_read_b128 v[136:139], v28 offset:51200
    ds_read_b128 v[140:143], v28 offset:52224
    s_waitcnt lgkmcnt(2)
    v_bitop3_b32 v128, v128, v130, v132 bitop3:0x80
    s_waitcnt lgkmcnt(1)
    v_bitop3_b32 v134, v134, v136, v138 bitop3:0x80
    s_waitcnt lgkmcnt(0)
    v_bitop3_b32 v128, v128, v134, v140 bitop3:0x80
    v_bitop3_b32 v128, v128, v142, 1 bitop3:0x80
    v_cmp_ne_u32 s[56:57], 1, v128
    s_nop 1
    s_cmp_lg_u64 s[56:57], 0
    s_cbranch_scc1 Lver242
    s_mov_b32 m0, s1
    s_nop 3
    s_branch Lrare241b
Lrare243:
    s_nop 7
Lhv244:
    s_sub_u32 s66, s66, 1
    s_cbranch_scc1 Lbail
    s_add_u32 s31, s60, 327680
    s_add_u32 s3, s31, s73
    buffer_load_dwordx4 v[96:99], v0, s[4:7], s31 offen offset:0 sc1
    buffer_load_dwordx4 v[100:103], v0, s[4:7], s3 offen offset:0 sc1
    s_waitcnt vmcnt(0)
    v_or3_b32 v31, v96, v98, v100
    v_or_b32 v31, v31, v102
    v_cmp_gt_i32 vcc, 0, v31
    s_cbranch_vccnz Lhv244
    s_nop 3
    s_branch Lrare243b
Lrare245:
    s_nop 7
Lhv246:
    s_sub_u32 s66, s66, 1
    s_cbranch_scc1 Lbail
    s_add_u32 s31, s60, 327680
    s_add_u32 s3, s31, s73
    buffer_load_dwordx4 v[104:107], v0, s[4:7], s31 offen offset:1024 sc1
    buffer_load_dwordx4 v[108:111], v0, s[4:7], s3 offen offset:1024 sc1
    s_waitcnt vmcnt(0)
    v_or3_b32 v31, v104, v106, v108
    v_or_b32 v31, v31, v110
    v_cmp_gt_i32 vcc, 0, v31
    s_cbranch_vccnz Lhv246
    s_nop 3
    s_branch Lrare245b
Lrare247:
    s_nop 7
Lhv248:
    s_sub_u32 s66, s66, 1
    s_cbranch_scc1 Lbail
    s_add_u32 s31, s60, 327680
    s_add_u32 s3, s31, s73
    buffer_load_dwordx4 v[112:115], v0, s[4:7], s31 offen offset:2048 sc1
    buffer_load_dwordx4 v[116:119], v0, s[4:7], s3 offen offset:2048 sc1
    s_waitcnt vmcnt(0)
    v_or3_b32 v31, v112, v114, v116
    v_or_b32 v31, v31, v118
    v_cmp_gt_i32 vcc, 0, v31
    s_cbranch_vccnz Lhv248
    s_nop 3
    s_branch Lrare247b
Lrare249:
    s_nop 7
Lhv250:
    s_sub_u32 s66, s66, 1
    s_cbranch_scc1 Lbail
    s_add_u32 s31, s60, 327680
    s_add_u32 s3, s31, s73
    buffer_load_dwordx4 v[120:123], v0, s[4:7], s31 offen offset:3072 sc1
    buffer_load_dwordx4 v[124:127], v0, s[4:7], s3 offen offset:3072 sc1
    s_waitcnt vmcnt(0)
    v_or3_b32 v31, v120, v122, v124
    v_or_b32 v31, v31, v126
    v_cmp_gt_i32 vcc, 0, v31
    s_cbranch_vccnz Lhv250
    s_nop 3
    s_branch Lrare249b
Lrare251:
    s_nop 7
Lhv252:
    s_sub_u32 s66, s66, 1
    s_cbranch_scc1 Lbail
    s_add_u32 s31, s60, 331776
    s_add_u32 s3, s31, s73
    buffer_load_dwordx4 v[128:131], v0, s[4:7], s31 offen offset:0 sc1
    buffer_load_dwordx4 v[132:135], v0, s[4:7], s3 offen offset:0 sc1
    s_waitcnt vmcnt(0)
    v_or3_b32 v31, v128, v130, v132
    v_or_b32 v31, v31, v134
    v_cmp_gt_i32 vcc, 0, v31
    s_cbranch_vccnz Lhv252
    s_nop 3
    s_branch Lrare251b
Lrare253:
    s_nop 7
Lhv254:
    s_sub_u32 s66, s66, 1
    s_cbranch_scc1 Lbail
    s_add_u32 s31, s15, 327680
    s_add_u32 s3, s31, s73
    buffer_load_dwordx4 v[136:139], v0, s[4:7], s31 offen offset:0 sc1
    buffer_load_dwordx4 v[140:143], v0, s[4:7], s3 offen offset:0 sc1
    s_waitcnt vmcnt(0)
    v_or3_b32 v31, v136, v138, v140
    v_or_b32 v31, v31, v142
    v_cmp_gt_i32 vcc, 0, v31
    s_cbranch_vccnz Lhv254
    s_nop 3
    s_branch Lrare253b
Lrare255:
    s_nop 7
Lhv256:
    s_sub_u32 s66, s66, 1
    s_cbranch_scc1 Lbail
    s_add_u32 s31, s20, 327680
    s_add_u32 s3, s31, s73
    buffer_load_dwordx4 v[96:99], v0, s[4:7], s31 offen offset:0 sc1
    buffer_load_dwordx4 v[100:103], v0, s[4:7], s3 offen offset:0 sc1
    s_waitcnt vmcnt(0)
    v_or3_b32 v31, v96, v98, v100
    v_or_b32 v31, v31, v102
    v_cmp_gt_i32 vcc, 0, v31
    s_cbranch_vccnz Lhv256
    s_nop 3
    s_branch Lrare255b
Lrare257:
    s_nop 7
Lhv258:
    s_sub_u32 s66, s66, 1
    s_cbranch_scc1 Lbail
    s_add_u32 s31, s61, 327680
    s_add_u32 s3, s31, s73
    buffer_load_dwordx4 v[104:107], v0, s[4:7], s31 offen offset:0 sc1
    buffer_load_dwordx4 v[108:111], v0, s[4:7], s3 offen offset:0 sc1
    s_waitcnt vmcnt(0)
    v_or3_b32 v31, v104, v106, v108
    v_or_b32 v31, v31, v110
    v_cmp_gt_i32 vcc, 0, v31
    s_cbranch_vccnz Lhv258
    s_nop 3
    s_branch Lrare257b
Lrare260:
    s_nop 7
Lhv261:
    s_sub_u32 s66, s66, 1
    s_cbranch_scc1 Lbail
    s_add_u32 s31, s61, 327680
    s_add_u32 s3, s31, s73
    buffer_load_dwordx4 v[112:115], v0, s[4:7], s31 offen offset:1024 sc1
    buffer_load_dwordx4 v[116:119], v0, s[4:7], s3 offen offset:1024 sc1
    s_waitcnt vmcnt(0)
    v_or3_b32 v31, v112, v114, v116
    v_or_b32 v31, v31, v118
    v_cmp_gt_i32 vcc, 0, v31
    s_cbranch_vccnz Lhv261
    s_nop 3
    s_branch Lrare260b
Lrare262:
    s_nop 7
Lhv263:
    s_sub_u32 s66, s66, 1
    s_cbranch_scc1 Lbail
    s_add_u32 s31, s61, 327680
    s_add_u32 s3, s31, s73
    buffer_load_dwordx4 v[120:123], v0, s[4:7], s31 offen offset:2048 sc1
    buffer_load_dwordx4 v[124:127], v0, s[4:7], s3 offen offset:2048 sc1
    s_waitcnt vmcnt(0)
    v_or3_b32 v31, v120, v122, v124
    v_or_b32 v31, v31, v126
    v_cmp_gt_i32 vcc, 0, v31
    s_cbranch_vccnz Lhv263
    s_nop 3
    s_branch Lrare262b
Lrare264:
    s_nop 7
Lhv265:
    s_sub_u32 s66, s66, 1
    s_cbranch_scc1 Lbail
    s_add_u32 s31, s61, 327680
    s_add_u32 s3, s31, s73
    buffer_load_dwordx4 v[128:131], v0, s[4:7], s31 offen offset:3072 sc1
    buffer_load_dwordx4 v[132:135], v0, s[4:7], s3 offen offset:3072 sc1
    s_waitcnt vmcnt(0)
    v_or3_b32 v31, v128, v130, v132
    v_or_b32 v31, v31, v134
    v_cmp_gt_i32 vcc, 0, v31
    s_cbranch_vccnz Lhv265
    s_nop 3
    s_branch Lrare264b
Lrare266:
    s_nop 7
Lhv267:
    s_sub_u32 s66, s66, 1
    s_cbranch_scc1 Lbail
    s_add_u32 s31, s60, 415744
    s_add_u32 s3, s31, s73
    buffer_load_dwordx4 v[136:139], v0, s[4:7], s31 offen offset:0 sc1
    buffer_load_dwordx4 v[140:143], v0, s[4:7], s3 offen offset:0 sc1
    s_waitcnt vmcnt(0)
    v_or3_b32 v31, v136, v138, v140
    v_or_b32 v31, v31, v142
    v_cmp_gt_i32 vcc, 0, v31
    s_cbranch_vccnz Lhv267
    s_nop 3
    s_branch Lrare266b
Lrare268:
    s_nop 7
Lhv269:
    s_sub_u32 s66, s66, 1
    s_cbranch_scc1 Lbail
    s_add_u32 s31, s60, 415744
    s_add_u32 s3, s31, s73
    buffer_load_dwordx4 v[96:99], v0, s[4:7], s31 offen offset:1024 sc1
    buffer_load_dwordx4 v[100:103], v0, s[4:7], s3 offen offset:1024 sc1
    s_waitcnt vmcnt(0)
    v_or3_b32 v31, v96, v98, v100
    v_or_b32 v31, v31, v102
    v_cmp_gt_i32 vcc, 0, v31
    s_cbranch_vccnz Lhv269
    s_nop 3
    s_branch Lrare268b
Lrare270:
    s_nop 7
Lhv271:
    s_sub_u32 s66, s66, 1
    s_cbranch_scc1 Lbail
    s_add_u32 s31, s60, 415744
    s_add_u32 s3, s31, s73
    buffer_load_dwordx4 v[104:107], v0, s[4:7], s31 offen offset:2048 sc1
    buffer_load_dwordx4 v[108:111], v0, s[4:7], s3 offen offset:2048 sc1
    s_waitcnt vmcnt(0)
    v_or3_b32 v31, v104, v106, v108
    v_or_b32 v31, v31, v110
    v_cmp_gt_i32 vcc, 0, v31
    s_cbranch_vccnz Lhv271
    s_nop 3
    s_branch Lrare270b
Lrare272:
    s_nop 7
Lhv273:
    s_sub_u32 s66, s66, 1
    s_cbranch_scc1 Lbail
    s_add_u32 s31, s60, 415744
    s_add_u32 s3, s31, s73
    buffer_load_dwordx4 v[112:115], v0, s[4:7], s31 offen offset:3072 sc1
    buffer_load_dwordx4 v[116:119], v0, s[4:7], s3 offen offset:3072 sc1
    s_waitcnt vmcnt(0)
    v_or3_b32 v31, v112, v114, v116
    v_or_b32 v31, v31, v118
    v_cmp_gt_i32 vcc, 0, v31
    s_cbranch_vccnz Lhv273
    s_nop 3
    s_branch Lrare272b
Lrare274:
    s_nop 7
Lhv275:
    s_sub_u32 s66, s66, 1
    s_cbranch_scc1 Lbail
    s_add_u32 s31, s60, 419840
    s_add_u32 s3, s31, s73
    buffer_load_dwordx4 v[120:123], v0, s[4:7], s31 offen offset:0 sc1
    buffer_load_dwordx4 v[124:127], v0, s[4:7], s3 offen offset:0 sc1
    s_waitcnt vmcnt(0)
    v_or3_b32 v31, v120, v122, v124
    v_or_b32 v31, v31, v126
    v_cmp_gt_i32 vcc, 0, v31
    s_cbranch_vccnz Lhv275
    s_nop 3
    s_branch Lrare274b
Lrare276:
    s_nop 7
Lhv277:
    s_sub_u32 s66, s66, 1
    s_cbranch_scc1 Lbail
    s_add_u32 s31, s15, 415744
    s_add_u32 s3, s31, s73
    buffer_load_dwordx4 v[128:131], v0, s[4:7], s31 offen offset:0 sc1
    buffer_load_dwordx4 v[132:135], v0, s[4:7], s3 offen offset:0 sc1
    s_waitcnt vmcnt(0)
    v_or3_b32 v31, v128, v130, v132
    v_or_b32 v31, v31, v134
    v_cmp_gt_i32 vcc, 0, v31
    s_cbranch_vccnz Lhv277
    s_nop 3
    s_branch Lrare276b
Lrare278:
    s_nop 7
Lhv279:
    s_sub_u32 s66, s66, 1
    s_cbranch_scc1 Lbail
    s_add_u32 s31, s20, 415744
    s_add_u32 s3, s31, s73
    buffer_load_dwordx4 v[136:139], v0, s[4:7], s31 offen offset:0 sc1
    buffer_load_dwordx4 v[140:143], v0, s[4:7], s3 offen offset:0 sc1
    s_waitcnt vmcnt(0)
    v_or3_b32 v31, v136, v138, v140
    v_or_b32 v31, v31, v142
    v_cmp_gt_i32 vcc, 0, v31
    s_cbranch_vccnz Lhv279
    s_nop 3
    s_branch Lrare278b
Lrare280:
    s_nop 7
Lhv281:
    s_sub_u32 s66, s66, 1
    s_cbranch_scc1 Lbail
    s_add_u32 s31, s61, 415744
    s_add_u32 s3, s31, s73
    buffer_load_dwordx4 v[96:99], v0, s[4:7], s31 offen offset:0 sc1
    buffer_load_dwordx4 v[100:103], v0, s[4:7], s3 offen offset:0 sc1
    s_waitcnt vmcnt(0)
    v_or3_b32 v31, v96, v98, v100
    v_or_b32 v31, v31, v102
    v_cmp_gt_i32 vcc, 0, v31
    s_cbranch_vccnz Lhv281
    s_nop 3
    s_branch Lrare280b
Lrare282:
    s_nop 7
Lhv283:
    s_sub_u32 s66, s66, 1
    s_cbranch_scc1 Lbail
    s_add_u32 s31, s61, 415744
    s_add_u32 s3, s31, s73
    buffer_load_dwordx4 v[104:107], v0, s[4:7], s31 offen offset:1024 sc1
    buffer_load_dwordx4 v[108:111], v0, s[4:7], s3 offen offset:1024 sc1
    s_waitcnt vmcnt(0)
    v_or3_b32 v31, v104, v106, v108
    v_or_b32 v31, v31, v110
    v_cmp_gt_i32 vcc, 0, v31
    s_cbranch_vccnz Lhv283
    s_nop 3
    s_branch Lrare282b
Lrare284:
    s_nop 7
Lhv285:
    s_sub_u32 s66, s66, 1
    s_cbranch_scc1 Lbail
    s_add_u32 s31, s61, 415744
    s_add_u32 s3, s31, s73
    buffer_load_dwordx4 v[112:115], v0, s[4:7], s31 offen offset:2048 sc1
    buffer_load_dwordx4 v[116:119], v0, s[4:7], s3 offen offset:2048 sc1
    s_waitcnt vmcnt(0)
    v_or3_b32 v31, v112, v114, v116
    v_or_b32 v31, v31, v118
    v_cmp_gt_i32 vcc, 0, v31
    s_cbranch_vccnz Lhv285
    s_nop 3
    s_branch Lrare284b
Lrare286:
    s_nop 7
Lhv287:
    s_sub_u32 s66, s66, 1
    s_cbranch_scc1 Lbail
    s_add_u32 s31, s61, 415744
    s_add_u32 s3, s31, s73
    buffer_load_dwordx4 v[120:123], v0, s[4:7], s31 offen offset:3072 sc1
    buffer_load_dwordx4 v[124:127], v0, s[4:7], s3 offen offset:3072 sc1
    s_waitcnt vmcnt(0)
    v_or3_b32 v31, v120, v122, v124
    v_or_b32 v31, v31, v126
    v_cmp_gt_i32 vcc, 0, v31
    s_cbranch_vccnz Lhv287
    s_nop 3
    s_branch Lrare286b
.section .rodata,"a"
.p2align 6
.amdhsa_kernel interleave_layers__linear_attn_block__dense_activation_relu__prompt_kernel
  .amdhsa_next_free_vgpr 512
  .amdhsa_next_free_sgpr 102
  .amdhsa_accum_offset 256
  .amdhsa_group_segment_fixed_size 0
  .amdhsa_kernarg_size 72
  .amdhsa_user_sgpr_count 2
  .amdhsa_user_sgpr_kernarg_segment_ptr 1
  .amdhsa_system_sgpr_workgroup_id_x 1
.end_amdhsa_kernel
```
